```python
import torch

def _softmax(x, axis=-1):
    return torch.softmax(x, dim=axis)
def _gelu(x):
    return torch.nn.functional.gelu(x, approximate="tanh")
def _silu(x):
    return torch.nn.functional.silu(x)
def _sigmoid(x):
    return torch.sigmoid(x)
def _layernorm(x, axis=-1, eps=1e-5):
    m = x.mean(dim=axis, keepdim=True)
    v = x.var(dim=axis, keepdim=True, unbiased=False)
    return (x - m) / torch.sqrt(v + eps)
def _scatter_add(tgt, idx, src, axis=0):
    return tgt.clone().index_add_(axis, idx, src)
def _segment_sum(src, seg, n):
    out = torch.zeros((n,) + src.shape[1:], dtype=src.dtype)
    return out.index_add_(0, seg, src)
def _pad(x, pw):
    flat = tuple(v for pair in reversed(pw) for v in pair)
    return torch.nn.functional.pad(x, flat)

kernel_name = 'interleave_layers__linear_kernel_hedgehog__mixer_channel_mlp__prompt'

def setup_inputs():

    _w = (lambda a: (lambda t: t.to(torch.bfloat16) if t.is_floating_point() else t)(torch.as_tensor(a)))
    def _A_setup():
        B, S, D, H = 1, 2048, 512, 32
        Dh = D // H
        return {
            "x": _w((lambda *s: torch.randn(*s, dtype=torch.bfloat16) * 0.05)(B, S, D)),
            "wqkv": _w((lambda *s: torch.randn(*s, dtype=torch.bfloat16) * 0.4)(D, 3 * D)),
            "w_phi": _w((lambda *s: torch.randn(*s, dtype=torch.bfloat16) * 0.4)(H, Dh, Dh) * (Dh ** -0.5)),
            "wo": _w((lambda *s: torch.randn(*s, dtype=torch.bfloat16) * 0.05)(D, D)),
        }
    _A_in = _A_setup()

    def _B_setup():
        B, S, D, F = 1, 2048, 512, 1792
        return {
            "x": _w((lambda *s: torch.randn(*s, dtype=torch.bfloat16) * 0.05)(B, S, D)),
            "w1": _w((lambda *s: torch.randn(*s, dtype=torch.bfloat16) * 3.2)(D, F) * (D ** -0.5)),
            "b1": _w((lambda *s: torch.randn(*s, dtype=torch.bfloat16) * 0.8)(F)),
            "w2": _w((lambda *s: torch.randn(*s, dtype=torch.bfloat16) * 0.8)(F, D) * (F ** -0.5)),
            "b2": _w((lambda *s: torch.randn(*s, dtype=torch.bfloat16) * 0.8)(D)),
        }
    _B_in = _B_setup()

    return {
        "A_x": _A_in["x"],
        "A_wqkv": _A_in["wqkv"],
        "A_w_phi": _A_in["w_phi"],
        "A_wo": _A_in["wo"],
        "B_x": _B_in["x"],
        "B_w1": _B_in["w1"],
        "B_b1": _B_in["b1"],
        "B_w2": _B_in["w2"],
        "B_b2": _B_in["b2"],
    }

def reference(A_x, A_wqkv, A_w_phi, A_wo, B_x, B_w1, B_b1, B_w2, B_b2):
    def _A_ref(x, wqkv, w_phi, wo):
        B, S, D = x.shape
        H = 32; Dh = D // H
        qkv = (lambda x, *d: x.permute(*d))((x @ wqkv).reshape(B, S, 3, H, Dh), 2, 0, 3, 1, 4)
        q, k, v = qkv[0], qkv[1], qkv[2]
        pq = torch.einsum("bhsd,hdf->bhsf", q, w_phi)
        pk = torch.einsum("bhsd,hdf->bhsf", k, w_phi)
        phi_q = torch.concatenate([_softmax(pq, axis=-1), _softmax(-pq, axis=-1)], axis=-1)
        phi_k = torch.concatenate([_softmax(pk, axis=-1), _softmax(-pk, axis=-1)], axis=-1)
        kv = torch.einsum("bhsf,bhsd->bhfd", phi_k, v)
        z  = torch.einsum("bhsf->bhf", phi_k)
        num = torch.einsum("bhqf,bhfd->bhqd", phi_q, kv)
        den = torch.einsum("bhqf,bhf->bhq", phi_q, z)[..., None] + 1e-6
        o = num / den
        return (lambda x, *d: x.permute(*d))(o, 0, 2, 1, 3).reshape(B, S, D) @ wo

    def _B_ref(x, w1, b1, w2, b2):
        y = _layernorm(x, axis=-1)
        h = _gelu(torch.einsum("bsd,df->bsf", y, w1) + b1)
        return torch.einsum("bsf,fd->bsd", h, w2) + b2

    x = A_x
    x = x + _A_ref(_layernorm(x, axis=-1), A_wqkv, A_w_phi, A_wo)
    x = x + _B_ref(_layernorm(x, axis=-1), B_w1, B_b1, B_w2, B_b2)
    x = x + _A_ref(_layernorm(x, axis=-1), A_wqkv, A_w_phi, A_wo)
    x = x + _B_ref(_layernorm(x, axis=-1), B_w1, B_b1, B_w2, B_b2)
    return x
```

```asm
; @launch kernel=mega_kernel grid=(256,1,1) block=(768,1,1) lds=163840
.amdgcn_target "amdgcn-amd-amdhsa--gfx950"
.text
.p2align 8
.globl mega_kernel
.type mega_kernel,@function
mega_kernel:
    s_cmp_lt_u32 s2, 256
    s_cbranch_scc1 mega_kernel_go
    s_endpgm
mega_kernel_go:
    s_load_dwordx16 s[16:31], s[0:1], 0
    s_load_dwordx8 s[32:39], s[0:1], 64
    v_and_b32 v1, 63, v0
    v_lshrrev_b32 v0, 6, v0
    s_nop 0
    v_readfirstlane_b32 s4, v0
    v_lshrrev_b32 v2, 4, v1
    v_and_b32 v3, 15, v1
    s_and_b32 s5, s2, 7
    s_lshl_b32 s5, s5, 1
    s_bfe_u32 s6, s2, 0x10003
    s_add_u32 s5, s5, s6
    s_lshr_b32 s6, s2, 4
    s_and_b32 s7, s4, 3
    s_lshr_b32 s8, s4, 2
    s_waitcnt lgkmcnt(0)
    s_mov_b32 s12, s36
    s_mov_b32 s13, s37
    s_mov_b32 s14, 0x100
    s_mov_b32 s15, 0x00020000
    s_cmp_lt_u32 s4, 8
    s_cbranch_scc1 mega_kernel_compute
    v_mov_b32 v4, 163776
    v_mov_b32 v5, 0
    ds_write_b32 v4, v5
    ds_write_b32 v4, v5 offset:32
    s_waitcnt lgkmcnt(0)
    s_add_u32 s72, s38, 0x1580000
    s_addc_u32 s73, s39, 0
    s_mov_b32 s74, 0x3000
    s_mov_b32 s75, 0x00020000
    v_lshrrev_b32 v5, 3, v1
    v_and_b32 v6, 7, v1
    v_xor_b32 v6, v6, v5
    v_lshlrev_b32 v4, 10, v5
    v_lshl_add_u32 v4, v6, 4, v4
    s_lshl_b32 s60, s5, 2
    s_add_u32 s60, s60, s7
    s_lshl_b32 s60, s60, 15
    s_lshl_b32 s63, s7, 10
    s_lshl_b32 s64, s7, 12
    v_lshrrev_b32 v6, 2, v1
    v_mul_u32_u24 v5, 3072, v6
    v_lshrrev_b32 v6, 5, v1
    v_lshrrev_b32 v7, 1, v1
    v_xor_b32 v6, v6, v7
    v_and_b32 v6, 1, v6
    v_lshl_add_u32 v5, v6, 5, v5
    v_and_b32 v6, 1, v1
    v_lshl_add_u32 v5, v6, 4, v5
    s_mul_i32 s61, s7, 49152
    s_lshl_b32 s62, s6, 6
    s_add_u32 s61, s61, s62
    s_mov_b32 s40, s16
    s_mov_b32 s41, s17
    s_mov_b32 s42, 0x200000
    s_mov_b32 s43, 0x00020000
    s_mov_b32 s44, s18
    s_mov_b32 s45, s19
    s_mov_b32 s46, 0x180000
    s_mov_b32 s47, 0x00020000
    s_add_u32 s62, s61, 0
    s_add_u32 m0, s63, 0
    s_nop 0
    buffer_load_dwordx4 v5, s[44:47], s62 offen lds
    s_add_u32 s62, s61, 1024
    s_add_u32 m0, s63, 4096
    s_nop 0
    buffer_load_dwordx4 v5, s[44:47], s62 offen lds
    s_add_u32 s62, s61, 2048
    s_add_u32 m0, s63, 8192
    s_nop 0
    buffer_load_dwordx4 v5, s[44:47], s62 offen lds
    s_add_u32 s62, s60, 0
    s_add_u32 m0, s64, 61440
    s_nop 0
    buffer_load_dwordx4 v4, s[40:43], s62 offen lds
    s_add_u32 s62, s60, 8192
    s_add_u32 m0, s64, 62464
    s_nop 0
    buffer_load_dwordx4 v4, s[40:43], s62 offen lds
    s_add_u32 s62, s60, 16384
    s_add_u32 m0, s64, 63488
    s_nop 0
    buffer_load_dwordx4 v4, s[40:43], s62 offen lds
    s_add_u32 s62, s60, 24576
    s_add_u32 m0, s64, 64512
    s_nop 0
    buffer_load_dwordx4 v4, s[40:43], s62 offen lds
    s_add_u32 s62, s61, 196608
    s_add_u32 m0, s63, 12288
    s_nop 0
    buffer_load_dwordx4 v5, s[44:47], s62 offen lds
    s_add_u32 s62, s61, 197632
    s_add_u32 m0, s63, 16384
    s_nop 0
    buffer_load_dwordx4 v5, s[44:47], s62 offen lds
    s_add_u32 s62, s61, 198656
    s_add_u32 m0, s63, 20480
    s_nop 0
    buffer_load_dwordx4 v5, s[44:47], s62 offen lds
    s_add_u32 s62, s60, 128
    s_add_u32 m0, s64, 77824
    s_nop 0
    buffer_load_dwordx4 v4, s[40:43], s62 offen lds
    s_add_u32 s62, s60, 8320
    s_add_u32 m0, s64, 78848
    s_nop 0
    buffer_load_dwordx4 v4, s[40:43], s62 offen lds
    s_add_u32 s62, s60, 16512
    s_add_u32 m0, s64, 79872
    s_nop 0
    buffer_load_dwordx4 v4, s[40:43], s62 offen lds
    s_add_u32 s62, s60, 24704
    s_add_u32 m0, s64, 80896
    s_nop 0
    buffer_load_dwordx4 v4, s[40:43], s62 offen lds
    s_waitcnt vmcnt(7)
    s_barrier
    s_add_u32 s62, s61, 393216
    s_add_u32 m0, s63, 24576
    s_nop 0
    buffer_load_dwordx4 v5, s[44:47], s62 offen lds
    s_add_u32 s62, s61, 394240
    s_add_u32 m0, s63, 28672
    s_nop 0
    buffer_load_dwordx4 v5, s[44:47], s62 offen lds
    s_add_u32 s62, s61, 395264
    s_add_u32 m0, s63, 32768
    s_nop 0
    buffer_load_dwordx4 v5, s[44:47], s62 offen lds
    s_add_u32 s62, s60, 256
    s_add_u32 m0, s64, 94208
    s_nop 0
    buffer_load_dwordx4 v4, s[40:43], s62 offen lds
    s_add_u32 s62, s60, 8448
    s_add_u32 m0, s64, 95232
    s_nop 0
    buffer_load_dwordx4 v4, s[40:43], s62 offen lds
    s_add_u32 s62, s60, 16640
    s_add_u32 m0, s64, 96256
    s_nop 0
    buffer_load_dwordx4 v4, s[40:43], s62 offen lds
    s_add_u32 s62, s60, 24832
    s_add_u32 m0, s64, 97280
    s_nop 0
    buffer_load_dwordx4 v4, s[40:43], s62 offen lds
    s_waitcnt vmcnt(7)
    s_barrier
    s_add_u32 s62, s61, 589824
    s_add_u32 m0, s63, 36864
    s_nop 0
    buffer_load_dwordx4 v5, s[44:47], s62 offen lds
    s_add_u32 s62, s61, 590848
    s_add_u32 m0, s63, 40960
    s_nop 0
    buffer_load_dwordx4 v5, s[44:47], s62 offen lds
    s_add_u32 s62, s61, 591872
    s_add_u32 m0, s63, 45056
    s_nop 0
    buffer_load_dwordx4 v5, s[44:47], s62 offen lds
    s_add_u32 s62, s60, 384
    s_add_u32 m0, s64, 110592
    s_nop 0
    buffer_load_dwordx4 v4, s[40:43], s62 offen lds
    s_add_u32 s62, s60, 8576
    s_add_u32 m0, s64, 111616
    s_nop 0
    buffer_load_dwordx4 v4, s[40:43], s62 offen lds
    s_add_u32 s62, s60, 16768
    s_add_u32 m0, s64, 112640
    s_nop 0
    buffer_load_dwordx4 v4, s[40:43], s62 offen lds
    s_add_u32 s62, s60, 24960
    s_add_u32 m0, s64, 113664
    s_nop 0
    buffer_load_dwordx4 v4, s[40:43], s62 offen lds
    s_waitcnt vmcnt(7)
    s_barrier
    s_add_u32 s62, s61, 786432
    s_add_u32 m0, s63, 49152
    s_nop 0
    buffer_load_dwordx4 v5, s[44:47], s62 offen lds
    s_add_u32 s62, s61, 787456
    s_add_u32 m0, s63, 53248
    s_nop 0
    buffer_load_dwordx4 v5, s[44:47], s62 offen lds
    s_add_u32 s62, s61, 788480
    s_add_u32 m0, s63, 57344
    s_nop 0
    buffer_load_dwordx4 v5, s[44:47], s62 offen lds
    s_add_u32 s62, s60, 512
    s_add_u32 m0, s64, 126976
    s_nop 0
    buffer_load_dwordx4 v4, s[40:43], s62 offen lds
    s_add_u32 s62, s60, 8704
    s_add_u32 m0, s64, 128000
    s_nop 0
    buffer_load_dwordx4 v4, s[40:43], s62 offen lds
    s_add_u32 s62, s60, 16896
    s_add_u32 m0, s64, 129024
    s_nop 0
    buffer_load_dwordx4 v4, s[40:43], s62 offen lds
    s_add_u32 s62, s60, 25088
    s_add_u32 m0, s64, 130048
    s_nop 0
    buffer_load_dwordx4 v4, s[40:43], s62 offen lds
    s_waitcnt vmcnt(7)
    s_barrier
    s_add_u32 s62, s61, 983040
    s_add_u32 m0, s63, 0
    s_nop 0
    buffer_load_dwordx4 v5, s[44:47], s62 offen lds
    s_add_u32 s62, s61, 984064
    s_add_u32 m0, s63, 4096
    s_nop 0
    buffer_load_dwordx4 v5, s[44:47], s62 offen lds
    s_add_u32 s62, s61, 985088
    s_add_u32 m0, s63, 8192
    s_nop 0
    buffer_load_dwordx4 v5, s[44:47], s62 offen lds
    s_add_u32 s62, s60, 640
    s_add_u32 m0, s64, 61440
    s_nop 0
    buffer_load_dwordx4 v4, s[40:43], s62 offen lds
    s_add_u32 s62, s60, 8832
    s_add_u32 m0, s64, 62464
    s_nop 0
    buffer_load_dwordx4 v4, s[40:43], s62 offen lds
    s_add_u32 s62, s60, 17024
    s_add_u32 m0, s64, 63488
    s_nop 0
    buffer_load_dwordx4 v4, s[40:43], s62 offen lds
    s_add_u32 s62, s60, 25216
    s_add_u32 m0, s64, 64512
    s_nop 0
    buffer_load_dwordx4 v4, s[40:43], s62 offen lds
    s_waitcnt vmcnt(7)
    s_barrier
    s_add_u32 s62, s61, 1179648
    s_add_u32 m0, s63, 12288
    s_nop 0
    buffer_load_dwordx4 v5, s[44:47], s62 offen lds
    s_add_u32 s62, s61, 1180672
    s_add_u32 m0, s63, 16384
    s_nop 0
    buffer_load_dwordx4 v5, s[44:47], s62 offen lds
    s_add_u32 s62, s61, 1181696
    s_add_u32 m0, s63, 20480
    s_nop 0
    buffer_load_dwordx4 v5, s[44:47], s62 offen lds
    s_add_u32 s62, s60, 768
    s_add_u32 m0, s64, 77824
    s_nop 0
    buffer_load_dwordx4 v4, s[40:43], s62 offen lds
    s_add_u32 s62, s60, 8960
    s_add_u32 m0, s64, 78848
    s_nop 0
    buffer_load_dwordx4 v4, s[40:43], s62 offen lds
    s_add_u32 s62, s60, 17152
    s_add_u32 m0, s64, 79872
    s_nop 0
    buffer_load_dwordx4 v4, s[40:43], s62 offen lds
    s_add_u32 s62, s60, 25344
    s_add_u32 m0, s64, 80896
    s_nop 0
    buffer_load_dwordx4 v4, s[40:43], s62 offen lds
    s_waitcnt vmcnt(7)
    s_barrier
    s_add_u32 s62, s61, 1376256
    s_add_u32 m0, s63, 24576
    s_nop 0
    buffer_load_dwordx4 v5, s[44:47], s62 offen lds
    s_add_u32 s62, s61, 1377280
    s_add_u32 m0, s63, 28672
    s_nop 0
    buffer_load_dwordx4 v5, s[44:47], s62 offen lds
    s_add_u32 s62, s61, 1378304
    s_add_u32 m0, s63, 32768
    s_nop 0
    buffer_load_dwordx4 v5, s[44:47], s62 offen lds
    s_add_u32 s62, s60, 896
    s_add_u32 m0, s64, 94208
    s_nop 0
    buffer_load_dwordx4 v4, s[40:43], s62 offen lds
    s_add_u32 s62, s60, 9088
    s_add_u32 m0, s64, 95232
    s_nop 0
    buffer_load_dwordx4 v4, s[40:43], s62 offen lds
    s_add_u32 s62, s60, 17280
    s_add_u32 m0, s64, 96256
    s_nop 0
    buffer_load_dwordx4 v4, s[40:43], s62 offen lds
    s_add_u32 s62, s60, 25472
    s_add_u32 m0, s64, 97280
    s_nop 0
    buffer_load_dwordx4 v4, s[40:43], s62 offen lds
    s_waitcnt vmcnt(7)
    s_barrier
    s_waitcnt vmcnt(0)
    s_barrier
    s_barrier
    s_barrier
    s_waitcnt vmcnt(0) lgkmcnt(0)
    s_cmp_lg_u32 s4, 8
    s_cbranch_scc1 Lgx_3
    v_lshlrev_b32 v44, 2, v1
    s_mov_b32 s70, 0
    s_mov_b32 exec_lo, -1
    s_mov_b32 exec_hi, 0
Lgp_1:
    buffer_load_dword v40, v44, s[12:15], 0 offen sc1
    s_waitcnt vmcnt(0)
    v_and_b32 v41, 0xff, v40
    v_cmp_ne_u32 vcc, 16, v41
    s_add_u32 s70, s70, 1
    s_cmp_ge_u32 s70, 0x40000
    s_cbranch_scc1 Lgw_2
    s_and_b32 s71, vcc_lo, 0xffff
    s_cmp_eq_u32 s71, 0
    s_cbranch_scc1 Lgw_2
    s_sleep 8
    s_branch Lgp_1
Lgw_2:
    s_nop 3
    v_readlane_b32 s71, v40, s5
    s_mov_b64 exec, -1
    s_nop 3
    s_bfe_u32 s70, s71, 0x80008
    s_lshr_b32 s71, s71, 16
    s_mul_i32 s70, s70, s70
    s_lshl_b32 s71, s71, 4
    s_cmp_eq_u32 s70, s71
    s_cselect_b32 s71, 1, 2
    v_mov_b32 v40, s71
    v_mov_b32 v41, 163792
    ds_write_b32 v41, v40
    s_waitcnt lgkmcnt(0)
Lgx_3:
    s_nop 7
    s_nop 7
    s_waitcnt vmcnt(0) lgkmcnt(0)
    s_barrier
    s_cmp_lg_u32 s4, 8
    s_cbranch_scc1 Lg8_4
    s_lshl_b32 s70, s5, 6
    s_add_u32 s70, s70, s6
    s_lshl_b32 s70, s70, 2
    v_mov_b32 v40, 2
    v_mov_b32 v41, 0
    s_mov_b64 exec, 1
    buffer_store_dword v40, v41, s[72:75], s70 offen sc1
    s_mov_b64 exec, -1
    s_nop 1
Lg8_4:
    s_nop 7
    s_nop 7
    s_lshr_b32 s60, s6, 3
    s_lshl_b32 s61, s5, 1
    s_add_u32 s60, s60, s61
    s_and_b32 s61, s6, 7
    v_lshrrev_b32 v7, 3, v1
    v_lshlrev_b32 v4, 10, v7
    v_lshrrev_b32 v14, 1, v1
    v_xor_b32 v7, v2, v14
    v_and_b32 v7, 3, v7
    v_lshl_add_u32 v4, v7, 5, v4
    v_and_b32 v7, 1, v1
    v_lshl_add_u32 v4, v7, 4, v4
    v_lshrrev_b32 v7, 3, v1
    v_and_b32 v14, 7, v1
    v_xor_b32 v14, v14, v7
    v_lshlrev_b32 v6, 7, v7
    v_lshl_add_u32 v6, v14, 4, v6
    s_mov_b32 s40, s22
    s_mov_b32 s41, s23
    s_mov_b32 s42, 0x80000
    s_mov_b32 s43, 0x00020000
    s_mov_b32 s44, s38
    s_mov_b32 s45, s39
    s_mov_b32 s46, 0x420000
    s_mov_b32 s47, 0x00020000
    s_add_u32 s48, s38, 0x1400000
    s_addc_u32 s49, s39, 0
    s_mov_b32 s50, 0x11000
    s_mov_b32 s51, 0x00020000
    s_mul_i32 s63, s60, 135168
    s_lshl_b32 s62, s7, 13
    s_add_u32 s63, s63, s62
    s_mul_i32 s64, s7, 17408
    s_lshl_b32 s65, s7, 17
    s_lshl_b32 s62, s61, 7
    s_add_u32 s65, s65, s62
    s_lshl_b32 s68, s7, 11
    s_lshl_b32 s69, s7, 11
    v_lshrrev_b32 v7, 3, v1
    v_mul_u32_u24 v15, 2176, v7
    v_and_b32 v7, 7, v1
    v_lshl_add_u32 v15, v7, 4, v15
    v_lshlrev_b32 v5, 4, v1
    s_add_u32 s62, s65, 0
    s_add_u32 m0, s69, 0
    s_nop 0
    buffer_load_dwordx4 v4, s[40:43], s62 offen lds
    s_add_u32 s62, s65, 8192
    s_add_u32 m0, s69, 1024
    s_nop 0
    buffer_load_dwordx4 v4, s[40:43], s62 offen lds
    s_add_u32 s62, s65, 16384
    s_add_u32 m0, s69, 8192
    s_nop 0
    buffer_load_dwordx4 v4, s[40:43], s62 offen lds
    s_add_u32 s62, s65, 24576
    s_add_u32 m0, s69, 9216
    s_nop 0
    buffer_load_dwordx4 v4, s[40:43], s62 offen lds
    s_add_u32 s62, s65, 32768
    s_add_u32 m0, s69, 16384
    s_nop 0
    buffer_load_dwordx4 v4, s[40:43], s62 offen lds
    s_add_u32 s62, s65, 40960
    s_add_u32 m0, s69, 17408
    s_nop 0
    buffer_load_dwordx4 v4, s[40:43], s62 offen lds
    s_add_u32 s62, s65, 49152
    s_add_u32 m0, s69, 24576
    s_nop 0
    buffer_load_dwordx4 v4, s[40:43], s62 offen lds
    s_add_u32 s62, s65, 57344
    s_add_u32 m0, s69, 25600
    s_nop 0
    buffer_load_dwordx4 v4, s[40:43], s62 offen lds
    s_add_u32 s62, s65, 65536
    s_add_u32 m0, s69, 32768
    s_nop 0
    buffer_load_dwordx4 v4, s[40:43], s62 offen lds
    s_add_u32 s62, s65, 73728
    s_add_u32 m0, s69, 33792
    s_nop 0
    buffer_load_dwordx4 v4, s[40:43], s62 offen lds
    s_add_u32 s62, s65, 81920
    s_add_u32 m0, s69, 40960
    s_nop 0
    buffer_load_dwordx4 v4, s[40:43], s62 offen lds
    s_add_u32 s62, s65, 90112
    s_add_u32 m0, s69, 41984
    s_nop 0
    buffer_load_dwordx4 v4, s[40:43], s62 offen lds
    s_add_u32 s62, s65, 98304
    s_add_u32 m0, s69, 49152
    s_nop 0
    buffer_load_dwordx4 v4, s[40:43], s62 offen lds
    s_add_u32 s62, s65, 106496
    s_add_u32 m0, s69, 50176
    s_nop 0
    buffer_load_dwordx4 v4, s[40:43], s62 offen lds
    s_add_u32 s62, s65, 114688
    s_add_u32 m0, s69, 57344
    s_nop 0
    buffer_load_dwordx4 v4, s[40:43], s62 offen lds
    s_add_u32 s62, s65, 122880
    s_add_u32 m0, s69, 58368
    s_nop 0
    buffer_load_dwordx4 v4, s[40:43], s62 offen lds
    v_mov_b32 v13, 163776
    s_mov_b32 s66, 0
    s_cmp_lg_u32 s4, 8
    s_cbranch_scc1 Lpw_5
    s_lshl_b32 s67, s5, 8
    v_lshlrev_b32 v12, 4, v1
    v_add_u32 v12, s67, v12
    s_mov_b64 exec, 0xf
    s_mov_b32 s66, 0
Lpoll_7:
    buffer_load_dwordx4 v[8:11], v12, s[72:75], 0 offen sc1
    s_waitcnt vmcnt(0)
    v_min_u32 v8, v8, v9
    v_min_u32 v10, v10, v11
    v_min_u32 v8, v8, v10
    v_cmp_gt_u32 vcc, 2, v8
    s_add_u32 s66, s66, 1
    s_cmp_ge_u32 s66, 0x40000
    s_cbranch_scc1 Lpoll_7_x
    s_nop 3
    s_cmp_eq_u64 vcc, 0
    s_cbranch_scc1 Lpoll_7_x
    s_sleep 4
    s_branch Lpoll_7
Lpoll_7_x:
    s_mov_b64 exec, -1
    s_nop 7
    s_nop 7
    s_lshl_b32 s67, s6, 8
    s_add_u32 s67, s67, 4096
    s_lshl_b32 s66, s5, 2
    s_add_u32 s66, s66, s67
    v_mov_b32 v8, 2
    v_mov_b32 v9, 0
    s_mov_b64 exec, 1
    buffer_store_dword v8, v9, s[72:75], s66 offen sc1
    s_mov_b64 exec, -1
    s_nop 1
    v_lshlrev_b32 v12, 4, v1
    v_add_u32 v12, s67, v12
    s_mov_b64 exec, 0xf
    s_mov_b32 s66, 0
Lpoll_8:
    buffer_load_dwordx4 v[8:11], v12, s[72:75], 0 offen sc1
    s_waitcnt vmcnt(0)
    v_min_u32 v8, v8, v9
    v_min_u32 v10, v10, v11
    v_min_u32 v8, v8, v10
    v_cmp_gt_u32 vcc, 2, v8
    s_add_u32 s66, s66, 1
    s_cmp_ge_u32 s66, 0x40000
    s_cbranch_scc1 Lpoll_8_x
    s_nop 3
    s_cmp_eq_u64 vcc, 0
    s_cbranch_scc1 Lpoll_8_x
    s_sleep 4
    s_branch Lpoll_8
Lpoll_8_x:
    s_mov_b64 exec, -1
    s_nop 7
    s_nop 7
    v_mov_b32 v8, 2
    ds_write_b32 v13, v8
    s_waitcnt lgkmcnt(0)
    s_branch Lpx_6
Lpw_5:
    ds_read_b32 v8, v13
    s_waitcnt lgkmcnt(0)
    v_readfirstlane_b32 s67, v8
    s_add_u32 s66, s66, 1
    s_cmp_ge_u32 s66, 0x400000
    s_cbranch_scc1 Lpx_6
    s_cmp_eq_u32 s67, 2
    s_cbranch_scc1 Lpx_6
    s_sleep 1
    s_branch Lpw_5
Lpx_6:
    s_nop 7
    s_nop 7
    s_barrier
    s_add_u32 s76, s38, 0x1a00000
    s_addc_u32 s77, s39, 0
    s_mov_b32 s78, 0x40000
    s_mov_b32 s79, 0x00020000
    v_mov_b32 v17, 0
    s_cmp_eq_u32 s4, 9
    s_cbranch_scc1 Lcg9_9
    s_cmp_eq_u32 s4, 10
    s_cbranch_scc1 Lcg10_10
    s_branch Lcgx_11
Lcg9_9:
    s_nop 7
    s_nop 7
    v_lshlrev_b32 v16, 4, v1
    v_add_u32 v17, 163200, v16
    s_mul_i32 s70, s6, 448
    s_add_u32 s70, s70, 131072
    s_mov_b32 exec_lo, 0xfffffff
    s_mov_b32 exec_hi, 0
    buffer_load_dwordx4 v[20:23], v16, s[76:79], s70 offen sc1
    s_add_u32 s70, s70, 7168
    buffer_load_dwordx4 v[24:27], v16, s[76:79], s70 offen sc1
    s_add_u32 s70, s70, 7168
    buffer_load_dwordx4 v[28:31], v16, s[76:79], s70 offen sc1
    s_add_u32 s70, s70, 7168
    buffer_load_dwordx4 v[32:35], v16, s[76:79], s70 offen sc1
    s_add_u32 s70, s70, 7168
    buffer_load_dwordx4 v[36:39], v16, s[76:79], s70 offen sc1
    s_add_u32 s70, s70, 7168
    buffer_load_dwordx4 v[40:43], v16, s[76:79], s70 offen sc1
    s_add_u32 s70, s70, 7168
    buffer_load_dwordx4 v[44:47], v16, s[76:79], s70 offen sc1
    s_add_u32 s70, s70, 7168
    buffer_load_dwordx4 v[48:51], v16, s[76:79], s70 offen sc1
    s_add_u32 s70, s70, 7168
    buffer_load_dwordx4 v[52:55], v16, s[76:79], s70 offen sc1
    s_add_u32 s70, s70, 7168
    buffer_load_dwordx4 v[56:59], v16, s[76:79], s70 offen sc1
    s_add_u32 s70, s70, 7168
    buffer_load_dwordx4 v[60:63], v16, s[76:79], s70 offen sc1
    s_add_u32 s70, s70, 7168
    buffer_load_dwordx4 v[64:67], v16, s[76:79], s70 offen sc1
    s_add_u32 s70, s70, 7168
    buffer_load_dwordx4 v[68:71], v16, s[76:79], s70 offen sc1
    s_add_u32 s70, s70, 7168
    buffer_load_dwordx4 v[72:75], v16, s[76:79], s70 offen sc1
    s_add_u32 s70, s70, 7168
    buffer_load_dwordx4 v[76:79], v16, s[76:79], s70 offen sc1
    s_add_u32 s70, s70, 7168
    buffer_load_dwordx4 v[80:83], v16, s[76:79], s70 offen sc1
    s_add_u32 s70, s70, 7168
    s_mov_b64 exec, -1
    s_branch Lcgx_11
Lcg10_10:
    s_nop 7
    s_nop 7
    v_lshrrev_b32 v24, 2, v1
    v_cmp_le_u32 vcc, 3, v24
    s_nop 1
    v_cndmask_b32 v25, 0, 1, vcc
    v_mul_u32_u24 v26, 3, v25
    v_sub_u32 v24, v24, v26
    v_lshlrev_b32 v16, 11, v24
    v_lshl_add_u32 v16, v25, 6, v16
    v_and_b32 v24, 3, v1
    v_lshl_add_u32 v16, v24, 4, v16
    v_lshlrev_b32 v17, 4, v1
    v_add_u32 v17, 162816, v17
    s_lshl_b32 s70, s6, 7
    s_mov_b32 exec_lo, 0xffffff
    s_mov_b32 exec_hi, 0
    buffer_load_dwordx4 v[20:23], v16, s[76:79], s70 offen sc1
    s_add_u32 s70, s70, 6144
    buffer_load_dwordx4 v[24:27], v16, s[76:79], s70 offen sc1
    s_add_u32 s70, s70, 6144
    buffer_load_dwordx4 v[28:31], v16, s[76:79], s70 offen sc1
    s_add_u32 s70, s70, 6144
    buffer_load_dwordx4 v[32:35], v16, s[76:79], s70 offen sc1
    s_add_u32 s70, s70, 6144
    buffer_load_dwordx4 v[36:39], v16, s[76:79], s70 offen sc1
    s_add_u32 s70, s70, 6144
    buffer_load_dwordx4 v[40:43], v16, s[76:79], s70 offen sc1
    s_add_u32 s70, s70, 6144
    buffer_load_dwordx4 v[44:47], v16, s[76:79], s70 offen sc1
    s_add_u32 s70, s70, 6144
    buffer_load_dwordx4 v[48:51], v16, s[76:79], s70 offen sc1
    s_add_u32 s70, s70, 6144
    buffer_load_dwordx4 v[52:55], v16, s[76:79], s70 offen sc1
    s_add_u32 s70, s70, 6144
    buffer_load_dwordx4 v[56:59], v16, s[76:79], s70 offen sc1
    s_add_u32 s70, s70, 6144
    buffer_load_dwordx4 v[60:63], v16, s[76:79], s70 offen sc1
    s_add_u32 s70, s70, 6144
    buffer_load_dwordx4 v[64:67], v16, s[76:79], s70 offen sc1
    s_add_u32 s70, s70, 6144
    buffer_load_dwordx4 v[68:71], v16, s[76:79], s70 offen sc1
    s_add_u32 s70, s70, 6144
    buffer_load_dwordx4 v[72:75], v16, s[76:79], s70 offen sc1
    s_add_u32 s70, s70, 6144
    buffer_load_dwordx4 v[76:79], v16, s[76:79], s70 offen sc1
    s_add_u32 s70, s70, 6144
    buffer_load_dwordx4 v[80:83], v16, s[76:79], s70 offen sc1
    s_add_u32 s70, s70, 6144
    s_mov_b64 exec, -1
Lcgx_11:
    s_nop 7
    s_nop 7
    v_mov_b32 v100, 163792
    ds_read_b32 v100, v100
    s_waitcnt lgkmcnt(0)
    v_readfirstlane_b32 s71, v100
    s_nop 3
    s_cmp_eq_u32 s71, 1
    s_cbranch_scc0 mega_kernel_lslow
    s_barrier
    s_add_u32 s62, s64, 2048
    s_lshl_b32 m0, s7, 10
    s_add_u32 m0, m0, 106496
    s_nop 0
    buffer_load_dwordx4 v15, s[48:51], s62 offen sc1 lds
    s_add_u32 s62, s64, 0
    s_add_u32 m0, s68, 65536
    s_nop 0
    buffer_load_dwordx4 v6, s[48:51], s62 offen sc1 lds
    s_add_u32 s62, s64, 1024
    s_add_u32 m0, s68, 66560
    s_nop 0
    buffer_load_dwordx4 v6, s[48:51], s62 offen sc1 lds
    s_add_u32 s62, s64, 2176
    s_add_u32 m0, s68, 73728
    s_nop 0
    buffer_load_dwordx4 v6, s[48:51], s62 offen sc1 lds
    s_add_u32 s62, s64, 3200
    s_add_u32 m0, s68, 74752
    s_nop 0
    buffer_load_dwordx4 v6, s[48:51], s62 offen sc1 lds
    s_add_u32 s62, s64, 4352
    s_add_u32 m0, s68, 81920
    s_nop 0
    buffer_load_dwordx4 v6, s[48:51], s62 offen sc1 lds
    s_add_u32 s62, s64, 5376
    s_add_u32 m0, s68, 82944
    s_nop 0
    buffer_load_dwordx4 v6, s[48:51], s62 offen sc1 lds
    s_add_u32 s62, s64, 6528
    s_add_u32 m0, s68, 90112
    s_nop 0
    buffer_load_dwordx4 v6, s[48:51], s62 offen sc1 lds
    s_add_u32 s62, s64, 7552
    s_add_u32 m0, s68, 91136
    s_nop 0
    buffer_load_dwordx4 v6, s[48:51], s62 offen sc1 lds
    s_waitcnt vmcnt(6)
    s_barrier
    s_add_u32 s62, s64, 8704
    s_add_u32 m0, s68, 98304
    s_nop 0
    buffer_load_dwordx4 v6, s[48:51], s62 offen sc1 lds
    s_add_u32 s62, s64, 9728
    s_add_u32 m0, s68, 99328
    s_nop 0
    buffer_load_dwordx4 v6, s[48:51], s62 offen sc1 lds
    s_waitcnt vmcnt(6)
    s_barrier
    s_add_u32 s62, s64, 10880
    s_add_u32 m0, s68, 65536
    s_nop 0
    buffer_load_dwordx4 v6, s[48:51], s62 offen sc1 lds
    s_add_u32 s62, s64, 11904
    s_add_u32 m0, s68, 66560
    s_nop 0
    buffer_load_dwordx4 v6, s[48:51], s62 offen sc1 lds
    s_waitcnt vmcnt(6)
    s_barrier
    s_add_u32 s62, s64, 13056
    s_add_u32 m0, s68, 73728
    s_nop 0
    buffer_load_dwordx4 v6, s[48:51], s62 offen sc1 lds
    s_add_u32 s62, s64, 14080
    s_add_u32 m0, s68, 74752
    s_nop 0
    buffer_load_dwordx4 v6, s[48:51], s62 offen sc1 lds
    s_waitcnt vmcnt(6)
    s_barrier
    s_add_u32 s62, s64, 15232
    s_add_u32 m0, s68, 81920
    s_nop 0
    buffer_load_dwordx4 v6, s[48:51], s62 offen sc1 lds
    s_add_u32 s62, s64, 16256
    s_add_u32 m0, s68, 82944
    s_nop 0
    buffer_load_dwordx4 v6, s[48:51], s62 offen sc1 lds
    s_waitcnt vmcnt(6)
    s_barrier
    s_waitcnt vmcnt(4)
    s_barrier
    s_waitcnt vmcnt(2)
    s_barrier
    s_waitcnt vmcnt(0)
    s_barrier
    s_cmp_eq_u32 s4, 9
    s_cbranch_scc1 Lcg9_12
    s_cmp_eq_u32 s4, 10
    s_cbranch_scc1 Lcg10_13
    s_branch Lcgx_14
Lcg9_12:
    s_nop 7
    s_nop 7
    s_mov_b32 exec_lo, 0xfffffff
    s_mov_b32 exec_hi, 0
    s_waitcnt vmcnt(0)
    v_pk_add_f32 v[20:21], v[20:21], v[24:25]
    v_pk_add_f32 v[22:23], v[22:23], v[26:27]
    v_pk_add_f32 v[20:21], v[20:21], v[28:29]
    v_pk_add_f32 v[22:23], v[22:23], v[30:31]
    v_pk_add_f32 v[20:21], v[20:21], v[32:33]
    v_pk_add_f32 v[22:23], v[22:23], v[34:35]
    v_pk_add_f32 v[20:21], v[20:21], v[36:37]
    v_pk_add_f32 v[22:23], v[22:23], v[38:39]
    v_pk_add_f32 v[20:21], v[20:21], v[40:41]
    v_pk_add_f32 v[22:23], v[22:23], v[42:43]
    v_pk_add_f32 v[20:21], v[20:21], v[44:45]
    v_pk_add_f32 v[22:23], v[22:23], v[46:47]
    v_pk_add_f32 v[20:21], v[20:21], v[48:49]
    v_pk_add_f32 v[22:23], v[22:23], v[50:51]
    v_pk_add_f32 v[20:21], v[20:21], v[52:53]
    v_pk_add_f32 v[22:23], v[22:23], v[54:55]
    v_pk_add_f32 v[20:21], v[20:21], v[56:57]
    v_pk_add_f32 v[22:23], v[22:23], v[58:59]
    v_pk_add_f32 v[20:21], v[20:21], v[60:61]
    v_pk_add_f32 v[22:23], v[22:23], v[62:63]
    v_pk_add_f32 v[20:21], v[20:21], v[64:65]
    v_pk_add_f32 v[22:23], v[22:23], v[66:67]
    v_pk_add_f32 v[20:21], v[20:21], v[68:69]
    v_pk_add_f32 v[22:23], v[22:23], v[70:71]
    v_pk_add_f32 v[20:21], v[20:21], v[72:73]
    v_pk_add_f32 v[22:23], v[22:23], v[74:75]
    v_pk_add_f32 v[20:21], v[20:21], v[76:77]
    v_pk_add_f32 v[22:23], v[22:23], v[78:79]
    v_pk_add_f32 v[20:21], v[20:21], v[80:81]
    v_pk_add_f32 v[22:23], v[22:23], v[82:83]
    ds_write_b128 v17, v[20:23]
    s_waitcnt lgkmcnt(0)
    s_mov_b64 exec, -1
    s_branch Lcgx_14
Lcg10_13:
    s_nop 7
    s_nop 7
    s_mov_b32 exec_lo, 0xffffff
    s_mov_b32 exec_hi, 0
    s_waitcnt vmcnt(0)
    v_pk_add_f32 v[20:21], v[20:21], v[24:25]
    v_pk_add_f32 v[22:23], v[22:23], v[26:27]
    v_pk_add_f32 v[20:21], v[20:21], v[28:29]
    v_pk_add_f32 v[22:23], v[22:23], v[30:31]
    v_pk_add_f32 v[20:21], v[20:21], v[32:33]
    v_pk_add_f32 v[22:23], v[22:23], v[34:35]
    v_pk_add_f32 v[20:21], v[20:21], v[36:37]
    v_pk_add_f32 v[22:23], v[22:23], v[38:39]
    v_pk_add_f32 v[20:21], v[20:21], v[40:41]
    v_pk_add_f32 v[22:23], v[22:23], v[42:43]
    v_pk_add_f32 v[20:21], v[20:21], v[44:45]
    v_pk_add_f32 v[22:23], v[22:23], v[46:47]
    v_pk_add_f32 v[20:21], v[20:21], v[48:49]
    v_pk_add_f32 v[22:23], v[22:23], v[50:51]
    v_pk_add_f32 v[20:21], v[20:21], v[52:53]
    v_pk_add_f32 v[22:23], v[22:23], v[54:55]
    v_pk_add_f32 v[20:21], v[20:21], v[56:57]
    v_pk_add_f32 v[22:23], v[22:23], v[58:59]
    v_pk_add_f32 v[20:21], v[20:21], v[60:61]
    v_pk_add_f32 v[22:23], v[22:23], v[62:63]
    v_pk_add_f32 v[20:21], v[20:21], v[64:65]
    v_pk_add_f32 v[22:23], v[22:23], v[66:67]
    v_pk_add_f32 v[20:21], v[20:21], v[68:69]
    v_pk_add_f32 v[22:23], v[22:23], v[70:71]
    v_pk_add_f32 v[20:21], v[20:21], v[72:73]
    v_pk_add_f32 v[22:23], v[22:23], v[74:75]
    v_pk_add_f32 v[20:21], v[20:21], v[76:77]
    v_pk_add_f32 v[22:23], v[22:23], v[78:79]
    v_pk_add_f32 v[20:21], v[20:21], v[80:81]
    v_pk_add_f32 v[22:23], v[22:23], v[82:83]
    ds_write_b128 v17, v[20:23]
    s_waitcnt lgkmcnt(0)
    s_mov_b64 exec, -1
Lcgx_14:
    s_nop 7
    s_nop 7
    s_lshl_b32 s60, s5, 2
    s_add_u32 s60, s60, s7
    s_lshl_b32 s60, s60, 15
    s_lshl_b32 s63, s7, 10
    s_lshl_b32 s64, s7, 12
    s_mul_i32 s61, s6, 114688
    s_add_u32 s61, s61, s63
    s_add_u32 s40, s38, 0x600000
    s_addc_u32 s41, s39, 0
    s_mov_b32 s42, 0x200000
    s_mov_b32 s43, 0x00020000
    s_add_u32 s44, s38, 0x1800000
    s_addc_u32 s45, s39, 0
    s_mov_b32 s46, 0x1c0000
    s_mov_b32 s47, 0x00020000
    v_lshlrev_b32 v4, 4, v1
    s_barrier
    s_cmp_ge_u32 s7, 2
    s_cbranch_scc1 Lls_15
    s_add_u32 s62, s61, 12288
    s_add_u32 m0, s63, 12288
    s_nop 0
    buffer_load_dwordx4 v4, s[44:47], s62 offen lds
Lls_15:
    s_add_u32 s62, s61, 0
    s_add_u32 m0, s63, 0
    s_nop 0
    buffer_load_dwordx4 v4, s[44:47], s62 offen lds
    s_add_u32 s62, s61, 4096
    s_add_u32 m0, s63, 4096
    s_nop 0
    buffer_load_dwordx4 v4, s[44:47], s62 offen lds
    s_add_u32 s62, s61, 8192
    s_add_u32 m0, s63, 8192
    s_nop 0
    buffer_load_dwordx4 v4, s[44:47], s62 offen lds
    s_cmp_ge_u32 s7, 2
    s_cbranch_scc1 Lls_16
    s_add_u32 s62, s61, 26624
    s_add_u32 m0, s63, 26624
    s_nop 0
    buffer_load_dwordx4 v4, s[44:47], s62 offen lds
Lls_16:
    s_add_u32 s62, s61, 14336
    s_add_u32 m0, s63, 14336
    s_nop 0
    buffer_load_dwordx4 v4, s[44:47], s62 offen lds
    s_add_u32 s62, s61, 18432
    s_add_u32 m0, s63, 18432
    s_nop 0
    buffer_load_dwordx4 v4, s[44:47], s62 offen lds
    s_add_u32 s62, s61, 22528
    s_add_u32 m0, s63, 22528
    s_nop 0
    buffer_load_dwordx4 v4, s[44:47], s62 offen lds
    s_cmp_ge_u32 s7, 2
    s_cbranch_scc1 Lls_17
    s_add_u32 s62, s61, 40960
    s_add_u32 m0, s63, 40960
    s_nop 0
    buffer_load_dwordx4 v4, s[44:47], s62 offen lds
Lls_17:
    s_add_u32 s62, s61, 28672
    s_add_u32 m0, s63, 28672
    s_nop 0
    buffer_load_dwordx4 v4, s[44:47], s62 offen lds
    s_add_u32 s62, s61, 32768
    s_add_u32 m0, s63, 32768
    s_nop 0
    buffer_load_dwordx4 v4, s[44:47], s62 offen lds
    s_add_u32 s62, s61, 36864
    s_add_u32 m0, s63, 36864
    s_nop 0
    buffer_load_dwordx4 v4, s[44:47], s62 offen lds
    s_cmp_ge_u32 s7, 2
    s_cbranch_scc1 Lls_18
    s_add_u32 s62, s61, 55296
    s_add_u32 m0, s63, 55296
    s_nop 0
    buffer_load_dwordx4 v4, s[44:47], s62 offen lds
Lls_18:
    s_add_u32 s62, s61, 43008
    s_add_u32 m0, s63, 43008
    s_nop 0
    buffer_load_dwordx4 v4, s[44:47], s62 offen lds
    s_add_u32 s62, s61, 47104
    s_add_u32 m0, s63, 47104
    s_nop 0
    buffer_load_dwordx4 v4, s[44:47], s62 offen lds
    s_add_u32 s62, s61, 51200
    s_add_u32 m0, s63, 51200
    s_nop 0
    buffer_load_dwordx4 v4, s[44:47], s62 offen lds
    s_barrier
    s_barrier
    s_lshl_b32 s67, s5, 8
    v_lshlrev_b32 v12, 4, v1
    v_add_u32 v12, s67, v12
    s_mov_b64 exec, 0xf
    s_mov_b32 s66, 0
Lpoll_19:
    buffer_load_dwordx4 v[8:11], v12, s[72:75], 0 offen sc1
    s_waitcnt vmcnt(0)
    v_min_u32 v8, v8, v9
    v_min_u32 v10, v10, v11
    v_min_u32 v8, v8, v10
    v_cmp_gt_u32 vcc, 3, v8
    s_add_u32 s66, s66, 1
    s_cmp_ge_u32 s66, 0x40000
    s_cbranch_scc1 Lpoll_19_x
    s_nop 3
    s_cmp_eq_u64 vcc, 0
    s_cbranch_scc1 Lpoll_19_x
    s_sleep 4
    s_branch Lpoll_19
Lpoll_19_x:
    s_mov_b64 exec, -1
    s_nop 7
    s_nop 7
    s_add_u32 s62, s60, 0
    s_add_u32 m0, s64, 86016
    s_nop 0
    buffer_load_dwordx4 v4, s[40:43], s62 offen sc1 lds
    s_add_u32 s62, s60, 1024
    s_add_u32 m0, s64, 87040
    s_nop 0
    buffer_load_dwordx4 v4, s[40:43], s62 offen sc1 lds
    s_add_u32 s62, s60, 16384
    s_add_u32 m0, s64, 88064
    s_nop 0
    buffer_load_dwordx4 v4, s[40:43], s62 offen sc1 lds
    s_add_u32 s62, s60, 17408
    s_add_u32 m0, s64, 89088
    s_nop 0
    buffer_load_dwordx4 v4, s[40:43], s62 offen sc1 lds
    s_add_u32 s62, s60, 2048
    s_add_u32 m0, s64, 102400
    s_nop 0
    buffer_load_dwordx4 v4, s[40:43], s62 offen sc1 lds
    s_add_u32 s62, s60, 3072
    s_add_u32 m0, s64, 103424
    s_nop 0
    buffer_load_dwordx4 v4, s[40:43], s62 offen sc1 lds
    s_add_u32 s62, s60, 18432
    s_add_u32 m0, s64, 104448
    s_nop 0
    buffer_load_dwordx4 v4, s[40:43], s62 offen sc1 lds
    s_add_u32 s62, s60, 19456
    s_add_u32 m0, s64, 105472
    s_nop 0
    buffer_load_dwordx4 v4, s[40:43], s62 offen sc1 lds
    s_add_u32 s62, s60, 4096
    s_add_u32 m0, s64, 118784
    s_nop 0
    buffer_load_dwordx4 v4, s[40:43], s62 offen sc1 lds
    s_add_u32 s62, s60, 5120
    s_add_u32 m0, s64, 119808
    s_nop 0
    buffer_load_dwordx4 v4, s[40:43], s62 offen sc1 lds
    s_add_u32 s62, s60, 20480
    s_add_u32 m0, s64, 120832
    s_nop 0
    buffer_load_dwordx4 v4, s[40:43], s62 offen sc1 lds
    s_add_u32 s62, s60, 21504
    s_add_u32 m0, s64, 121856
    s_nop 0
    buffer_load_dwordx4 v4, s[40:43], s62 offen sc1 lds
    s_add_u32 s48, s38, 0x14a0000
    s_addc_u32 s49, s39, 0
    s_mov_b32 s50, 0x20000
    s_mov_b32 s51, 0x00020000
    v_and_b32 v14, 31, v1
    v_lshlrev_b32 v32, 6, v14
    s_lshl_b32 s62, s5, 2
    s_add_u32 s62, s62, s7
    s_lshl_b32 s62, s62, 11
    buffer_load_dwordx4 v[16:19], v32, s[48:51], s62 offen offset:0 sc1
    buffer_load_dwordx4 v[20:23], v32, s[48:51], s62 offen offset:16 sc1
    buffer_load_dwordx4 v[24:27], v32, s[48:51], s62 offen offset:32 sc1
    buffer_load_dwordx4 v[28:31], v32, s[48:51], s62 offen offset:48 sc1
    s_cmp_ge_u32 s7, 2
    s_cbranch_scc1 Lls_20
    s_add_u32 s62, s61, 69632
    s_add_u32 m0, s63, 69632
    s_nop 0
    buffer_load_dwordx4 v4, s[44:47], s62 offen lds
Lls_20:
    s_add_u32 s62, s61, 57344
    s_add_u32 m0, s63, 57344
    s_nop 0
    buffer_load_dwordx4 v4, s[44:47], s62 offen lds
    s_add_u32 s62, s61, 61440
    s_add_u32 m0, s63, 61440
    s_nop 0
    buffer_load_dwordx4 v4, s[44:47], s62 offen lds
    s_add_u32 s62, s61, 65536
    s_add_u32 m0, s63, 65536
    s_nop 0
    buffer_load_dwordx4 v4, s[44:47], s62 offen lds
    s_cmp_ge_u32 s7, 2
    s_cbranch_scc1 Lls_21
    s_add_u32 s62, s61, 83968
    s_add_u32 m0, s63, 83968
    s_nop 0
    buffer_load_dwordx4 v4, s[44:47], s62 offen lds
Lls_21:
    s_add_u32 s62, s61, 71680
    s_add_u32 m0, s63, 71680
    s_nop 0
    buffer_load_dwordx4 v4, s[44:47], s62 offen lds
    s_add_u32 s62, s61, 75776
    s_add_u32 m0, s63, 75776
    s_nop 0
    buffer_load_dwordx4 v4, s[44:47], s62 offen lds
    s_add_u32 s62, s61, 79872
    s_add_u32 m0, s63, 79872
    s_nop 0
    buffer_load_dwordx4 v4, s[44:47], s62 offen lds
    s_waitcnt vmcnt(18)
    s_barrier
    s_add_u32 s62, s60, 6144
    s_add_u32 m0, s64, 135168
    s_nop 0
    buffer_load_dwordx4 v4, s[40:43], s62 offen sc1 lds
    s_add_u32 s62, s60, 7168
    s_add_u32 m0, s64, 136192
    s_nop 0
    buffer_load_dwordx4 v4, s[40:43], s62 offen sc1 lds
    s_add_u32 s62, s60, 22528
    s_add_u32 m0, s64, 137216
    s_nop 0
    buffer_load_dwordx4 v4, s[40:43], s62 offen sc1 lds
    s_add_u32 s62, s60, 23552
    s_add_u32 m0, s64, 138240
    s_nop 0
    buffer_load_dwordx4 v4, s[40:43], s62 offen sc1 lds
    s_waitcnt vmcnt(18)
    s_barrier
    s_add_u32 s62, s60, 8192
    s_add_u32 m0, s64, 86016
    s_nop 0
    buffer_load_dwordx4 v4, s[40:43], s62 offen sc1 lds
    s_add_u32 s62, s60, 9216
    s_add_u32 m0, s64, 87040
    s_nop 0
    buffer_load_dwordx4 v4, s[40:43], s62 offen sc1 lds
    s_add_u32 s62, s60, 24576
    s_add_u32 m0, s64, 88064
    s_nop 0
    buffer_load_dwordx4 v4, s[40:43], s62 offen sc1 lds
    s_add_u32 s62, s60, 25600
    s_add_u32 m0, s64, 89088
    s_nop 0
    buffer_load_dwordx4 v4, s[40:43], s62 offen sc1 lds
    s_waitcnt vmcnt(14)
    v_pk_add_f32 v[16:17], v[16:17], v[18:19]
    v_pk_add_f32 v[16:17], v[16:17], v[20:21]
    v_pk_add_f32 v[16:17], v[16:17], v[22:23]
    v_pk_add_f32 v[16:17], v[16:17], v[24:25]
    v_pk_add_f32 v[16:17], v[16:17], v[26:27]
    v_pk_add_f32 v[16:17], v[16:17], v[28:29]
    v_pk_add_f32 v[16:17], v[16:17], v[30:31]
    v_mul_f32 v16, 0x3b000000, v16
    v_mul_f32 v17, 0x3b000000, v17
    v_fma_f32 v17, -v16, v16, v17
    v_max_f32 v17, 0, v17
    v_mov_b32 v33, v17
    v_cvt_pk_bf16_f32 v32, v33, v33
    v_lshlrev_b32 v33, 16, v32
    v_add_f32 v33, 0x3727c5ac, v33
    v_cvt_pk_bf16_f32 v32, v33, v33
    v_lshlrev_b32 v33, 16, v32
    v_sqrt_f32 v33, v33
    s_nop 0
    v_cvt_pk_bf16_f32 v32, v33, v33
    v_lshlrev_b32 v33, 16, v32
    v_cvt_pk_bf16_f32 v32, v16, v16
    v_lshlrev_b32 v32, 16, v32
    v_rcp_f32 v33, v33
    v_sub_f32 v16, v16, v32
    v_mul_f32 v16, v16, v33
    v_mul_f32 v17, v17, v33
    v_mul_f32 v17, v17, v33
    v_mul_f32 v32, v32, v33
    v_cvt_pk_bf16_f32 v16, v16, v16
    v_lshlrev_b32 v16, 16, v16
    v_add_f32 v16, v16, v32
    v_cvt_pk_bf16_f32 v32, v17, v17
    v_lshlrev_b32 v17, 16, v32
    v_add_f32 v17, 0x3727c5ac, v17
    v_cvt_pk_bf16_f32 v32, v17, v17
    v_lshlrev_b32 v17, 16, v32
    v_sqrt_f32 v17, v17
    s_nop 0
    v_cvt_pk_bf16_f32 v32, v17, v17
    v_lshlrev_b32 v17, 16, v32
    v_rcp_f32 v17, v17
    s_nop 0
    v_mul_f32 v16, -v16, v17
    v_mul_f32 v17, v17, v33
    s_lshl_b32 s62, s7, 8
    s_add_u32 s62, s62, 161792
    v_lshlrev_b32 v14, 3, v14
    v_add_u32 v14, s62, v14
    ds_write_b64 v14, v[16:17]
    s_waitcnt lgkmcnt(0)
    s_barrier
    s_add_u32 s62, s60, 10240
    s_add_u32 m0, s64, 102400
    s_nop 0
    buffer_load_dwordx4 v4, s[40:43], s62 offen sc1 lds
    s_add_u32 s62, s60, 11264
    s_add_u32 m0, s64, 103424
    s_nop 0
    buffer_load_dwordx4 v4, s[40:43], s62 offen sc1 lds
    s_add_u32 s62, s60, 26624
    s_add_u32 m0, s64, 104448
    s_nop 0
    buffer_load_dwordx4 v4, s[40:43], s62 offen sc1 lds
    s_add_u32 s62, s60, 27648
    s_add_u32 m0, s64, 105472
    s_nop 0
    buffer_load_dwordx4 v4, s[40:43], s62 offen sc1 lds
    s_waitcnt vmcnt(8)
    s_barrier
    s_cmp_ge_u32 s7, 2
    s_cbranch_scc1 Lls_22
    s_add_u32 s62, s61, 98304
    s_add_u32 m0, s63, 12288
    s_nop 0
    buffer_load_dwordx4 v4, s[44:47], s62 offen lds
Lls_22:
    s_add_u32 s62, s61, 86016
    s_add_u32 m0, s63, 0
    s_nop 0
    buffer_load_dwordx4 v4, s[44:47], s62 offen lds
    s_add_u32 s62, s61, 90112
    s_add_u32 m0, s63, 4096
    s_nop 0
    buffer_load_dwordx4 v4, s[44:47], s62 offen lds
    s_add_u32 s62, s61, 94208
    s_add_u32 m0, s63, 8192
    s_nop 0
    buffer_load_dwordx4 v4, s[44:47], s62 offen lds
    s_add_u32 s62, s60, 12288
    s_add_u32 m0, s64, 118784
    s_nop 0
    buffer_load_dwordx4 v4, s[40:43], s62 offen sc1 lds
    s_add_u32 s62, s60, 13312
    s_add_u32 m0, s64, 119808
    s_nop 0
    buffer_load_dwordx4 v4, s[40:43], s62 offen sc1 lds
    s_add_u32 s62, s60, 28672
    s_add_u32 m0, s64, 120832
    s_nop 0
    buffer_load_dwordx4 v4, s[40:43], s62 offen sc1 lds
    s_add_u32 s62, s60, 29696
    s_add_u32 m0, s64, 121856
    s_nop 0
    buffer_load_dwordx4 v4, s[40:43], s62 offen sc1 lds
    s_waitcnt vmcnt(11)
    s_barrier
    s_cmp_ge_u32 s7, 2
    s_cbranch_scc1 Lls_23
    s_add_u32 s62, s61, 112640
    s_add_u32 m0, s63, 26624
    s_nop 0
    buffer_load_dwordx4 v4, s[44:47], s62 offen lds
Lls_23:
    s_add_u32 s62, s61, 100352
    s_add_u32 m0, s63, 14336
    s_nop 0
    buffer_load_dwordx4 v4, s[44:47], s62 offen lds
    s_add_u32 s62, s61, 104448
    s_add_u32 m0, s63, 18432
    s_nop 0
    buffer_load_dwordx4 v4, s[44:47], s62 offen lds
    s_add_u32 s62, s61, 108544
    s_add_u32 m0, s63, 22528
    s_nop 0
    buffer_load_dwordx4 v4, s[44:47], s62 offen lds
    s_add_u32 s62, s60, 14336
    s_add_u32 m0, s64, 135168
    s_nop 0
    buffer_load_dwordx4 v4, s[40:43], s62 offen sc1 lds
    s_add_u32 s62, s60, 15360
    s_add_u32 m0, s64, 136192
    s_nop 0
    buffer_load_dwordx4 v4, s[40:43], s62 offen sc1 lds
    s_add_u32 s62, s60, 30720
    s_add_u32 m0, s64, 137216
    s_nop 0
    buffer_load_dwordx4 v4, s[40:43], s62 offen sc1 lds
    s_add_u32 s62, s60, 31744
    s_add_u32 m0, s64, 138240
    s_nop 0
    buffer_load_dwordx4 v4, s[40:43], s62 offen sc1 lds
    s_waitcnt vmcnt(14)
    s_barrier
    s_waitcnt vmcnt(7)
    s_barrier
    s_waitcnt vmcnt(0)
    s_barrier
    s_lshr_b32 s60, s6, 3
    s_lshl_b32 s61, s5, 1
    s_add_u32 s60, s60, s61
    s_and_b32 s61, s6, 7
    v_lshrrev_b32 v6, 3, v1
    v_lshlrev_b32 v4, 10, v6
    v_lshrrev_b32 v7, 1, v1
    v_xor_b32 v6, v2, v7
    v_and_b32 v6, 3, v6
    v_lshl_add_u32 v4, v6, 5, v4
    v_and_b32 v6, 1, v1
    v_lshl_add_u32 v4, v6, 4, v4
    s_mov_b32 s40, s30
    s_mov_b32 s41, s31
    s_mov_b32 s42, 0x1c0000
    s_mov_b32 s43, 0x00020000
    s_add_u32 s44, s38, 0xc00000
    s_addc_u32 s45, s39, 0
    s_mov_b32 s46, 0x720000
    s_mov_b32 s47, 0x00020000
    s_mul_i32 s63, s60, 233472
    s_mul_i32 s62, s7, 14336
    s_add_u32 s63, s63, s62
    s_mul_i32 s64, s7, 458752
    s_lshl_b32 s62, s61, 7
    s_add_u32 s64, s64, s62
    s_lshl_b32 s65, s7, 12
    v_lshlrev_b32 v5, 4, v1
    s_barrier
    s_add_u32 s62, s64, 0
    s_add_u32 m0, s65, 0
    s_nop 0
    buffer_load_dwordx4 v4, s[40:43], s62 offen lds
    s_add_u32 s62, s64, 8192
    s_add_u32 m0, s65, 1024
    s_nop 0
    buffer_load_dwordx4 v4, s[40:43], s62 offen lds
    s_add_u32 s62, s64, 16384
    s_add_u32 m0, s65, 2048
    s_nop 0
    buffer_load_dwordx4 v4, s[40:43], s62 offen lds
    s_add_u32 s62, s64, 24576
    s_add_u32 m0, s65, 3072
    s_nop 0
    buffer_load_dwordx4 v4, s[40:43], s62 offen lds
    s_add_u32 s62, s64, 32768
    s_add_u32 m0, s65, 16384
    s_nop 0
    buffer_load_dwordx4 v4, s[40:43], s62 offen lds
    s_add_u32 s62, s64, 40960
    s_add_u32 m0, s65, 17408
    s_nop 0
    buffer_load_dwordx4 v4, s[40:43], s62 offen lds
    s_add_u32 s62, s64, 49152
    s_add_u32 m0, s65, 18432
    s_nop 0
    buffer_load_dwordx4 v4, s[40:43], s62 offen lds
    s_add_u32 s62, s64, 57344
    s_add_u32 m0, s65, 19456
    s_nop 0
    buffer_load_dwordx4 v4, s[40:43], s62 offen lds
    s_add_u32 s62, s64, 65536
    s_add_u32 m0, s65, 32768
    s_nop 0
    buffer_load_dwordx4 v4, s[40:43], s62 offen lds
    s_add_u32 s62, s64, 73728
    s_add_u32 m0, s65, 33792
    s_nop 0
    buffer_load_dwordx4 v4, s[40:43], s62 offen lds
    s_add_u32 s62, s64, 81920
    s_add_u32 m0, s65, 34816
    s_nop 0
    buffer_load_dwordx4 v4, s[40:43], s62 offen lds
    s_add_u32 s62, s64, 90112
    s_add_u32 m0, s65, 35840
    s_nop 0
    buffer_load_dwordx4 v4, s[40:43], s62 offen lds
    s_add_u32 s62, s64, 114688
    s_add_u32 m0, s65, 49152
    s_nop 0
    buffer_load_dwordx4 v4, s[40:43], s62 offen lds
    s_add_u32 s62, s64, 122880
    s_add_u32 m0, s65, 50176
    s_nop 0
    buffer_load_dwordx4 v4, s[40:43], s62 offen lds
    s_add_u32 s62, s64, 131072
    s_add_u32 m0, s65, 51200
    s_nop 0
    buffer_load_dwordx4 v4, s[40:43], s62 offen lds
    s_add_u32 s62, s64, 139264
    s_add_u32 m0, s65, 52224
    s_nop 0
    buffer_load_dwordx4 v4, s[40:43], s62 offen lds
    s_add_u32 s62, s64, 147456
    s_add_u32 m0, s65, 65536
    s_nop 0
    buffer_load_dwordx4 v4, s[40:43], s62 offen lds
    s_add_u32 s62, s64, 155648
    s_add_u32 m0, s65, 66560
    s_nop 0
    buffer_load_dwordx4 v4, s[40:43], s62 offen lds
    s_add_u32 s62, s64, 163840
    s_add_u32 m0, s65, 67584
    s_nop 0
    buffer_load_dwordx4 v4, s[40:43], s62 offen lds
    s_add_u32 s62, s64, 172032
    s_add_u32 m0, s65, 68608
    s_nop 0
    buffer_load_dwordx4 v4, s[40:43], s62 offen lds
    s_add_u32 s62, s64, 180224
    s_add_u32 m0, s65, 81920
    s_nop 0
    buffer_load_dwordx4 v4, s[40:43], s62 offen lds
    s_add_u32 s62, s64, 188416
    s_add_u32 m0, s65, 82944
    s_nop 0
    buffer_load_dwordx4 v4, s[40:43], s62 offen lds
    s_add_u32 s62, s64, 196608
    s_add_u32 m0, s65, 83968
    s_nop 0
    buffer_load_dwordx4 v4, s[40:43], s62 offen lds
    s_add_u32 s62, s64, 204800
    s_add_u32 m0, s65, 84992
    s_nop 0
    buffer_load_dwordx4 v4, s[40:43], s62 offen lds
    s_barrier
    s_lshl_b32 s67, s5, 8
    v_lshlrev_b32 v12, 4, v1
    v_add_u32 v12, s67, v12
    s_mov_b64 exec, 0xf
    s_mov_b32 s66, 0
Lpoll_24:
    buffer_load_dwordx4 v[8:11], v12, s[72:75], 0 offen sc1
    s_waitcnt vmcnt(0)
    v_min_u32 v8, v8, v9
    v_min_u32 v10, v10, v11
    v_min_u32 v8, v8, v10
    v_cmp_gt_u32 vcc, 4, v8
    s_add_u32 s66, s66, 1
    s_cmp_ge_u32 s66, 0x40000
    s_cbranch_scc1 Lpoll_24_x
    s_nop 3
    s_cmp_eq_u64 vcc, 0
    s_cbranch_scc1 Lpoll_24_x
    s_sleep 4
    s_branch Lpoll_24
Lpoll_24_x:
    s_mov_b64 exec, -1
    s_nop 7
    s_nop 7
    s_barrier
    s_add_u32 s62, s64, 98304
    s_add_u32 m0, s65, 98304
    s_nop 0
    buffer_load_dwordx4 v4, s[40:43], s62 offen lds
    s_add_u32 s62, s64, 106496
    s_add_u32 m0, s65, 99328
    s_nop 0
    buffer_load_dwordx4 v4, s[40:43], s62 offen lds
    s_add_u32 s62, s64, 212992
    s_add_u32 m0, s65, 100352
    s_nop 0
    buffer_load_dwordx4 v4, s[40:43], s62 offen lds
    s_add_u32 s62, s64, 221184
    s_add_u32 m0, s65, 101376
    s_nop 0
    buffer_load_dwordx4 v4, s[40:43], s62 offen lds
    s_add_u32 s62, s64, 229376
    s_add_u32 m0, s65, 114688
    s_nop 0
    buffer_load_dwordx4 v4, s[40:43], s62 offen lds
    s_add_u32 s62, s64, 237568
    s_add_u32 m0, s65, 115712
    s_nop 0
    buffer_load_dwordx4 v4, s[40:43], s62 offen lds
    s_add_u32 s62, s64, 245760
    s_add_u32 m0, s65, 116736
    s_nop 0
    buffer_load_dwordx4 v4, s[40:43], s62 offen lds
    s_add_u32 s62, s64, 253952
    s_add_u32 m0, s65, 117760
    s_nop 0
    buffer_load_dwordx4 v4, s[40:43], s62 offen lds
    s_add_u32 s62, s64, 262144
    s_add_u32 m0, s65, 131072
    s_nop 0
    buffer_load_dwordx4 v4, s[40:43], s62 offen lds
    s_add_u32 s62, s64, 270336
    s_add_u32 m0, s65, 132096
    s_nop 0
    buffer_load_dwordx4 v4, s[40:43], s62 offen lds
    s_add_u32 s62, s64, 278528
    s_add_u32 m0, s65, 133120
    s_nop 0
    buffer_load_dwordx4 v4, s[40:43], s62 offen lds
    s_add_u32 s62, s64, 286720
    s_add_u32 m0, s65, 134144
    s_nop 0
    buffer_load_dwordx4 v4, s[40:43], s62 offen lds
    s_barrier
    s_barrier
    s_add_u32 s62, s64, 294912
    s_add_u32 m0, s65, 0
    s_nop 0
    buffer_load_dwordx4 v4, s[40:43], s62 offen lds
    s_add_u32 s62, s64, 303104
    s_add_u32 m0, s65, 1024
    s_nop 0
    buffer_load_dwordx4 v4, s[40:43], s62 offen lds
    s_add_u32 s62, s64, 311296
    s_add_u32 m0, s65, 2048
    s_nop 0
    buffer_load_dwordx4 v4, s[40:43], s62 offen lds
    s_add_u32 s62, s64, 319488
    s_add_u32 m0, s65, 3072
    s_nop 0
    buffer_load_dwordx4 v4, s[40:43], s62 offen lds
    s_barrier
    s_add_u32 s62, s64, 344064
    s_add_u32 m0, s65, 16384
    s_nop 0
    buffer_load_dwordx4 v4, s[40:43], s62 offen lds
    s_add_u32 s62, s64, 352256
    s_add_u32 m0, s65, 17408
    s_nop 0
    buffer_load_dwordx4 v4, s[40:43], s62 offen lds
    s_add_u32 s62, s64, 360448
    s_add_u32 m0, s65, 18432
    s_nop 0
    buffer_load_dwordx4 v4, s[40:43], s62 offen lds
    s_add_u32 s62, s64, 368640
    s_add_u32 m0, s65, 19456
    s_nop 0
    buffer_load_dwordx4 v4, s[40:43], s62 offen lds
    s_barrier
    s_add_u32 s62, s64, 376832
    s_add_u32 m0, s65, 32768
    s_nop 0
    buffer_load_dwordx4 v4, s[40:43], s62 offen lds
    s_add_u32 s62, s64, 385024
    s_add_u32 m0, s65, 33792
    s_nop 0
    buffer_load_dwordx4 v4, s[40:43], s62 offen lds
    s_add_u32 s62, s64, 393216
    s_add_u32 m0, s65, 34816
    s_nop 0
    buffer_load_dwordx4 v4, s[40:43], s62 offen lds
    s_add_u32 s62, s64, 401408
    s_add_u32 m0, s65, 35840
    s_nop 0
    buffer_load_dwordx4 v4, s[40:43], s62 offen lds
    s_barrier
    s_add_u32 s62, s64, 409600
    s_add_u32 m0, s65, 49152
    s_nop 0
    buffer_load_dwordx4 v4, s[40:43], s62 offen lds
    s_add_u32 s62, s64, 417792
    s_add_u32 m0, s65, 50176
    s_nop 0
    buffer_load_dwordx4 v4, s[40:43], s62 offen lds
    s_add_u32 s62, s64, 425984
    s_add_u32 m0, s65, 51200
    s_nop 0
    buffer_load_dwordx4 v4, s[40:43], s62 offen lds
    s_add_u32 s62, s64, 434176
    s_add_u32 m0, s65, 52224
    s_nop 0
    buffer_load_dwordx4 v4, s[40:43], s62 offen lds
    s_barrier
    s_add_u32 s62, s64, 327680
    s_add_u32 m0, s65, 65536
    s_nop 0
    buffer_load_dwordx4 v4, s[40:43], s62 offen lds
    s_add_u32 s62, s64, 335872
    s_add_u32 m0, s65, 66560
    s_nop 0
    buffer_load_dwordx4 v4, s[40:43], s62 offen lds
    s_add_u32 s62, s64, 442368
    s_add_u32 m0, s65, 67584
    s_nop 0
    buffer_load_dwordx4 v4, s[40:43], s62 offen lds
    s_add_u32 s62, s64, 450560
    s_add_u32 m0, s65, 68608
    s_nop 0
    buffer_load_dwordx4 v4, s[40:43], s62 offen lds
    s_waitcnt vmcnt(28)
    s_barrier
    s_waitcnt vmcnt(24)
    s_barrier
    s_waitcnt vmcnt(20)
    s_barrier
    s_waitcnt vmcnt(16)
    s_barrier
    s_waitcnt vmcnt(12)
    s_barrier
    s_waitcnt vmcnt(8)
    s_barrier
    s_waitcnt vmcnt(4)
    s_barrier
    s_waitcnt vmcnt(0)
    s_barrier
    s_lshl_b32 s60, s5, 2
    s_add_u32 s60, s60, s7
    s_lshl_b32 s60, s60, 15
    s_lshl_b32 s63, s7, 10
    s_lshl_b32 s64, s7, 12
    s_mul_i32 s61, s6, 98304
    s_add_u32 s61, s61, s63
    s_add_u32 s40, s38, 0x800000
    s_addc_u32 s41, s39, 0
    s_mov_b32 s42, 0x200000
    s_mov_b32 s43, 0x00020000
    s_add_u32 s44, s38, 0x1600000
    s_addc_u32 s45, s39, 0
    s_mov_b32 s46, 0x180000
    s_mov_b32 s47, 0x00020000
    v_lshlrev_b32 v4, 4, v1
    s_barrier
    s_add_u32 s62, s61, 0
    s_add_u32 m0, s63, 0
    s_nop 0
    buffer_load_dwordx4 v4, s[44:47], s62 offen lds
    s_add_u32 s62, s61, 4096
    s_add_u32 m0, s63, 4096
    s_nop 0
    buffer_load_dwordx4 v4, s[44:47], s62 offen lds
    s_add_u32 s62, s61, 8192
    s_add_u32 m0, s63, 8192
    s_nop 0
    buffer_load_dwordx4 v4, s[44:47], s62 offen lds
    s_add_u32 s62, s61, 12288
    s_add_u32 m0, s63, 12288
    s_nop 0
    buffer_load_dwordx4 v4, s[44:47], s62 offen lds
    s_add_u32 s62, s61, 16384
    s_add_u32 m0, s63, 16384
    s_nop 0
    buffer_load_dwordx4 v4, s[44:47], s62 offen lds
    s_add_u32 s62, s61, 20480
    s_add_u32 m0, s63, 20480
    s_nop 0
    buffer_load_dwordx4 v4, s[44:47], s62 offen lds
    s_add_u32 s62, s61, 24576
    s_add_u32 m0, s63, 24576
    s_nop 0
    buffer_load_dwordx4 v4, s[44:47], s62 offen lds
    s_add_u32 s62, s61, 28672
    s_add_u32 m0, s63, 28672
    s_nop 0
    buffer_load_dwordx4 v4, s[44:47], s62 offen lds
    s_add_u32 s62, s61, 32768
    s_add_u32 m0, s63, 32768
    s_nop 0
    buffer_load_dwordx4 v4, s[44:47], s62 offen lds
    s_add_u32 s62, s61, 36864
    s_add_u32 m0, s63, 36864
    s_nop 0
    buffer_load_dwordx4 v4, s[44:47], s62 offen lds
    s_add_u32 s62, s61, 40960
    s_add_u32 m0, s63, 40960
    s_nop 0
    buffer_load_dwordx4 v4, s[44:47], s62 offen lds
    s_add_u32 s62, s61, 45056
    s_add_u32 m0, s63, 45056
    s_nop 0
    buffer_load_dwordx4 v4, s[44:47], s62 offen lds
    s_add_u32 s62, s61, 49152
    s_add_u32 m0, s63, 49152
    s_nop 0
    buffer_load_dwordx4 v4, s[44:47], s62 offen lds
    s_add_u32 s62, s61, 53248
    s_add_u32 m0, s63, 53248
    s_nop 0
    buffer_load_dwordx4 v4, s[44:47], s62 offen lds
    s_add_u32 s62, s61, 57344
    s_add_u32 m0, s63, 57344
    s_nop 0
    buffer_load_dwordx4 v4, s[44:47], s62 offen lds
    s_add_u32 s62, s61, 61440
    s_add_u32 m0, s63, 61440
    s_nop 0
    buffer_load_dwordx4 v4, s[44:47], s62 offen lds
    s_add_u32 s62, s61, 65536
    s_add_u32 m0, s63, 65536
    s_nop 0
    buffer_load_dwordx4 v4, s[44:47], s62 offen lds
    s_add_u32 s62, s61, 69632
    s_add_u32 m0, s63, 69632
    s_nop 0
    buffer_load_dwordx4 v4, s[44:47], s62 offen lds
    s_add_u32 s62, s61, 73728
    s_add_u32 m0, s63, 73728
    s_nop 0
    buffer_load_dwordx4 v4, s[44:47], s62 offen lds
    s_add_u32 s62, s61, 77824
    s_add_u32 m0, s63, 77824
    s_nop 0
    buffer_load_dwordx4 v4, s[44:47], s62 offen lds
    s_add_u32 s62, s61, 81920
    s_add_u32 m0, s63, 81920
    s_nop 0
    buffer_load_dwordx4 v4, s[44:47], s62 offen lds
    s_barrier
    s_barrier
    s_lshl_b32 s67, s5, 8
    v_lshlrev_b32 v12, 4, v1
    v_add_u32 v12, s67, v12
    s_mov_b64 exec, 0xf
    s_mov_b32 s66, 0
Lpoll_25:
    buffer_load_dwordx4 v[8:11], v12, s[72:75], 0 offen sc1
    s_waitcnt vmcnt(0)
    v_min_u32 v8, v8, v9
    v_min_u32 v10, v10, v11
    v_min_u32 v8, v8, v10
    v_cmp_gt_u32 vcc, 5, v8
    s_add_u32 s66, s66, 1
    s_cmp_ge_u32 s66, 0x40000
    s_cbranch_scc1 Lpoll_25_x
    s_nop 3
    s_cmp_eq_u64 vcc, 0
    s_cbranch_scc1 Lpoll_25_x
    s_sleep 4
    s_branch Lpoll_25
Lpoll_25_x:
    s_mov_b64 exec, -1
    s_nop 7
    s_nop 7
    s_add_u32 s62, s60, 0
    s_add_u32 m0, s64, 86016
    s_nop 0
    buffer_load_dwordx4 v4, s[40:43], s62 offen sc1 lds
    s_add_u32 s62, s60, 1024
    s_add_u32 m0, s64, 87040
    s_nop 0
    buffer_load_dwordx4 v4, s[40:43], s62 offen sc1 lds
    s_add_u32 s62, s60, 16384
    s_add_u32 m0, s64, 88064
    s_nop 0
    buffer_load_dwordx4 v4, s[40:43], s62 offen sc1 lds
    s_add_u32 s62, s60, 17408
    s_add_u32 m0, s64, 89088
    s_nop 0
    buffer_load_dwordx4 v4, s[40:43], s62 offen sc1 lds
    s_add_u32 s62, s60, 2048
    s_add_u32 m0, s64, 102400
    s_nop 0
    buffer_load_dwordx4 v4, s[40:43], s62 offen sc1 lds
    s_add_u32 s62, s60, 3072
    s_add_u32 m0, s64, 103424
    s_nop 0
    buffer_load_dwordx4 v4, s[40:43], s62 offen sc1 lds
    s_add_u32 s62, s60, 18432
    s_add_u32 m0, s64, 104448
    s_nop 0
    buffer_load_dwordx4 v4, s[40:43], s62 offen sc1 lds
    s_add_u32 s62, s60, 19456
    s_add_u32 m0, s64, 105472
    s_nop 0
    buffer_load_dwordx4 v4, s[40:43], s62 offen sc1 lds
    s_add_u32 s62, s60, 4096
    s_add_u32 m0, s64, 118784
    s_nop 0
    buffer_load_dwordx4 v4, s[40:43], s62 offen sc1 lds
    s_add_u32 s62, s60, 5120
    s_add_u32 m0, s64, 119808
    s_nop 0
    buffer_load_dwordx4 v4, s[40:43], s62 offen sc1 lds
    s_add_u32 s62, s60, 20480
    s_add_u32 m0, s64, 120832
    s_nop 0
    buffer_load_dwordx4 v4, s[40:43], s62 offen sc1 lds
    s_add_u32 s62, s60, 21504
    s_add_u32 m0, s64, 121856
    s_nop 0
    buffer_load_dwordx4 v4, s[40:43], s62 offen sc1 lds
    s_add_u32 s48, s38, 0x14c0000
    s_addc_u32 s49, s39, 0
    s_mov_b32 s50, 0x20000
    s_mov_b32 s51, 0x00020000
    v_and_b32 v14, 31, v1
    v_lshlrev_b32 v32, 6, v14
    s_lshl_b32 s62, s5, 2
    s_add_u32 s62, s62, s7
    s_lshl_b32 s62, s62, 11
    buffer_load_dwordx4 v[16:19], v32, s[48:51], s62 offen offset:0 sc1
    buffer_load_dwordx4 v[20:23], v32, s[48:51], s62 offen offset:16 sc1
    buffer_load_dwordx4 v[24:27], v32, s[48:51], s62 offen offset:32 sc1
    buffer_load_dwordx4 v[28:31], v32, s[48:51], s62 offen offset:48 sc1
    s_waitcnt vmcnt(12)
    s_barrier
    s_add_u32 s62, s60, 6144
    s_add_u32 m0, s64, 135168
    s_nop 0
    buffer_load_dwordx4 v4, s[40:43], s62 offen sc1 lds
    s_add_u32 s62, s60, 7168
    s_add_u32 m0, s64, 136192
    s_nop 0
    buffer_load_dwordx4 v4, s[40:43], s62 offen sc1 lds
    s_add_u32 s62, s60, 22528
    s_add_u32 m0, s64, 137216
    s_nop 0
    buffer_load_dwordx4 v4, s[40:43], s62 offen sc1 lds
    s_add_u32 s62, s60, 23552
    s_add_u32 m0, s64, 138240
    s_nop 0
    buffer_load_dwordx4 v4, s[40:43], s62 offen sc1 lds
    s_waitcnt vmcnt(12)
    s_barrier
    s_add_u32 s62, s60, 8192
    s_add_u32 m0, s64, 86016
    s_nop 0
    buffer_load_dwordx4 v4, s[40:43], s62 offen sc1 lds
    s_add_u32 s62, s60, 9216
    s_add_u32 m0, s64, 87040
    s_nop 0
    buffer_load_dwordx4 v4, s[40:43], s62 offen sc1 lds
    s_add_u32 s62, s60, 24576
    s_add_u32 m0, s64, 88064
    s_nop 0
    buffer_load_dwordx4 v4, s[40:43], s62 offen sc1 lds
    s_add_u32 s62, s60, 25600
    s_add_u32 m0, s64, 89088
    s_nop 0
    buffer_load_dwordx4 v4, s[40:43], s62 offen sc1 lds
    s_waitcnt vmcnt(8)
    v_pk_add_f32 v[16:17], v[16:17], v[18:19]
    v_pk_add_f32 v[16:17], v[16:17], v[20:21]
    v_pk_add_f32 v[16:17], v[16:17], v[22:23]
    v_pk_add_f32 v[16:17], v[16:17], v[24:25]
    v_pk_add_f32 v[16:17], v[16:17], v[26:27]
    v_pk_add_f32 v[16:17], v[16:17], v[28:29]
    v_pk_add_f32 v[16:17], v[16:17], v[30:31]
    v_mul_f32 v16, 0x3b000000, v16
    v_mul_f32 v17, 0x3b000000, v17
    v_fma_f32 v17, -v16, v16, v17
    v_max_f32 v17, 0, v17
    v_mov_b32 v33, v17
    v_cvt_pk_bf16_f32 v32, v33, v33
    v_lshlrev_b32 v33, 16, v32
    v_add_f32 v33, 0x3727c5ac, v33
    v_cvt_pk_bf16_f32 v32, v33, v33
    v_lshlrev_b32 v33, 16, v32
    v_sqrt_f32 v33, v33
    s_nop 0
    v_cvt_pk_bf16_f32 v32, v33, v33
    v_lshlrev_b32 v33, 16, v32
    v_cvt_pk_bf16_f32 v32, v16, v16
    v_lshlrev_b32 v32, 16, v32
    v_rcp_f32 v17, v33
    s_nop 0
    v_mul_f32 v16, -v32, v17
    s_lshl_b32 s62, s7, 8
    s_add_u32 s62, s62, 161792
    v_lshlrev_b32 v14, 3, v14
    v_add_u32 v14, s62, v14
    ds_write_b64 v14, v[16:17]
    s_waitcnt lgkmcnt(0)
    s_barrier
    s_add_u32 s62, s60, 10240
    s_add_u32 m0, s64, 102400
    s_nop 0
    buffer_load_dwordx4 v4, s[40:43], s62 offen sc1 lds
    s_add_u32 s62, s60, 11264
    s_add_u32 m0, s64, 103424
    s_nop 0
    buffer_load_dwordx4 v4, s[40:43], s62 offen sc1 lds
    s_add_u32 s62, s60, 26624
    s_add_u32 m0, s64, 104448
    s_nop 0
    buffer_load_dwordx4 v4, s[40:43], s62 offen sc1 lds
    s_add_u32 s62, s60, 27648
    s_add_u32 m0, s64, 105472
    s_nop 0
    buffer_load_dwordx4 v4, s[40:43], s62 offen sc1 lds
    s_waitcnt vmcnt(8)
    s_barrier
    s_add_u32 s62, s60, 12288
    s_add_u32 m0, s64, 118784
    s_nop 0
    buffer_load_dwordx4 v4, s[40:43], s62 offen sc1 lds
    s_add_u32 s62, s60, 13312
    s_add_u32 m0, s64, 119808
    s_nop 0
    buffer_load_dwordx4 v4, s[40:43], s62 offen sc1 lds
    s_add_u32 s62, s60, 28672
    s_add_u32 m0, s64, 120832
    s_nop 0
    buffer_load_dwordx4 v4, s[40:43], s62 offen sc1 lds
    s_add_u32 s62, s60, 29696
    s_add_u32 m0, s64, 121856
    s_nop 0
    buffer_load_dwordx4 v4, s[40:43], s62 offen sc1 lds
    s_waitcnt vmcnt(8)
    s_barrier
    s_add_u32 s62, s61, 86016
    s_add_u32 m0, s63, 0
    s_nop 0
    buffer_load_dwordx4 v4, s[44:47], s62 offen lds
    s_add_u32 s62, s61, 90112
    s_add_u32 m0, s63, 4096
    s_nop 0
    buffer_load_dwordx4 v4, s[44:47], s62 offen lds
    s_add_u32 s62, s61, 94208
    s_add_u32 m0, s63, 8192
    s_nop 0
    buffer_load_dwordx4 v4, s[44:47], s62 offen lds
    s_add_u32 s62, s60, 14336
    s_add_u32 m0, s64, 135168
    s_nop 0
    buffer_load_dwordx4 v4, s[40:43], s62 offen sc1 lds
    s_add_u32 s62, s60, 15360
    s_add_u32 m0, s64, 136192
    s_nop 0
    buffer_load_dwordx4 v4, s[40:43], s62 offen sc1 lds
    s_add_u32 s62, s60, 30720
    s_add_u32 m0, s64, 137216
    s_nop 0
    buffer_load_dwordx4 v4, s[40:43], s62 offen sc1 lds
    s_add_u32 s62, s60, 31744
    s_add_u32 m0, s64, 138240
    s_nop 0
    buffer_load_dwordx4 v4, s[40:43], s62 offen sc1 lds
    s_waitcnt vmcnt(11)
    s_barrier
    s_waitcnt vmcnt(7)
    s_barrier
    s_waitcnt vmcnt(0)
    s_barrier
    s_lshr_b32 s60, s6, 3
    s_lshl_b32 s61, s5, 1
    s_add_u32 s60, s60, s61
    s_and_b32 s61, s6, 7
    v_lshrrev_b32 v7, 3, v1
    v_lshlrev_b32 v4, 10, v7
    v_lshrrev_b32 v14, 1, v1
    v_xor_b32 v7, v2, v14
    v_and_b32 v7, 3, v7
    v_lshl_add_u32 v4, v7, 5, v4
    v_and_b32 v7, 1, v1
    v_lshl_add_u32 v4, v7, 4, v4
    v_lshrrev_b32 v7, 3, v1
    v_and_b32 v14, 7, v1
    v_xor_b32 v14, v14, v7
    v_lshlrev_b32 v6, 7, v7
    v_lshl_add_u32 v6, v14, 4, v6
    s_mov_b32 s40, s22
    s_mov_b32 s41, s23
    s_mov_b32 s42, 0x80000
    s_mov_b32 s43, 0x00020000
    s_mov_b32 s44, s38
    s_mov_b32 s45, s39
    s_mov_b32 s46, 0x420000
    s_mov_b32 s47, 0x00020000
    s_add_u32 s48, s38, 0x1411000
    s_addc_u32 s49, s39, 0
    s_mov_b32 s50, 0x11000
    s_mov_b32 s51, 0x00020000
    s_mul_i32 s63, s60, 135168
    s_lshl_b32 s62, s7, 13
    s_add_u32 s63, s63, s62
    s_mul_i32 s64, s7, 17408
    s_lshl_b32 s65, s7, 17
    s_lshl_b32 s62, s61, 7
    s_add_u32 s65, s65, s62
    s_lshl_b32 s68, s7, 11
    s_lshl_b32 s69, s7, 11
    v_lshrrev_b32 v7, 3, v1
    v_mul_u32_u24 v15, 2176, v7
    v_and_b32 v7, 7, v1
    v_lshl_add_u32 v15, v7, 4, v15
    v_lshlrev_b32 v5, 4, v1
    s_barrier
    s_add_u32 s62, s65, 0
    s_add_u32 m0, s69, 0
    s_nop 0
    buffer_load_dwordx4 v4, s[40:43], s62 offen lds
    s_add_u32 s62, s65, 8192
    s_add_u32 m0, s69, 1024
    s_nop 0
    buffer_load_dwordx4 v4, s[40:43], s62 offen lds
    s_add_u32 s62, s65, 16384
    s_add_u32 m0, s69, 8192
    s_nop 0
    buffer_load_dwordx4 v4, s[40:43], s62 offen lds
    s_add_u32 s62, s65, 24576
    s_add_u32 m0, s69, 9216
    s_nop 0
    buffer_load_dwordx4 v4, s[40:43], s62 offen lds
    s_add_u32 s62, s65, 32768
    s_add_u32 m0, s69, 16384
    s_nop 0
    buffer_load_dwordx4 v4, s[40:43], s62 offen lds
    s_add_u32 s62, s65, 40960
    s_add_u32 m0, s69, 17408
    s_nop 0
    buffer_load_dwordx4 v4, s[40:43], s62 offen lds
    s_add_u32 s62, s65, 49152
    s_add_u32 m0, s69, 24576
    s_nop 0
    buffer_load_dwordx4 v4, s[40:43], s62 offen lds
    s_add_u32 s62, s65, 57344
    s_add_u32 m0, s69, 25600
    s_nop 0
    buffer_load_dwordx4 v4, s[40:43], s62 offen lds
    s_add_u32 s62, s65, 65536
    s_add_u32 m0, s69, 32768
    s_nop 0
    buffer_load_dwordx4 v4, s[40:43], s62 offen lds
    s_add_u32 s62, s65, 73728
    s_add_u32 m0, s69, 33792
    s_nop 0
    buffer_load_dwordx4 v4, s[40:43], s62 offen lds
    s_add_u32 s62, s65, 81920
    s_add_u32 m0, s69, 40960
    s_nop 0
    buffer_load_dwordx4 v4, s[40:43], s62 offen lds
    s_add_u32 s62, s65, 90112
    s_add_u32 m0, s69, 41984
    s_nop 0
    buffer_load_dwordx4 v4, s[40:43], s62 offen lds
    s_add_u32 s62, s65, 98304
    s_add_u32 m0, s69, 49152
    s_nop 0
    buffer_load_dwordx4 v4, s[40:43], s62 offen lds
    s_add_u32 s62, s65, 106496
    s_add_u32 m0, s69, 50176
    s_nop 0
    buffer_load_dwordx4 v4, s[40:43], s62 offen lds
    s_add_u32 s62, s65, 114688
    s_add_u32 m0, s69, 57344
    s_nop 0
    buffer_load_dwordx4 v4, s[40:43], s62 offen lds
    s_add_u32 s62, s65, 122880
    s_add_u32 m0, s69, 58368
    s_nop 0
    buffer_load_dwordx4 v4, s[40:43], s62 offen lds
    s_barrier
    s_barrier
    v_mov_b32 v13, 163776
    s_mov_b32 s66, 0
    s_cmp_lg_u32 s4, 8
    s_cbranch_scc1 Lpw_26
    s_lshl_b32 s67, s5, 8
    v_lshlrev_b32 v12, 4, v1
    v_add_u32 v12, s67, v12
    s_mov_b64 exec, 0xf
    s_mov_b32 s66, 0
Lpoll_28:
    buffer_load_dwordx4 v[8:11], v12, s[72:75], 0 offen sc1
    s_waitcnt vmcnt(0)
    v_min_u32 v8, v8, v9
    v_min_u32 v10, v10, v11
    v_min_u32 v8, v8, v10
    v_cmp_gt_u32 vcc, 6, v8
    s_add_u32 s66, s66, 1
    s_cmp_ge_u32 s66, 0x40000
    s_cbranch_scc1 Lpoll_28_x
    s_nop 3
    s_cmp_eq_u64 vcc, 0
    s_cbranch_scc1 Lpoll_28_x
    s_sleep 4
    s_branch Lpoll_28
Lpoll_28_x:
    s_mov_b64 exec, -1
    s_nop 7
    s_nop 7
    s_lshl_b32 s67, s6, 8
    s_add_u32 s67, s67, 4096
    s_lshl_b32 s66, s5, 2
    s_add_u32 s66, s66, s67
    v_mov_b32 v8, 6
    v_mov_b32 v9, 0
    s_mov_b64 exec, 1
    buffer_store_dword v8, v9, s[72:75], s66 offen sc1
    s_mov_b64 exec, -1
    s_nop 1
    v_lshlrev_b32 v12, 4, v1
    v_add_u32 v12, s67, v12
    s_mov_b64 exec, 0xf
    s_mov_b32 s66, 0
Lpoll_29:
    buffer_load_dwordx4 v[8:11], v12, s[72:75], 0 offen sc1
    s_waitcnt vmcnt(0)
    v_min_u32 v8, v8, v9
    v_min_u32 v10, v10, v11
    v_min_u32 v8, v8, v10
    v_cmp_gt_u32 vcc, 6, v8
    s_add_u32 s66, s66, 1
    s_cmp_ge_u32 s66, 0x40000
    s_cbranch_scc1 Lpoll_29_x
    s_nop 3
    s_cmp_eq_u64 vcc, 0
    s_cbranch_scc1 Lpoll_29_x
    s_sleep 4
    s_branch Lpoll_29
Lpoll_29_x:
    s_mov_b64 exec, -1
    s_nop 7
    s_nop 7
    v_mov_b32 v8, 6
    ds_write_b32 v13, v8
    s_waitcnt lgkmcnt(0)
    s_branch Lpx_27
Lpw_26:
    ds_read_b32 v8, v13
    s_waitcnt lgkmcnt(0)
    v_readfirstlane_b32 s67, v8
    s_add_u32 s66, s66, 1
    s_cmp_ge_u32 s66, 0x400000
    s_cbranch_scc1 Lpx_27
    s_cmp_eq_u32 s67, 6
    s_cbranch_scc1 Lpx_27
    s_sleep 1
    s_branch Lpw_26
Lpx_27:
    s_nop 7
    s_nop 7
    s_barrier
    s_add_u32 s62, s64, 2048
    s_lshl_b32 m0, s7, 10
    s_add_u32 m0, m0, 106496
    s_nop 0
    buffer_load_dwordx4 v15, s[48:51], s62 offen sc1 lds
    s_add_u32 s62, s64, 0
    s_add_u32 m0, s68, 65536
    s_nop 0
    buffer_load_dwordx4 v6, s[48:51], s62 offen sc1 lds
    s_add_u32 s62, s64, 1024
    s_add_u32 m0, s68, 66560
    s_nop 0
    buffer_load_dwordx4 v6, s[48:51], s62 offen sc1 lds
    s_add_u32 s62, s64, 2176
    s_add_u32 m0, s68, 73728
    s_nop 0
    buffer_load_dwordx4 v6, s[48:51], s62 offen sc1 lds
    s_add_u32 s62, s64, 3200
    s_add_u32 m0, s68, 74752
    s_nop 0
    buffer_load_dwordx4 v6, s[48:51], s62 offen sc1 lds
    s_add_u32 s62, s64, 4352
    s_add_u32 m0, s68, 81920
    s_nop 0
    buffer_load_dwordx4 v6, s[48:51], s62 offen sc1 lds
    s_add_u32 s62, s64, 5376
    s_add_u32 m0, s68, 82944
    s_nop 0
    buffer_load_dwordx4 v6, s[48:51], s62 offen sc1 lds
    s_add_u32 s62, s64, 6528
    s_add_u32 m0, s68, 90112
    s_nop 0
    buffer_load_dwordx4 v6, s[48:51], s62 offen sc1 lds
    s_add_u32 s62, s64, 7552
    s_add_u32 m0, s68, 91136
    s_nop 0
    buffer_load_dwordx4 v6, s[48:51], s62 offen sc1 lds
    s_waitcnt vmcnt(6)
    s_barrier
    s_add_u32 s62, s64, 8704
    s_add_u32 m0, s68, 98304
    s_nop 0
    buffer_load_dwordx4 v6, s[48:51], s62 offen sc1 lds
    s_add_u32 s62, s64, 9728
    s_add_u32 m0, s68, 99328
    s_nop 0
    buffer_load_dwordx4 v6, s[48:51], s62 offen sc1 lds
    s_waitcnt vmcnt(6)
    s_barrier
    s_add_u32 s62, s64, 10880
    s_add_u32 m0, s68, 65536
    s_nop 0
    buffer_load_dwordx4 v6, s[48:51], s62 offen sc1 lds
    s_add_u32 s62, s64, 11904
    s_add_u32 m0, s68, 66560
    s_nop 0
    buffer_load_dwordx4 v6, s[48:51], s62 offen sc1 lds
    s_waitcnt vmcnt(6)
    s_barrier
    s_add_u32 s62, s64, 13056
    s_add_u32 m0, s68, 73728
    s_nop 0
    buffer_load_dwordx4 v6, s[48:51], s62 offen sc1 lds
    s_add_u32 s62, s64, 14080
    s_add_u32 m0, s68, 74752
    s_nop 0
    buffer_load_dwordx4 v6, s[48:51], s62 offen sc1 lds
    s_waitcnt vmcnt(6)
    s_barrier
    s_add_u32 s62, s64, 15232
    s_add_u32 m0, s68, 81920
    s_nop 0
    buffer_load_dwordx4 v6, s[48:51], s62 offen sc1 lds
    s_add_u32 s62, s64, 16256
    s_add_u32 m0, s68, 82944
    s_nop 0
    buffer_load_dwordx4 v6, s[48:51], s62 offen sc1 lds
    s_waitcnt vmcnt(6)
    s_barrier
    s_waitcnt vmcnt(4)
    s_barrier
    s_waitcnt vmcnt(2)
    s_barrier
    s_waitcnt vmcnt(0)
    s_barrier
    s_lshl_b32 s60, s5, 2
    s_add_u32 s60, s60, s7
    s_lshl_b32 s60, s60, 15
    s_lshl_b32 s63, s7, 10
    s_lshl_b32 s64, s7, 12
    s_mul_i32 s61, s6, 114688
    s_add_u32 s61, s61, s63
    s_add_u32 s40, s38, 0x600000
    s_addc_u32 s41, s39, 0
    s_mov_b32 s42, 0x200000
    s_mov_b32 s43, 0x00020000
    s_add_u32 s44, s38, 0x1800000
    s_addc_u32 s45, s39, 0
    s_mov_b32 s46, 0x1c0000
    s_mov_b32 s47, 0x00020000
    v_lshlrev_b32 v4, 4, v1
    s_barrier
    s_cmp_ge_u32 s7, 2
    s_cbranch_scc1 Lls_30
    s_add_u32 s62, s61, 12288
    s_add_u32 m0, s63, 12288
    s_nop 0
    buffer_load_dwordx4 v4, s[44:47], s62 offen lds
Lls_30:
    s_add_u32 s62, s61, 0
    s_add_u32 m0, s63, 0
    s_nop 0
    buffer_load_dwordx4 v4, s[44:47], s62 offen lds
    s_add_u32 s62, s61, 4096
    s_add_u32 m0, s63, 4096
    s_nop 0
    buffer_load_dwordx4 v4, s[44:47], s62 offen lds
    s_add_u32 s62, s61, 8192
    s_add_u32 m0, s63, 8192
    s_nop 0
    buffer_load_dwordx4 v4, s[44:47], s62 offen lds
    s_cmp_ge_u32 s7, 2
    s_cbranch_scc1 Lls_31
    s_add_u32 s62, s61, 26624
    s_add_u32 m0, s63, 26624
    s_nop 0
    buffer_load_dwordx4 v4, s[44:47], s62 offen lds
Lls_31:
    s_add_u32 s62, s61, 14336
    s_add_u32 m0, s63, 14336
    s_nop 0
    buffer_load_dwordx4 v4, s[44:47], s62 offen lds
    s_add_u32 s62, s61, 18432
    s_add_u32 m0, s63, 18432
    s_nop 0
    buffer_load_dwordx4 v4, s[44:47], s62 offen lds
    s_add_u32 s62, s61, 22528
    s_add_u32 m0, s63, 22528
    s_nop 0
    buffer_load_dwordx4 v4, s[44:47], s62 offen lds
    s_cmp_ge_u32 s7, 2
    s_cbranch_scc1 Lls_32
    s_add_u32 s62, s61, 40960
    s_add_u32 m0, s63, 40960
    s_nop 0
    buffer_load_dwordx4 v4, s[44:47], s62 offen lds
Lls_32:
    s_add_u32 s62, s61, 28672
    s_add_u32 m0, s63, 28672
    s_nop 0
    buffer_load_dwordx4 v4, s[44:47], s62 offen lds
    s_add_u32 s62, s61, 32768
    s_add_u32 m0, s63, 32768
    s_nop 0
    buffer_load_dwordx4 v4, s[44:47], s62 offen lds
    s_add_u32 s62, s61, 36864
    s_add_u32 m0, s63, 36864
    s_nop 0
    buffer_load_dwordx4 v4, s[44:47], s62 offen lds
    s_cmp_ge_u32 s7, 2
    s_cbranch_scc1 Lls_33
    s_add_u32 s62, s61, 55296
    s_add_u32 m0, s63, 55296
    s_nop 0
    buffer_load_dwordx4 v4, s[44:47], s62 offen lds
Lls_33:
    s_add_u32 s62, s61, 43008
    s_add_u32 m0, s63, 43008
    s_nop 0
    buffer_load_dwordx4 v4, s[44:47], s62 offen lds
    s_add_u32 s62, s61, 47104
    s_add_u32 m0, s63, 47104
    s_nop 0
    buffer_load_dwordx4 v4, s[44:47], s62 offen lds
    s_add_u32 s62, s61, 51200
    s_add_u32 m0, s63, 51200
    s_nop 0
    buffer_load_dwordx4 v4, s[44:47], s62 offen lds
    s_barrier
    s_barrier
    s_lshl_b32 s67, s5, 8
    v_lshlrev_b32 v12, 4, v1
    v_add_u32 v12, s67, v12
    s_mov_b64 exec, 0xf
    s_mov_b32 s66, 0
Lpoll_34:
    buffer_load_dwordx4 v[8:11], v12, s[72:75], 0 offen sc1
    s_waitcnt vmcnt(0)
    v_min_u32 v8, v8, v9
    v_min_u32 v10, v10, v11
    v_min_u32 v8, v8, v10
    v_cmp_gt_u32 vcc, 7, v8
    s_add_u32 s66, s66, 1
    s_cmp_ge_u32 s66, 0x40000
    s_cbranch_scc1 Lpoll_34_x
    s_nop 3
    s_cmp_eq_u64 vcc, 0
    s_cbranch_scc1 Lpoll_34_x
    s_sleep 4
    s_branch Lpoll_34
Lpoll_34_x:
    s_mov_b64 exec, -1
    s_nop 7
    s_nop 7
    s_add_u32 s62, s60, 0
    s_add_u32 m0, s64, 86016
    s_nop 0
    buffer_load_dwordx4 v4, s[40:43], s62 offen sc1 lds
    s_add_u32 s62, s60, 1024
    s_add_u32 m0, s64, 87040
    s_nop 0
    buffer_load_dwordx4 v4, s[40:43], s62 offen sc1 lds
    s_add_u32 s62, s60, 16384
    s_add_u32 m0, s64, 88064
    s_nop 0
    buffer_load_dwordx4 v4, s[40:43], s62 offen sc1 lds
    s_add_u32 s62, s60, 17408
    s_add_u32 m0, s64, 89088
    s_nop 0
    buffer_load_dwordx4 v4, s[40:43], s62 offen sc1 lds
    s_add_u32 s62, s60, 2048
    s_add_u32 m0, s64, 102400
    s_nop 0
    buffer_load_dwordx4 v4, s[40:43], s62 offen sc1 lds
    s_add_u32 s62, s60, 3072
    s_add_u32 m0, s64, 103424
    s_nop 0
    buffer_load_dwordx4 v4, s[40:43], s62 offen sc1 lds
    s_add_u32 s62, s60, 18432
    s_add_u32 m0, s64, 104448
    s_nop 0
    buffer_load_dwordx4 v4, s[40:43], s62 offen sc1 lds
    s_add_u32 s62, s60, 19456
    s_add_u32 m0, s64, 105472
    s_nop 0
    buffer_load_dwordx4 v4, s[40:43], s62 offen sc1 lds
    s_add_u32 s62, s60, 4096
    s_add_u32 m0, s64, 118784
    s_nop 0
    buffer_load_dwordx4 v4, s[40:43], s62 offen sc1 lds
    s_add_u32 s62, s60, 5120
    s_add_u32 m0, s64, 119808
    s_nop 0
    buffer_load_dwordx4 v4, s[40:43], s62 offen sc1 lds
    s_add_u32 s62, s60, 20480
    s_add_u32 m0, s64, 120832
    s_nop 0
    buffer_load_dwordx4 v4, s[40:43], s62 offen sc1 lds
    s_add_u32 s62, s60, 21504
    s_add_u32 m0, s64, 121856
    s_nop 0
    buffer_load_dwordx4 v4, s[40:43], s62 offen sc1 lds
    s_add_u32 s48, s38, 0x14e0000
    s_addc_u32 s49, s39, 0
    s_mov_b32 s50, 0x20000
    s_mov_b32 s51, 0x00020000
    v_and_b32 v14, 31, v1
    v_lshlrev_b32 v32, 6, v14
    s_lshl_b32 s62, s5, 2
    s_add_u32 s62, s62, s7
    s_lshl_b32 s62, s62, 11
    buffer_load_dwordx4 v[16:19], v32, s[48:51], s62 offen offset:0 sc1
    buffer_load_dwordx4 v[20:23], v32, s[48:51], s62 offen offset:16 sc1
    buffer_load_dwordx4 v[24:27], v32, s[48:51], s62 offen offset:32 sc1
    buffer_load_dwordx4 v[28:31], v32, s[48:51], s62 offen offset:48 sc1
    s_cmp_ge_u32 s7, 2
    s_cbranch_scc1 Lls_35
    s_add_u32 s62, s61, 69632
    s_add_u32 m0, s63, 69632
    s_nop 0
    buffer_load_dwordx4 v4, s[44:47], s62 offen lds
Lls_35:
    s_add_u32 s62, s61, 57344
    s_add_u32 m0, s63, 57344
    s_nop 0
    buffer_load_dwordx4 v4, s[44:47], s62 offen lds
    s_add_u32 s62, s61, 61440
    s_add_u32 m0, s63, 61440
    s_nop 0
    buffer_load_dwordx4 v4, s[44:47], s62 offen lds
    s_add_u32 s62, s61, 65536
    s_add_u32 m0, s63, 65536
    s_nop 0
    buffer_load_dwordx4 v4, s[44:47], s62 offen lds
    s_cmp_ge_u32 s7, 2
    s_cbranch_scc1 Lls_36
    s_add_u32 s62, s61, 83968
    s_add_u32 m0, s63, 83968
    s_nop 0
    buffer_load_dwordx4 v4, s[44:47], s62 offen lds
Lls_36:
    s_add_u32 s62, s61, 71680
    s_add_u32 m0, s63, 71680
    s_nop 0
    buffer_load_dwordx4 v4, s[44:47], s62 offen lds
    s_add_u32 s62, s61, 75776
    s_add_u32 m0, s63, 75776
    s_nop 0
    buffer_load_dwordx4 v4, s[44:47], s62 offen lds
    s_add_u32 s62, s61, 79872
    s_add_u32 m0, s63, 79872
    s_nop 0
    buffer_load_dwordx4 v4, s[44:47], s62 offen lds
    s_waitcnt vmcnt(18)
    s_barrier
    s_add_u32 s62, s60, 6144
    s_add_u32 m0, s64, 135168
    s_nop 0
    buffer_load_dwordx4 v4, s[40:43], s62 offen sc1 lds
    s_add_u32 s62, s60, 7168
    s_add_u32 m0, s64, 136192
    s_nop 0
    buffer_load_dwordx4 v4, s[40:43], s62 offen sc1 lds
    s_add_u32 s62, s60, 22528
    s_add_u32 m0, s64, 137216
    s_nop 0
    buffer_load_dwordx4 v4, s[40:43], s62 offen sc1 lds
    s_add_u32 s62, s60, 23552
    s_add_u32 m0, s64, 138240
    s_nop 0
    buffer_load_dwordx4 v4, s[40:43], s62 offen sc1 lds
    s_waitcnt vmcnt(18)
    s_barrier
    s_add_u32 s62, s60, 8192
    s_add_u32 m0, s64, 86016
    s_nop 0
    buffer_load_dwordx4 v4, s[40:43], s62 offen sc1 lds
    s_add_u32 s62, s60, 9216
    s_add_u32 m0, s64, 87040
    s_nop 0
    buffer_load_dwordx4 v4, s[40:43], s62 offen sc1 lds
    s_add_u32 s62, s60, 24576
    s_add_u32 m0, s64, 88064
    s_nop 0
    buffer_load_dwordx4 v4, s[40:43], s62 offen sc1 lds
    s_add_u32 s62, s60, 25600
    s_add_u32 m0, s64, 89088
    s_nop 0
    buffer_load_dwordx4 v4, s[40:43], s62 offen sc1 lds
    s_waitcnt vmcnt(14)
    v_pk_add_f32 v[16:17], v[16:17], v[18:19]
    v_pk_add_f32 v[16:17], v[16:17], v[20:21]
    v_pk_add_f32 v[16:17], v[16:17], v[22:23]
    v_pk_add_f32 v[16:17], v[16:17], v[24:25]
    v_pk_add_f32 v[16:17], v[16:17], v[26:27]
    v_pk_add_f32 v[16:17], v[16:17], v[28:29]
    v_pk_add_f32 v[16:17], v[16:17], v[30:31]
    v_mul_f32 v16, 0x3b000000, v16
    v_mul_f32 v17, 0x3b000000, v17
    v_fma_f32 v17, -v16, v16, v17
    v_max_f32 v17, 0, v17
    v_mov_b32 v33, v17
    v_cvt_pk_bf16_f32 v32, v33, v33
    v_lshlrev_b32 v33, 16, v32
    v_add_f32 v33, 0x3727c5ac, v33
    v_cvt_pk_bf16_f32 v32, v33, v33
    v_lshlrev_b32 v33, 16, v32
    v_sqrt_f32 v33, v33
    s_nop 0
    v_cvt_pk_bf16_f32 v32, v33, v33
    v_lshlrev_b32 v33, 16, v32
    v_cvt_pk_bf16_f32 v32, v16, v16
    v_lshlrev_b32 v32, 16, v32
    v_rcp_f32 v33, v33
    v_sub_f32 v16, v16, v32
    v_mul_f32 v16, v16, v33
    v_mul_f32 v17, v17, v33
    v_mul_f32 v17, v17, v33
    v_mul_f32 v32, v32, v33
    v_cvt_pk_bf16_f32 v16, v16, v16
    v_lshlrev_b32 v16, 16, v16
    v_add_f32 v16, v16, v32
    v_cvt_pk_bf16_f32 v32, v17, v17
    v_lshlrev_b32 v17, 16, v32
    v_add_f32 v17, 0x3727c5ac, v17
    v_cvt_pk_bf16_f32 v32, v17, v17
    v_lshlrev_b32 v17, 16, v32
    v_sqrt_f32 v17, v17
    s_nop 0
    v_cvt_pk_bf16_f32 v32, v17, v17
    v_lshlrev_b32 v17, 16, v32
    v_rcp_f32 v17, v17
    s_nop 0
    v_mul_f32 v16, -v16, v17
    v_mul_f32 v17, v17, v33
    s_lshl_b32 s62, s7, 8
    s_add_u32 s62, s62, 161792
    v_lshlrev_b32 v14, 3, v14
    v_add_u32 v14, s62, v14
    ds_write_b64 v14, v[16:17]
    s_waitcnt lgkmcnt(0)
    s_barrier
    s_add_u32 s62, s60, 10240
    s_add_u32 m0, s64, 102400
    s_nop 0
    buffer_load_dwordx4 v4, s[40:43], s62 offen sc1 lds
    s_add_u32 s62, s60, 11264
    s_add_u32 m0, s64, 103424
    s_nop 0
    buffer_load_dwordx4 v4, s[40:43], s62 offen sc1 lds
    s_add_u32 s62, s60, 26624
    s_add_u32 m0, s64, 104448
    s_nop 0
    buffer_load_dwordx4 v4, s[40:43], s62 offen sc1 lds
    s_add_u32 s62, s60, 27648
    s_add_u32 m0, s64, 105472
    s_nop 0
    buffer_load_dwordx4 v4, s[40:43], s62 offen sc1 lds
    s_waitcnt vmcnt(8)
    s_barrier
    s_cmp_ge_u32 s7, 2
    s_cbranch_scc1 Lls_37
    s_add_u32 s62, s61, 98304
    s_add_u32 m0, s63, 12288
    s_nop 0
    buffer_load_dwordx4 v4, s[44:47], s62 offen lds
Lls_37:
    s_add_u32 s62, s61, 86016
    s_add_u32 m0, s63, 0
    s_nop 0
    buffer_load_dwordx4 v4, s[44:47], s62 offen lds
    s_add_u32 s62, s61, 90112
    s_add_u32 m0, s63, 4096
    s_nop 0
    buffer_load_dwordx4 v4, s[44:47], s62 offen lds
    s_add_u32 s62, s61, 94208
    s_add_u32 m0, s63, 8192
    s_nop 0
    buffer_load_dwordx4 v4, s[44:47], s62 offen lds
    s_add_u32 s62, s60, 12288
    s_add_u32 m0, s64, 118784
    s_nop 0
    buffer_load_dwordx4 v4, s[40:43], s62 offen sc1 lds
    s_add_u32 s62, s60, 13312
    s_add_u32 m0, s64, 119808
    s_nop 0
    buffer_load_dwordx4 v4, s[40:43], s62 offen sc1 lds
    s_add_u32 s62, s60, 28672
    s_add_u32 m0, s64, 120832
    s_nop 0
    buffer_load_dwordx4 v4, s[40:43], s62 offen sc1 lds
    s_add_u32 s62, s60, 29696
    s_add_u32 m0, s64, 121856
    s_nop 0
    buffer_load_dwordx4 v4, s[40:43], s62 offen sc1 lds
    s_waitcnt vmcnt(11)
    s_barrier
    s_cmp_ge_u32 s7, 2
    s_cbranch_scc1 Lls_38
    s_add_u32 s62, s61, 112640
    s_add_u32 m0, s63, 26624
    s_nop 0
    buffer_load_dwordx4 v4, s[44:47], s62 offen lds
Lls_38:
    s_add_u32 s62, s61, 100352
    s_add_u32 m0, s63, 14336
    s_nop 0
    buffer_load_dwordx4 v4, s[44:47], s62 offen lds
    s_add_u32 s62, s61, 104448
    s_add_u32 m0, s63, 18432
    s_nop 0
    buffer_load_dwordx4 v4, s[44:47], s62 offen lds
    s_add_u32 s62, s61, 108544
    s_add_u32 m0, s63, 22528
    s_nop 0
    buffer_load_dwordx4 v4, s[44:47], s62 offen lds
    s_add_u32 s62, s60, 14336
    s_add_u32 m0, s64, 135168
    s_nop 0
    buffer_load_dwordx4 v4, s[40:43], s62 offen sc1 lds
    s_add_u32 s62, s60, 15360
    s_add_u32 m0, s64, 136192
    s_nop 0
    buffer_load_dwordx4 v4, s[40:43], s62 offen sc1 lds
    s_add_u32 s62, s60, 30720
    s_add_u32 m0, s64, 137216
    s_nop 0
    buffer_load_dwordx4 v4, s[40:43], s62 offen sc1 lds
    s_add_u32 s62, s60, 31744
    s_add_u32 m0, s64, 138240
    s_nop 0
    buffer_load_dwordx4 v4, s[40:43], s62 offen sc1 lds
    s_waitcnt vmcnt(14)
    s_barrier
    s_waitcnt vmcnt(7)
    s_barrier
    s_waitcnt vmcnt(0)
    s_barrier
    s_lshr_b32 s60, s6, 3
    s_lshl_b32 s61, s5, 1
    s_add_u32 s60, s60, s61
    s_and_b32 s61, s6, 7
    v_lshrrev_b32 v6, 3, v1
    v_lshlrev_b32 v4, 10, v6
    v_lshrrev_b32 v7, 1, v1
    v_xor_b32 v6, v2, v7
    v_and_b32 v6, 3, v6
    v_lshl_add_u32 v4, v6, 5, v4
    v_and_b32 v6, 1, v1
    v_lshl_add_u32 v4, v6, 4, v4
    s_mov_b32 s40, s30
    s_mov_b32 s41, s31
    s_mov_b32 s42, 0x1c0000
    s_mov_b32 s43, 0x00020000
    s_add_u32 s44, s38, 0xc00000
    s_addc_u32 s45, s39, 0
    s_mov_b32 s46, 0x720000
    s_mov_b32 s47, 0x00020000
    s_mul_i32 s63, s60, 233472
    s_mul_i32 s62, s7, 14336
    s_add_u32 s63, s63, s62
    s_mul_i32 s64, s7, 458752
    s_lshl_b32 s62, s61, 7
    s_add_u32 s64, s64, s62
    s_lshl_b32 s65, s7, 12
    v_lshlrev_b32 v5, 4, v1
    s_barrier
    s_add_u32 s62, s64, 0
    s_add_u32 m0, s65, 0
    s_nop 0
    buffer_load_dwordx4 v4, s[40:43], s62 offen lds
    s_add_u32 s62, s64, 8192
    s_add_u32 m0, s65, 1024
    s_nop 0
    buffer_load_dwordx4 v4, s[40:43], s62 offen lds
    s_add_u32 s62, s64, 16384
    s_add_u32 m0, s65, 2048
    s_nop 0
    buffer_load_dwordx4 v4, s[40:43], s62 offen lds
    s_add_u32 s62, s64, 24576
    s_add_u32 m0, s65, 3072
    s_nop 0
    buffer_load_dwordx4 v4, s[40:43], s62 offen lds
    s_add_u32 s62, s64, 32768
    s_add_u32 m0, s65, 16384
    s_nop 0
    buffer_load_dwordx4 v4, s[40:43], s62 offen lds
    s_add_u32 s62, s64, 40960
    s_add_u32 m0, s65, 17408
    s_nop 0
    buffer_load_dwordx4 v4, s[40:43], s62 offen lds
    s_add_u32 s62, s64, 49152
    s_add_u32 m0, s65, 18432
    s_nop 0
    buffer_load_dwordx4 v4, s[40:43], s62 offen lds
    s_add_u32 s62, s64, 57344
    s_add_u32 m0, s65, 19456
    s_nop 0
    buffer_load_dwordx4 v4, s[40:43], s62 offen lds
    s_add_u32 s62, s64, 65536
    s_add_u32 m0, s65, 32768
    s_nop 0
    buffer_load_dwordx4 v4, s[40:43], s62 offen lds
    s_add_u32 s62, s64, 73728
    s_add_u32 m0, s65, 33792
    s_nop 0
    buffer_load_dwordx4 v4, s[40:43], s62 offen lds
    s_add_u32 s62, s64, 81920
    s_add_u32 m0, s65, 34816
    s_nop 0
    buffer_load_dwordx4 v4, s[40:43], s62 offen lds
    s_add_u32 s62, s64, 90112
    s_add_u32 m0, s65, 35840
    s_nop 0
    buffer_load_dwordx4 v4, s[40:43], s62 offen lds
    s_add_u32 s62, s64, 114688
    s_add_u32 m0, s65, 49152
    s_nop 0
    buffer_load_dwordx4 v4, s[40:43], s62 offen lds
    s_add_u32 s62, s64, 122880
    s_add_u32 m0, s65, 50176
    s_nop 0
    buffer_load_dwordx4 v4, s[40:43], s62 offen lds
    s_add_u32 s62, s64, 131072
    s_add_u32 m0, s65, 51200
    s_nop 0
    buffer_load_dwordx4 v4, s[40:43], s62 offen lds
    s_add_u32 s62, s64, 139264
    s_add_u32 m0, s65, 52224
    s_nop 0
    buffer_load_dwordx4 v4, s[40:43], s62 offen lds
    s_add_u32 s62, s64, 147456
    s_add_u32 m0, s65, 65536
    s_nop 0
    buffer_load_dwordx4 v4, s[40:43], s62 offen lds
    s_add_u32 s62, s64, 155648
    s_add_u32 m0, s65, 66560
    s_nop 0
    buffer_load_dwordx4 v4, s[40:43], s62 offen lds
    s_add_u32 s62, s64, 163840
    s_add_u32 m0, s65, 67584
    s_nop 0
    buffer_load_dwordx4 v4, s[40:43], s62 offen lds
    s_add_u32 s62, s64, 172032
    s_add_u32 m0, s65, 68608
    s_nop 0
    buffer_load_dwordx4 v4, s[40:43], s62 offen lds
    s_add_u32 s62, s64, 180224
    s_add_u32 m0, s65, 81920
    s_nop 0
    buffer_load_dwordx4 v4, s[40:43], s62 offen lds
    s_add_u32 s62, s64, 188416
    s_add_u32 m0, s65, 82944
    s_nop 0
    buffer_load_dwordx4 v4, s[40:43], s62 offen lds
    s_add_u32 s62, s64, 196608
    s_add_u32 m0, s65, 83968
    s_nop 0
    buffer_load_dwordx4 v4, s[40:43], s62 offen lds
    s_add_u32 s62, s64, 204800
    s_add_u32 m0, s65, 84992
    s_nop 0
    buffer_load_dwordx4 v4, s[40:43], s62 offen lds
    s_barrier
    s_lshl_b32 s67, s5, 8
    v_lshlrev_b32 v12, 4, v1
    v_add_u32 v12, s67, v12
    s_mov_b64 exec, 0xf
    s_mov_b32 s66, 0
Lpoll_39:
    buffer_load_dwordx4 v[8:11], v12, s[72:75], 0 offen sc1
    s_waitcnt vmcnt(0)
    v_min_u32 v8, v8, v9
    v_min_u32 v10, v10, v11
    v_min_u32 v8, v8, v10
    v_cmp_gt_u32 vcc, 8, v8
    s_add_u32 s66, s66, 1
    s_cmp_ge_u32 s66, 0x40000
    s_cbranch_scc1 Lpoll_39_x
    s_nop 3
    s_cmp_eq_u64 vcc, 0
    s_cbranch_scc1 Lpoll_39_x
    s_sleep 4
    s_branch Lpoll_39
Lpoll_39_x:
    s_mov_b64 exec, -1
    s_nop 7
    s_nop 7
    s_barrier
    s_add_u32 s62, s64, 98304
    s_add_u32 m0, s65, 98304
    s_nop 0
    buffer_load_dwordx4 v4, s[40:43], s62 offen lds
    s_add_u32 s62, s64, 106496
    s_add_u32 m0, s65, 99328
    s_nop 0
    buffer_load_dwordx4 v4, s[40:43], s62 offen lds
    s_add_u32 s62, s64, 212992
    s_add_u32 m0, s65, 100352
    s_nop 0
    buffer_load_dwordx4 v4, s[40:43], s62 offen lds
    s_add_u32 s62, s64, 221184
    s_add_u32 m0, s65, 101376
    s_nop 0
    buffer_load_dwordx4 v4, s[40:43], s62 offen lds
    s_add_u32 s62, s64, 229376
    s_add_u32 m0, s65, 114688
    s_nop 0
    buffer_load_dwordx4 v4, s[40:43], s62 offen lds
    s_add_u32 s62, s64, 237568
    s_add_u32 m0, s65, 115712
    s_nop 0
    buffer_load_dwordx4 v4, s[40:43], s62 offen lds
    s_add_u32 s62, s64, 245760
    s_add_u32 m0, s65, 116736
    s_nop 0
    buffer_load_dwordx4 v4, s[40:43], s62 offen lds
    s_add_u32 s62, s64, 253952
    s_add_u32 m0, s65, 117760
    s_nop 0
    buffer_load_dwordx4 v4, s[40:43], s62 offen lds
    s_add_u32 s62, s64, 262144
    s_add_u32 m0, s65, 131072
    s_nop 0
    buffer_load_dwordx4 v4, s[40:43], s62 offen lds
    s_add_u32 s62, s64, 270336
    s_add_u32 m0, s65, 132096
    s_nop 0
    buffer_load_dwordx4 v4, s[40:43], s62 offen lds
    s_add_u32 s62, s64, 278528
    s_add_u32 m0, s65, 133120
    s_nop 0
    buffer_load_dwordx4 v4, s[40:43], s62 offen lds
    s_add_u32 s62, s64, 286720
    s_add_u32 m0, s65, 134144
    s_nop 0
    buffer_load_dwordx4 v4, s[40:43], s62 offen lds
    s_barrier
    s_barrier
    s_add_u32 s62, s64, 294912
    s_add_u32 m0, s65, 0
    s_nop 0
    buffer_load_dwordx4 v4, s[40:43], s62 offen lds
    s_add_u32 s62, s64, 303104
    s_add_u32 m0, s65, 1024
    s_nop 0
    buffer_load_dwordx4 v4, s[40:43], s62 offen lds
    s_add_u32 s62, s64, 311296
    s_add_u32 m0, s65, 2048
    s_nop 0
    buffer_load_dwordx4 v4, s[40:43], s62 offen lds
    s_add_u32 s62, s64, 319488
    s_add_u32 m0, s65, 3072
    s_nop 0
    buffer_load_dwordx4 v4, s[40:43], s62 offen lds
    s_barrier
    s_add_u32 s62, s64, 344064
    s_add_u32 m0, s65, 16384
    s_nop 0
    buffer_load_dwordx4 v4, s[40:43], s62 offen lds
    s_add_u32 s62, s64, 352256
    s_add_u32 m0, s65, 17408
    s_nop 0
    buffer_load_dwordx4 v4, s[40:43], s62 offen lds
    s_add_u32 s62, s64, 360448
    s_add_u32 m0, s65, 18432
    s_nop 0
    buffer_load_dwordx4 v4, s[40:43], s62 offen lds
    s_add_u32 s62, s64, 368640
    s_add_u32 m0, s65, 19456
    s_nop 0
    buffer_load_dwordx4 v4, s[40:43], s62 offen lds
    s_barrier
    s_add_u32 s62, s64, 376832
    s_add_u32 m0, s65, 32768
    s_nop 0
    buffer_load_dwordx4 v4, s[40:43], s62 offen lds
    s_add_u32 s62, s64, 385024
    s_add_u32 m0, s65, 33792
    s_nop 0
    buffer_load_dwordx4 v4, s[40:43], s62 offen lds
    s_add_u32 s62, s64, 393216
    s_add_u32 m0, s65, 34816
    s_nop 0
    buffer_load_dwordx4 v4, s[40:43], s62 offen lds
    s_add_u32 s62, s64, 401408
    s_add_u32 m0, s65, 35840
    s_nop 0
    buffer_load_dwordx4 v4, s[40:43], s62 offen lds
    s_barrier
    s_add_u32 s62, s64, 409600
    s_add_u32 m0, s65, 49152
    s_nop 0
    buffer_load_dwordx4 v4, s[40:43], s62 offen lds
    s_add_u32 s62, s64, 417792
    s_add_u32 m0, s65, 50176
    s_nop 0
    buffer_load_dwordx4 v4, s[40:43], s62 offen lds
    s_add_u32 s62, s64, 425984
    s_add_u32 m0, s65, 51200
    s_nop 0
    buffer_load_dwordx4 v4, s[40:43], s62 offen lds
    s_add_u32 s62, s64, 434176
    s_add_u32 m0, s65, 52224
    s_nop 0
    buffer_load_dwordx4 v4, s[40:43], s62 offen lds
    s_barrier
    s_add_u32 s62, s64, 327680
    s_add_u32 m0, s65, 65536
    s_nop 0
    buffer_load_dwordx4 v4, s[40:43], s62 offen lds
    s_add_u32 s62, s64, 335872
    s_add_u32 m0, s65, 66560
    s_nop 0
    buffer_load_dwordx4 v4, s[40:43], s62 offen lds
    s_add_u32 s62, s64, 442368
    s_add_u32 m0, s65, 67584
    s_nop 0
    buffer_load_dwordx4 v4, s[40:43], s62 offen lds
    s_add_u32 s62, s64, 450560
    s_add_u32 m0, s65, 68608
    s_nop 0
    buffer_load_dwordx4 v4, s[40:43], s62 offen lds
    s_waitcnt vmcnt(28)
    s_barrier
    s_waitcnt vmcnt(24)
    s_barrier
    s_waitcnt vmcnt(20)
    s_barrier
    s_waitcnt vmcnt(16)
    s_barrier
    s_waitcnt vmcnt(12)
    s_barrier
    s_waitcnt vmcnt(8)
    s_barrier
    s_waitcnt vmcnt(4)
    s_barrier
    s_waitcnt vmcnt(0)
    s_barrier
    s_endpgm
mega_kernel_lslow:
    s_nop 7
    s_nop 7
    s_barrier
    s_add_u32 s62, s64, 2048
    s_lshl_b32 m0, s7, 10
    s_add_u32 m0, m0, 106496
    s_nop 0
    buffer_load_dwordx4 v15, s[48:51], s62 offen sc1 lds
    s_add_u32 s62, s64, 0
    s_add_u32 m0, s68, 65536
    s_nop 0
    buffer_load_dwordx4 v6, s[48:51], s62 offen sc1 lds
    s_add_u32 s62, s64, 1024
    s_add_u32 m0, s68, 66560
    s_nop 0
    buffer_load_dwordx4 v6, s[48:51], s62 offen sc1 lds
    s_add_u32 s62, s64, 2176
    s_add_u32 m0, s68, 73728
    s_nop 0
    buffer_load_dwordx4 v6, s[48:51], s62 offen sc1 lds
    s_add_u32 s62, s64, 3200
    s_add_u32 m0, s68, 74752
    s_nop 0
    buffer_load_dwordx4 v6, s[48:51], s62 offen sc1 lds
    s_add_u32 s62, s64, 4352
    s_add_u32 m0, s68, 81920
    s_nop 0
    buffer_load_dwordx4 v6, s[48:51], s62 offen sc1 lds
    s_add_u32 s62, s64, 5376
    s_add_u32 m0, s68, 82944
    s_nop 0
    buffer_load_dwordx4 v6, s[48:51], s62 offen sc1 lds
    s_add_u32 s62, s64, 6528
    s_add_u32 m0, s68, 90112
    s_nop 0
    buffer_load_dwordx4 v6, s[48:51], s62 offen sc1 lds
    s_add_u32 s62, s64, 7552
    s_add_u32 m0, s68, 91136
    s_nop 0
    buffer_load_dwordx4 v6, s[48:51], s62 offen sc1 lds
    s_waitcnt vmcnt(6)
    s_barrier
    s_add_u32 s62, s64, 8704
    s_add_u32 m0, s68, 98304
    s_nop 0
    buffer_load_dwordx4 v6, s[48:51], s62 offen sc1 lds
    s_add_u32 s62, s64, 9728
    s_add_u32 m0, s68, 99328
    s_nop 0
    buffer_load_dwordx4 v6, s[48:51], s62 offen sc1 lds
    s_waitcnt vmcnt(6)
    s_barrier
    s_add_u32 s62, s64, 10880
    s_add_u32 m0, s68, 65536
    s_nop 0
    buffer_load_dwordx4 v6, s[48:51], s62 offen sc1 lds
    s_add_u32 s62, s64, 11904
    s_add_u32 m0, s68, 66560
    s_nop 0
    buffer_load_dwordx4 v6, s[48:51], s62 offen sc1 lds
    s_waitcnt vmcnt(6)
    s_barrier
    s_add_u32 s62, s64, 13056
    s_add_u32 m0, s68, 73728
    s_nop 0
    buffer_load_dwordx4 v6, s[48:51], s62 offen sc1 lds
    s_add_u32 s62, s64, 14080
    s_add_u32 m0, s68, 74752
    s_nop 0
    buffer_load_dwordx4 v6, s[48:51], s62 offen sc1 lds
    s_waitcnt vmcnt(6)
    s_barrier
    s_add_u32 s62, s64, 15232
    s_add_u32 m0, s68, 81920
    s_nop 0
    buffer_load_dwordx4 v6, s[48:51], s62 offen sc1 lds
    s_add_u32 s62, s64, 16256
    s_add_u32 m0, s68, 82944
    s_nop 0
    buffer_load_dwordx4 v6, s[48:51], s62 offen sc1 lds
    s_waitcnt vmcnt(6)
    s_barrier
    s_waitcnt vmcnt(4)
    s_barrier
    s_waitcnt vmcnt(2)
    s_barrier
    s_waitcnt vmcnt(0)
    s_barrier
    s_cmp_eq_u32 s4, 9
    s_cbranch_scc1 Lcg9_40
    s_cmp_eq_u32 s4, 10
    s_cbranch_scc1 Lcg10_41
    s_branch Lcgx_42
Lcg9_40:
    s_nop 7
    s_nop 7
    s_mov_b32 exec_lo, 0xfffffff
    s_mov_b32 exec_hi, 0
    s_waitcnt vmcnt(0)
    v_pk_add_f32 v[20:21], v[20:21], v[24:25]
    v_pk_add_f32 v[22:23], v[22:23], v[26:27]
    v_pk_add_f32 v[20:21], v[20:21], v[28:29]
    v_pk_add_f32 v[22:23], v[22:23], v[30:31]
    v_pk_add_f32 v[20:21], v[20:21], v[32:33]
    v_pk_add_f32 v[22:23], v[22:23], v[34:35]
    v_pk_add_f32 v[20:21], v[20:21], v[36:37]
    v_pk_add_f32 v[22:23], v[22:23], v[38:39]
    v_pk_add_f32 v[20:21], v[20:21], v[40:41]
    v_pk_add_f32 v[22:23], v[22:23], v[42:43]
    v_pk_add_f32 v[20:21], v[20:21], v[44:45]
    v_pk_add_f32 v[22:23], v[22:23], v[46:47]
    v_pk_add_f32 v[20:21], v[20:21], v[48:49]
    v_pk_add_f32 v[22:23], v[22:23], v[50:51]
    v_pk_add_f32 v[20:21], v[20:21], v[52:53]
    v_pk_add_f32 v[22:23], v[22:23], v[54:55]
    v_pk_add_f32 v[20:21], v[20:21], v[56:57]
    v_pk_add_f32 v[22:23], v[22:23], v[58:59]
    v_pk_add_f32 v[20:21], v[20:21], v[60:61]
    v_pk_add_f32 v[22:23], v[22:23], v[62:63]
    v_pk_add_f32 v[20:21], v[20:21], v[64:65]
    v_pk_add_f32 v[22:23], v[22:23], v[66:67]
    v_pk_add_f32 v[20:21], v[20:21], v[68:69]
    v_pk_add_f32 v[22:23], v[22:23], v[70:71]
    v_pk_add_f32 v[20:21], v[20:21], v[72:73]
    v_pk_add_f32 v[22:23], v[22:23], v[74:75]
    v_pk_add_f32 v[20:21], v[20:21], v[76:77]
    v_pk_add_f32 v[22:23], v[22:23], v[78:79]
    v_pk_add_f32 v[20:21], v[20:21], v[80:81]
    v_pk_add_f32 v[22:23], v[22:23], v[82:83]
    ds_write_b128 v17, v[20:23]
    s_waitcnt lgkmcnt(0)
    s_mov_b64 exec, -1
    s_branch Lcgx_42
Lcg10_41:
    s_nop 7
    s_nop 7
    s_mov_b32 exec_lo, 0xffffff
    s_mov_b32 exec_hi, 0
    s_waitcnt vmcnt(0)
    v_pk_add_f32 v[20:21], v[20:21], v[24:25]
    v_pk_add_f32 v[22:23], v[22:23], v[26:27]
    v_pk_add_f32 v[20:21], v[20:21], v[28:29]
    v_pk_add_f32 v[22:23], v[22:23], v[30:31]
    v_pk_add_f32 v[20:21], v[20:21], v[32:33]
    v_pk_add_f32 v[22:23], v[22:23], v[34:35]
    v_pk_add_f32 v[20:21], v[20:21], v[36:37]
    v_pk_add_f32 v[22:23], v[22:23], v[38:39]
    v_pk_add_f32 v[20:21], v[20:21], v[40:41]
    v_pk_add_f32 v[22:23], v[22:23], v[42:43]
    v_pk_add_f32 v[20:21], v[20:21], v[44:45]
    v_pk_add_f32 v[22:23], v[22:23], v[46:47]
    v_pk_add_f32 v[20:21], v[20:21], v[48:49]
    v_pk_add_f32 v[22:23], v[22:23], v[50:51]
    v_pk_add_f32 v[20:21], v[20:21], v[52:53]
    v_pk_add_f32 v[22:23], v[22:23], v[54:55]
    v_pk_add_f32 v[20:21], v[20:21], v[56:57]
    v_pk_add_f32 v[22:23], v[22:23], v[58:59]
    v_pk_add_f32 v[20:21], v[20:21], v[60:61]
    v_pk_add_f32 v[22:23], v[22:23], v[62:63]
    v_pk_add_f32 v[20:21], v[20:21], v[64:65]
    v_pk_add_f32 v[22:23], v[22:23], v[66:67]
    v_pk_add_f32 v[20:21], v[20:21], v[68:69]
    v_pk_add_f32 v[22:23], v[22:23], v[70:71]
    v_pk_add_f32 v[20:21], v[20:21], v[72:73]
    v_pk_add_f32 v[22:23], v[22:23], v[74:75]
    v_pk_add_f32 v[20:21], v[20:21], v[76:77]
    v_pk_add_f32 v[22:23], v[22:23], v[78:79]
    v_pk_add_f32 v[20:21], v[20:21], v[80:81]
    v_pk_add_f32 v[22:23], v[22:23], v[82:83]
    ds_write_b128 v17, v[20:23]
    s_waitcnt lgkmcnt(0)
    s_mov_b64 exec, -1
Lcgx_42:
    s_nop 7
    s_nop 7
    s_lshl_b32 s60, s5, 2
    s_add_u32 s60, s60, s7
    s_lshl_b32 s60, s60, 15
    s_lshl_b32 s63, s7, 10
    s_lshl_b32 s64, s7, 12
    s_mul_i32 s61, s6, 114688
    s_add_u32 s61, s61, s63
    s_add_u32 s40, s38, 0x600000
    s_addc_u32 s41, s39, 0
    s_mov_b32 s42, 0x200000
    s_mov_b32 s43, 0x00020000
    s_add_u32 s44, s38, 0x1800000
    s_addc_u32 s45, s39, 0
    s_mov_b32 s46, 0x1c0000
    s_mov_b32 s47, 0x00020000
    v_lshlrev_b32 v4, 4, v1
    s_barrier
    s_cmp_ge_u32 s7, 2
    s_cbranch_scc1 Lls_43
    s_add_u32 s62, s61, 12288
    s_add_u32 m0, s63, 12288
    s_nop 0
    buffer_load_dwordx4 v4, s[44:47], s62 offen lds
Lls_43:
    s_add_u32 s62, s61, 0
    s_add_u32 m0, s63, 0
    s_nop 0
    buffer_load_dwordx4 v4, s[44:47], s62 offen lds
    s_add_u32 s62, s61, 4096
    s_add_u32 m0, s63, 4096
    s_nop 0
    buffer_load_dwordx4 v4, s[44:47], s62 offen lds
    s_add_u32 s62, s61, 8192
    s_add_u32 m0, s63, 8192
    s_nop 0
    buffer_load_dwordx4 v4, s[44:47], s62 offen lds
    s_cmp_ge_u32 s7, 2
    s_cbranch_scc1 Lls_44
    s_add_u32 s62, s61, 26624
    s_add_u32 m0, s63, 26624
    s_nop 0
    buffer_load_dwordx4 v4, s[44:47], s62 offen lds
Lls_44:
    s_add_u32 s62, s61, 14336
    s_add_u32 m0, s63, 14336
    s_nop 0
    buffer_load_dwordx4 v4, s[44:47], s62 offen lds
    s_add_u32 s62, s61, 18432
    s_add_u32 m0, s63, 18432
    s_nop 0
    buffer_load_dwordx4 v4, s[44:47], s62 offen lds
    s_add_u32 s62, s61, 22528
    s_add_u32 m0, s63, 22528
    s_nop 0
    buffer_load_dwordx4 v4, s[44:47], s62 offen lds
    s_cmp_ge_u32 s7, 2
    s_cbranch_scc1 Lls_45
    s_add_u32 s62, s61, 40960
    s_add_u32 m0, s63, 40960
    s_nop 0
    buffer_load_dwordx4 v4, s[44:47], s62 offen lds
Lls_45:
    s_add_u32 s62, s61, 28672
    s_add_u32 m0, s63, 28672
    s_nop 0
    buffer_load_dwordx4 v4, s[44:47], s62 offen lds
    s_add_u32 s62, s61, 32768
    s_add_u32 m0, s63, 32768
    s_nop 0
    buffer_load_dwordx4 v4, s[44:47], s62 offen lds
    s_add_u32 s62, s61, 36864
    s_add_u32 m0, s63, 36864
    s_nop 0
    buffer_load_dwordx4 v4, s[44:47], s62 offen lds
    s_cmp_ge_u32 s7, 2
    s_cbranch_scc1 Lls_46
    s_add_u32 s62, s61, 55296
    s_add_u32 m0, s63, 55296
    s_nop 0
    buffer_load_dwordx4 v4, s[44:47], s62 offen lds
Lls_46:
    s_add_u32 s62, s61, 43008
    s_add_u32 m0, s63, 43008
    s_nop 0
    buffer_load_dwordx4 v4, s[44:47], s62 offen lds
    s_add_u32 s62, s61, 47104
    s_add_u32 m0, s63, 47104
    s_nop 0
    buffer_load_dwordx4 v4, s[44:47], s62 offen lds
    s_add_u32 s62, s61, 51200
    s_add_u32 m0, s63, 51200
    s_nop 0
    buffer_load_dwordx4 v4, s[44:47], s62 offen lds
    s_barrier
    s_barrier
    s_lshl_b32 s67, s5, 8
    v_lshlrev_b32 v12, 4, v1
    v_add_u32 v12, s67, v12
    s_mov_b64 exec, 0xf
    s_mov_b32 s66, 0
Lpoll_47:
    buffer_load_dwordx4 v[8:11], v12, s[72:75], 0 offen sc1
    s_waitcnt vmcnt(0)
    v_min_u32 v8, v8, v9
    v_min_u32 v10, v10, v11
    v_min_u32 v8, v8, v10
    v_cmp_gt_u32 vcc, 3, v8
    s_add_u32 s66, s66, 1
    s_cmp_ge_u32 s66, 0x40000
    s_cbranch_scc1 Lpoll_47_x
    s_nop 3
    s_cmp_eq_u64 vcc, 0
    s_cbranch_scc1 Lpoll_47_x
    s_sleep 4
    s_branch Lpoll_47
Lpoll_47_x:
    s_mov_b64 exec, -1
    s_nop 7
    s_nop 7
    s_add_u32 s62, s60, 0
    s_add_u32 m0, s64, 86016
    s_nop 0
    buffer_load_dwordx4 v4, s[40:43], s62 offen sc1 lds
    s_add_u32 s62, s60, 1024
    s_add_u32 m0, s64, 87040
    s_nop 0
    buffer_load_dwordx4 v4, s[40:43], s62 offen sc1 lds
    s_add_u32 s62, s60, 16384
    s_add_u32 m0, s64, 88064
    s_nop 0
    buffer_load_dwordx4 v4, s[40:43], s62 offen sc1 lds
    s_add_u32 s62, s60, 17408
    s_add_u32 m0, s64, 89088
    s_nop 0
    buffer_load_dwordx4 v4, s[40:43], s62 offen sc1 lds
    s_add_u32 s62, s60, 2048
    s_add_u32 m0, s64, 102400
    s_nop 0
    buffer_load_dwordx4 v4, s[40:43], s62 offen sc1 lds
    s_add_u32 s62, s60, 3072
    s_add_u32 m0, s64, 103424
    s_nop 0
    buffer_load_dwordx4 v4, s[40:43], s62 offen sc1 lds
    s_add_u32 s62, s60, 18432
    s_add_u32 m0, s64, 104448
    s_nop 0
    buffer_load_dwordx4 v4, s[40:43], s62 offen sc1 lds
    s_add_u32 s62, s60, 19456
    s_add_u32 m0, s64, 105472
    s_nop 0
    buffer_load_dwordx4 v4, s[40:43], s62 offen sc1 lds
    s_add_u32 s62, s60, 4096
    s_add_u32 m0, s64, 118784
    s_nop 0
    buffer_load_dwordx4 v4, s[40:43], s62 offen sc1 lds
    s_add_u32 s62, s60, 5120
    s_add_u32 m0, s64, 119808
    s_nop 0
    buffer_load_dwordx4 v4, s[40:43], s62 offen sc1 lds
    s_add_u32 s62, s60, 20480
    s_add_u32 m0, s64, 120832
    s_nop 0
    buffer_load_dwordx4 v4, s[40:43], s62 offen sc1 lds
    s_add_u32 s62, s60, 21504
    s_add_u32 m0, s64, 121856
    s_nop 0
    buffer_load_dwordx4 v4, s[40:43], s62 offen sc1 lds
    s_add_u32 s48, s38, 0x14a0000
    s_addc_u32 s49, s39, 0
    s_mov_b32 s50, 0x20000
    s_mov_b32 s51, 0x00020000
    v_and_b32 v14, 31, v1
    v_lshlrev_b32 v32, 6, v14
    s_lshl_b32 s62, s5, 2
    s_add_u32 s62, s62, s7
    s_lshl_b32 s62, s62, 11
    buffer_load_dwordx4 v[16:19], v32, s[48:51], s62 offen offset:0 sc1
    buffer_load_dwordx4 v[20:23], v32, s[48:51], s62 offen offset:16 sc1
    buffer_load_dwordx4 v[24:27], v32, s[48:51], s62 offen offset:32 sc1
    buffer_load_dwordx4 v[28:31], v32, s[48:51], s62 offen offset:48 sc1
    s_cmp_ge_u32 s7, 2
    s_cbranch_scc1 Lls_48
    s_add_u32 s62, s61, 69632
    s_add_u32 m0, s63, 69632
    s_nop 0
    buffer_load_dwordx4 v4, s[44:47], s62 offen lds
Lls_48:
    s_add_u32 s62, s61, 57344
    s_add_u32 m0, s63, 57344
    s_nop 0
    buffer_load_dwordx4 v4, s[44:47], s62 offen lds
    s_add_u32 s62, s61, 61440
    s_add_u32 m0, s63, 61440
    s_nop 0
    buffer_load_dwordx4 v4, s[44:47], s62 offen lds
    s_add_u32 s62, s61, 65536
    s_add_u32 m0, s63, 65536
    s_nop 0
    buffer_load_dwordx4 v4, s[44:47], s62 offen lds
    s_cmp_ge_u32 s7, 2
    s_cbranch_scc1 Lls_49
    s_add_u32 s62, s61, 83968
    s_add_u32 m0, s63, 83968
    s_nop 0
    buffer_load_dwordx4 v4, s[44:47], s62 offen lds
Lls_49:
    s_add_u32 s62, s61, 71680
    s_add_u32 m0, s63, 71680
    s_nop 0
    buffer_load_dwordx4 v4, s[44:47], s62 offen lds
    s_add_u32 s62, s61, 75776
    s_add_u32 m0, s63, 75776
    s_nop 0
    buffer_load_dwordx4 v4, s[44:47], s62 offen lds
    s_add_u32 s62, s61, 79872
    s_add_u32 m0, s63, 79872
    s_nop 0
    buffer_load_dwordx4 v4, s[44:47], s62 offen lds
    s_waitcnt vmcnt(18)
    s_barrier
    s_add_u32 s62, s60, 6144
    s_add_u32 m0, s64, 135168
    s_nop 0
    buffer_load_dwordx4 v4, s[40:43], s62 offen sc1 lds
    s_add_u32 s62, s60, 7168
    s_add_u32 m0, s64, 136192
    s_nop 0
    buffer_load_dwordx4 v4, s[40:43], s62 offen sc1 lds
    s_add_u32 s62, s60, 22528
    s_add_u32 m0, s64, 137216
    s_nop 0
    buffer_load_dwordx4 v4, s[40:43], s62 offen sc1 lds
    s_add_u32 s62, s60, 23552
    s_add_u32 m0, s64, 138240
    s_nop 0
    buffer_load_dwordx4 v4, s[40:43], s62 offen sc1 lds
    s_waitcnt vmcnt(18)
    s_barrier
    s_add_u32 s62, s60, 8192
    s_add_u32 m0, s64, 86016
    s_nop 0
    buffer_load_dwordx4 v4, s[40:43], s62 offen sc1 lds
    s_add_u32 s62, s60, 9216
    s_add_u32 m0, s64, 87040
    s_nop 0
    buffer_load_dwordx4 v4, s[40:43], s62 offen sc1 lds
    s_add_u32 s62, s60, 24576
    s_add_u32 m0, s64, 88064
    s_nop 0
    buffer_load_dwordx4 v4, s[40:43], s62 offen sc1 lds
    s_add_u32 s62, s60, 25600
    s_add_u32 m0, s64, 89088
    s_nop 0
    buffer_load_dwordx4 v4, s[40:43], s62 offen sc1 lds
    s_waitcnt vmcnt(14)
    v_pk_add_f32 v[16:17], v[16:17], v[18:19]
    v_pk_add_f32 v[16:17], v[16:17], v[20:21]
    v_pk_add_f32 v[16:17], v[16:17], v[22:23]
    v_pk_add_f32 v[16:17], v[16:17], v[24:25]
    v_pk_add_f32 v[16:17], v[16:17], v[26:27]
    v_pk_add_f32 v[16:17], v[16:17], v[28:29]
    v_pk_add_f32 v[16:17], v[16:17], v[30:31]
    v_mul_f32 v16, 0x3b000000, v16
    v_mul_f32 v17, 0x3b000000, v17
    v_fma_f32 v17, -v16, v16, v17
    v_max_f32 v17, 0, v17
    v_mov_b32 v33, v17
    v_cvt_pk_bf16_f32 v32, v33, v33
    v_lshlrev_b32 v33, 16, v32
    v_add_f32 v33, 0x3727c5ac, v33
    v_cvt_pk_bf16_f32 v32, v33, v33
    v_lshlrev_b32 v33, 16, v32
    v_sqrt_f32 v33, v33
    s_nop 0
    v_cvt_pk_bf16_f32 v32, v33, v33
    v_lshlrev_b32 v33, 16, v32
    v_cvt_pk_bf16_f32 v32, v16, v16
    v_lshlrev_b32 v32, 16, v32
    v_rcp_f32 v33, v33
    v_sub_f32 v16, v16, v32
    v_mul_f32 v16, v16, v33
    v_mul_f32 v17, v17, v33
    v_mul_f32 v17, v17, v33
    v_mul_f32 v32, v32, v33
    v_cvt_pk_bf16_f32 v16, v16, v16
    v_lshlrev_b32 v16, 16, v16
    v_add_f32 v16, v16, v32
    v_cvt_pk_bf16_f32 v32, v17, v17
    v_lshlrev_b32 v17, 16, v32
    v_add_f32 v17, 0x3727c5ac, v17
    v_cvt_pk_bf16_f32 v32, v17, v17
    v_lshlrev_b32 v17, 16, v32
    v_sqrt_f32 v17, v17
    s_nop 0
    v_cvt_pk_bf16_f32 v32, v17, v17
    v_lshlrev_b32 v17, 16, v32
    v_rcp_f32 v17, v17
    s_nop 0
    v_mul_f32 v16, -v16, v17
    v_mul_f32 v17, v17, v33
    s_lshl_b32 s62, s7, 8
    s_add_u32 s62, s62, 161792
    v_lshlrev_b32 v14, 3, v14
    v_add_u32 v14, s62, v14
    ds_write_b64 v14, v[16:17]
    s_waitcnt lgkmcnt(0)
    s_barrier
    s_add_u32 s62, s60, 10240
    s_add_u32 m0, s64, 102400
    s_nop 0
    buffer_load_dwordx4 v4, s[40:43], s62 offen sc1 lds
    s_add_u32 s62, s60, 11264
    s_add_u32 m0, s64, 103424
    s_nop 0
    buffer_load_dwordx4 v4, s[40:43], s62 offen sc1 lds
    s_add_u32 s62, s60, 26624
    s_add_u32 m0, s64, 104448
    s_nop 0
    buffer_load_dwordx4 v4, s[40:43], s62 offen sc1 lds
    s_add_u32 s62, s60, 27648
    s_add_u32 m0, s64, 105472
    s_nop 0
    buffer_load_dwordx4 v4, s[40:43], s62 offen sc1 lds
    s_waitcnt vmcnt(8)
    s_barrier
    s_cmp_ge_u32 s7, 2
    s_cbranch_scc1 Lls_50
    s_add_u32 s62, s61, 98304
    s_add_u32 m0, s63, 12288
    s_nop 0
    buffer_load_dwordx4 v4, s[44:47], s62 offen lds
Lls_50:
    s_add_u32 s62, s61, 86016
    s_add_u32 m0, s63, 0
    s_nop 0
    buffer_load_dwordx4 v4, s[44:47], s62 offen lds
    s_add_u32 s62, s61, 90112
    s_add_u32 m0, s63, 4096
    s_nop 0
    buffer_load_dwordx4 v4, s[44:47], s62 offen lds
    s_add_u32 s62, s61, 94208
    s_add_u32 m0, s63, 8192
    s_nop 0
    buffer_load_dwordx4 v4, s[44:47], s62 offen lds
    s_add_u32 s62, s60, 12288
    s_add_u32 m0, s64, 118784
    s_nop 0
    buffer_load_dwordx4 v4, s[40:43], s62 offen sc1 lds
    s_add_u32 s62, s60, 13312
    s_add_u32 m0, s64, 119808
    s_nop 0
    buffer_load_dwordx4 v4, s[40:43], s62 offen sc1 lds
    s_add_u32 s62, s60, 28672
    s_add_u32 m0, s64, 120832
    s_nop 0
    buffer_load_dwordx4 v4, s[40:43], s62 offen sc1 lds
    s_add_u32 s62, s60, 29696
    s_add_u32 m0, s64, 121856
    s_nop 0
    buffer_load_dwordx4 v4, s[40:43], s62 offen sc1 lds
    s_waitcnt vmcnt(11)
    s_barrier
    s_cmp_ge_u32 s7, 2
    s_cbranch_scc1 Lls_51
    s_add_u32 s62, s61, 112640
    s_add_u32 m0, s63, 26624
    s_nop 0
    buffer_load_dwordx4 v4, s[44:47], s62 offen lds
Lls_51:
    s_add_u32 s62, s61, 100352
    s_add_u32 m0, s63, 14336
    s_nop 0
    buffer_load_dwordx4 v4, s[44:47], s62 offen lds
    s_add_u32 s62, s61, 104448
    s_add_u32 m0, s63, 18432
    s_nop 0
    buffer_load_dwordx4 v4, s[44:47], s62 offen lds
    s_add_u32 s62, s61, 108544
    s_add_u32 m0, s63, 22528
    s_nop 0
    buffer_load_dwordx4 v4, s[44:47], s62 offen lds
    s_add_u32 s62, s60, 14336
    s_add_u32 m0, s64, 135168
    s_nop 0
    buffer_load_dwordx4 v4, s[40:43], s62 offen sc1 lds
    s_add_u32 s62, s60, 15360
    s_add_u32 m0, s64, 136192
    s_nop 0
    buffer_load_dwordx4 v4, s[40:43], s62 offen sc1 lds
    s_add_u32 s62, s60, 30720
    s_add_u32 m0, s64, 137216
    s_nop 0
    buffer_load_dwordx4 v4, s[40:43], s62 offen sc1 lds
    s_add_u32 s62, s60, 31744
    s_add_u32 m0, s64, 138240
    s_nop 0
    buffer_load_dwordx4 v4, s[40:43], s62 offen sc1 lds
    s_waitcnt vmcnt(14)
    s_barrier
    s_waitcnt vmcnt(7)
    s_barrier
    s_waitcnt vmcnt(0)
    s_barrier
    s_lshr_b32 s60, s6, 3
    s_lshl_b32 s61, s5, 1
    s_add_u32 s60, s60, s61
    s_and_b32 s61, s6, 7
    v_lshrrev_b32 v6, 3, v1
    v_lshlrev_b32 v4, 10, v6
    v_lshrrev_b32 v7, 1, v1
    v_xor_b32 v6, v2, v7
    v_and_b32 v6, 3, v6
    v_lshl_add_u32 v4, v6, 5, v4
    v_and_b32 v6, 1, v1
    v_lshl_add_u32 v4, v6, 4, v4
    s_mov_b32 s40, s30
    s_mov_b32 s41, s31
    s_mov_b32 s42, 0x1c0000
    s_mov_b32 s43, 0x00020000
    s_add_u32 s44, s38, 0xc00000
    s_addc_u32 s45, s39, 0
    s_mov_b32 s46, 0x720000
    s_mov_b32 s47, 0x00020000
    s_mul_i32 s63, s60, 233472
    s_mul_i32 s62, s7, 14336
    s_add_u32 s63, s63, s62
    s_mul_i32 s64, s7, 458752
    s_lshl_b32 s62, s61, 7
    s_add_u32 s64, s64, s62
    s_lshl_b32 s65, s7, 12
    v_lshlrev_b32 v5, 4, v1
    s_barrier
    s_add_u32 s62, s64, 0
    s_add_u32 m0, s65, 0
    s_nop 0
    buffer_load_dwordx4 v4, s[40:43], s62 offen lds
    s_add_u32 s62, s64, 8192
    s_add_u32 m0, s65, 1024
    s_nop 0
    buffer_load_dwordx4 v4, s[40:43], s62 offen lds
    s_add_u32 s62, s64, 16384
    s_add_u32 m0, s65, 2048
    s_nop 0
    buffer_load_dwordx4 v4, s[40:43], s62 offen lds
    s_add_u32 s62, s64, 24576
    s_add_u32 m0, s65, 3072
    s_nop 0
    buffer_load_dwordx4 v4, s[40:43], s62 offen lds
    s_add_u32 s62, s64, 32768
    s_add_u32 m0, s65, 16384
    s_nop 0
    buffer_load_dwordx4 v4, s[40:43], s62 offen lds
    s_add_u32 s62, s64, 40960
    s_add_u32 m0, s65, 17408
    s_nop 0
    buffer_load_dwordx4 v4, s[40:43], s62 offen lds
    s_add_u32 s62, s64, 49152
    s_add_u32 m0, s65, 18432
    s_nop 0
    buffer_load_dwordx4 v4, s[40:43], s62 offen lds
    s_add_u32 s62, s64, 57344
    s_add_u32 m0, s65, 19456
    s_nop 0
    buffer_load_dwordx4 v4, s[40:43], s62 offen lds
    s_add_u32 s62, s64, 65536
    s_add_u32 m0, s65, 32768
    s_nop 0
    buffer_load_dwordx4 v4, s[40:43], s62 offen lds
    s_add_u32 s62, s64, 73728
    s_add_u32 m0, s65, 33792
    s_nop 0
    buffer_load_dwordx4 v4, s[40:43], s62 offen lds
    s_add_u32 s62, s64, 81920
    s_add_u32 m0, s65, 34816
    s_nop 0
    buffer_load_dwordx4 v4, s[40:43], s62 offen lds
    s_add_u32 s62, s64, 90112
    s_add_u32 m0, s65, 35840
    s_nop 0
    buffer_load_dwordx4 v4, s[40:43], s62 offen lds
    s_add_u32 s62, s64, 114688
    s_add_u32 m0, s65, 49152
    s_nop 0
    buffer_load_dwordx4 v4, s[40:43], s62 offen lds
    s_add_u32 s62, s64, 122880
    s_add_u32 m0, s65, 50176
    s_nop 0
    buffer_load_dwordx4 v4, s[40:43], s62 offen lds
    s_add_u32 s62, s64, 131072
    s_add_u32 m0, s65, 51200
    s_nop 0
    buffer_load_dwordx4 v4, s[40:43], s62 offen lds
    s_add_u32 s62, s64, 139264
    s_add_u32 m0, s65, 52224
    s_nop 0
    buffer_load_dwordx4 v4, s[40:43], s62 offen lds
    s_add_u32 s62, s64, 147456
    s_add_u32 m0, s65, 65536
    s_nop 0
    buffer_load_dwordx4 v4, s[40:43], s62 offen lds
    s_add_u32 s62, s64, 155648
    s_add_u32 m0, s65, 66560
    s_nop 0
    buffer_load_dwordx4 v4, s[40:43], s62 offen lds
    s_add_u32 s62, s64, 163840
    s_add_u32 m0, s65, 67584
    s_nop 0
    buffer_load_dwordx4 v4, s[40:43], s62 offen lds
    s_add_u32 s62, s64, 172032
    s_add_u32 m0, s65, 68608
    s_nop 0
    buffer_load_dwordx4 v4, s[40:43], s62 offen lds
    s_add_u32 s62, s64, 180224
    s_add_u32 m0, s65, 81920
    s_nop 0
    buffer_load_dwordx4 v4, s[40:43], s62 offen lds
    s_add_u32 s62, s64, 188416
    s_add_u32 m0, s65, 82944
    s_nop 0
    buffer_load_dwordx4 v4, s[40:43], s62 offen lds
    s_add_u32 s62, s64, 196608
    s_add_u32 m0, s65, 83968
    s_nop 0
    buffer_load_dwordx4 v4, s[40:43], s62 offen lds
    s_add_u32 s62, s64, 204800
    s_add_u32 m0, s65, 84992
    s_nop 0
    buffer_load_dwordx4 v4, s[40:43], s62 offen lds
    s_barrier
    s_lshl_b32 s67, s5, 8
    v_lshlrev_b32 v12, 4, v1
    v_add_u32 v12, s67, v12
    s_mov_b64 exec, 0xf
    s_mov_b32 s66, 0
Lpoll_52:
    buffer_load_dwordx4 v[8:11], v12, s[72:75], 0 offen sc1
    s_waitcnt vmcnt(0)
    v_min_u32 v8, v8, v9
    v_min_u32 v10, v10, v11
    v_min_u32 v8, v8, v10
    v_cmp_gt_u32 vcc, 4, v8
    s_add_u32 s66, s66, 1
    s_cmp_ge_u32 s66, 0x40000
    s_cbranch_scc1 Lpoll_52_x
    s_nop 3
    s_cmp_eq_u64 vcc, 0
    s_cbranch_scc1 Lpoll_52_x
    s_sleep 4
    s_branch Lpoll_52
Lpoll_52_x:
    s_mov_b64 exec, -1
    s_nop 7
    s_nop 7
    s_barrier
    s_add_u32 s62, s64, 98304
    s_add_u32 m0, s65, 98304
    s_nop 0
    buffer_load_dwordx4 v4, s[40:43], s62 offen lds
    s_add_u32 s62, s64, 106496
    s_add_u32 m0, s65, 99328
    s_nop 0
    buffer_load_dwordx4 v4, s[40:43], s62 offen lds
    s_add_u32 s62, s64, 212992
    s_add_u32 m0, s65, 100352
    s_nop 0
    buffer_load_dwordx4 v4, s[40:43], s62 offen lds
    s_add_u32 s62, s64, 221184
    s_add_u32 m0, s65, 101376
    s_nop 0
    buffer_load_dwordx4 v4, s[40:43], s62 offen lds
    s_add_u32 s62, s64, 229376
    s_add_u32 m0, s65, 114688
    s_nop 0
    buffer_load_dwordx4 v4, s[40:43], s62 offen lds
    s_add_u32 s62, s64, 237568
    s_add_u32 m0, s65, 115712
    s_nop 0
    buffer_load_dwordx4 v4, s[40:43], s62 offen lds
    s_add_u32 s62, s64, 245760
    s_add_u32 m0, s65, 116736
    s_nop 0
    buffer_load_dwordx4 v4, s[40:43], s62 offen lds
    s_add_u32 s62, s64, 253952
    s_add_u32 m0, s65, 117760
    s_nop 0
    buffer_load_dwordx4 v4, s[40:43], s62 offen lds
    s_add_u32 s62, s64, 262144
    s_add_u32 m0, s65, 131072
    s_nop 0
    buffer_load_dwordx4 v4, s[40:43], s62 offen lds
    s_add_u32 s62, s64, 270336
    s_add_u32 m0, s65, 132096
    s_nop 0
    buffer_load_dwordx4 v4, s[40:43], s62 offen lds
    s_add_u32 s62, s64, 278528
    s_add_u32 m0, s65, 133120
    s_nop 0
    buffer_load_dwordx4 v4, s[40:43], s62 offen lds
    s_add_u32 s62, s64, 286720
    s_add_u32 m0, s65, 134144
    s_nop 0
    buffer_load_dwordx4 v4, s[40:43], s62 offen lds
    s_barrier
    s_barrier
    s_add_u32 s62, s64, 294912
    s_add_u32 m0, s65, 0
    s_nop 0
    buffer_load_dwordx4 v4, s[40:43], s62 offen lds
    s_add_u32 s62, s64, 303104
    s_add_u32 m0, s65, 1024
    s_nop 0
    buffer_load_dwordx4 v4, s[40:43], s62 offen lds
    s_add_u32 s62, s64, 311296
    s_add_u32 m0, s65, 2048
    s_nop 0
    buffer_load_dwordx4 v4, s[40:43], s62 offen lds
    s_add_u32 s62, s64, 319488
    s_add_u32 m0, s65, 3072
    s_nop 0
    buffer_load_dwordx4 v4, s[40:43], s62 offen lds
    s_barrier
    s_add_u32 s62, s64, 344064
    s_add_u32 m0, s65, 16384
    s_nop 0
    buffer_load_dwordx4 v4, s[40:43], s62 offen lds
    s_add_u32 s62, s64, 352256
    s_add_u32 m0, s65, 17408
    s_nop 0
    buffer_load_dwordx4 v4, s[40:43], s62 offen lds
    s_add_u32 s62, s64, 360448
    s_add_u32 m0, s65, 18432
    s_nop 0
    buffer_load_dwordx4 v4, s[40:43], s62 offen lds
    s_add_u32 s62, s64, 368640
    s_add_u32 m0, s65, 19456
    s_nop 0
    buffer_load_dwordx4 v4, s[40:43], s62 offen lds
    s_barrier
    s_add_u32 s62, s64, 376832
    s_add_u32 m0, s65, 32768
    s_nop 0
    buffer_load_dwordx4 v4, s[40:43], s62 offen lds
    s_add_u32 s62, s64, 385024
    s_add_u32 m0, s65, 33792
    s_nop 0
    buffer_load_dwordx4 v4, s[40:43], s62 offen lds
    s_add_u32 s62, s64, 393216
    s_add_u32 m0, s65, 34816
    s_nop 0
    buffer_load_dwordx4 v4, s[40:43], s62 offen lds
    s_add_u32 s62, s64, 401408
    s_add_u32 m0, s65, 35840
    s_nop 0
    buffer_load_dwordx4 v4, s[40:43], s62 offen lds
    s_barrier
    s_add_u32 s62, s64, 409600
    s_add_u32 m0, s65, 49152
    s_nop 0
    buffer_load_dwordx4 v4, s[40:43], s62 offen lds
    s_add_u32 s62, s64, 417792
    s_add_u32 m0, s65, 50176
    s_nop 0
    buffer_load_dwordx4 v4, s[40:43], s62 offen lds
    s_add_u32 s62, s64, 425984
    s_add_u32 m0, s65, 51200
    s_nop 0
    buffer_load_dwordx4 v4, s[40:43], s62 offen lds
    s_add_u32 s62, s64, 434176
    s_add_u32 m0, s65, 52224
    s_nop 0
    buffer_load_dwordx4 v4, s[40:43], s62 offen lds
    s_barrier
    s_add_u32 s62, s64, 327680
    s_add_u32 m0, s65, 65536
    s_nop 0
    buffer_load_dwordx4 v4, s[40:43], s62 offen lds
    s_add_u32 s62, s64, 335872
    s_add_u32 m0, s65, 66560
    s_nop 0
    buffer_load_dwordx4 v4, s[40:43], s62 offen lds
    s_add_u32 s62, s64, 442368
    s_add_u32 m0, s65, 67584
    s_nop 0
    buffer_load_dwordx4 v4, s[40:43], s62 offen lds
    s_add_u32 s62, s64, 450560
    s_add_u32 m0, s65, 68608
    s_nop 0
    buffer_load_dwordx4 v4, s[40:43], s62 offen lds
    s_waitcnt vmcnt(28)
    s_barrier
    s_waitcnt vmcnt(24)
    s_barrier
    s_waitcnt vmcnt(20)
    s_barrier
    s_waitcnt vmcnt(16)
    s_barrier
    s_waitcnt vmcnt(12)
    s_barrier
    s_waitcnt vmcnt(8)
    s_barrier
    s_waitcnt vmcnt(4)
    s_barrier
    s_waitcnt vmcnt(0)
    s_barrier
    s_lshl_b32 s60, s5, 2
    s_add_u32 s60, s60, s7
    s_lshl_b32 s60, s60, 15
    s_lshl_b32 s63, s7, 10
    s_lshl_b32 s64, s7, 12
    s_mul_i32 s61, s6, 98304
    s_add_u32 s61, s61, s63
    s_add_u32 s40, s38, 0x800000
    s_addc_u32 s41, s39, 0
    s_mov_b32 s42, 0x200000
    s_mov_b32 s43, 0x00020000
    s_add_u32 s44, s38, 0x1600000
    s_addc_u32 s45, s39, 0
    s_mov_b32 s46, 0x180000
    s_mov_b32 s47, 0x00020000
    v_lshlrev_b32 v4, 4, v1
    s_barrier
    s_add_u32 s62, s61, 0
    s_add_u32 m0, s63, 0
    s_nop 0
    buffer_load_dwordx4 v4, s[44:47], s62 offen lds
    s_add_u32 s62, s61, 4096
    s_add_u32 m0, s63, 4096
    s_nop 0
    buffer_load_dwordx4 v4, s[44:47], s62 offen lds
    s_add_u32 s62, s61, 8192
    s_add_u32 m0, s63, 8192
    s_nop 0
    buffer_load_dwordx4 v4, s[44:47], s62 offen lds
    s_add_u32 s62, s61, 12288
    s_add_u32 m0, s63, 12288
    s_nop 0
    buffer_load_dwordx4 v4, s[44:47], s62 offen lds
    s_add_u32 s62, s61, 16384
    s_add_u32 m0, s63, 16384
    s_nop 0
    buffer_load_dwordx4 v4, s[44:47], s62 offen lds
    s_add_u32 s62, s61, 20480
    s_add_u32 m0, s63, 20480
    s_nop 0
    buffer_load_dwordx4 v4, s[44:47], s62 offen lds
    s_add_u32 s62, s61, 24576
    s_add_u32 m0, s63, 24576
    s_nop 0
    buffer_load_dwordx4 v4, s[44:47], s62 offen lds
    s_add_u32 s62, s61, 28672
    s_add_u32 m0, s63, 28672
    s_nop 0
    buffer_load_dwordx4 v4, s[44:47], s62 offen lds
    s_add_u32 s62, s61, 32768
    s_add_u32 m0, s63, 32768
    s_nop 0
    buffer_load_dwordx4 v4, s[44:47], s62 offen lds
    s_add_u32 s62, s61, 36864
    s_add_u32 m0, s63, 36864
    s_nop 0
    buffer_load_dwordx4 v4, s[44:47], s62 offen lds
    s_add_u32 s62, s61, 40960
    s_add_u32 m0, s63, 40960
    s_nop 0
    buffer_load_dwordx4 v4, s[44:47], s62 offen lds
    s_add_u32 s62, s61, 45056
    s_add_u32 m0, s63, 45056
    s_nop 0
    buffer_load_dwordx4 v4, s[44:47], s62 offen lds
    s_add_u32 s62, s61, 49152
    s_add_u32 m0, s63, 49152
    s_nop 0
    buffer_load_dwordx4 v4, s[44:47], s62 offen lds
    s_add_u32 s62, s61, 53248
    s_add_u32 m0, s63, 53248
    s_nop 0
    buffer_load_dwordx4 v4, s[44:47], s62 offen lds
    s_add_u32 s62, s61, 57344
    s_add_u32 m0, s63, 57344
    s_nop 0
    buffer_load_dwordx4 v4, s[44:47], s62 offen lds
    s_add_u32 s62, s61, 61440
    s_add_u32 m0, s63, 61440
    s_nop 0
    buffer_load_dwordx4 v4, s[44:47], s62 offen lds
    s_add_u32 s62, s61, 65536
    s_add_u32 m0, s63, 65536
    s_nop 0
    buffer_load_dwordx4 v4, s[44:47], s62 offen lds
    s_add_u32 s62, s61, 69632
    s_add_u32 m0, s63, 69632
    s_nop 0
    buffer_load_dwordx4 v4, s[44:47], s62 offen lds
    s_add_u32 s62, s61, 73728
    s_add_u32 m0, s63, 73728
    s_nop 0
    buffer_load_dwordx4 v4, s[44:47], s62 offen lds
    s_add_u32 s62, s61, 77824
    s_add_u32 m0, s63, 77824
    s_nop 0
    buffer_load_dwordx4 v4, s[44:47], s62 offen lds
    s_add_u32 s62, s61, 81920
    s_add_u32 m0, s63, 81920
    s_nop 0
    buffer_load_dwordx4 v4, s[44:47], s62 offen lds
    s_barrier
    s_barrier
    s_lshl_b32 s67, s5, 8
    v_lshlrev_b32 v12, 4, v1
    v_add_u32 v12, s67, v12
    s_mov_b64 exec, 0xf
    s_mov_b32 s66, 0
Lpoll_53:
    buffer_load_dwordx4 v[8:11], v12, s[72:75], 0 offen sc1
    s_waitcnt vmcnt(0)
    v_min_u32 v8, v8, v9
    v_min_u32 v10, v10, v11
    v_min_u32 v8, v8, v10
    v_cmp_gt_u32 vcc, 5, v8
    s_add_u32 s66, s66, 1
    s_cmp_ge_u32 s66, 0x40000
    s_cbranch_scc1 Lpoll_53_x
    s_nop 3
    s_cmp_eq_u64 vcc, 0
    s_cbranch_scc1 Lpoll_53_x
    s_sleep 4
    s_branch Lpoll_53
Lpoll_53_x:
    s_mov_b64 exec, -1
    s_nop 7
    s_nop 7
    s_add_u32 s62, s60, 0
    s_add_u32 m0, s64, 86016
    s_nop 0
    buffer_load_dwordx4 v4, s[40:43], s62 offen sc1 lds
    s_add_u32 s62, s60, 1024
    s_add_u32 m0, s64, 87040
    s_nop 0
    buffer_load_dwordx4 v4, s[40:43], s62 offen sc1 lds
    s_add_u32 s62, s60, 16384
    s_add_u32 m0, s64, 88064
    s_nop 0
    buffer_load_dwordx4 v4, s[40:43], s62 offen sc1 lds
    s_add_u32 s62, s60, 17408
    s_add_u32 m0, s64, 89088
    s_nop 0
    buffer_load_dwordx4 v4, s[40:43], s62 offen sc1 lds
    s_add_u32 s62, s60, 2048
    s_add_u32 m0, s64, 102400
    s_nop 0
    buffer_load_dwordx4 v4, s[40:43], s62 offen sc1 lds
    s_add_u32 s62, s60, 3072
    s_add_u32 m0, s64, 103424
    s_nop 0
    buffer_load_dwordx4 v4, s[40:43], s62 offen sc1 lds
    s_add_u32 s62, s60, 18432
    s_add_u32 m0, s64, 104448
    s_nop 0
    buffer_load_dwordx4 v4, s[40:43], s62 offen sc1 lds
    s_add_u32 s62, s60, 19456
    s_add_u32 m0, s64, 105472
    s_nop 0
    buffer_load_dwordx4 v4, s[40:43], s62 offen sc1 lds
    s_add_u32 s62, s60, 4096
    s_add_u32 m0, s64, 118784
    s_nop 0
    buffer_load_dwordx4 v4, s[40:43], s62 offen sc1 lds
    s_add_u32 s62, s60, 5120
    s_add_u32 m0, s64, 119808
    s_nop 0
    buffer_load_dwordx4 v4, s[40:43], s62 offen sc1 lds
    s_add_u32 s62, s60, 20480
    s_add_u32 m0, s64, 120832
    s_nop 0
    buffer_load_dwordx4 v4, s[40:43], s62 offen sc1 lds
    s_add_u32 s62, s60, 21504
    s_add_u32 m0, s64, 121856
    s_nop 0
    buffer_load_dwordx4 v4, s[40:43], s62 offen sc1 lds
    s_add_u32 s48, s38, 0x14c0000
    s_addc_u32 s49, s39, 0
    s_mov_b32 s50, 0x20000
    s_mov_b32 s51, 0x00020000
    v_and_b32 v14, 31, v1
    v_lshlrev_b32 v32, 6, v14
    s_lshl_b32 s62, s5, 2
    s_add_u32 s62, s62, s7
    s_lshl_b32 s62, s62, 11
    buffer_load_dwordx4 v[16:19], v32, s[48:51], s62 offen offset:0 sc1
    buffer_load_dwordx4 v[20:23], v32, s[48:51], s62 offen offset:16 sc1
    buffer_load_dwordx4 v[24:27], v32, s[48:51], s62 offen offset:32 sc1
    buffer_load_dwordx4 v[28:31], v32, s[48:51], s62 offen offset:48 sc1
    s_waitcnt vmcnt(12)
    s_barrier
    s_add_u32 s62, s60, 6144
    s_add_u32 m0, s64, 135168
    s_nop 0
    buffer_load_dwordx4 v4, s[40:43], s62 offen sc1 lds
    s_add_u32 s62, s60, 7168
    s_add_u32 m0, s64, 136192
    s_nop 0
    buffer_load_dwordx4 v4, s[40:43], s62 offen sc1 lds
    s_add_u32 s62, s60, 22528
    s_add_u32 m0, s64, 137216
    s_nop 0
    buffer_load_dwordx4 v4, s[40:43], s62 offen sc1 lds
    s_add_u32 s62, s60, 23552
    s_add_u32 m0, s64, 138240
    s_nop 0
    buffer_load_dwordx4 v4, s[40:43], s62 offen sc1 lds
    s_waitcnt vmcnt(12)
    s_barrier
    s_add_u32 s62, s60, 8192
    s_add_u32 m0, s64, 86016
    s_nop 0
    buffer_load_dwordx4 v4, s[40:43], s62 offen sc1 lds
    s_add_u32 s62, s60, 9216
    s_add_u32 m0, s64, 87040
    s_nop 0
    buffer_load_dwordx4 v4, s[40:43], s62 offen sc1 lds
    s_add_u32 s62, s60, 24576
    s_add_u32 m0, s64, 88064
    s_nop 0
    buffer_load_dwordx4 v4, s[40:43], s62 offen sc1 lds
    s_add_u32 s62, s60, 25600
    s_add_u32 m0, s64, 89088
    s_nop 0
    buffer_load_dwordx4 v4, s[40:43], s62 offen sc1 lds
    s_waitcnt vmcnt(8)
    v_pk_add_f32 v[16:17], v[16:17], v[18:19]
    v_pk_add_f32 v[16:17], v[16:17], v[20:21]
    v_pk_add_f32 v[16:17], v[16:17], v[22:23]
    v_pk_add_f32 v[16:17], v[16:17], v[24:25]
    v_pk_add_f32 v[16:17], v[16:17], v[26:27]
    v_pk_add_f32 v[16:17], v[16:17], v[28:29]
    v_pk_add_f32 v[16:17], v[16:17], v[30:31]
    v_mul_f32 v16, 0x3b000000, v16
    v_mul_f32 v17, 0x3b000000, v17
    v_fma_f32 v17, -v16, v16, v17
    v_max_f32 v17, 0, v17
    v_mov_b32 v33, v17
    v_cvt_pk_bf16_f32 v32, v33, v33
    v_lshlrev_b32 v33, 16, v32
    v_add_f32 v33, 0x3727c5ac, v33
    v_cvt_pk_bf16_f32 v32, v33, v33
    v_lshlrev_b32 v33, 16, v32
    v_sqrt_f32 v33, v33
    s_nop 0
    v_cvt_pk_bf16_f32 v32, v33, v33
    v_lshlrev_b32 v33, 16, v32
    v_cvt_pk_bf16_f32 v32, v16, v16
    v_lshlrev_b32 v32, 16, v32
    v_rcp_f32 v17, v33
    s_nop 0
    v_mul_f32 v16, -v32, v17
    s_lshl_b32 s62, s7, 8
    s_add_u32 s62, s62, 161792
    v_lshlrev_b32 v14, 3, v14
    v_add_u32 v14, s62, v14
    ds_write_b64 v14, v[16:17]
    s_waitcnt lgkmcnt(0)
    s_barrier
    s_add_u32 s62, s60, 10240
    s_add_u32 m0, s64, 102400
    s_nop 0
    buffer_load_dwordx4 v4, s[40:43], s62 offen sc1 lds
    s_add_u32 s62, s60, 11264
    s_add_u32 m0, s64, 103424
    s_nop 0
    buffer_load_dwordx4 v4, s[40:43], s62 offen sc1 lds
    s_add_u32 s62, s60, 26624
    s_add_u32 m0, s64, 104448
    s_nop 0
    buffer_load_dwordx4 v4, s[40:43], s62 offen sc1 lds
    s_add_u32 s62, s60, 27648
    s_add_u32 m0, s64, 105472
    s_nop 0
    buffer_load_dwordx4 v4, s[40:43], s62 offen sc1 lds
    s_waitcnt vmcnt(8)
    s_barrier
    s_add_u32 s62, s60, 12288
    s_add_u32 m0, s64, 118784
    s_nop 0
    buffer_load_dwordx4 v4, s[40:43], s62 offen sc1 lds
    s_add_u32 s62, s60, 13312
    s_add_u32 m0, s64, 119808
    s_nop 0
    buffer_load_dwordx4 v4, s[40:43], s62 offen sc1 lds
    s_add_u32 s62, s60, 28672
    s_add_u32 m0, s64, 120832
    s_nop 0
    buffer_load_dwordx4 v4, s[40:43], s62 offen sc1 lds
    s_add_u32 s62, s60, 29696
    s_add_u32 m0, s64, 121856
    s_nop 0
    buffer_load_dwordx4 v4, s[40:43], s62 offen sc1 lds
    s_waitcnt vmcnt(8)
    s_barrier
    s_add_u32 s62, s61, 86016
    s_add_u32 m0, s63, 0
    s_nop 0
    buffer_load_dwordx4 v4, s[44:47], s62 offen lds
    s_add_u32 s62, s61, 90112
    s_add_u32 m0, s63, 4096
    s_nop 0
    buffer_load_dwordx4 v4, s[44:47], s62 offen lds
    s_add_u32 s62, s61, 94208
    s_add_u32 m0, s63, 8192
    s_nop 0
    buffer_load_dwordx4 v4, s[44:47], s62 offen lds
    s_add_u32 s62, s60, 14336
    s_add_u32 m0, s64, 135168
    s_nop 0
    buffer_load_dwordx4 v4, s[40:43], s62 offen sc1 lds
    s_add_u32 s62, s60, 15360
    s_add_u32 m0, s64, 136192
    s_nop 0
    buffer_load_dwordx4 v4, s[40:43], s62 offen sc1 lds
    s_add_u32 s62, s60, 30720
    s_add_u32 m0, s64, 137216
    s_nop 0
    buffer_load_dwordx4 v4, s[40:43], s62 offen sc1 lds
    s_add_u32 s62, s60, 31744
    s_add_u32 m0, s64, 138240
    s_nop 0
    buffer_load_dwordx4 v4, s[40:43], s62 offen sc1 lds
    s_waitcnt vmcnt(11)
    s_barrier
    s_waitcnt vmcnt(7)
    s_barrier
    s_waitcnt vmcnt(0)
    s_barrier
    s_lshr_b32 s60, s6, 3
    s_lshl_b32 s61, s5, 1
    s_add_u32 s60, s60, s61
    s_and_b32 s61, s6, 7
    v_lshrrev_b32 v7, 3, v1
    v_lshlrev_b32 v4, 10, v7
    v_lshrrev_b32 v14, 1, v1
    v_xor_b32 v7, v2, v14
    v_and_b32 v7, 3, v7
    v_lshl_add_u32 v4, v7, 5, v4
    v_and_b32 v7, 1, v1
    v_lshl_add_u32 v4, v7, 4, v4
    v_lshrrev_b32 v7, 3, v1
    v_and_b32 v14, 7, v1
    v_xor_b32 v14, v14, v7
    v_lshlrev_b32 v6, 7, v7
    v_lshl_add_u32 v6, v14, 4, v6
    s_mov_b32 s40, s22
    s_mov_b32 s41, s23
    s_mov_b32 s42, 0x80000
    s_mov_b32 s43, 0x00020000
    s_add_u32 s44, s38, 0x2000000
    s_addc_u32 s45, s39, 0
    s_mov_b32 s46, 0x420000
    s_mov_b32 s47, 0x00020000
    s_add_u32 s48, s38, 0x1411000
    s_addc_u32 s49, s39, 0
    s_mov_b32 s50, 0x11000
    s_mov_b32 s51, 0x00020000
    s_mul_i32 s63, s60, 135168
    s_lshl_b32 s62, s7, 13
    s_add_u32 s63, s63, s62
    s_mul_i32 s64, s7, 17408
    s_lshl_b32 s65, s7, 17
    s_lshl_b32 s62, s61, 7
    s_add_u32 s65, s65, s62
    s_lshl_b32 s68, s7, 11
    s_lshl_b32 s69, s7, 11
    v_lshrrev_b32 v7, 3, v1
    v_mul_u32_u24 v15, 2176, v7
    v_and_b32 v7, 7, v1
    v_lshl_add_u32 v15, v7, 4, v15
    v_lshlrev_b32 v5, 4, v1
    s_barrier
    s_add_u32 s62, s65, 0
    s_add_u32 m0, s69, 0
    s_nop 0
    buffer_load_dwordx4 v4, s[40:43], s62 offen lds
    s_add_u32 s62, s65, 8192
    s_add_u32 m0, s69, 1024
    s_nop 0
    buffer_load_dwordx4 v4, s[40:43], s62 offen lds
    s_add_u32 s62, s65, 16384
    s_add_u32 m0, s69, 8192
    s_nop 0
    buffer_load_dwordx4 v4, s[40:43], s62 offen lds
    s_add_u32 s62, s65, 24576
    s_add_u32 m0, s69, 9216
    s_nop 0
    buffer_load_dwordx4 v4, s[40:43], s62 offen lds
    s_add_u32 s62, s65, 32768
    s_add_u32 m0, s69, 16384
    s_nop 0
    buffer_load_dwordx4 v4, s[40:43], s62 offen lds
    s_add_u32 s62, s65, 40960
    s_add_u32 m0, s69, 17408
    s_nop 0
    buffer_load_dwordx4 v4, s[40:43], s62 offen lds
    s_add_u32 s62, s65, 49152
    s_add_u32 m0, s69, 24576
    s_nop 0
    buffer_load_dwordx4 v4, s[40:43], s62 offen lds
    s_add_u32 s62, s65, 57344
    s_add_u32 m0, s69, 25600
    s_nop 0
    buffer_load_dwordx4 v4, s[40:43], s62 offen lds
    s_add_u32 s62, s65, 65536
    s_add_u32 m0, s69, 32768
    s_nop 0
    buffer_load_dwordx4 v4, s[40:43], s62 offen lds
    s_add_u32 s62, s65, 73728
    s_add_u32 m0, s69, 33792
    s_nop 0
    buffer_load_dwordx4 v4, s[40:43], s62 offen lds
    s_add_u32 s62, s65, 81920
    s_add_u32 m0, s69, 40960
    s_nop 0
    buffer_load_dwordx4 v4, s[40:43], s62 offen lds
    s_add_u32 s62, s65, 90112
    s_add_u32 m0, s69, 41984
    s_nop 0
    buffer_load_dwordx4 v4, s[40:43], s62 offen lds
    s_add_u32 s62, s65, 98304
    s_add_u32 m0, s69, 49152
    s_nop 0
    buffer_load_dwordx4 v4, s[40:43], s62 offen lds
    s_add_u32 s62, s65, 106496
    s_add_u32 m0, s69, 50176
    s_nop 0
    buffer_load_dwordx4 v4, s[40:43], s62 offen lds
    s_add_u32 s62, s65, 114688
    s_add_u32 m0, s69, 57344
    s_nop 0
    buffer_load_dwordx4 v4, s[40:43], s62 offen lds
    s_add_u32 s62, s65, 122880
    s_add_u32 m0, s69, 58368
    s_nop 0
    buffer_load_dwordx4 v4, s[40:43], s62 offen lds
    s_barrier
    s_barrier
    v_mov_b32 v13, 163776
    s_mov_b32 s66, 0
    s_cmp_lg_u32 s4, 8
    s_cbranch_scc1 Lpw_54
    s_lshl_b32 s67, s5, 8
    v_lshlrev_b32 v12, 4, v1
    v_add_u32 v12, s67, v12
    s_mov_b64 exec, 0xf
    s_mov_b32 s66, 0
Lpoll_56:
    buffer_load_dwordx4 v[8:11], v12, s[72:75], 0 offen sc1
    s_waitcnt vmcnt(0)
    v_min_u32 v8, v8, v9
    v_min_u32 v10, v10, v11
    v_min_u32 v8, v8, v10
    v_cmp_gt_u32 vcc, 6, v8
    s_add_u32 s66, s66, 1
    s_cmp_ge_u32 s66, 0x40000
    s_cbranch_scc1 Lpoll_56_x
    s_nop 3
    s_cmp_eq_u64 vcc, 0
    s_cbranch_scc1 Lpoll_56_x
    s_sleep 4
    s_branch Lpoll_56
Lpoll_56_x:
    s_mov_b64 exec, -1
    s_nop 7
    s_nop 7
    s_lshl_b32 s67, s6, 8
    s_add_u32 s67, s67, 4096
    s_lshl_b32 s66, s5, 2
    s_add_u32 s66, s66, s67
    v_mov_b32 v8, 6
    v_mov_b32 v9, 0
    s_mov_b64 exec, 1
    buffer_store_dword v8, v9, s[72:75], s66 offen sc1
    s_mov_b64 exec, -1
    s_nop 1
    v_lshlrev_b32 v12, 4, v1
    v_add_u32 v12, s67, v12
    s_mov_b64 exec, 0xf
    s_mov_b32 s66, 0
Lpoll_57:
    buffer_load_dwordx4 v[8:11], v12, s[72:75], 0 offen sc1
    s_waitcnt vmcnt(0)
    v_min_u32 v8, v8, v9
    v_min_u32 v10, v10, v11
    v_min_u32 v8, v8, v10
    v_cmp_gt_u32 vcc, 6, v8
    s_add_u32 s66, s66, 1
    s_cmp_ge_u32 s66, 0x40000
    s_cbranch_scc1 Lpoll_57_x
    s_nop 3
    s_cmp_eq_u64 vcc, 0
    s_cbranch_scc1 Lpoll_57_x
    s_sleep 4
    s_branch Lpoll_57
Lpoll_57_x:
    s_mov_b64 exec, -1
    s_nop 7
    s_nop 7
    v_mov_b32 v8, 6
    ds_write_b32 v13, v8
    s_waitcnt lgkmcnt(0)
    s_branch Lpx_55
Lpw_54:
    ds_read_b32 v8, v13
    s_waitcnt lgkmcnt(0)
    v_readfirstlane_b32 s67, v8
    s_add_u32 s66, s66, 1
    s_cmp_ge_u32 s66, 0x400000
    s_cbranch_scc1 Lpx_55
    s_cmp_eq_u32 s67, 6
    s_cbranch_scc1 Lpx_55
    s_sleep 1
    s_branch Lpw_54
Lpx_55:
    s_nop 7
    s_nop 7
    s_barrier
    s_add_u32 s62, s64, 2048
    s_lshl_b32 m0, s7, 10
    s_add_u32 m0, m0, 106496
    s_nop 0
    buffer_load_dwordx4 v15, s[48:51], s62 offen sc1 lds
    s_add_u32 s62, s64, 0
    s_add_u32 m0, s68, 65536
    s_nop 0
    buffer_load_dwordx4 v6, s[48:51], s62 offen sc1 lds
    s_add_u32 s62, s64, 1024
    s_add_u32 m0, s68, 66560
    s_nop 0
    buffer_load_dwordx4 v6, s[48:51], s62 offen sc1 lds
    s_add_u32 s62, s64, 2176
    s_add_u32 m0, s68, 73728
    s_nop 0
    buffer_load_dwordx4 v6, s[48:51], s62 offen sc1 lds
    s_add_u32 s62, s64, 3200
    s_add_u32 m0, s68, 74752
    s_nop 0
    buffer_load_dwordx4 v6, s[48:51], s62 offen sc1 lds
    s_add_u32 s62, s64, 4352
    s_add_u32 m0, s68, 81920
    s_nop 0
    buffer_load_dwordx4 v6, s[48:51], s62 offen sc1 lds
    s_add_u32 s62, s64, 5376
    s_add_u32 m0, s68, 82944
    s_nop 0
    buffer_load_dwordx4 v6, s[48:51], s62 offen sc1 lds
    s_add_u32 s62, s64, 6528
    s_add_u32 m0, s68, 90112
    s_nop 0
    buffer_load_dwordx4 v6, s[48:51], s62 offen sc1 lds
    s_add_u32 s62, s64, 7552
    s_add_u32 m0, s68, 91136
    s_nop 0
    buffer_load_dwordx4 v6, s[48:51], s62 offen sc1 lds
    s_waitcnt vmcnt(6)
    s_barrier
    s_add_u32 s62, s64, 8704
    s_add_u32 m0, s68, 98304
    s_nop 0
    buffer_load_dwordx4 v6, s[48:51], s62 offen sc1 lds
    s_add_u32 s62, s64, 9728
    s_add_u32 m0, s68, 99328
    s_nop 0
    buffer_load_dwordx4 v6, s[48:51], s62 offen sc1 lds
    s_waitcnt vmcnt(6)
    s_barrier
    s_add_u32 s62, s64, 10880
    s_add_u32 m0, s68, 65536
    s_nop 0
    buffer_load_dwordx4 v6, s[48:51], s62 offen sc1 lds
    s_add_u32 s62, s64, 11904
    s_add_u32 m0, s68, 66560
    s_nop 0
    buffer_load_dwordx4 v6, s[48:51], s62 offen sc1 lds
    s_waitcnt vmcnt(6)
    s_barrier
    s_add_u32 s62, s64, 13056
    s_add_u32 m0, s68, 73728
    s_nop 0
    buffer_load_dwordx4 v6, s[48:51], s62 offen sc1 lds
    s_add_u32 s62, s64, 14080
    s_add_u32 m0, s68, 74752
    s_nop 0
    buffer_load_dwordx4 v6, s[48:51], s62 offen sc1 lds
    s_waitcnt vmcnt(6)
    s_barrier
    s_add_u32 s62, s64, 15232
    s_add_u32 m0, s68, 81920
    s_nop 0
    buffer_load_dwordx4 v6, s[48:51], s62 offen sc1 lds
    s_add_u32 s62, s64, 16256
    s_add_u32 m0, s68, 82944
    s_nop 0
    buffer_load_dwordx4 v6, s[48:51], s62 offen sc1 lds
    s_waitcnt vmcnt(6)
    s_barrier
    s_waitcnt vmcnt(4)
    s_barrier
    s_waitcnt vmcnt(2)
    s_barrier
    s_waitcnt vmcnt(0)
    s_barrier
    s_lshl_b32 s60, s5, 2
    s_add_u32 s60, s60, s7
    s_lshl_b32 s60, s60, 15
    s_lshl_b32 s63, s7, 10
    s_lshl_b32 s64, s7, 12
    s_mul_i32 s61, s6, 114688
    s_add_u32 s61, s61, s63
    s_add_u32 s40, s38, 0xa00000
    s_addc_u32 s41, s39, 0
    s_mov_b32 s42, 0x200000
    s_mov_b32 s43, 0x00020000
    s_add_u32 s44, s38, 0x1800000
    s_addc_u32 s45, s39, 0
    s_mov_b32 s46, 0x1c0000
    s_mov_b32 s47, 0x00020000
    v_lshlrev_b32 v4, 4, v1
    s_barrier
    s_cmp_ge_u32 s7, 2
    s_cbranch_scc1 Lls_58
    s_add_u32 s62, s61, 12288
    s_add_u32 m0, s63, 12288
    s_nop 0
    buffer_load_dwordx4 v4, s[44:47], s62 offen lds
Lls_58:
    s_add_u32 s62, s61, 0
    s_add_u32 m0, s63, 0
    s_nop 0
    buffer_load_dwordx4 v4, s[44:47], s62 offen lds
    s_add_u32 s62, s61, 4096
    s_add_u32 m0, s63, 4096
    s_nop 0
    buffer_load_dwordx4 v4, s[44:47], s62 offen lds
    s_add_u32 s62, s61, 8192
    s_add_u32 m0, s63, 8192
    s_nop 0
    buffer_load_dwordx4 v4, s[44:47], s62 offen lds
    s_cmp_ge_u32 s7, 2
    s_cbranch_scc1 Lls_59
    s_add_u32 s62, s61, 26624
    s_add_u32 m0, s63, 26624
    s_nop 0
    buffer_load_dwordx4 v4, s[44:47], s62 offen lds
Lls_59:
    s_add_u32 s62, s61, 14336
    s_add_u32 m0, s63, 14336
    s_nop 0
    buffer_load_dwordx4 v4, s[44:47], s62 offen lds
    s_add_u32 s62, s61, 18432
    s_add_u32 m0, s63, 18432
    s_nop 0
    buffer_load_dwordx4 v4, s[44:47], s62 offen lds
    s_add_u32 s62, s61, 22528
    s_add_u32 m0, s63, 22528
    s_nop 0
    buffer_load_dwordx4 v4, s[44:47], s62 offen lds
    s_cmp_ge_u32 s7, 2
    s_cbranch_scc1 Lls_60
    s_add_u32 s62, s61, 40960
    s_add_u32 m0, s63, 40960
    s_nop 0
    buffer_load_dwordx4 v4, s[44:47], s62 offen lds
Lls_60:
    s_add_u32 s62, s61, 28672
    s_add_u32 m0, s63, 28672
    s_nop 0
    buffer_load_dwordx4 v4, s[44:47], s62 offen lds
    s_add_u32 s62, s61, 32768
    s_add_u32 m0, s63, 32768
    s_nop 0
    buffer_load_dwordx4 v4, s[44:47], s62 offen lds
    s_add_u32 s62, s61, 36864
    s_add_u32 m0, s63, 36864
    s_nop 0
    buffer_load_dwordx4 v4, s[44:47], s62 offen lds
    s_cmp_ge_u32 s7, 2
    s_cbranch_scc1 Lls_61
    s_add_u32 s62, s61, 55296
    s_add_u32 m0, s63, 55296
    s_nop 0
    buffer_load_dwordx4 v4, s[44:47], s62 offen lds
Lls_61:
    s_add_u32 s62, s61, 43008
    s_add_u32 m0, s63, 43008
    s_nop 0
    buffer_load_dwordx4 v4, s[44:47], s62 offen lds
    s_add_u32 s62, s61, 47104
    s_add_u32 m0, s63, 47104
    s_nop 0
    buffer_load_dwordx4 v4, s[44:47], s62 offen lds
    s_add_u32 s62, s61, 51200
    s_add_u32 m0, s63, 51200
    s_nop 0
    buffer_load_dwordx4 v4, s[44:47], s62 offen lds
    s_barrier
    s_barrier
    s_lshl_b32 s67, s5, 8
    v_lshlrev_b32 v12, 4, v1
    v_add_u32 v12, s67, v12
    s_mov_b64 exec, 0xf
    s_mov_b32 s66, 0
Lpoll_62:
    buffer_load_dwordx4 v[8:11], v12, s[72:75], 0 offen sc1
    s_waitcnt vmcnt(0)
    v_min_u32 v8, v8, v9
    v_min_u32 v10, v10, v11
    v_min_u32 v8, v8, v10
    v_cmp_gt_u32 vcc, 7, v8
    s_add_u32 s66, s66, 1
    s_cmp_ge_u32 s66, 0x40000
    s_cbranch_scc1 Lpoll_62_x
    s_nop 3
    s_cmp_eq_u64 vcc, 0
    s_cbranch_scc1 Lpoll_62_x
    s_sleep 4
    s_branch Lpoll_62
Lpoll_62_x:
    s_mov_b64 exec, -1
    s_nop 7
    s_nop 7
    s_add_u32 s62, s60, 0
    s_add_u32 m0, s64, 86016
    s_nop 0
    buffer_load_dwordx4 v4, s[40:43], s62 offen sc1 lds
    s_add_u32 s62, s60, 1024
    s_add_u32 m0, s64, 87040
    s_nop 0
    buffer_load_dwordx4 v4, s[40:43], s62 offen sc1 lds
    s_add_u32 s62, s60, 16384
    s_add_u32 m0, s64, 88064
    s_nop 0
    buffer_load_dwordx4 v4, s[40:43], s62 offen sc1 lds
    s_add_u32 s62, s60, 17408
    s_add_u32 m0, s64, 89088
    s_nop 0
    buffer_load_dwordx4 v4, s[40:43], s62 offen sc1 lds
    s_add_u32 s62, s60, 2048
    s_add_u32 m0, s64, 102400
    s_nop 0
    buffer_load_dwordx4 v4, s[40:43], s62 offen sc1 lds
    s_add_u32 s62, s60, 3072
    s_add_u32 m0, s64, 103424
    s_nop 0
    buffer_load_dwordx4 v4, s[40:43], s62 offen sc1 lds
    s_add_u32 s62, s60, 18432
    s_add_u32 m0, s64, 104448
    s_nop 0
    buffer_load_dwordx4 v4, s[40:43], s62 offen sc1 lds
    s_add_u32 s62, s60, 19456
    s_add_u32 m0, s64, 105472
    s_nop 0
    buffer_load_dwordx4 v4, s[40:43], s62 offen sc1 lds
    s_add_u32 s62, s60, 4096
    s_add_u32 m0, s64, 118784
    s_nop 0
    buffer_load_dwordx4 v4, s[40:43], s62 offen sc1 lds
    s_add_u32 s62, s60, 5120
    s_add_u32 m0, s64, 119808
    s_nop 0
    buffer_load_dwordx4 v4, s[40:43], s62 offen sc1 lds
    s_add_u32 s62, s60, 20480
    s_add_u32 m0, s64, 120832
    s_nop 0
    buffer_load_dwordx4 v4, s[40:43], s62 offen sc1 lds
    s_add_u32 s62, s60, 21504
    s_add_u32 m0, s64, 121856
    s_nop 0
    buffer_load_dwordx4 v4, s[40:43], s62 offen sc1 lds
    s_add_u32 s48, s38, 0x14e0000
    s_addc_u32 s49, s39, 0
    s_mov_b32 s50, 0x20000
    s_mov_b32 s51, 0x00020000
    v_and_b32 v14, 31, v1
    v_lshlrev_b32 v32, 6, v14
    s_lshl_b32 s62, s5, 2
    s_add_u32 s62, s62, s7
    s_lshl_b32 s62, s62, 11
    buffer_load_dwordx4 v[16:19], v32, s[48:51], s62 offen offset:0 sc1
    buffer_load_dwordx4 v[20:23], v32, s[48:51], s62 offen offset:16 sc1
    buffer_load_dwordx4 v[24:27], v32, s[48:51], s62 offen offset:32 sc1
    buffer_load_dwordx4 v[28:31], v32, s[48:51], s62 offen offset:48 sc1
    s_cmp_ge_u32 s7, 2
    s_cbranch_scc1 Lls_63
    s_add_u32 s62, s61, 69632
    s_add_u32 m0, s63, 69632
    s_nop 0
    buffer_load_dwordx4 v4, s[44:47], s62 offen lds
Lls_63:
    s_add_u32 s62, s61, 57344
    s_add_u32 m0, s63, 57344
    s_nop 0
    buffer_load_dwordx4 v4, s[44:47], s62 offen lds
    s_add_u32 s62, s61, 61440
    s_add_u32 m0, s63, 61440
    s_nop 0
    buffer_load_dwordx4 v4, s[44:47], s62 offen lds
    s_add_u32 s62, s61, 65536
    s_add_u32 m0, s63, 65536
    s_nop 0
    buffer_load_dwordx4 v4, s[44:47], s62 offen lds
    s_cmp_ge_u32 s7, 2
    s_cbranch_scc1 Lls_64
    s_add_u32 s62, s61, 83968
    s_add_u32 m0, s63, 83968
    s_nop 0
    buffer_load_dwordx4 v4, s[44:47], s62 offen lds
Lls_64:
    s_add_u32 s62, s61, 71680
    s_add_u32 m0, s63, 71680
    s_nop 0
    buffer_load_dwordx4 v4, s[44:47], s62 offen lds
    s_add_u32 s62, s61, 75776
    s_add_u32 m0, s63, 75776
    s_nop 0
    buffer_load_dwordx4 v4, s[44:47], s62 offen lds
    s_add_u32 s62, s61, 79872
    s_add_u32 m0, s63, 79872
    s_nop 0
    buffer_load_dwordx4 v4, s[44:47], s62 offen lds
    s_waitcnt vmcnt(18)
    s_barrier
    s_add_u32 s62, s60, 6144
    s_add_u32 m0, s64, 135168
    s_nop 0
    buffer_load_dwordx4 v4, s[40:43], s62 offen sc1 lds
    s_add_u32 s62, s60, 7168
    s_add_u32 m0, s64, 136192
    s_nop 0
    buffer_load_dwordx4 v4, s[40:43], s62 offen sc1 lds
    s_add_u32 s62, s60, 22528
    s_add_u32 m0, s64, 137216
    s_nop 0
    buffer_load_dwordx4 v4, s[40:43], s62 offen sc1 lds
    s_add_u32 s62, s60, 23552
    s_add_u32 m0, s64, 138240
    s_nop 0
    buffer_load_dwordx4 v4, s[40:43], s62 offen sc1 lds
    s_waitcnt vmcnt(18)
    s_barrier
    s_add_u32 s62, s60, 8192
    s_add_u32 m0, s64, 86016
    s_nop 0
    buffer_load_dwordx4 v4, s[40:43], s62 offen sc1 lds
    s_add_u32 s62, s60, 9216
    s_add_u32 m0, s64, 87040
    s_nop 0
    buffer_load_dwordx4 v4, s[40:43], s62 offen sc1 lds
    s_add_u32 s62, s60, 24576
    s_add_u32 m0, s64, 88064
    s_nop 0
    buffer_load_dwordx4 v4, s[40:43], s62 offen sc1 lds
    s_add_u32 s62, s60, 25600
    s_add_u32 m0, s64, 89088
    s_nop 0
    buffer_load_dwordx4 v4, s[40:43], s62 offen sc1 lds
    s_waitcnt vmcnt(14)
    v_pk_add_f32 v[16:17], v[16:17], v[18:19]
    v_pk_add_f32 v[16:17], v[16:17], v[20:21]
    v_pk_add_f32 v[16:17], v[16:17], v[22:23]
    v_pk_add_f32 v[16:17], v[16:17], v[24:25]
    v_pk_add_f32 v[16:17], v[16:17], v[26:27]
    v_pk_add_f32 v[16:17], v[16:17], v[28:29]
    v_pk_add_f32 v[16:17], v[16:17], v[30:31]
    v_mul_f32 v16, 0x3b000000, v16
    v_mul_f32 v17, 0x3b000000, v17
    v_fma_f32 v17, -v16, v16, v17
    v_max_f32 v17, 0, v17
    v_mov_b32 v33, v17
    v_cvt_pk_bf16_f32 v32, v33, v33
    v_lshlrev_b32 v33, 16, v32
    v_add_f32 v33, 0x3727c5ac, v33
    v_cvt_pk_bf16_f32 v32, v33, v33
    v_lshlrev_b32 v33, 16, v32
    v_sqrt_f32 v33, v33
    s_nop 0
    v_cvt_pk_bf16_f32 v32, v33, v33
    v_lshlrev_b32 v33, 16, v32
    v_cvt_pk_bf16_f32 v32, v16, v16
    v_lshlrev_b32 v32, 16, v32
    v_rcp_f32 v33, v33
    v_sub_f32 v16, v16, v32
    v_mul_f32 v16, v16, v33
    v_mul_f32 v17, v17, v33
    v_mul_f32 v17, v17, v33
    v_mul_f32 v32, v32, v33
    v_cvt_pk_bf16_f32 v16, v16, v16
    v_lshlrev_b32 v16, 16, v16
    v_add_f32 v16, v16, v32
    v_cvt_pk_bf16_f32 v32, v17, v17
    v_lshlrev_b32 v17, 16, v32
    v_add_f32 v17, 0x3727c5ac, v17
    v_cvt_pk_bf16_f32 v32, v17, v17
    v_lshlrev_b32 v17, 16, v32
    v_sqrt_f32 v17, v17
    s_nop 0
    v_cvt_pk_bf16_f32 v32, v17, v17
    v_lshlrev_b32 v17, 16, v32
    v_rcp_f32 v17, v17
    s_nop 0
    v_mul_f32 v16, -v16, v17
    v_mul_f32 v17, v17, v33
    s_lshl_b32 s62, s7, 8
    s_add_u32 s62, s62, 161792
    v_lshlrev_b32 v14, 3, v14
    v_add_u32 v14, s62, v14
    ds_write_b64 v14, v[16:17]
    s_waitcnt lgkmcnt(0)
    s_barrier
    s_add_u32 s62, s60, 10240
    s_add_u32 m0, s64, 102400
    s_nop 0
    buffer_load_dwordx4 v4, s[40:43], s62 offen sc1 lds
    s_add_u32 s62, s60, 11264
    s_add_u32 m0, s64, 103424
    s_nop 0
    buffer_load_dwordx4 v4, s[40:43], s62 offen sc1 lds
    s_add_u32 s62, s60, 26624
    s_add_u32 m0, s64, 104448
    s_nop 0
    buffer_load_dwordx4 v4, s[40:43], s62 offen sc1 lds
    s_add_u32 s62, s60, 27648
    s_add_u32 m0, s64, 105472
    s_nop 0
    buffer_load_dwordx4 v4, s[40:43], s62 offen sc1 lds
    s_waitcnt vmcnt(8)
    s_barrier
    s_cmp_ge_u32 s7, 2
    s_cbranch_scc1 Lls_65
    s_add_u32 s62, s61, 98304
    s_add_u32 m0, s63, 12288
    s_nop 0
    buffer_load_dwordx4 v4, s[44:47], s62 offen lds
Lls_65:
    s_add_u32 s62, s61, 86016
    s_add_u32 m0, s63, 0
    s_nop 0
    buffer_load_dwordx4 v4, s[44:47], s62 offen lds
    s_add_u32 s62, s61, 90112
    s_add_u32 m0, s63, 4096
    s_nop 0
    buffer_load_dwordx4 v4, s[44:47], s62 offen lds
    s_add_u32 s62, s61, 94208
    s_add_u32 m0, s63, 8192
    s_nop 0
    buffer_load_dwordx4 v4, s[44:47], s62 offen lds
    s_add_u32 s62, s60, 12288
    s_add_u32 m0, s64, 118784
    s_nop 0
    buffer_load_dwordx4 v4, s[40:43], s62 offen sc1 lds
    s_add_u32 s62, s60, 13312
    s_add_u32 m0, s64, 119808
    s_nop 0
    buffer_load_dwordx4 v4, s[40:43], s62 offen sc1 lds
    s_add_u32 s62, s60, 28672
    s_add_u32 m0, s64, 120832
    s_nop 0
    buffer_load_dwordx4 v4, s[40:43], s62 offen sc1 lds
    s_add_u32 s62, s60, 29696
    s_add_u32 m0, s64, 121856
    s_nop 0
    buffer_load_dwordx4 v4, s[40:43], s62 offen sc1 lds
    s_waitcnt vmcnt(11)
    s_barrier
    s_cmp_ge_u32 s7, 2
    s_cbranch_scc1 Lls_66
    s_add_u32 s62, s61, 112640
    s_add_u32 m0, s63, 26624
    s_nop 0
    buffer_load_dwordx4 v4, s[44:47], s62 offen lds
Lls_66:
    s_add_u32 s62, s61, 100352
    s_add_u32 m0, s63, 14336
    s_nop 0
    buffer_load_dwordx4 v4, s[44:47], s62 offen lds
    s_add_u32 s62, s61, 104448
    s_add_u32 m0, s63, 18432
    s_nop 0
    buffer_load_dwordx4 v4, s[44:47], s62 offen lds
    s_add_u32 s62, s61, 108544
    s_add_u32 m0, s63, 22528
    s_nop 0
    buffer_load_dwordx4 v4, s[44:47], s62 offen lds
    s_add_u32 s62, s60, 14336
    s_add_u32 m0, s64, 135168
    s_nop 0
    buffer_load_dwordx4 v4, s[40:43], s62 offen sc1 lds
    s_add_u32 s62, s60, 15360
    s_add_u32 m0, s64, 136192
    s_nop 0
    buffer_load_dwordx4 v4, s[40:43], s62 offen sc1 lds
    s_add_u32 s62, s60, 30720
    s_add_u32 m0, s64, 137216
    s_nop 0
    buffer_load_dwordx4 v4, s[40:43], s62 offen sc1 lds
    s_add_u32 s62, s60, 31744
    s_add_u32 m0, s64, 138240
    s_nop 0
    buffer_load_dwordx4 v4, s[40:43], s62 offen sc1 lds
    s_waitcnt vmcnt(14)
    s_barrier
    s_waitcnt vmcnt(7)
    s_barrier
    s_waitcnt vmcnt(0)
    s_barrier
    s_lshr_b32 s60, s6, 3
    s_lshl_b32 s61, s5, 1
    s_add_u32 s60, s60, s61
    s_and_b32 s61, s6, 7
    v_lshrrev_b32 v6, 3, v1
    v_lshlrev_b32 v4, 10, v6
    v_lshrrev_b32 v7, 1, v1
    v_xor_b32 v6, v2, v7
    v_and_b32 v6, 3, v6
    v_lshl_add_u32 v4, v6, 5, v4
    v_and_b32 v6, 1, v1
    v_lshl_add_u32 v4, v6, 4, v4
    s_mov_b32 s40, s30
    s_mov_b32 s41, s31
    s_mov_b32 s42, 0x1c0000
    s_mov_b32 s43, 0x00020000
    s_add_u32 s44, s38, 0x2500000
    s_addc_u32 s45, s39, 0
    s_mov_b32 s46, 0x720000
    s_mov_b32 s47, 0x00020000
    s_mul_i32 s63, s60, 233472
    s_mul_i32 s62, s7, 14336
    s_add_u32 s63, s63, s62
    s_mul_i32 s64, s7, 458752
    s_lshl_b32 s62, s61, 7
    s_add_u32 s64, s64, s62
    s_lshl_b32 s65, s7, 12
    v_lshlrev_b32 v5, 4, v1
    s_barrier
    s_add_u32 s62, s64, 0
    s_add_u32 m0, s65, 0
    s_nop 0
    buffer_load_dwordx4 v4, s[40:43], s62 offen lds
    s_add_u32 s62, s64, 8192
    s_add_u32 m0, s65, 1024
    s_nop 0
    buffer_load_dwordx4 v4, s[40:43], s62 offen lds
    s_add_u32 s62, s64, 16384
    s_add_u32 m0, s65, 2048
    s_nop 0
    buffer_load_dwordx4 v4, s[40:43], s62 offen lds
    s_add_u32 s62, s64, 24576
    s_add_u32 m0, s65, 3072
    s_nop 0
    buffer_load_dwordx4 v4, s[40:43], s62 offen lds
    s_add_u32 s62, s64, 32768
    s_add_u32 m0, s65, 16384
    s_nop 0
    buffer_load_dwordx4 v4, s[40:43], s62 offen lds
    s_add_u32 s62, s64, 40960
    s_add_u32 m0, s65, 17408
    s_nop 0
    buffer_load_dwordx4 v4, s[40:43], s62 offen lds
    s_add_u32 s62, s64, 49152
    s_add_u32 m0, s65, 18432
    s_nop 0
    buffer_load_dwordx4 v4, s[40:43], s62 offen lds
    s_add_u32 s62, s64, 57344
    s_add_u32 m0, s65, 19456
    s_nop 0
    buffer_load_dwordx4 v4, s[40:43], s62 offen lds
    s_add_u32 s62, s64, 65536
    s_add_u32 m0, s65, 32768
    s_nop 0
    buffer_load_dwordx4 v4, s[40:43], s62 offen lds
    s_add_u32 s62, s64, 73728
    s_add_u32 m0, s65, 33792
    s_nop 0
    buffer_load_dwordx4 v4, s[40:43], s62 offen lds
    s_add_u32 s62, s64, 81920
    s_add_u32 m0, s65, 34816
    s_nop 0
    buffer_load_dwordx4 v4, s[40:43], s62 offen lds
    s_add_u32 s62, s64, 90112
    s_add_u32 m0, s65, 35840
    s_nop 0
    buffer_load_dwordx4 v4, s[40:43], s62 offen lds
    s_add_u32 s62, s64, 114688
    s_add_u32 m0, s65, 49152
    s_nop 0
    buffer_load_dwordx4 v4, s[40:43], s62 offen lds
    s_add_u32 s62, s64, 122880
    s_add_u32 m0, s65, 50176
    s_nop 0
    buffer_load_dwordx4 v4, s[40:43], s62 offen lds
    s_add_u32 s62, s64, 131072
    s_add_u32 m0, s65, 51200
    s_nop 0
    buffer_load_dwordx4 v4, s[40:43], s62 offen lds
    s_add_u32 s62, s64, 139264
    s_add_u32 m0, s65, 52224
    s_nop 0
    buffer_load_dwordx4 v4, s[40:43], s62 offen lds
    s_add_u32 s62, s64, 147456
    s_add_u32 m0, s65, 65536
    s_nop 0
    buffer_load_dwordx4 v4, s[40:43], s62 offen lds
    s_add_u32 s62, s64, 155648
    s_add_u32 m0, s65, 66560
    s_nop 0
    buffer_load_dwordx4 v4, s[40:43], s62 offen lds
    s_add_u32 s62, s64, 163840
    s_add_u32 m0, s65, 67584
    s_nop 0
    buffer_load_dwordx4 v4, s[40:43], s62 offen lds
    s_add_u32 s62, s64, 172032
    s_add_u32 m0, s65, 68608
    s_nop 0
    buffer_load_dwordx4 v4, s[40:43], s62 offen lds
    s_add_u32 s62, s64, 180224
    s_add_u32 m0, s65, 81920
    s_nop 0
    buffer_load_dwordx4 v4, s[40:43], s62 offen lds
    s_add_u32 s62, s64, 188416
    s_add_u32 m0, s65, 82944
    s_nop 0
    buffer_load_dwordx4 v4, s[40:43], s62 offen lds
    s_add_u32 s62, s64, 196608
    s_add_u32 m0, s65, 83968
    s_nop 0
    buffer_load_dwordx4 v4, s[40:43], s62 offen lds
    s_add_u32 s62, s64, 204800
    s_add_u32 m0, s65, 84992
    s_nop 0
    buffer_load_dwordx4 v4, s[40:43], s62 offen lds
    s_barrier
    s_lshl_b32 s67, s5, 8
    v_lshlrev_b32 v12, 4, v1
    v_add_u32 v12, s67, v12
    s_mov_b64 exec, 0xf
    s_mov_b32 s66, 0
Lpoll_67:
    buffer_load_dwordx4 v[8:11], v12, s[72:75], 0 offen sc1
    s_waitcnt vmcnt(0)
    v_min_u32 v8, v8, v9
    v_min_u32 v10, v10, v11
    v_min_u32 v8, v8, v10
    v_cmp_gt_u32 vcc, 8, v8
    s_add_u32 s66, s66, 1
    s_cmp_ge_u32 s66, 0x40000
    s_cbranch_scc1 Lpoll_67_x
    s_nop 3
    s_cmp_eq_u64 vcc, 0
    s_cbranch_scc1 Lpoll_67_x
    s_sleep 4
    s_branch Lpoll_67
Lpoll_67_x:
    s_mov_b64 exec, -1
    s_nop 7
    s_nop 7
    s_barrier
    s_add_u32 s62, s64, 98304
    s_add_u32 m0, s65, 98304
    s_nop 0
    buffer_load_dwordx4 v4, s[40:43], s62 offen lds
    s_add_u32 s62, s64, 106496
    s_add_u32 m0, s65, 99328
    s_nop 0
    buffer_load_dwordx4 v4, s[40:43], s62 offen lds
    s_add_u32 s62, s64, 212992
    s_add_u32 m0, s65, 100352
    s_nop 0
    buffer_load_dwordx4 v4, s[40:43], s62 offen lds
    s_add_u32 s62, s64, 221184
    s_add_u32 m0, s65, 101376
    s_nop 0
    buffer_load_dwordx4 v4, s[40:43], s62 offen lds
    s_add_u32 s62, s64, 229376
    s_add_u32 m0, s65, 114688
    s_nop 0
    buffer_load_dwordx4 v4, s[40:43], s62 offen lds
    s_add_u32 s62, s64, 237568
    s_add_u32 m0, s65, 115712
    s_nop 0
    buffer_load_dwordx4 v4, s[40:43], s62 offen lds
    s_add_u32 s62, s64, 245760
    s_add_u32 m0, s65, 116736
    s_nop 0
    buffer_load_dwordx4 v4, s[40:43], s62 offen lds
    s_add_u32 s62, s64, 253952
    s_add_u32 m0, s65, 117760
    s_nop 0
    buffer_load_dwordx4 v4, s[40:43], s62 offen lds
    s_add_u32 s62, s64, 262144
    s_add_u32 m0, s65, 131072
    s_nop 0
    buffer_load_dwordx4 v4, s[40:43], s62 offen lds
    s_add_u32 s62, s64, 270336
    s_add_u32 m0, s65, 132096
    s_nop 0
    buffer_load_dwordx4 v4, s[40:43], s62 offen lds
    s_add_u32 s62, s64, 278528
    s_add_u32 m0, s65, 133120
    s_nop 0
    buffer_load_dwordx4 v4, s[40:43], s62 offen lds
    s_add_u32 s62, s64, 286720
    s_add_u32 m0, s65, 134144
    s_nop 0
    buffer_load_dwordx4 v4, s[40:43], s62 offen lds
    s_barrier
    s_barrier
    s_add_u32 s62, s64, 294912
    s_add_u32 m0, s65, 0
    s_nop 0
    buffer_load_dwordx4 v4, s[40:43], s62 offen lds
    s_add_u32 s62, s64, 303104
    s_add_u32 m0, s65, 1024
    s_nop 0
    buffer_load_dwordx4 v4, s[40:43], s62 offen lds
    s_add_u32 s62, s64, 311296
    s_add_u32 m0, s65, 2048
    s_nop 0
    buffer_load_dwordx4 v4, s[40:43], s62 offen lds
    s_add_u32 s62, s64, 319488
    s_add_u32 m0, s65, 3072
    s_nop 0
    buffer_load_dwordx4 v4, s[40:43], s62 offen lds
    s_barrier
    s_add_u32 s62, s64, 344064
    s_add_u32 m0, s65, 16384
    s_nop 0
    buffer_load_dwordx4 v4, s[40:43], s62 offen lds
    s_add_u32 s62, s64, 352256
    s_add_u32 m0, s65, 17408
    s_nop 0
    buffer_load_dwordx4 v4, s[40:43], s62 offen lds
    s_add_u32 s62, s64, 360448
    s_add_u32 m0, s65, 18432
    s_nop 0
    buffer_load_dwordx4 v4, s[40:43], s62 offen lds
    s_add_u32 s62, s64, 368640
    s_add_u32 m0, s65, 19456
    s_nop 0
    buffer_load_dwordx4 v4, s[40:43], s62 offen lds
    s_barrier
    s_add_u32 s62, s64, 376832
    s_add_u32 m0, s65, 32768
    s_nop 0
    buffer_load_dwordx4 v4, s[40:43], s62 offen lds
    s_add_u32 s62, s64, 385024
    s_add_u32 m0, s65, 33792
    s_nop 0
    buffer_load_dwordx4 v4, s[40:43], s62 offen lds
    s_add_u32 s62, s64, 393216
    s_add_u32 m0, s65, 34816
    s_nop 0
    buffer_load_dwordx4 v4, s[40:43], s62 offen lds
    s_add_u32 s62, s64, 401408
    s_add_u32 m0, s65, 35840
    s_nop 0
    buffer_load_dwordx4 v4, s[40:43], s62 offen lds
    s_barrier
    s_add_u32 s62, s64, 409600
    s_add_u32 m0, s65, 49152
    s_nop 0
    buffer_load_dwordx4 v4, s[40:43], s62 offen lds
    s_add_u32 s62, s64, 417792
    s_add_u32 m0, s65, 50176
    s_nop 0
    buffer_load_dwordx4 v4, s[40:43], s62 offen lds
    s_add_u32 s62, s64, 425984
    s_add_u32 m0, s65, 51200
    s_nop 0
    buffer_load_dwordx4 v4, s[40:43], s62 offen lds
    s_add_u32 s62, s64, 434176
    s_add_u32 m0, s65, 52224
    s_nop 0
    buffer_load_dwordx4 v4, s[40:43], s62 offen lds
    s_barrier
    s_add_u32 s62, s64, 327680
    s_add_u32 m0, s65, 65536
    s_nop 0
    buffer_load_dwordx4 v4, s[40:43], s62 offen lds
    s_add_u32 s62, s64, 335872
    s_add_u32 m0, s65, 66560
    s_nop 0
    buffer_load_dwordx4 v4, s[40:43], s62 offen lds
    s_add_u32 s62, s64, 442368
    s_add_u32 m0, s65, 67584
    s_nop 0
    buffer_load_dwordx4 v4, s[40:43], s62 offen lds
    s_add_u32 s62, s64, 450560
    s_add_u32 m0, s65, 68608
    s_nop 0
    buffer_load_dwordx4 v4, s[40:43], s62 offen lds
    s_waitcnt vmcnt(28)
    s_barrier
    s_waitcnt vmcnt(24)
    s_barrier
    s_waitcnt vmcnt(20)
    s_barrier
    s_waitcnt vmcnt(16)
    s_barrier
    s_waitcnt vmcnt(12)
    s_barrier
    s_waitcnt vmcnt(8)
    s_barrier
    s_waitcnt vmcnt(4)
    s_barrier
    s_waitcnt vmcnt(0)
    s_barrier
    s_endpgm
mega_kernel_compute:
    s_nop 7
    s_nop 7
    s_cmp_lg_u32 s4, 0
    s_cbranch_scc1 Litc_68
    s_mov_b32 s72, s18
    s_mov_b32 s73, s19
    s_mov_b32 s74, 0x180000
    s_mov_b32 s75, 0x00020000
    s_lshl_b32 s76, s5, 4
    s_add_u32 s76, s76, s6
    s_mul_i32 s76, s76, 6144
    v_lshlrev_b32 v164, 7, v1
    s_mov_b32 exec_lo, 0xffffffff
    s_mov_b32 exec_hi, 0xffff
    buffer_load_dword v165, v164, s[72:75], s76 offen
    s_mov_b64 exec, -1
    s_nop 3
Litc_68:
    s_cmp_lg_u32 s4, 1
    s_cbranch_scc1 Litc_69
    s_mov_b32 s72, s16
    s_mov_b32 s73, s17
    s_mov_b32 s74, 0x200000
    s_mov_b32 s75, 0x00020000
    s_lshl_b32 s76, s5, 4
    s_add_u32 s76, s76, s6
    s_mul_i32 s76, s76, 8192
    v_lshlrev_b32 v164, 7, v1
    s_mov_b32 exec_lo, 0xffffffff
    s_mov_b32 exec_hi, 0xffffffff
    buffer_load_dword v165, v164, s[72:75], s76 offen
    s_mov_b64 exec, -1
    s_nop 3
Litc_69:
    s_lshl_b32 s63, s5, 2
    s_add_u32 s63, s63, s7
    s_mul_i32 s65, s63, 67584
    s_lshl_b32 s63, s63, 11
    s_lshl_b32 s62, s6, 1
    s_add_u32 s62, s62, s8
    s_lshl_b32 s60, s62, 10
    s_add_u32 s65, s65, s60
    s_mov_b32 s90, 0
    s_mov_b32 s91, 0
    s_mov_b32 s80, 0
    s_mov_b32 s81, 0
    s_mov_b32 s82, 0
    s_mov_b32 s83, 0
    s_add_u32 s92, s38, 0x1600000
    s_addc_u32 s93, s39, 0
    s_mov_b32 s94, 0x180000
    s_mov_b32 s95, 0x00020000
    v_mov_b32 v128, 0
    v_mov_b32 v129, 0
    v_mov_b32 v130, 0
    v_mov_b32 v131, 0
    s_lshl_b32 s84, s2, 2
    s_add_u32 s84, s84, s7
    v_lshlrev_b32 v132, 4, v1
    s_cmp_ge_u32 s84, 832
    s_cbranch_scc1 Lsjd_70
    s_cmp_lt_u32 s4, 4
    s_cbranch_scc1 Lsjd_70
    s_lshl_b32 s88, s7, 12
    s_add_u32 s88, s88, 145408
    v_lshrrev_b32 v80, 3, v1
    v_lshrrev_b32 v82, 1, v1
    v_xor_b32 v81, v2, v82
    v_and_b32 v81, 3, v81
    v_lshlrev_b32 v83, 5, v81
    v_and_b32 v81, 1, v1
    v_lshl_add_u32 v83, v81, 4, v83
    v_lshrrev_b32 v81, 2, v80
    v_and_b32 v82, 3, v80
    v_lshl_add_u32 v84, v81, 3, v82
    v_lshrrev_b32 v81, 2, v1
    v_lshlrev_b32 v128, 7, v81
    v_and_b32 v82, 3, v1
    v_lshl_add_u32 v128, v82, 3, v128
    v_add_u32 v128, s88, v128
    v_and_b32 v81, 3, v80
    v_lshl_add_u32 v128, v81, 5, v128
    v_xor_b32 v129, 32, v128
    v_xor_b32 v130, 64, v128
    v_xor_b32 v131, 96, v128
    s_cmp_ge_u32 s84, 384
    s_cbranch_scc1 Lsjw_72
    s_mov_b32 s72, s18
    s_mov_b32 s73, s19
    s_mov_b32 s74, 0x180000
    s_mov_b32 s75, 0x00020000
    s_add_u32 s92, s38, 0x1600000
    s_addc_u32 s93, s39, 0
    s_mov_b32 s94, 0x180000
    s_mov_b32 s95, 0x00020000
    s_mul_i32 s86, s84, 2731
    s_lshr_b32 s86, s86, 16
    s_mul_i32 s87, s86, 24
    s_sub_u32 s87, s84, s87
    s_mul_i32 s89, s86, 98304
    s_lshl_b32 s85, s87, 7
    s_add_u32 s89, s89, s85
    s_and_b32 s85, s87, 7
    s_mul_i32 s85, s85, 196608
    s_mul_i32 s86, s86, 6144
    s_add_u32 s85, s85, s86
    s_lshr_b32 s87, s87, 3
    s_lshl_b32 s87, s87, 10
    s_add_u32 s85, s85, s87
    s_add_u32 s80, s85, 0
    s_add_u32 s81, s85, 3072
    s_add_u32 s82, s85, 98304
    s_add_u32 s83, s85, 101376
    s_lshl_b32 s91, s84, 8
    v_mul_u32_u24 v85, 3072, v84
    v_add_u32 v85, v85, v83
    s_add_u32 s85, s89, 0
    s_add_u32 m0, s88, 0
    s_nop 0
    buffer_load_dwordx4 v85, s[72:75], s85 offen lds
    s_add_u32 s85, s89, 49152
    s_add_u32 m0, s88, 1024
    s_nop 0
    buffer_load_dwordx4 v85, s[72:75], s85 offen lds
    s_add_u32 s85, s89, 12288
    s_add_u32 m0, s88, 2048
    s_nop 0
    buffer_load_dwordx4 v85, s[72:75], s85 offen lds
    s_add_u32 s85, s89, 61440
    s_add_u32 m0, s88, 3072
    s_nop 0
    buffer_load_dwordx4 v85, s[72:75], s85 offen lds
    s_mov_b32 s90, 1
    s_branch Lsjd_70
Lsjw_72:
    s_nop 7
    s_nop 7
    s_mov_b32 s72, s26
    s_mov_b32 s73, s27
    s_mov_b32 s74, 0x1c0000
    s_mov_b32 s75, 0x00020000
    s_add_u32 s92, s38, 0x1800000
    s_addc_u32 s93, s39, 0
    s_mov_b32 s94, 0x1c0000
    s_mov_b32 s95, 0x00020000
    s_sub_u32 s84, s84, 384
    s_lshl_b32 s91, s84, 8
    s_add_u32 s91, s91, 131072
    s_mul_i32 s86, s84, 2341
    s_lshr_b32 s86, s86, 16
    s_mul_i32 s87, s86, 28
    s_sub_u32 s87, s84, s87
    s_mul_i32 s89, s86, 114688
    s_lshl_b32 s85, s87, 7
    s_add_u32 s89, s89, s85
    s_mul_i32 s86, s86, 7
    s_lshl_b32 s85, s87, 2
    s_add_u32 s85, s85, 0
    s_mul_i32 s84, s85, 9363
    s_lshr_b32 s84, s84, 16
    s_mul_i32 s84, s84, 105
    s_add_u32 s85, s85, s84
    s_add_u32 s85, s85, s86
    s_lshl_b32 s80, s85, 10
    s_lshl_b32 s85, s87, 2
    s_add_u32 s85, s85, 1
    s_mul_i32 s84, s85, 9363
    s_lshr_b32 s84, s84, 16
    s_mul_i32 s84, s84, 105
    s_add_u32 s85, s85, s84
    s_add_u32 s85, s85, s86
    s_lshl_b32 s81, s85, 10
    s_lshl_b32 s85, s87, 2
    s_add_u32 s85, s85, 2
    s_mul_i32 s84, s85, 9363
    s_lshr_b32 s84, s84, 16
    s_mul_i32 s84, s84, 105
    s_add_u32 s85, s85, s84
    s_add_u32 s85, s85, s86
    s_lshl_b32 s82, s85, 10
    s_lshl_b32 s85, s87, 2
    s_add_u32 s85, s85, 3
    s_mul_i32 s84, s85, 9363
    s_lshr_b32 s84, s84, 16
    s_mul_i32 s84, s84, 105
    s_add_u32 s85, s85, s84
    s_add_u32 s85, s85, s86
    s_lshl_b32 s83, s85, 10
    v_mul_u32_u24 v85, 3584, v84
    v_add_u32 v85, v85, v83
    s_add_u32 s85, s89, 0
    s_add_u32 m0, s88, 0
    s_nop 0
    buffer_load_dwordx4 v85, s[72:75], s85 offen lds
    s_add_u32 s85, s89, 57344
    s_add_u32 m0, s88, 1024
    s_nop 0
    buffer_load_dwordx4 v85, s[72:75], s85 offen lds
    s_add_u32 s85, s89, 14336
    s_add_u32 m0, s88, 2048
    s_nop 0
    buffer_load_dwordx4 v85, s[72:75], s85 offen lds
    s_add_u32 s85, s89, 71680
    s_add_u32 m0, s88, 3072
    s_nop 0
    buffer_load_dwordx4 v85, s[72:75], s85 offen lds
    s_mov_b32 s90, 1
    s_branch Lsjd_70
Lsjd_70:
    s_nop 7
    s_nop 7
    v_mov_b32 v44, 0x3f803f80
    v_mov_b32 v45, 0x3f803f80
    v_mov_b32 v46, 0x3f803f80
    v_mov_b32 v47, 0x3f803f80
    v_lshlrev_b32 v5, 7, v2
    v_and_b32 v4, 4, v3
    v_lshl_add_u32 v5, v4, 2, v5
    v_and_b32 v4, 3, v3
    v_lshl_add_u32 v5, v4, 1, v5
    s_mov_b32 s48, s20
    s_mov_b32 s49, s21
    s_mov_b32 s50, 0x4000
    s_mov_b32 s51, 0x00020000
    s_mov_b32 s52, s38
    s_mov_b32 s53, s39
    s_mov_b32 s54, 0x420000
    s_mov_b32 s55, 0x00020000
    s_add_u32 s56, s38, 0x1400000
    s_addc_u32 s57, s39, 0
    s_mov_b32 s58, 0x11000
    s_mov_b32 s59, 0x00020000
    s_lshl_b32 s60, s62, 9
    buffer_load_ushort v48, v5, s[48:51], s60 offen offset:0
    buffer_load_ushort v49, v5, s[48:51], s60 offen offset:32
    buffer_load_ushort v50, v5, s[48:51], s60 offen offset:64
    buffer_load_ushort v51, v5, s[48:51], s60 offen offset:96
    buffer_load_ushort v52, v5, s[48:51], s60 offen offset:8
    buffer_load_ushort v53, v5, s[48:51], s60 offen offset:40
    buffer_load_ushort v54, v5, s[48:51], s60 offen offset:72
    buffer_load_ushort v55, v5, s[48:51], s60 offen offset:104
    s_cmp_lg_u32 s5, s6
    s_cbranch_scc1 Lnz_74
    s_cmp_lg_u32 s4, 0
    s_cbranch_scc1 Lnz_74
    s_add_u32 s44, s38, 0x1400000
    s_addc_u32 s45, s39, 0
    s_mov_b32 s46, 0x22000
    s_mov_b32 s47, 0x00020000
    v_mov_b32 v72, 0
    v_mov_b32 v73, 0
    v_mov_b32 v74, 0
    v_mov_b32 v75, 0
    v_lshlrev_b32 v4, 4, v1
    s_mul_i32 s60, s6, 4352
    buffer_store_dwordx4 v[72:75], v4, s[44:47], s60 offen offset:0 sc1
    buffer_store_dwordx4 v[72:75], v4, s[44:47], s60 offen offset:1024 sc1
    buffer_store_dwordx4 v[72:75], v4, s[44:47], s60 offen offset:2048 sc1
    buffer_store_dwordx4 v[72:75], v4, s[44:47], s60 offen offset:3072 sc1
    s_mov_b32 exec_lo, 0xffff
    s_mov_b32 exec_hi, 0
    s_add_u32 s61, s60, 4096
    buffer_store_dwordx4 v[72:75], v4, s[44:47], s61 offen sc1
    s_mov_b64 exec, -1
    s_add_u32 s60, s60, 69632
    buffer_store_dwordx4 v[72:75], v4, s[44:47], s60 offen offset:0 sc1
    buffer_store_dwordx4 v[72:75], v4, s[44:47], s60 offen offset:1024 sc1
    buffer_store_dwordx4 v[72:75], v4, s[44:47], s60 offen offset:2048 sc1
    buffer_store_dwordx4 v[72:75], v4, s[44:47], s60 offen offset:3072 sc1
    s_mov_b32 exec_lo, 0xffff
    s_mov_b32 exec_hi, 0
    s_add_u32 s61, s60, 4096
    buffer_store_dwordx4 v[72:75], v4, s[44:47], s61 offen sc1
    s_mov_b64 exec, -1
    s_add_u32 s60, s60, 69632
    s_waitcnt vmcnt(0)
    s_add_u32 s60, s6, 128
    v_mov_b32 v72, 1
    v_mov_b32 v73, 0
    s_mov_b64 exec, 1
    buffer_store_byte v72, v73, s[12:15], s60 offen sc1
    s_mov_b64 exec, -1
    s_nop 1
Lnz_74:
    s_nop 7
    s_nop 7
    s_lshl_b32 s66, s8, 5
    s_cmp_lg_u32 s8, 0
    s_cbranch_scc1 Lhh1_75
    s_lshl_b32 s79, s7, 12
    v_and_b32 v140, 7, v3
    v_xor_b32 v140, v140, v2
    v_lshlrev_b32 v140, 4, v140
    v_lshl_add_u32 v140, v3, 7, v140
    v_add_u32 v142, s79, v140
    v_xor_b32 v143, 64, v142
    v_add_u32 v144, 0x10000, v142
    v_add_u32 v145, 0x20000, v142
    v_add_u32 v146, 0x10000, v143
    v_add_u32 v147, 0x20000, v143
    v_bfe_u32 v140, v1, 2, 2
    v_lshl_add_u32 v140, v2, 3, v140
    v_lshlrev_b32 v140, 6, v140
    v_and_b32 v141, 3, v1
    v_lshl_add_u32 v140, v141, 3, v140
    v_and_b32 v141, 1, v2
    v_lshl_add_u32 v140, v141, 5, v140
    v_xor_b32 v148, s66, v140
    v_add_u32 v149, 0x10000, v148
    s_lshl_b32 s79, s4, 8
    s_add_u32 s79, s79, 143360
    v_lshlrev_b32 v150, 4, v2
    v_add_u32 v150, s79, v150
    v_mov_b32 v32, 0
    v_mov_b32 v33, 0
    v_mov_b32 v34, 0
    v_mov_b32 v35, 0
    v_mov_b32 v36, 0
    v_mov_b32 v37, 0
    v_mov_b32 v38, 0
    v_mov_b32 v39, 0
    v_mov_b32 v40, 0
    v_mov_b32 v41, 0
    v_mov_b32 v42, 0
    v_mov_b32 v43, 0
    s_barrier
    ds_read_b128 v[72:75], v142 offset:61440
    ds_read_b128 v[76:79], v142 offset:63488
    ds_read_b64_tr_b16 v[80:81], v148 offset:0
    ds_read_b64_tr_b16 v[82:83], v148 offset:256
    ds_read_b64_tr_b16 v[84:85], v148 offset:4096
    ds_read_b64_tr_b16 v[86:87], v148 offset:4352
    ds_read_b64_tr_b16 v[88:89], v148 offset:8192
    ds_read_b64_tr_b16 v[90:91], v148 offset:8448
    s_waitcnt lgkmcnt(0)
    v_mfma_f32_16x16x32_bf16 v[8:11], v[80:83], v[72:75], 0
    ds_read_b128 v[92:95], v143 offset:61440
    v_mfma_f32_16x16x32_bf16 v[20:23], v[80:83], v[76:79], 0
    ds_read_b128 v[96:99], v143 offset:63488
    v_mfma_f32_16x16x32_bf16 v[12:15], v[84:87], v[72:75], 0
    ds_read_b64_tr_b16 v[100:101], v148 offset:2048
    v_mfma_f32_16x16x32_bf16 v[24:27], v[84:87], v[76:79], 0
    ds_read_b64_tr_b16 v[102:103], v148 offset:2304
    ds_read_b64_tr_b16 v[104:105], v148 offset:6144
    v_mfma_f32_16x16x32_bf16 v[16:19], v[88:91], v[72:75], 0
    ds_read_b64_tr_b16 v[106:107], v148 offset:6400
    v_mfma_f32_16x16x32_bf16 v[28:31], v[88:91], v[76:79], 0
    ds_read_b64_tr_b16 v[108:109], v148 offset:10240
    v_mfma_f32_16x16x32_bf16 v[64:67], v[44:47], v[72:75], 0
    ds_read_b64_tr_b16 v[110:111], v148 offset:10496
    v_mfma_f32_16x16x32_bf16 v[68:71], v[72:75], v[72:75], 0
    s_cmp_lg_u32 s7, 0
    s_cbranch_scc1 Lcs_77
    v_mfma_f32_16x16x32_bf16 v[32:35], v[80:83], v[44:47], v[32:35]
    v_mfma_f32_16x16x32_bf16 v[36:39], v[84:87], v[44:47], v[36:39]
    v_mfma_f32_16x16x32_bf16 v[40:43], v[88:91], v[44:47], v[40:43]
Lcs_77:
    s_waitcnt lgkmcnt(0)
    s_waitcnt lgkmcnt(0)
    s_barrier
    v_mfma_f32_16x16x32_bf16 v[8:11], v[100:103], v[92:95], v[8:11]
    ds_read_b128 v[72:75], v144 offset:12288
    v_mfma_f32_16x16x32_bf16 v[20:23], v[100:103], v[96:99], v[20:23]
    ds_read_b128 v[76:79], v144 offset:14336
    v_mfma_f32_16x16x32_bf16 v[12:15], v[104:107], v[92:95], v[12:15]
    ds_read_b64_tr_b16 v[80:81], v148 offset:12288
    v_mfma_f32_16x16x32_bf16 v[24:27], v[104:107], v[96:99], v[24:27]
    ds_read_b64_tr_b16 v[82:83], v148 offset:12544
    ds_read_b64_tr_b16 v[84:85], v148 offset:16384
    v_mfma_f32_16x16x32_bf16 v[16:19], v[108:111], v[92:95], v[16:19]
    ds_read_b64_tr_b16 v[86:87], v148 offset:16640
    v_mfma_f32_16x16x32_bf16 v[28:31], v[108:111], v[96:99], v[28:31]
    ds_read_b64_tr_b16 v[88:89], v148 offset:20480
    v_mfma_f32_16x16x32_bf16 v[64:67], v[44:47], v[92:95], v[64:67]
    ds_read_b64_tr_b16 v[90:91], v148 offset:20736
    v_mfma_f32_16x16x32_bf16 v[68:71], v[92:95], v[92:95], v[68:71]
    s_cmp_lg_u32 s7, 1
    s_cbranch_scc1 Lcs_78
    v_mfma_f32_16x16x32_bf16 v[32:35], v[100:103], v[44:47], v[32:35]
    v_mfma_f32_16x16x32_bf16 v[36:39], v[104:107], v[44:47], v[36:39]
    v_mfma_f32_16x16x32_bf16 v[40:43], v[108:111], v[44:47], v[40:43]
Lcs_78:
    s_cmp_eq_u32 s90, 0
    s_cbranch_scc1 Lsjf_79
    s_waitcnt vmcnt(0)
    ds_read_b64_tr_b16 v[112:113], v128 offset:0
    ds_read_b64_tr_b16 v[114:115], v128 offset:2048
    ds_read_b64_tr_b16 v[116:117], v129 offset:0
    ds_read_b64_tr_b16 v[118:119], v129 offset:2048
    ds_read_b64_tr_b16 v[120:121], v130 offset:0
    ds_read_b64_tr_b16 v[122:123], v130 offset:2048
    ds_read_b64_tr_b16 v[124:125], v131 offset:0
    ds_read_b64_tr_b16 v[126:127], v131 offset:2048
    s_waitcnt lgkmcnt(0)
    buffer_store_dwordx4 v[112:115], v132, s[92:95], s80 offen sc1
    buffer_store_dwordx4 v[116:119], v132, s[92:95], s81 offen sc1
    buffer_store_dwordx4 v[120:123], v132, s[92:95], s82 offen sc1
    buffer_store_dwordx4 v[124:127], v132, s[92:95], s83 offen sc1
    s_mov_b32 s84, 0x3f803f80
    v_mov_b32 v133, 0
    v_mov_b32 v134, 0
    v_mov_b32 v135, 0
    v_mov_b32 v136, 0
    v_dot2c_f32_bf16 v133, s84, v112
    v_dot2c_f32_bf16 v133, s84, v113
    v_dot2c_f32_bf16 v133, s84, v114
    v_dot2c_f32_bf16 v133, s84, v115
    v_dot2c_f32_bf16 v134, s84, v116
    v_dot2c_f32_bf16 v134, s84, v117
    v_dot2c_f32_bf16 v134, s84, v118
    v_dot2c_f32_bf16 v134, s84, v119
    v_dot2c_f32_bf16 v135, s84, v120
    v_dot2c_f32_bf16 v135, s84, v121
    v_dot2c_f32_bf16 v135, s84, v122
    v_dot2c_f32_bf16 v135, s84, v123
    v_dot2c_f32_bf16 v136, s84, v124
    v_dot2c_f32_bf16 v136, s84, v125
    v_dot2c_f32_bf16 v136, s84, v126
    v_dot2c_f32_bf16 v136, s84, v127
    v_mov_b32 v137, v133
    s_nop 1
    v_permlane16_swap_b32 v133, v137
    v_add_f32 v133, v133, v137
    v_mov_b32 v137, v133
    s_nop 1
    v_permlane32_swap_b32 v133, v137
    v_add_f32 v133, v133, v137
    v_mov_b32 v137, v134
    s_nop 1
    v_permlane16_swap_b32 v134, v137
    v_add_f32 v134, v134, v137
    v_mov_b32 v137, v134
    s_nop 1
    v_permlane32_swap_b32 v134, v137
    v_add_f32 v134, v134, v137
    v_mov_b32 v137, v135
    s_nop 1
    v_permlane16_swap_b32 v135, v137
    v_add_f32 v135, v135, v137
    v_mov_b32 v137, v135
    s_nop 1
    v_permlane32_swap_b32 v135, v137
    v_add_f32 v135, v135, v137
    v_mov_b32 v137, v136
    s_nop 1
    v_permlane16_swap_b32 v136, v137
    v_add_f32 v136, v136, v137
    v_mov_b32 v137, v136
    s_nop 1
    v_permlane32_swap_b32 v136, v137
    v_add_f32 v136, v136, v137
    v_cmp_eq_u32 vcc, 1, v2
    s_nop 1
    v_cndmask_b32 v133, v133, v134, vcc
    v_cmp_eq_u32 vcc, 2, v2
    s_nop 1
    v_cndmask_b32 v133, v133, v135, vcc
    v_cmp_eq_u32 vcc, 3, v2
    s_nop 1
    v_cndmask_b32 v133, v133, v136, vcc
    s_add_u32 s72, s38, 0x1a00000
    s_addc_u32 s73, s39, 0
    s_mov_b32 s74, 0x40000
    s_mov_b32 s75, 0x00020000
    v_lshlrev_b32 v137, 2, v1
    buffer_store_dword v133, v137, s[72:75], s91 offen sc1
    s_nop 3
Lsjf_79:
    s_nop 7
    s_nop 7
    s_waitcnt lgkmcnt(0)
    v_mfma_f32_16x16x32_bf16 v[8:11], v[80:83], v[72:75], v[8:11]
    ds_read_b128 v[92:95], v146 offset:12288
    v_mfma_f32_16x16x32_bf16 v[20:23], v[80:83], v[76:79], v[20:23]
    ds_read_b128 v[96:99], v146 offset:14336
    v_mfma_f32_16x16x32_bf16 v[12:15], v[84:87], v[72:75], v[12:15]
    ds_read_b64_tr_b16 v[100:101], v148 offset:14336
    v_mfma_f32_16x16x32_bf16 v[24:27], v[84:87], v[76:79], v[24:27]
    ds_read_b64_tr_b16 v[102:103], v148 offset:14592
    ds_read_b64_tr_b16 v[104:105], v148 offset:18432
    v_mfma_f32_16x16x32_bf16 v[16:19], v[88:91], v[72:75], v[16:19]
    ds_read_b64_tr_b16 v[106:107], v148 offset:18688
    v_mfma_f32_16x16x32_bf16 v[28:31], v[88:91], v[76:79], v[28:31]
    ds_read_b64_tr_b16 v[108:109], v148 offset:22528
    v_mfma_f32_16x16x32_bf16 v[64:67], v[44:47], v[72:75], v[64:67]
    ds_read_b64_tr_b16 v[110:111], v148 offset:22784
    v_mfma_f32_16x16x32_bf16 v[68:71], v[72:75], v[72:75], v[68:71]
    s_cmp_lg_u32 s7, 2
    s_cbranch_scc1 Lcs_80
    v_mfma_f32_16x16x32_bf16 v[32:35], v[80:83], v[44:47], v[32:35]
    v_mfma_f32_16x16x32_bf16 v[36:39], v[84:87], v[44:47], v[36:39]
    v_mfma_f32_16x16x32_bf16 v[40:43], v[88:91], v[44:47], v[40:43]
Lcs_80:
    s_cmp_lg_u32 s4, 5
    s_cbranch_scc1 Lfz_81
    s_add_u32 s72, s38, 0x1580000
    s_addc_u32 s73, s39, 0
    s_mov_b32 s74, 0x3000
    s_mov_b32 s75, 0x00020000
    s_lshl_b32 s70, s5, 6
    s_add_u32 s70, s70, s6
    s_lshl_b32 s70, s70, 2
    v_mov_b32 v56, 0
    v_mov_b32 v57, 0
    s_mov_b64 exec, 1
    buffer_store_dword v56, v57, s[72:75], s70 offen sc1
    s_mov_b64 exec, -1
    s_nop 1
    s_lshl_b32 s70, s6, 6
    s_add_u32 s70, s70, s5
    s_lshl_b32 s70, s70, 2
    s_add_u32 s70, s70, 4096
    s_mov_b64 exec, 1
    buffer_store_dword v56, v57, s[72:75], s70 offen sc1
    s_mov_b64 exec, -1
    s_nop 3
Lfz_81:
    s_waitcnt lgkmcnt(0)
    s_waitcnt lgkmcnt(0)
    s_barrier
    v_mfma_f32_16x16x32_bf16 v[8:11], v[100:103], v[92:95], v[8:11]
    ds_read_b128 v[72:75], v144 offset:28672
    v_mfma_f32_16x16x32_bf16 v[20:23], v[100:103], v[96:99], v[20:23]
    ds_read_b128 v[76:79], v144 offset:30720
    v_mfma_f32_16x16x32_bf16 v[12:15], v[104:107], v[92:95], v[12:15]
    ds_read_b64_tr_b16 v[80:81], v148 offset:24576
    v_mfma_f32_16x16x32_bf16 v[24:27], v[104:107], v[96:99], v[24:27]
    ds_read_b64_tr_b16 v[82:83], v148 offset:24832
    ds_read_b64_tr_b16 v[84:85], v148 offset:28672
    v_mfma_f32_16x16x32_bf16 v[16:19], v[108:111], v[92:95], v[16:19]
    ds_read_b64_tr_b16 v[86:87], v148 offset:28928
    v_mfma_f32_16x16x32_bf16 v[28:31], v[108:111], v[96:99], v[28:31]
    ds_read_b64_tr_b16 v[88:89], v148 offset:32768
    v_mfma_f32_16x16x32_bf16 v[64:67], v[44:47], v[92:95], v[64:67]
    ds_read_b64_tr_b16 v[90:91], v148 offset:33024
    v_mfma_f32_16x16x32_bf16 v[68:71], v[92:95], v[92:95], v[68:71]
    s_cmp_lg_u32 s7, 3
    s_cbranch_scc1 Lcs_82
    v_mfma_f32_16x16x32_bf16 v[32:35], v[100:103], v[44:47], v[32:35]
    v_mfma_f32_16x16x32_bf16 v[36:39], v[104:107], v[44:47], v[36:39]
    v_mfma_f32_16x16x32_bf16 v[40:43], v[108:111], v[44:47], v[40:43]
Lcs_82:
    s_cmp_lg_u32 s4, 3
    s_cbranch_scc1 Litc_83
    s_mov_b32 s72, s30
    s_mov_b32 s73, s31
    s_mov_b32 s74, 0x1c0000
    s_mov_b32 s75, 0x00020000
    s_lshl_b32 s76, s5, 4
    s_add_u32 s76, s76, s6
    s_mul_i32 s76, s76, 7168
    v_lshlrev_b32 v164, 7, v1
    s_mov_b32 exec_lo, 0xffffffff
    s_mov_b32 exec_hi, 0xffffff
    buffer_load_dword v165, v164, s[72:75], s76 offen
    s_mov_b64 exec, -1
    s_nop 3
Litc_83:
    s_cmp_lg_u32 s4, 4
    s_cbranch_scc1 Litc_84
    s_mov_b32 s72, s22
    s_mov_b32 s73, s23
    s_mov_b32 s74, 0x80000
    s_mov_b32 s75, 0x00020000
    s_lshl_b32 s76, s5, 4
    s_add_u32 s76, s76, s6
    s_mul_i32 s76, s76, 2048
    v_lshlrev_b32 v164, 7, v1
    s_mov_b32 exec_lo, 0xffff
    s_mov_b32 exec_hi, 0x0
    buffer_load_dword v165, v164, s[72:75], s76 offen
    s_mov_b64 exec, -1
    s_nop 3
Litc_84:
    s_waitcnt lgkmcnt(0)
    v_mfma_f32_16x16x32_bf16 v[8:11], v[80:83], v[72:75], v[8:11]
    ds_read_b128 v[92:95], v146 offset:28672
    v_mfma_f32_16x16x32_bf16 v[20:23], v[80:83], v[76:79], v[20:23]
    ds_read_b128 v[96:99], v146 offset:30720
    v_mfma_f32_16x16x32_bf16 v[12:15], v[84:87], v[72:75], v[12:15]
    ds_read_b64_tr_b16 v[100:101], v148 offset:26624
    v_mfma_f32_16x16x32_bf16 v[24:27], v[84:87], v[76:79], v[24:27]
    ds_read_b64_tr_b16 v[102:103], v148 offset:26880
    ds_read_b64_tr_b16 v[104:105], v148 offset:30720
    v_mfma_f32_16x16x32_bf16 v[16:19], v[88:91], v[72:75], v[16:19]
    ds_read_b64_tr_b16 v[106:107], v148 offset:30976
    v_mfma_f32_16x16x32_bf16 v[28:31], v[88:91], v[76:79], v[28:31]
    ds_read_b64_tr_b16 v[108:109], v148 offset:34816
    v_mfma_f32_16x16x32_bf16 v[64:67], v[44:47], v[72:75], v[64:67]
    ds_read_b64_tr_b16 v[110:111], v148 offset:35072
    v_mfma_f32_16x16x32_bf16 v[68:71], v[72:75], v[72:75], v[68:71]
    s_cmp_lg_u32 s7, 0
    s_cbranch_scc1 Lcs_85
    v_mfma_f32_16x16x32_bf16 v[32:35], v[80:83], v[44:47], v[32:35]
    v_mfma_f32_16x16x32_bf16 v[36:39], v[84:87], v[44:47], v[36:39]
    v_mfma_f32_16x16x32_bf16 v[40:43], v[88:91], v[44:47], v[40:43]
Lcs_85:
    s_waitcnt lgkmcnt(0)
    s_waitcnt lgkmcnt(0)
    s_barrier
    v_mfma_f32_16x16x32_bf16 v[8:11], v[100:103], v[92:95], v[8:11]
    ds_read_b128 v[72:75], v144 offset:45056
    v_mfma_f32_16x16x32_bf16 v[20:23], v[100:103], v[96:99], v[20:23]
    ds_read_b128 v[76:79], v144 offset:47104
    v_mfma_f32_16x16x32_bf16 v[12:15], v[104:107], v[92:95], v[12:15]
    ds_read_b64_tr_b16 v[80:81], v148 offset:36864
    v_mfma_f32_16x16x32_bf16 v[24:27], v[104:107], v[96:99], v[24:27]
    ds_read_b64_tr_b16 v[82:83], v148 offset:37120
    ds_read_b64_tr_b16 v[84:85], v148 offset:40960
    v_mfma_f32_16x16x32_bf16 v[16:19], v[108:111], v[92:95], v[16:19]
    ds_read_b64_tr_b16 v[86:87], v148 offset:41216
    v_mfma_f32_16x16x32_bf16 v[28:31], v[108:111], v[96:99], v[28:31]
    ds_read_b64_tr_b16 v[88:89], v148 offset:45056
    v_mfma_f32_16x16x32_bf16 v[64:67], v[44:47], v[92:95], v[64:67]
    ds_read_b64_tr_b16 v[90:91], v148 offset:45312
    v_mfma_f32_16x16x32_bf16 v[68:71], v[92:95], v[92:95], v[68:71]
    s_cmp_lg_u32 s7, 1
    s_cbranch_scc1 Lcs_86
    v_mfma_f32_16x16x32_bf16 v[32:35], v[100:103], v[44:47], v[32:35]
    v_mfma_f32_16x16x32_bf16 v[36:39], v[104:107], v[44:47], v[36:39]
    v_mfma_f32_16x16x32_bf16 v[40:43], v[108:111], v[44:47], v[40:43]
Lcs_86:
    s_waitcnt lgkmcnt(0)
    v_mfma_f32_16x16x32_bf16 v[8:11], v[80:83], v[72:75], v[8:11]
    ds_read_b128 v[92:95], v146 offset:45056
    v_mfma_f32_16x16x32_bf16 v[20:23], v[80:83], v[76:79], v[20:23]
    ds_read_b128 v[96:99], v146 offset:47104
    v_mfma_f32_16x16x32_bf16 v[12:15], v[84:87], v[72:75], v[12:15]
    ds_read_b64_tr_b16 v[100:101], v148 offset:38912
    v_mfma_f32_16x16x32_bf16 v[24:27], v[84:87], v[76:79], v[24:27]
    ds_read_b64_tr_b16 v[102:103], v148 offset:39168
    ds_read_b64_tr_b16 v[104:105], v148 offset:43008
    v_mfma_f32_16x16x32_bf16 v[16:19], v[88:91], v[72:75], v[16:19]
    ds_read_b64_tr_b16 v[106:107], v148 offset:43264
    v_mfma_f32_16x16x32_bf16 v[28:31], v[88:91], v[76:79], v[28:31]
    ds_read_b64_tr_b16 v[108:109], v148 offset:47104
    v_mfma_f32_16x16x32_bf16 v[64:67], v[44:47], v[72:75], v[64:67]
    ds_read_b64_tr_b16 v[110:111], v148 offset:47360
    v_mfma_f32_16x16x32_bf16 v[68:71], v[72:75], v[72:75], v[68:71]
    s_cmp_lg_u32 s7, 2
    s_cbranch_scc1 Lcs_87
    v_mfma_f32_16x16x32_bf16 v[32:35], v[80:83], v[44:47], v[32:35]
    v_mfma_f32_16x16x32_bf16 v[36:39], v[84:87], v[44:47], v[36:39]
    v_mfma_f32_16x16x32_bf16 v[40:43], v[88:91], v[44:47], v[40:43]
Lcs_87:
    s_waitcnt lgkmcnt(0)
    s_waitcnt lgkmcnt(0)
    s_barrier
    v_mfma_f32_16x16x32_bf16 v[8:11], v[100:103], v[92:95], v[8:11]
    ds_read_b128 v[72:75], v144 offset:61440
    v_mfma_f32_16x16x32_bf16 v[20:23], v[100:103], v[96:99], v[20:23]
    ds_read_b128 v[76:79], v144 offset:63488
    v_mfma_f32_16x16x32_bf16 v[12:15], v[104:107], v[92:95], v[12:15]
    ds_read_b64_tr_b16 v[80:81], v148 offset:49152
    v_mfma_f32_16x16x32_bf16 v[24:27], v[104:107], v[96:99], v[24:27]
    ds_read_b64_tr_b16 v[82:83], v148 offset:49408
    ds_read_b64_tr_b16 v[84:85], v148 offset:53248
    v_mfma_f32_16x16x32_bf16 v[16:19], v[108:111], v[92:95], v[16:19]
    ds_read_b64_tr_b16 v[86:87], v148 offset:53504
    v_mfma_f32_16x16x32_bf16 v[28:31], v[108:111], v[96:99], v[28:31]
    ds_read_b64_tr_b16 v[88:89], v148 offset:57344
    v_mfma_f32_16x16x32_bf16 v[64:67], v[44:47], v[92:95], v[64:67]
    ds_read_b64_tr_b16 v[90:91], v148 offset:57600
    v_mfma_f32_16x16x32_bf16 v[68:71], v[92:95], v[92:95], v[68:71]
    s_cmp_lg_u32 s7, 3
    s_cbranch_scc1 Lcs_88
    v_mfma_f32_16x16x32_bf16 v[32:35], v[100:103], v[44:47], v[32:35]
    v_mfma_f32_16x16x32_bf16 v[36:39], v[104:107], v[44:47], v[36:39]
    v_mfma_f32_16x16x32_bf16 v[40:43], v[108:111], v[44:47], v[40:43]
Lcs_88:
    s_waitcnt vmcnt(0)
    s_cmp_lg_u32 s4, 5
    s_cbranch_scc1 Lini_89
    s_getreg_b32 s71, hwreg(HW_REG_XCC_ID)
    s_and_b32 s71, s71, 15
    s_mul_i32 s70, s71, s71
    s_lshl_b32 s70, s70, 16
    s_lshl_b32 s71, s71, 8
    s_add_u32 s70, s70, s71
    s_add_u32 s70, s70, 1
    v_mov_b32 v4, s70
    v_mov_b32 v5, 0
    s_lshl_b32 s70, s5, 2
    s_mov_b64 exec, 1
    buffer_atomic_add v4, v5, s[12:15], s70 offen
    s_mov_b64 exec, -1
    s_nop 3
Lini_89:
    v_cmp_gt_u32 vcc, 8, v3
    v_lshl_or_b32 v4, v49, 16, v48
    v_lshl_or_b32 v5, v51, 16, v50
    v_cndmask_b32 v56, 0, v4, vcc
    v_cndmask_b32 v57, 0, v5, vcc
    v_cndmask_b32 v58, v4, 0, vcc
    v_cndmask_b32 v59, v5, 0, vcc
    v_lshl_or_b32 v4, v53, 16, v52
    v_lshl_or_b32 v5, v55, 16, v54
    v_cndmask_b32 v60, 0, v4, vcc
    v_cndmask_b32 v61, 0, v5, vcc
    v_cndmask_b32 v62, v4, 0, vcc
    v_cndmask_b32 v63, v5, 0, vcc
    s_waitcnt lgkmcnt(0)
    v_mfma_f32_16x16x32_bf16 v[8:11], v[80:83], v[72:75], v[8:11]
    ds_read_b128 v[92:95], v146 offset:61440
    v_mfma_f32_16x16x32_bf16 v[20:23], v[80:83], v[76:79], v[20:23]
    ds_read_b128 v[96:99], v146 offset:63488
    v_mfma_f32_16x16x32_bf16 v[12:15], v[84:87], v[72:75], v[12:15]
    ds_read_b64_tr_b16 v[100:101], v148 offset:51200
    v_mfma_f32_16x16x32_bf16 v[24:27], v[84:87], v[76:79], v[24:27]
    ds_read_b64_tr_b16 v[102:103], v148 offset:51456
    ds_read_b64_tr_b16 v[104:105], v148 offset:55296
    v_mfma_f32_16x16x32_bf16 v[16:19], v[88:91], v[72:75], v[16:19]
    ds_read_b64_tr_b16 v[106:107], v148 offset:55552
    v_mfma_f32_16x16x32_bf16 v[28:31], v[88:91], v[76:79], v[28:31]
    ds_read_b64_tr_b16 v[108:109], v148 offset:59392
    v_mfma_f32_16x16x32_bf16 v[64:67], v[44:47], v[72:75], v[64:67]
    ds_read_b64_tr_b16 v[110:111], v148 offset:59648
    v_mfma_f32_16x16x32_bf16 v[68:71], v[72:75], v[72:75], v[68:71]
    s_cmp_lg_u32 s7, 0
    s_cbranch_scc1 Lcs_90
    v_mfma_f32_16x16x32_bf16 v[32:35], v[80:83], v[44:47], v[32:35]
    v_mfma_f32_16x16x32_bf16 v[36:39], v[84:87], v[44:47], v[36:39]
    v_mfma_f32_16x16x32_bf16 v[40:43], v[88:91], v[44:47], v[40:43]
Lcs_90:
    s_waitcnt lgkmcnt(0)
    s_waitcnt lgkmcnt(0)
    s_barrier
    v_mfma_f32_16x16x32_bf16 v[8:11], v[100:103], v[92:95], v[8:11]
    ds_read_b128 v[72:75], v142 offset:61440
    v_mfma_f32_16x16x32_bf16 v[20:23], v[100:103], v[96:99], v[20:23]
    ds_read_b128 v[76:79], v142 offset:63488
    v_mfma_f32_16x16x32_bf16 v[12:15], v[104:107], v[92:95], v[12:15]
    ds_read_b64_tr_b16 v[80:81], v148 offset:0
    v_mfma_f32_16x16x32_bf16 v[24:27], v[104:107], v[96:99], v[24:27]
    ds_read_b64_tr_b16 v[82:83], v148 offset:256
    ds_read_b64_tr_b16 v[84:85], v148 offset:4096
    v_mfma_f32_16x16x32_bf16 v[16:19], v[108:111], v[92:95], v[16:19]
    ds_read_b64_tr_b16 v[86:87], v148 offset:4352
    v_mfma_f32_16x16x32_bf16 v[28:31], v[108:111], v[96:99], v[28:31]
    ds_read_b64_tr_b16 v[88:89], v148 offset:8192
    v_mfma_f32_16x16x32_bf16 v[64:67], v[44:47], v[92:95], v[64:67]
    ds_read_b64_tr_b16 v[90:91], v148 offset:8448
    v_mfma_f32_16x16x32_bf16 v[68:71], v[92:95], v[92:95], v[68:71]
    s_cmp_lg_u32 s7, 1
    s_cbranch_scc1 Lcs_91
    v_mfma_f32_16x16x32_bf16 v[32:35], v[100:103], v[44:47], v[32:35]
    v_mfma_f32_16x16x32_bf16 v[36:39], v[104:107], v[44:47], v[36:39]
    v_mfma_f32_16x16x32_bf16 v[40:43], v[108:111], v[44:47], v[40:43]
Lcs_91:
    s_waitcnt lgkmcnt(0)
    v_mfma_f32_16x16x32_bf16 v[8:11], v[80:83], v[72:75], v[8:11]
    ds_read_b128 v[92:95], v143 offset:61440
    v_mfma_f32_16x16x32_bf16 v[20:23], v[80:83], v[76:79], v[20:23]
    ds_read_b128 v[96:99], v143 offset:63488
    v_mfma_f32_16x16x32_bf16 v[12:15], v[84:87], v[72:75], v[12:15]
    ds_read_b64_tr_b16 v[100:101], v148 offset:2048
    v_mfma_f32_16x16x32_bf16 v[24:27], v[84:87], v[76:79], v[24:27]
    ds_read_b64_tr_b16 v[102:103], v148 offset:2304
    ds_read_b64_tr_b16 v[104:105], v148 offset:6144
    v_mfma_f32_16x16x32_bf16 v[16:19], v[88:91], v[72:75], v[16:19]
    ds_read_b64_tr_b16 v[106:107], v148 offset:6400
    v_mfma_f32_16x16x32_bf16 v[28:31], v[88:91], v[76:79], v[28:31]
    ds_read_b64_tr_b16 v[108:109], v148 offset:10240
    v_mfma_f32_16x16x32_bf16 v[64:67], v[44:47], v[72:75], v[64:67]
    ds_read_b64_tr_b16 v[110:111], v148 offset:10496
    v_mfma_f32_16x16x32_bf16 v[68:71], v[72:75], v[72:75], v[68:71]
    s_cmp_lg_u32 s7, 2
    s_cbranch_scc1 Lcs_92
    v_mfma_f32_16x16x32_bf16 v[32:35], v[80:83], v[44:47], v[32:35]
    v_mfma_f32_16x16x32_bf16 v[36:39], v[84:87], v[44:47], v[36:39]
    v_mfma_f32_16x16x32_bf16 v[40:43], v[88:91], v[44:47], v[40:43]
Lcs_92:
    s_waitcnt lgkmcnt(0)
    s_waitcnt lgkmcnt(0)
    s_barrier
    v_mfma_f32_16x16x32_bf16 v[8:11], v[100:103], v[92:95], v[8:11]
    ds_read_b128 v[72:75], v144 offset:12288
    v_mfma_f32_16x16x32_bf16 v[20:23], v[100:103], v[96:99], v[20:23]
    ds_read_b128 v[76:79], v144 offset:14336
    v_mfma_f32_16x16x32_bf16 v[12:15], v[104:107], v[92:95], v[12:15]
    ds_read_b64_tr_b16 v[80:81], v148 offset:12288
    v_mfma_f32_16x16x32_bf16 v[24:27], v[104:107], v[96:99], v[24:27]
    ds_read_b64_tr_b16 v[82:83], v148 offset:12544
    ds_read_b64_tr_b16 v[84:85], v148 offset:16384
    v_mfma_f32_16x16x32_bf16 v[16:19], v[108:111], v[92:95], v[16:19]
    ds_read_b64_tr_b16 v[86:87], v148 offset:16640
    v_mfma_f32_16x16x32_bf16 v[28:31], v[108:111], v[96:99], v[28:31]
    ds_read_b64_tr_b16 v[88:89], v148 offset:20480
    v_mfma_f32_16x16x32_bf16 v[64:67], v[44:47], v[92:95], v[64:67]
    ds_read_b64_tr_b16 v[90:91], v148 offset:20736
    v_mfma_f32_16x16x32_bf16 v[68:71], v[92:95], v[92:95], v[68:71]
    s_cmp_lg_u32 s7, 3
    s_cbranch_scc1 Lcs_93
    v_mfma_f32_16x16x32_bf16 v[32:35], v[100:103], v[44:47], v[32:35]
    v_mfma_f32_16x16x32_bf16 v[36:39], v[104:107], v[44:47], v[36:39]
    v_mfma_f32_16x16x32_bf16 v[40:43], v[108:111], v[44:47], v[40:43]
Lcs_93:
    s_nop 7
    s_nop 7
    s_mov_b32 exec_lo, 0x00010001
    s_mov_b32 exec_hi, 0x00010001
    ds_write_b128 v150, v[32:35] offset:0
    ds_write_b128 v150, v[36:39] offset:64
    ds_write_b128 v150, v[40:43] offset:128
    s_mov_b64 exec, -1
    s_nop 3
    s_waitcnt lgkmcnt(3)
    v_mfma_f32_16x16x32_bf16 v[8:11], v[80:83], v[72:75], v[8:11]
    ds_read_b128 v[92:95], v146 offset:12288
    v_mfma_f32_16x16x32_bf16 v[20:23], v[80:83], v[76:79], v[20:23]
    ds_read_b128 v[96:99], v146 offset:14336
    v_mfma_f32_16x16x32_bf16 v[12:15], v[84:87], v[72:75], v[12:15]
    ds_read_b64_tr_b16 v[100:101], v148 offset:14336
    v_mfma_f32_16x16x32_bf16 v[24:27], v[84:87], v[76:79], v[24:27]
    ds_read_b64_tr_b16 v[102:103], v148 offset:14592
    ds_read_b64_tr_b16 v[104:105], v148 offset:18432
    v_mfma_f32_16x16x32_bf16 v[16:19], v[88:91], v[72:75], v[16:19]
    ds_read_b64_tr_b16 v[106:107], v148 offset:18688
    v_mfma_f32_16x16x32_bf16 v[28:31], v[88:91], v[76:79], v[28:31]
    ds_read_b64_tr_b16 v[108:109], v148 offset:22528
    v_mfma_f32_16x16x32_bf16 v[64:67], v[44:47], v[72:75], v[64:67]
    ds_read_b64_tr_b16 v[110:111], v148 offset:22784
    v_mfma_f32_16x16x32_bf16 v[68:71], v[72:75], v[72:75], v[68:71]
    v_mfma_f32_16x16x32_bf16 v[32:35], v[80:83], v[44:47], 0
    v_mfma_f32_16x16x32_bf16 v[36:39], v[84:87], v[44:47], 0
    v_mfma_f32_16x16x32_bf16 v[40:43], v[88:91], v[44:47], 0
    s_waitcnt lgkmcnt(0)
    s_waitcnt lgkmcnt(0)
    s_barrier
    v_mfma_f32_16x16x32_bf16 v[8:11], v[100:103], v[92:95], v[8:11]
    ds_read_b128 v[72:75], v144 offset:28672
    v_mfma_f32_16x16x32_bf16 v[20:23], v[100:103], v[96:99], v[20:23]
    ds_read_b128 v[76:79], v144 offset:30720
    v_mfma_f32_16x16x32_bf16 v[12:15], v[104:107], v[92:95], v[12:15]
    ds_read_b64_tr_b16 v[80:81], v148 offset:24576
    v_mfma_f32_16x16x32_bf16 v[24:27], v[104:107], v[96:99], v[24:27]
    ds_read_b64_tr_b16 v[82:83], v148 offset:24832
    ds_read_b64_tr_b16 v[84:85], v148 offset:28672
    v_mfma_f32_16x16x32_bf16 v[16:19], v[108:111], v[92:95], v[16:19]
    ds_read_b64_tr_b16 v[86:87], v148 offset:28928
    v_mfma_f32_16x16x32_bf16 v[28:31], v[108:111], v[96:99], v[28:31]
    ds_read_b64_tr_b16 v[88:89], v148 offset:32768
    v_mfma_f32_16x16x32_bf16 v[64:67], v[44:47], v[92:95], v[64:67]
    ds_read_b64_tr_b16 v[90:91], v148 offset:33024
    v_mfma_f32_16x16x32_bf16 v[68:71], v[92:95], v[92:95], v[68:71]
    v_mfma_f32_16x16x32_bf16 v[32:35], v[100:103], v[44:47], v[32:35]
    v_mfma_f32_16x16x32_bf16 v[36:39], v[104:107], v[44:47], v[36:39]
    v_mfma_f32_16x16x32_bf16 v[40:43], v[108:111], v[44:47], v[40:43]
    s_waitcnt lgkmcnt(0)
    v_mfma_f32_16x16x32_bf16 v[8:11], v[80:83], v[72:75], v[8:11]
    ds_read_b128 v[92:95], v146 offset:28672
    v_mfma_f32_16x16x32_bf16 v[20:23], v[80:83], v[76:79], v[20:23]
    ds_read_b128 v[96:99], v146 offset:30720
    v_mfma_f32_16x16x32_bf16 v[12:15], v[84:87], v[72:75], v[12:15]
    ds_read_b64_tr_b16 v[100:101], v148 offset:26624
    v_mfma_f32_16x16x32_bf16 v[24:27], v[84:87], v[76:79], v[24:27]
    ds_read_b64_tr_b16 v[102:103], v148 offset:26880
    ds_read_b64_tr_b16 v[104:105], v148 offset:30720
    v_mfma_f32_16x16x32_bf16 v[16:19], v[88:91], v[72:75], v[16:19]
    ds_read_b64_tr_b16 v[106:107], v148 offset:30976
    v_mfma_f32_16x16x32_bf16 v[28:31], v[88:91], v[76:79], v[28:31]
    ds_read_b64_tr_b16 v[108:109], v148 offset:34816
    v_mfma_f32_16x16x32_bf16 v[64:67], v[44:47], v[72:75], v[64:67]
    ds_read_b64_tr_b16 v[110:111], v148 offset:35072
    v_mfma_f32_16x16x32_bf16 v[68:71], v[72:75], v[72:75], v[68:71]
    v_mfma_f32_16x16x32_bf16 v[32:35], v[80:83], v[44:47], v[32:35]
    v_mfma_f32_16x16x32_bf16 v[36:39], v[84:87], v[44:47], v[36:39]
    v_mfma_f32_16x16x32_bf16 v[40:43], v[88:91], v[44:47], v[40:43]
    s_waitcnt lgkmcnt(0)
    v_mfma_f32_16x16x32_bf16 v[8:11], v[100:103], v[92:95], v[8:11]
    v_mfma_f32_16x16x32_bf16 v[20:23], v[100:103], v[96:99], v[20:23]
    v_mfma_f32_16x16x32_bf16 v[12:15], v[104:107], v[92:95], v[12:15]
    v_mfma_f32_16x16x32_bf16 v[24:27], v[104:107], v[96:99], v[24:27]
    v_mfma_f32_16x16x32_bf16 v[16:19], v[108:111], v[92:95], v[16:19]
    v_mfma_f32_16x16x32_bf16 v[28:31], v[108:111], v[96:99], v[28:31]
    v_mfma_f32_16x16x32_bf16 v[64:67], v[44:47], v[92:95], v[64:67]
    v_mfma_f32_16x16x32_bf16 v[68:71], v[92:95], v[92:95], v[68:71]
    v_mfma_f32_16x16x32_bf16 v[32:35], v[100:103], v[44:47], v[32:35]
    v_mfma_f32_16x16x32_bf16 v[36:39], v[104:107], v[44:47], v[36:39]
    v_mfma_f32_16x16x32_bf16 v[40:43], v[108:111], v[44:47], v[40:43]
    s_cmp_lg_u32 s4, 0
    s_cbranch_scc1 Lptc_94
    s_lshl_b32 s76, s5, 4
    s_add_u32 s76, s76, s6
    v_lshlrev_b32 v164, 7, v1
    s_add_u32 s72, s38, 0x600000
    s_addc_u32 s73, s39, 0
    s_mov_b32 s74, 0x200000
    s_mov_b32 s75, 0x00020000
    s_lshl_b32 s76, s76, 13
    s_mov_b32 exec_lo, 0xffffffff
    s_mov_b32 exec_hi, 0xffffffff
    buffer_load_dword v165, v164, s[72:75], s76 offen
    s_mov_b64 exec, -1
    s_nop 3
Lptc_94:
    s_cmp_lg_u32 s4, 1
    s_cbranch_scc1 Lptc_95
    s_lshl_b32 s76, s5, 4
    s_add_u32 s76, s76, s6
    v_lshlrev_b32 v164, 7, v1
    s_add_u32 s72, s38, 0x800000
    s_addc_u32 s73, s39, 0
    s_mov_b32 s74, 0x200000
    s_mov_b32 s75, 0x00020000
    s_lshl_b32 s76, s76, 13
    s_mov_b32 exec_lo, 0xffffffff
    s_mov_b32 exec_hi, 0xffffffff
    buffer_load_dword v165, v164, s[72:75], s76 offen
    s_mov_b64 exec, -1
    s_nop 3
Lptc_95:
    s_cmp_lg_u32 s4, 2
    s_cbranch_scc1 Lptc_96
    s_lshl_b32 s76, s5, 4
    s_add_u32 s76, s76, s6
    v_lshlrev_b32 v164, 7, v1
    s_add_u32 s72, s38, 0xc00000
    s_addc_u32 s73, s39, 0
    s_mov_b32 s74, 0x720000
    s_mov_b32 s75, 0x00020000
    s_mul_i32 s76, s76, 29184
    s_add_u32 s76, s76, 0
    s_mov_b32 exec_lo, 0xffffffff
    s_mov_b32 exec_hi, 0xffffffff
    buffer_load_dword v165, v164, s[72:75], s76 offen
    s_mov_b64 exec, -1
    s_nop 3
Lptc_96:
    s_cmp_lg_u32 s4, 3
    s_cbranch_scc1 Lptc_97
    s_lshl_b32 s76, s5, 4
    s_add_u32 s76, s76, s6
    v_lshlrev_b32 v164, 7, v1
    s_add_u32 s72, s38, 0xc00000
    s_addc_u32 s73, s39, 0
    s_mov_b32 s74, 0x720000
    s_mov_b32 s75, 0x00020000
    s_mul_i32 s76, s76, 29184
    s_add_u32 s76, s76, 8192
    s_mov_b32 exec_lo, 0xffffffff
    s_mov_b32 exec_hi, 0xffffffff
    buffer_load_dword v165, v164, s[72:75], s76 offen
    s_mov_b64 exec, -1
    s_nop 3
Lptc_97:
    s_cmp_lg_u32 s4, 4
    s_cbranch_scc1 Lptc_98
    s_lshl_b32 s76, s5, 4
    s_add_u32 s76, s76, s6
    v_lshlrev_b32 v164, 7, v1
    s_add_u32 s72, s38, 0xc00000
    s_addc_u32 s73, s39, 0
    s_mov_b32 s74, 0x720000
    s_mov_b32 s75, 0x00020000
    s_mul_i32 s76, s76, 29184
    s_add_u32 s76, s76, 16384
    s_mov_b32 exec_lo, 0xffffffff
    s_mov_b32 exec_hi, 0xffffffff
    buffer_load_dword v165, v164, s[72:75], s76 offen
    s_mov_b64 exec, -1
    s_nop 3
Lptc_98:
    s_cmp_lg_u32 s4, 5
    s_cbranch_scc1 Lptc_99
    s_lshl_b32 s76, s5, 4
    s_add_u32 s76, s76, s6
    v_lshlrev_b32 v164, 7, v1
    s_add_u32 s72, s38, 0xc00000
    s_addc_u32 s73, s39, 0
    s_mov_b32 s74, 0x720000
    s_mov_b32 s75, 0x00020000
    s_mul_i32 s76, s76, 29184
    s_add_u32 s76, s76, 24576
    s_mov_b32 exec_lo, 0xffffffff
    s_mov_b32 exec_hi, 0xf
    buffer_load_dword v165, v164, s[72:75], s76 offen
    s_mov_b64 exec, -1
    s_nop 3
Lptc_99:
    s_cmp_lg_u32 s4, 6
    s_cbranch_scc1 Lptc_100
    s_lshl_b32 s76, s5, 4
    s_add_u32 s76, s76, s6
    v_lshlrev_b32 v164, 7, v1
    s_add_u32 s72, s38, 0x1480000
    s_addc_u32 s73, s39, 0
    s_mov_b32 s74, 0x80000
    s_mov_b32 s75, 0x00020000
    s_lshl_b32 s76, s76, 9
    v_lshrrev_b32 v164, 2, v1
    v_add_u32 v164, 1, v164
    v_lshlrev_b32 v164, 17, v164
    v_and_b32 v165, 3, v1
    v_lshl_add_u32 v164, v165, 7, v164
    s_mov_b32 exec_lo, 0xfff
    s_mov_b32 exec_hi, 0x0
    buffer_load_dword v165, v164, s[72:75], s76 offen
    s_mov_b64 exec, -1
    s_nop 3
Lptc_100:
    s_lshl_b32 s79, s8, 10
    s_add_u32 s79, s79, 143360
    v_lshlrev_b32 v150, 4, v2
    v_add_u32 v150, s79, v150
    ds_read_b128 v[72:75], v150 offset:0
    ds_read_b128 v[76:79], v150 offset:64
    ds_read_b128 v[80:83], v150 offset:128
    ds_read_b128 v[88:91], v150 offset:256
    ds_read_b128 v[92:95], v150 offset:320
    ds_read_b128 v[96:99], v150 offset:384
    s_waitcnt lgkmcnt(3)
    v_pk_add_f32 v[32:33], v[32:33], v[72:73]
    v_pk_add_f32 v[34:35], v[34:35], v[74:75]
    v_pk_add_f32 v[36:37], v[36:37], v[76:77]
    v_pk_add_f32 v[38:39], v[38:39], v[78:79]
    v_pk_add_f32 v[40:41], v[40:41], v[80:81]
    v_pk_add_f32 v[42:43], v[42:43], v[82:83]
    ds_read_b128 v[72:75], v150 offset:512
    ds_read_b128 v[76:79], v150 offset:576
    ds_read_b128 v[80:83], v150 offset:640
    s_waitcnt lgkmcnt(3)
    v_pk_add_f32 v[32:33], v[32:33], v[88:89]
    v_pk_add_f32 v[34:35], v[34:35], v[90:91]
    v_pk_add_f32 v[36:37], v[36:37], v[92:93]
    v_pk_add_f32 v[38:39], v[38:39], v[94:95]
    v_pk_add_f32 v[40:41], v[40:41], v[96:97]
    v_pk_add_f32 v[42:43], v[42:43], v[98:99]
    ds_read_b128 v[88:91], v150 offset:768
    ds_read_b128 v[92:95], v150 offset:832
    ds_read_b128 v[96:99], v150 offset:896
    s_waitcnt lgkmcnt(3)
    v_pk_add_f32 v[32:33], v[32:33], v[72:73]
    v_pk_add_f32 v[34:35], v[34:35], v[74:75]
    v_pk_add_f32 v[36:37], v[36:37], v[76:77]
    v_pk_add_f32 v[38:39], v[38:39], v[78:79]
    v_pk_add_f32 v[40:41], v[40:41], v[80:81]
    v_pk_add_f32 v[42:43], v[42:43], v[82:83]
    s_waitcnt lgkmcnt(0)
    v_pk_add_f32 v[32:33], v[32:33], v[88:89]
    v_pk_add_f32 v[34:35], v[34:35], v[90:91]
    v_pk_add_f32 v[36:37], v[36:37], v[92:93]
    v_pk_add_f32 v[38:39], v[38:39], v[94:95]
    v_pk_add_f32 v[40:41], v[40:41], v[96:97]
    v_pk_add_f32 v[42:43], v[42:43], v[98:99]
    v_and_b32 v4, 3, v3
    v_cmp_eq_u32 vcc, 1, v4
    s_nop 1
    v_cndmask_b32 v136, v68, v69, vcc
    v_cmp_eq_u32 vcc, 2, v4
    s_nop 1
    v_cndmask_b32 v136, v136, v70, vcc
    v_cmp_eq_u32 vcc, 3, v4
    s_nop 1
    v_cndmask_b32 v136, v136, v71, vcc
    v_lshrrev_b32 v4, 2, v3
    v_cmp_eq_u32 vcc, v4, v2
    s_nop 1
    v_cndmask_b32 v136, 0, v136, vcc
    v_mul_f32 v132, 0x3e800000, v64
    v_mov_b32 v4, v132
    s_nop 1
    v_permlane16_swap_b32 v132, v4
    v_add_f32 v132, v132, v4
    v_mov_b32 v4, v132
    s_nop 1
    v_permlane32_swap_b32 v132, v4
    v_add_f32 v132, v132, v4
    v_mov_b32 v4, v136
    s_nop 1
    v_permlane16_swap_b32 v136, v4
    v_add_f32 v136, v136, v4
    v_mov_b32 v4, v136
    s_nop 1
    v_permlane32_swap_b32 v136, v4
    v_add_f32 v136, v136, v4
    v_mul_f32 v132, 0x3b000000, v132
    v_mul_f32 v136, 0x3b000000, v136
    v_fma_f32 v136, -v132, v132, v136
    v_max_f32 v136, 0, v136
    v_mov_b32 v5, v136
    v_cvt_pk_bf16_f32 v4, v5, v5
    v_lshlrev_b32 v5, 16, v4
    v_add_f32 v5, 0x3727c5ac, v5
    v_cvt_pk_bf16_f32 v4, v5, v5
    v_lshlrev_b32 v5, 16, v4
    v_sqrt_f32 v5, v5
    s_nop 0
    v_cvt_pk_bf16_f32 v4, v5, v5
    v_lshlrev_b32 v5, 16, v4
    v_cvt_pk_bf16_f32 v4, v132, v132
    v_lshlrev_b32 v4, 16, v4
    v_rcp_f32 v136, v5
    s_nop 0
    v_mul_f32 v132, -v4, v136
    v_mov_b32 v133, v136
    s_lshl_b32 s60, s4, 9
    s_add_u32 s60, s60, 135168
    v_lshlrev_b32 v4, 3, v1
    v_add_u32 v4, s60, v4
    ds_write_b64 v4, v[132:133]
    v_xor_b32 v4, 2048, v4
    s_waitcnt lgkmcnt(0)
    s_barrier
    ds_read_b64 v[134:135], v4
    s_waitcnt lgkmcnt(0)
    v_mov_b32 v138, v135
    s_branch Ljoin_76
Lhh1_75:
    s_nop 7
    s_nop 7
    s_lshl_b32 s79, s7, 12
    v_and_b32 v140, 7, v3
    v_xor_b32 v140, v140, v2
    v_lshlrev_b32 v140, 4, v140
    v_lshl_add_u32 v140, v3, 7, v140
    v_add_u32 v142, s79, v140
    v_xor_b32 v143, 64, v142
    v_add_u32 v144, 0x10000, v142
    v_add_u32 v145, 0x20000, v142
    v_add_u32 v146, 0x10000, v143
    v_add_u32 v147, 0x20000, v143
    v_bfe_u32 v140, v1, 2, 2
    v_lshl_add_u32 v140, v2, 3, v140
    v_lshlrev_b32 v140, 6, v140
    v_and_b32 v141, 3, v1
    v_lshl_add_u32 v140, v141, 3, v140
    v_and_b32 v141, 1, v2
    v_lshl_add_u32 v140, v141, 5, v140
    v_xor_b32 v148, s66, v140
    v_add_u32 v149, 0x10000, v148
    s_lshl_b32 s79, s4, 8
    s_add_u32 s79, s79, 143360
    v_lshlrev_b32 v150, 4, v2
    v_add_u32 v150, s79, v150
    v_mov_b32 v32, 0
    v_mov_b32 v33, 0
    v_mov_b32 v34, 0
    v_mov_b32 v35, 0
    v_mov_b32 v36, 0
    v_mov_b32 v37, 0
    v_mov_b32 v38, 0
    v_mov_b32 v39, 0
    v_mov_b32 v40, 0
    v_mov_b32 v41, 0
    v_mov_b32 v42, 0
    v_mov_b32 v43, 0
    s_barrier
    ds_read_b128 v[72:75], v142 offset:61440
    ds_read_b128 v[76:79], v142 offset:63488
    ds_read_b64_tr_b16 v[80:81], v148 offset:0
    ds_read_b64_tr_b16 v[82:83], v148 offset:256
    ds_read_b64_tr_b16 v[84:85], v148 offset:4096
    ds_read_b64_tr_b16 v[86:87], v148 offset:4352
    ds_read_b64_tr_b16 v[88:89], v148 offset:8192
    ds_read_b64_tr_b16 v[90:91], v148 offset:8448
    s_waitcnt lgkmcnt(0)
    v_mfma_f32_16x16x32_bf16 v[8:11], v[80:83], v[72:75], 0
    ds_read_b128 v[92:95], v143 offset:61440
    v_mfma_f32_16x16x32_bf16 v[20:23], v[80:83], v[76:79], 0
    ds_read_b128 v[96:99], v143 offset:63488
    v_mfma_f32_16x16x32_bf16 v[12:15], v[84:87], v[72:75], 0
    ds_read_b64_tr_b16 v[100:101], v148 offset:2048
    v_mfma_f32_16x16x32_bf16 v[24:27], v[84:87], v[76:79], 0
    ds_read_b64_tr_b16 v[102:103], v148 offset:2304
    ds_read_b64_tr_b16 v[104:105], v148 offset:6144
    v_mfma_f32_16x16x32_bf16 v[16:19], v[88:91], v[72:75], 0
    ds_read_b64_tr_b16 v[106:107], v148 offset:6400
    v_mfma_f32_16x16x32_bf16 v[28:31], v[88:91], v[76:79], 0
    ds_read_b64_tr_b16 v[108:109], v148 offset:10240
    v_mfma_f32_16x16x32_bf16 v[64:67], v[44:47], v[76:79], 0
    ds_read_b64_tr_b16 v[110:111], v148 offset:10496
    v_mfma_f32_16x16x32_bf16 v[68:71], v[76:79], v[76:79], 0
    s_cmp_lg_u32 s7, 0
    s_cbranch_scc1 Lcs_101
    v_mfma_f32_16x16x32_bf16 v[32:35], v[80:83], v[44:47], v[32:35]
    v_mfma_f32_16x16x32_bf16 v[36:39], v[84:87], v[44:47], v[36:39]
    v_mfma_f32_16x16x32_bf16 v[40:43], v[88:91], v[44:47], v[40:43]
Lcs_101:
    s_waitcnt lgkmcnt(0)
    s_waitcnt lgkmcnt(0)
    s_barrier
    v_mfma_f32_16x16x32_bf16 v[8:11], v[100:103], v[92:95], v[8:11]
    ds_read_b128 v[72:75], v144 offset:12288
    v_mfma_f32_16x16x32_bf16 v[20:23], v[100:103], v[96:99], v[20:23]
    ds_read_b128 v[76:79], v144 offset:14336
    v_mfma_f32_16x16x32_bf16 v[12:15], v[104:107], v[92:95], v[12:15]
    ds_read_b64_tr_b16 v[80:81], v148 offset:12288
    v_mfma_f32_16x16x32_bf16 v[24:27], v[104:107], v[96:99], v[24:27]
    ds_read_b64_tr_b16 v[82:83], v148 offset:12544
    ds_read_b64_tr_b16 v[84:85], v148 offset:16384
    v_mfma_f32_16x16x32_bf16 v[16:19], v[108:111], v[92:95], v[16:19]
    ds_read_b64_tr_b16 v[86:87], v148 offset:16640
    v_mfma_f32_16x16x32_bf16 v[28:31], v[108:111], v[96:99], v[28:31]
    ds_read_b64_tr_b16 v[88:89], v148 offset:20480
    v_mfma_f32_16x16x32_bf16 v[64:67], v[44:47], v[96:99], v[64:67]
    ds_read_b64_tr_b16 v[90:91], v148 offset:20736
    v_mfma_f32_16x16x32_bf16 v[68:71], v[96:99], v[96:99], v[68:71]
    s_cmp_lg_u32 s7, 1
    s_cbranch_scc1 Lcs_102
    v_mfma_f32_16x16x32_bf16 v[32:35], v[100:103], v[44:47], v[32:35]
    v_mfma_f32_16x16x32_bf16 v[36:39], v[104:107], v[44:47], v[36:39]
    v_mfma_f32_16x16x32_bf16 v[40:43], v[108:111], v[44:47], v[40:43]
Lcs_102:
    s_cmp_eq_u32 s90, 0
    s_cbranch_scc1 Lsjf_103
    s_waitcnt vmcnt(0)
    ds_read_b64_tr_b16 v[112:113], v128 offset:0
    ds_read_b64_tr_b16 v[114:115], v128 offset:2048
    ds_read_b64_tr_b16 v[116:117], v129 offset:0
    ds_read_b64_tr_b16 v[118:119], v129 offset:2048
    ds_read_b64_tr_b16 v[120:121], v130 offset:0
    ds_read_b64_tr_b16 v[122:123], v130 offset:2048
    ds_read_b64_tr_b16 v[124:125], v131 offset:0
    ds_read_b64_tr_b16 v[126:127], v131 offset:2048
    s_waitcnt lgkmcnt(0)
    buffer_store_dwordx4 v[112:115], v132, s[92:95], s80 offen sc1
    buffer_store_dwordx4 v[116:119], v132, s[92:95], s81 offen sc1
    buffer_store_dwordx4 v[120:123], v132, s[92:95], s82 offen sc1
    buffer_store_dwordx4 v[124:127], v132, s[92:95], s83 offen sc1
    s_mov_b32 s84, 0x3f803f80
    v_mov_b32 v133, 0
    v_mov_b32 v134, 0
    v_mov_b32 v135, 0
    v_mov_b32 v136, 0
    v_dot2c_f32_bf16 v133, s84, v112
    v_dot2c_f32_bf16 v133, s84, v113
    v_dot2c_f32_bf16 v133, s84, v114
    v_dot2c_f32_bf16 v133, s84, v115
    v_dot2c_f32_bf16 v134, s84, v116
    v_dot2c_f32_bf16 v134, s84, v117
    v_dot2c_f32_bf16 v134, s84, v118
    v_dot2c_f32_bf16 v134, s84, v119
    v_dot2c_f32_bf16 v135, s84, v120
    v_dot2c_f32_bf16 v135, s84, v121
    v_dot2c_f32_bf16 v135, s84, v122
    v_dot2c_f32_bf16 v135, s84, v123
    v_dot2c_f32_bf16 v136, s84, v124
    v_dot2c_f32_bf16 v136, s84, v125
    v_dot2c_f32_bf16 v136, s84, v126
    v_dot2c_f32_bf16 v136, s84, v127
    v_mov_b32 v137, v133
    s_nop 1
    v_permlane16_swap_b32 v133, v137
    v_add_f32 v133, v133, v137
    v_mov_b32 v137, v133
    s_nop 1
    v_permlane32_swap_b32 v133, v137
    v_add_f32 v133, v133, v137
    v_mov_b32 v137, v134
    s_nop 1
    v_permlane16_swap_b32 v134, v137
    v_add_f32 v134, v134, v137
    v_mov_b32 v137, v134
    s_nop 1
    v_permlane32_swap_b32 v134, v137
    v_add_f32 v134, v134, v137
    v_mov_b32 v137, v135
    s_nop 1
    v_permlane16_swap_b32 v135, v137
    v_add_f32 v135, v135, v137
    v_mov_b32 v137, v135
    s_nop 1
    v_permlane32_swap_b32 v135, v137
    v_add_f32 v135, v135, v137
    v_mov_b32 v137, v136
    s_nop 1
    v_permlane16_swap_b32 v136, v137
    v_add_f32 v136, v136, v137
    v_mov_b32 v137, v136
    s_nop 1
    v_permlane32_swap_b32 v136, v137
    v_add_f32 v136, v136, v137
    v_cmp_eq_u32 vcc, 1, v2
    s_nop 1
    v_cndmask_b32 v133, v133, v134, vcc
    v_cmp_eq_u32 vcc, 2, v2
    s_nop 1
    v_cndmask_b32 v133, v133, v135, vcc
    v_cmp_eq_u32 vcc, 3, v2
    s_nop 1
    v_cndmask_b32 v133, v133, v136, vcc
    s_add_u32 s72, s38, 0x1a00000
    s_addc_u32 s73, s39, 0
    s_mov_b32 s74, 0x40000
    s_mov_b32 s75, 0x00020000
    v_lshlrev_b32 v137, 2, v1
    buffer_store_dword v133, v137, s[72:75], s91 offen sc1
    s_nop 3
Lsjf_103:
    s_nop 7
    s_nop 7
    s_waitcnt lgkmcnt(0)
    v_mfma_f32_16x16x32_bf16 v[8:11], v[80:83], v[72:75], v[8:11]
    ds_read_b128 v[92:95], v146 offset:12288
    v_mfma_f32_16x16x32_bf16 v[20:23], v[80:83], v[76:79], v[20:23]
    ds_read_b128 v[96:99], v146 offset:14336
    v_mfma_f32_16x16x32_bf16 v[12:15], v[84:87], v[72:75], v[12:15]
    ds_read_b64_tr_b16 v[100:101], v148 offset:14336
    v_mfma_f32_16x16x32_bf16 v[24:27], v[84:87], v[76:79], v[24:27]
    ds_read_b64_tr_b16 v[102:103], v148 offset:14592
    ds_read_b64_tr_b16 v[104:105], v148 offset:18432
    v_mfma_f32_16x16x32_bf16 v[16:19], v[88:91], v[72:75], v[16:19]
    ds_read_b64_tr_b16 v[106:107], v148 offset:18688
    v_mfma_f32_16x16x32_bf16 v[28:31], v[88:91], v[76:79], v[28:31]
    ds_read_b64_tr_b16 v[108:109], v148 offset:22528
    v_mfma_f32_16x16x32_bf16 v[64:67], v[44:47], v[76:79], v[64:67]
    ds_read_b64_tr_b16 v[110:111], v148 offset:22784
    v_mfma_f32_16x16x32_bf16 v[68:71], v[76:79], v[76:79], v[68:71]
    s_cmp_lg_u32 s7, 2
    s_cbranch_scc1 Lcs_104
    v_mfma_f32_16x16x32_bf16 v[32:35], v[80:83], v[44:47], v[32:35]
    v_mfma_f32_16x16x32_bf16 v[36:39], v[84:87], v[44:47], v[36:39]
    v_mfma_f32_16x16x32_bf16 v[40:43], v[88:91], v[44:47], v[40:43]
Lcs_104:
    s_cmp_lg_u32 s4, 5
    s_cbranch_scc1 Lfz_105
    s_add_u32 s72, s38, 0x1580000
    s_addc_u32 s73, s39, 0
    s_mov_b32 s74, 0x3000
    s_mov_b32 s75, 0x00020000
    s_lshl_b32 s70, s5, 6
    s_add_u32 s70, s70, s6
    s_lshl_b32 s70, s70, 2
    v_mov_b32 v56, 0
    v_mov_b32 v57, 0
    s_mov_b64 exec, 1
    buffer_store_dword v56, v57, s[72:75], s70 offen sc1
    s_mov_b64 exec, -1
    s_nop 1
    s_lshl_b32 s70, s6, 6
    s_add_u32 s70, s70, s5
    s_lshl_b32 s70, s70, 2
    s_add_u32 s70, s70, 4096
    s_mov_b64 exec, 1
    buffer_store_dword v56, v57, s[72:75], s70 offen sc1
    s_mov_b64 exec, -1
    s_nop 3
Lfz_105:
    s_waitcnt lgkmcnt(0)
    s_waitcnt lgkmcnt(0)
    s_barrier
    v_mfma_f32_16x16x32_bf16 v[8:11], v[100:103], v[92:95], v[8:11]
    ds_read_b128 v[72:75], v144 offset:28672
    v_mfma_f32_16x16x32_bf16 v[20:23], v[100:103], v[96:99], v[20:23]
    ds_read_b128 v[76:79], v144 offset:30720
    v_mfma_f32_16x16x32_bf16 v[12:15], v[104:107], v[92:95], v[12:15]
    ds_read_b64_tr_b16 v[80:81], v148 offset:24576
    v_mfma_f32_16x16x32_bf16 v[24:27], v[104:107], v[96:99], v[24:27]
    ds_read_b64_tr_b16 v[82:83], v148 offset:24832
    ds_read_b64_tr_b16 v[84:85], v148 offset:28672
    v_mfma_f32_16x16x32_bf16 v[16:19], v[108:111], v[92:95], v[16:19]
    ds_read_b64_tr_b16 v[86:87], v148 offset:28928
    v_mfma_f32_16x16x32_bf16 v[28:31], v[108:111], v[96:99], v[28:31]
    ds_read_b64_tr_b16 v[88:89], v148 offset:32768
    v_mfma_f32_16x16x32_bf16 v[64:67], v[44:47], v[96:99], v[64:67]
    ds_read_b64_tr_b16 v[90:91], v148 offset:33024
    v_mfma_f32_16x16x32_bf16 v[68:71], v[96:99], v[96:99], v[68:71]
    s_cmp_lg_u32 s7, 3
    s_cbranch_scc1 Lcs_106
    v_mfma_f32_16x16x32_bf16 v[32:35], v[100:103], v[44:47], v[32:35]
    v_mfma_f32_16x16x32_bf16 v[36:39], v[104:107], v[44:47], v[36:39]
    v_mfma_f32_16x16x32_bf16 v[40:43], v[108:111], v[44:47], v[40:43]
Lcs_106:
    s_cmp_lg_u32 s4, 3
    s_cbranch_scc1 Litc_107
    s_mov_b32 s72, s30
    s_mov_b32 s73, s31
    s_mov_b32 s74, 0x1c0000
    s_mov_b32 s75, 0x00020000
    s_lshl_b32 s76, s5, 4
    s_add_u32 s76, s76, s6
    s_mul_i32 s76, s76, 7168
    v_lshlrev_b32 v164, 7, v1
    s_mov_b32 exec_lo, 0xffffffff
    s_mov_b32 exec_hi, 0xffffff
    buffer_load_dword v165, v164, s[72:75], s76 offen
    s_mov_b64 exec, -1
    s_nop 3
Litc_107:
    s_cmp_lg_u32 s4, 4
    s_cbranch_scc1 Litc_108
    s_mov_b32 s72, s22
    s_mov_b32 s73, s23
    s_mov_b32 s74, 0x80000
    s_mov_b32 s75, 0x00020000
    s_lshl_b32 s76, s5, 4
    s_add_u32 s76, s76, s6
    s_mul_i32 s76, s76, 2048
    v_lshlrev_b32 v164, 7, v1
    s_mov_b32 exec_lo, 0xffff
    s_mov_b32 exec_hi, 0x0
    buffer_load_dword v165, v164, s[72:75], s76 offen
    s_mov_b64 exec, -1
    s_nop 3
Litc_108:
    s_waitcnt lgkmcnt(0)
    v_mfma_f32_16x16x32_bf16 v[8:11], v[80:83], v[72:75], v[8:11]
    ds_read_b128 v[92:95], v146 offset:28672
    v_mfma_f32_16x16x32_bf16 v[20:23], v[80:83], v[76:79], v[20:23]
    ds_read_b128 v[96:99], v146 offset:30720
    v_mfma_f32_16x16x32_bf16 v[12:15], v[84:87], v[72:75], v[12:15]
    ds_read_b64_tr_b16 v[100:101], v148 offset:26624
    v_mfma_f32_16x16x32_bf16 v[24:27], v[84:87], v[76:79], v[24:27]
    ds_read_b64_tr_b16 v[102:103], v148 offset:26880
    ds_read_b64_tr_b16 v[104:105], v148 offset:30720
    v_mfma_f32_16x16x32_bf16 v[16:19], v[88:91], v[72:75], v[16:19]
    ds_read_b64_tr_b16 v[106:107], v148 offset:30976
    v_mfma_f32_16x16x32_bf16 v[28:31], v[88:91], v[76:79], v[28:31]
    ds_read_b64_tr_b16 v[108:109], v148 offset:34816
    v_mfma_f32_16x16x32_bf16 v[64:67], v[44:47], v[76:79], v[64:67]
    ds_read_b64_tr_b16 v[110:111], v148 offset:35072
    v_mfma_f32_16x16x32_bf16 v[68:71], v[76:79], v[76:79], v[68:71]
    s_cmp_lg_u32 s7, 0
    s_cbranch_scc1 Lcs_109
    v_mfma_f32_16x16x32_bf16 v[32:35], v[80:83], v[44:47], v[32:35]
    v_mfma_f32_16x16x32_bf16 v[36:39], v[84:87], v[44:47], v[36:39]
    v_mfma_f32_16x16x32_bf16 v[40:43], v[88:91], v[44:47], v[40:43]
Lcs_109:
    s_waitcnt lgkmcnt(0)
    s_waitcnt lgkmcnt(0)
    s_barrier
    v_mfma_f32_16x16x32_bf16 v[8:11], v[100:103], v[92:95], v[8:11]
    ds_read_b128 v[72:75], v144 offset:45056
    v_mfma_f32_16x16x32_bf16 v[20:23], v[100:103], v[96:99], v[20:23]
    ds_read_b128 v[76:79], v144 offset:47104
    v_mfma_f32_16x16x32_bf16 v[12:15], v[104:107], v[92:95], v[12:15]
    ds_read_b64_tr_b16 v[80:81], v148 offset:36864
    v_mfma_f32_16x16x32_bf16 v[24:27], v[104:107], v[96:99], v[24:27]
    ds_read_b64_tr_b16 v[82:83], v148 offset:37120
    ds_read_b64_tr_b16 v[84:85], v148 offset:40960
    v_mfma_f32_16x16x32_bf16 v[16:19], v[108:111], v[92:95], v[16:19]
    ds_read_b64_tr_b16 v[86:87], v148 offset:41216
    v_mfma_f32_16x16x32_bf16 v[28:31], v[108:111], v[96:99], v[28:31]
    ds_read_b64_tr_b16 v[88:89], v148 offset:45056
    v_mfma_f32_16x16x32_bf16 v[64:67], v[44:47], v[96:99], v[64:67]
    ds_read_b64_tr_b16 v[90:91], v148 offset:45312
    v_mfma_f32_16x16x32_bf16 v[68:71], v[96:99], v[96:99], v[68:71]
    s_cmp_lg_u32 s7, 1
    s_cbranch_scc1 Lcs_110
    v_mfma_f32_16x16x32_bf16 v[32:35], v[100:103], v[44:47], v[32:35]
    v_mfma_f32_16x16x32_bf16 v[36:39], v[104:107], v[44:47], v[36:39]
    v_mfma_f32_16x16x32_bf16 v[40:43], v[108:111], v[44:47], v[40:43]
Lcs_110:
    s_waitcnt lgkmcnt(0)
    v_mfma_f32_16x16x32_bf16 v[8:11], v[80:83], v[72:75], v[8:11]
    ds_read_b128 v[92:95], v146 offset:45056
    v_mfma_f32_16x16x32_bf16 v[20:23], v[80:83], v[76:79], v[20:23]
    ds_read_b128 v[96:99], v146 offset:47104
    v_mfma_f32_16x16x32_bf16 v[12:15], v[84:87], v[72:75], v[12:15]
    ds_read_b64_tr_b16 v[100:101], v148 offset:38912
    v_mfma_f32_16x16x32_bf16 v[24:27], v[84:87], v[76:79], v[24:27]
    ds_read_b64_tr_b16 v[102:103], v148 offset:39168
    ds_read_b64_tr_b16 v[104:105], v148 offset:43008
    v_mfma_f32_16x16x32_bf16 v[16:19], v[88:91], v[72:75], v[16:19]
    ds_read_b64_tr_b16 v[106:107], v148 offset:43264
    v_mfma_f32_16x16x32_bf16 v[28:31], v[88:91], v[76:79], v[28:31]
    ds_read_b64_tr_b16 v[108:109], v148 offset:47104
    v_mfma_f32_16x16x32_bf16 v[64:67], v[44:47], v[76:79], v[64:67]
    ds_read_b64_tr_b16 v[110:111], v148 offset:47360
    v_mfma_f32_16x16x32_bf16 v[68:71], v[76:79], v[76:79], v[68:71]
    s_cmp_lg_u32 s7, 2
    s_cbranch_scc1 Lcs_111
    v_mfma_f32_16x16x32_bf16 v[32:35], v[80:83], v[44:47], v[32:35]
    v_mfma_f32_16x16x32_bf16 v[36:39], v[84:87], v[44:47], v[36:39]
    v_mfma_f32_16x16x32_bf16 v[40:43], v[88:91], v[44:47], v[40:43]
Lcs_111:
    s_waitcnt lgkmcnt(0)
    s_waitcnt lgkmcnt(0)
    s_barrier
    v_mfma_f32_16x16x32_bf16 v[8:11], v[100:103], v[92:95], v[8:11]
    ds_read_b128 v[72:75], v144 offset:61440
    v_mfma_f32_16x16x32_bf16 v[20:23], v[100:103], v[96:99], v[20:23]
    ds_read_b128 v[76:79], v144 offset:63488
    v_mfma_f32_16x16x32_bf16 v[12:15], v[104:107], v[92:95], v[12:15]
    ds_read_b64_tr_b16 v[80:81], v148 offset:49152
    v_mfma_f32_16x16x32_bf16 v[24:27], v[104:107], v[96:99], v[24:27]
    ds_read_b64_tr_b16 v[82:83], v148 offset:49408
    ds_read_b64_tr_b16 v[84:85], v148 offset:53248
    v_mfma_f32_16x16x32_bf16 v[16:19], v[108:111], v[92:95], v[16:19]
    ds_read_b64_tr_b16 v[86:87], v148 offset:53504
    v_mfma_f32_16x16x32_bf16 v[28:31], v[108:111], v[96:99], v[28:31]
    ds_read_b64_tr_b16 v[88:89], v148 offset:57344
    v_mfma_f32_16x16x32_bf16 v[64:67], v[44:47], v[96:99], v[64:67]
    ds_read_b64_tr_b16 v[90:91], v148 offset:57600
    v_mfma_f32_16x16x32_bf16 v[68:71], v[96:99], v[96:99], v[68:71]
    s_cmp_lg_u32 s7, 3
    s_cbranch_scc1 Lcs_112
    v_mfma_f32_16x16x32_bf16 v[32:35], v[100:103], v[44:47], v[32:35]
    v_mfma_f32_16x16x32_bf16 v[36:39], v[104:107], v[44:47], v[36:39]
    v_mfma_f32_16x16x32_bf16 v[40:43], v[108:111], v[44:47], v[40:43]
Lcs_112:
    s_waitcnt vmcnt(0)
    s_cmp_lg_u32 s4, 5
    s_cbranch_scc1 Lini_113
    s_getreg_b32 s71, hwreg(HW_REG_XCC_ID)
    s_and_b32 s71, s71, 15
    s_mul_i32 s70, s71, s71
    s_lshl_b32 s70, s70, 16
    s_lshl_b32 s71, s71, 8
    s_add_u32 s70, s70, s71
    s_add_u32 s70, s70, 1
    v_mov_b32 v4, s70
    v_mov_b32 v5, 0
    s_lshl_b32 s70, s5, 2
    s_mov_b64 exec, 1
    buffer_atomic_add v4, v5, s[12:15], s70 offen
    s_mov_b64 exec, -1
    s_nop 3
Lini_113:
    v_cmp_gt_u32 vcc, 8, v3
    v_lshl_or_b32 v4, v49, 16, v48
    v_lshl_or_b32 v5, v51, 16, v50
    v_cndmask_b32 v56, 0, v4, vcc
    v_cndmask_b32 v57, 0, v5, vcc
    v_cndmask_b32 v58, v4, 0, vcc
    v_cndmask_b32 v59, v5, 0, vcc
    v_lshl_or_b32 v4, v53, 16, v52
    v_lshl_or_b32 v5, v55, 16, v54
    v_cndmask_b32 v60, 0, v4, vcc
    v_cndmask_b32 v61, 0, v5, vcc
    v_cndmask_b32 v62, v4, 0, vcc
    v_cndmask_b32 v63, v5, 0, vcc
    s_waitcnt lgkmcnt(0)
    v_mfma_f32_16x16x32_bf16 v[8:11], v[80:83], v[72:75], v[8:11]
    ds_read_b128 v[92:95], v146 offset:61440
    v_mfma_f32_16x16x32_bf16 v[20:23], v[80:83], v[76:79], v[20:23]
    ds_read_b128 v[96:99], v146 offset:63488
    v_mfma_f32_16x16x32_bf16 v[12:15], v[84:87], v[72:75], v[12:15]
    ds_read_b64_tr_b16 v[100:101], v148 offset:51200
    v_mfma_f32_16x16x32_bf16 v[24:27], v[84:87], v[76:79], v[24:27]
    ds_read_b64_tr_b16 v[102:103], v148 offset:51456
    ds_read_b64_tr_b16 v[104:105], v148 offset:55296
    v_mfma_f32_16x16x32_bf16 v[16:19], v[88:91], v[72:75], v[16:19]
    ds_read_b64_tr_b16 v[106:107], v148 offset:55552
    v_mfma_f32_16x16x32_bf16 v[28:31], v[88:91], v[76:79], v[28:31]
    ds_read_b64_tr_b16 v[108:109], v148 offset:59392
    v_mfma_f32_16x16x32_bf16 v[64:67], v[44:47], v[76:79], v[64:67]
    ds_read_b64_tr_b16 v[110:111], v148 offset:59648
    v_mfma_f32_16x16x32_bf16 v[68:71], v[76:79], v[76:79], v[68:71]
    s_cmp_lg_u32 s7, 0
    s_cbranch_scc1 Lcs_114
    v_mfma_f32_16x16x32_bf16 v[32:35], v[80:83], v[44:47], v[32:35]
    v_mfma_f32_16x16x32_bf16 v[36:39], v[84:87], v[44:47], v[36:39]
    v_mfma_f32_16x16x32_bf16 v[40:43], v[88:91], v[44:47], v[40:43]
Lcs_114:
    s_waitcnt lgkmcnt(0)
    s_waitcnt lgkmcnt(0)
    s_barrier
    v_mfma_f32_16x16x32_bf16 v[8:11], v[100:103], v[92:95], v[8:11]
    ds_read_b128 v[72:75], v142 offset:61440
    v_mfma_f32_16x16x32_bf16 v[20:23], v[100:103], v[96:99], v[20:23]
    ds_read_b128 v[76:79], v142 offset:63488
    v_mfma_f32_16x16x32_bf16 v[12:15], v[104:107], v[92:95], v[12:15]
    ds_read_b64_tr_b16 v[80:81], v148 offset:0
    v_mfma_f32_16x16x32_bf16 v[24:27], v[104:107], v[96:99], v[24:27]
    ds_read_b64_tr_b16 v[82:83], v148 offset:256
    ds_read_b64_tr_b16 v[84:85], v148 offset:4096
    v_mfma_f32_16x16x32_bf16 v[16:19], v[108:111], v[92:95], v[16:19]
    ds_read_b64_tr_b16 v[86:87], v148 offset:4352
    v_mfma_f32_16x16x32_bf16 v[28:31], v[108:111], v[96:99], v[28:31]
    ds_read_b64_tr_b16 v[88:89], v148 offset:8192
    v_mfma_f32_16x16x32_bf16 v[64:67], v[44:47], v[96:99], v[64:67]
    ds_read_b64_tr_b16 v[90:91], v148 offset:8448
    v_mfma_f32_16x16x32_bf16 v[68:71], v[96:99], v[96:99], v[68:71]
    s_cmp_lg_u32 s7, 1
    s_cbranch_scc1 Lcs_115
    v_mfma_f32_16x16x32_bf16 v[32:35], v[100:103], v[44:47], v[32:35]
    v_mfma_f32_16x16x32_bf16 v[36:39], v[104:107], v[44:47], v[36:39]
    v_mfma_f32_16x16x32_bf16 v[40:43], v[108:111], v[44:47], v[40:43]
Lcs_115:
    s_waitcnt lgkmcnt(0)
    v_mfma_f32_16x16x32_bf16 v[8:11], v[80:83], v[72:75], v[8:11]
    ds_read_b128 v[92:95], v143 offset:61440
    v_mfma_f32_16x16x32_bf16 v[20:23], v[80:83], v[76:79], v[20:23]
    ds_read_b128 v[96:99], v143 offset:63488
    v_mfma_f32_16x16x32_bf16 v[12:15], v[84:87], v[72:75], v[12:15]
    ds_read_b64_tr_b16 v[100:101], v148 offset:2048
    v_mfma_f32_16x16x32_bf16 v[24:27], v[84:87], v[76:79], v[24:27]
    ds_read_b64_tr_b16 v[102:103], v148 offset:2304
    ds_read_b64_tr_b16 v[104:105], v148 offset:6144
    v_mfma_f32_16x16x32_bf16 v[16:19], v[88:91], v[72:75], v[16:19]
    ds_read_b64_tr_b16 v[106:107], v148 offset:6400
    v_mfma_f32_16x16x32_bf16 v[28:31], v[88:91], v[76:79], v[28:31]
    ds_read_b64_tr_b16 v[108:109], v148 offset:10240
    v_mfma_f32_16x16x32_bf16 v[64:67], v[44:47], v[76:79], v[64:67]
    ds_read_b64_tr_b16 v[110:111], v148 offset:10496
    v_mfma_f32_16x16x32_bf16 v[68:71], v[76:79], v[76:79], v[68:71]
    s_cmp_lg_u32 s7, 2
    s_cbranch_scc1 Lcs_116
    v_mfma_f32_16x16x32_bf16 v[32:35], v[80:83], v[44:47], v[32:35]
    v_mfma_f32_16x16x32_bf16 v[36:39], v[84:87], v[44:47], v[36:39]
    v_mfma_f32_16x16x32_bf16 v[40:43], v[88:91], v[44:47], v[40:43]
Lcs_116:
    s_waitcnt lgkmcnt(0)
    s_waitcnt lgkmcnt(0)
    s_barrier
    v_mfma_f32_16x16x32_bf16 v[8:11], v[100:103], v[92:95], v[8:11]
    ds_read_b128 v[72:75], v144 offset:12288
    v_mfma_f32_16x16x32_bf16 v[20:23], v[100:103], v[96:99], v[20:23]
    ds_read_b128 v[76:79], v144 offset:14336
    v_mfma_f32_16x16x32_bf16 v[12:15], v[104:107], v[92:95], v[12:15]
    ds_read_b64_tr_b16 v[80:81], v148 offset:12288
    v_mfma_f32_16x16x32_bf16 v[24:27], v[104:107], v[96:99], v[24:27]
    ds_read_b64_tr_b16 v[82:83], v148 offset:12544
    ds_read_b64_tr_b16 v[84:85], v148 offset:16384
    v_mfma_f32_16x16x32_bf16 v[16:19], v[108:111], v[92:95], v[16:19]
    ds_read_b64_tr_b16 v[86:87], v148 offset:16640
    v_mfma_f32_16x16x32_bf16 v[28:31], v[108:111], v[96:99], v[28:31]
    ds_read_b64_tr_b16 v[88:89], v148 offset:20480
    v_mfma_f32_16x16x32_bf16 v[64:67], v[44:47], v[96:99], v[64:67]
    ds_read_b64_tr_b16 v[90:91], v148 offset:20736
    v_mfma_f32_16x16x32_bf16 v[68:71], v[96:99], v[96:99], v[68:71]
    s_cmp_lg_u32 s7, 3
    s_cbranch_scc1 Lcs_117
    v_mfma_f32_16x16x32_bf16 v[32:35], v[100:103], v[44:47], v[32:35]
    v_mfma_f32_16x16x32_bf16 v[36:39], v[104:107], v[44:47], v[36:39]
    v_mfma_f32_16x16x32_bf16 v[40:43], v[108:111], v[44:47], v[40:43]
Lcs_117:
    s_nop 7
    s_nop 7
    s_mov_b32 exec_lo, 0x00010001
    s_mov_b32 exec_hi, 0x00010001
    ds_write_b128 v150, v[32:35] offset:0
    ds_write_b128 v150, v[36:39] offset:64
    ds_write_b128 v150, v[40:43] offset:128
    s_mov_b64 exec, -1
    s_nop 3
    s_waitcnt lgkmcnt(3)
    v_mfma_f32_16x16x32_bf16 v[8:11], v[80:83], v[72:75], v[8:11]
    ds_read_b128 v[92:95], v146 offset:12288
    v_mfma_f32_16x16x32_bf16 v[20:23], v[80:83], v[76:79], v[20:23]
    ds_read_b128 v[96:99], v146 offset:14336
    v_mfma_f32_16x16x32_bf16 v[12:15], v[84:87], v[72:75], v[12:15]
    ds_read_b64_tr_b16 v[100:101], v148 offset:14336
    v_mfma_f32_16x16x32_bf16 v[24:27], v[84:87], v[76:79], v[24:27]
    ds_read_b64_tr_b16 v[102:103], v148 offset:14592
    ds_read_b64_tr_b16 v[104:105], v148 offset:18432
    v_mfma_f32_16x16x32_bf16 v[16:19], v[88:91], v[72:75], v[16:19]
    ds_read_b64_tr_b16 v[106:107], v148 offset:18688
    v_mfma_f32_16x16x32_bf16 v[28:31], v[88:91], v[76:79], v[28:31]
    ds_read_b64_tr_b16 v[108:109], v148 offset:22528
    v_mfma_f32_16x16x32_bf16 v[64:67], v[44:47], v[76:79], v[64:67]
    ds_read_b64_tr_b16 v[110:111], v148 offset:22784
    v_mfma_f32_16x16x32_bf16 v[68:71], v[76:79], v[76:79], v[68:71]
    v_mfma_f32_16x16x32_bf16 v[32:35], v[80:83], v[44:47], 0
    v_mfma_f32_16x16x32_bf16 v[36:39], v[84:87], v[44:47], 0
    v_mfma_f32_16x16x32_bf16 v[40:43], v[88:91], v[44:47], 0
    s_waitcnt lgkmcnt(0)
    s_waitcnt lgkmcnt(0)
    s_barrier
    v_mfma_f32_16x16x32_bf16 v[8:11], v[100:103], v[92:95], v[8:11]
    ds_read_b128 v[72:75], v144 offset:28672
    v_mfma_f32_16x16x32_bf16 v[20:23], v[100:103], v[96:99], v[20:23]
    ds_read_b128 v[76:79], v144 offset:30720
    v_mfma_f32_16x16x32_bf16 v[12:15], v[104:107], v[92:95], v[12:15]
    ds_read_b64_tr_b16 v[80:81], v148 offset:24576
    v_mfma_f32_16x16x32_bf16 v[24:27], v[104:107], v[96:99], v[24:27]
    ds_read_b64_tr_b16 v[82:83], v148 offset:24832
    ds_read_b64_tr_b16 v[84:85], v148 offset:28672
    v_mfma_f32_16x16x32_bf16 v[16:19], v[108:111], v[92:95], v[16:19]
    ds_read_b64_tr_b16 v[86:87], v148 offset:28928
    v_mfma_f32_16x16x32_bf16 v[28:31], v[108:111], v[96:99], v[28:31]
    ds_read_b64_tr_b16 v[88:89], v148 offset:32768
    v_mfma_f32_16x16x32_bf16 v[64:67], v[44:47], v[96:99], v[64:67]
    ds_read_b64_tr_b16 v[90:91], v148 offset:33024
    v_mfma_f32_16x16x32_bf16 v[68:71], v[96:99], v[96:99], v[68:71]
    v_mfma_f32_16x16x32_bf16 v[32:35], v[100:103], v[44:47], v[32:35]
    v_mfma_f32_16x16x32_bf16 v[36:39], v[104:107], v[44:47], v[36:39]
    v_mfma_f32_16x16x32_bf16 v[40:43], v[108:111], v[44:47], v[40:43]
    s_waitcnt lgkmcnt(0)
    v_mfma_f32_16x16x32_bf16 v[8:11], v[80:83], v[72:75], v[8:11]
    ds_read_b128 v[92:95], v146 offset:28672
    v_mfma_f32_16x16x32_bf16 v[20:23], v[80:83], v[76:79], v[20:23]
    ds_read_b128 v[96:99], v146 offset:30720
    v_mfma_f32_16x16x32_bf16 v[12:15], v[84:87], v[72:75], v[12:15]
    ds_read_b64_tr_b16 v[100:101], v148 offset:26624
    v_mfma_f32_16x16x32_bf16 v[24:27], v[84:87], v[76:79], v[24:27]
    ds_read_b64_tr_b16 v[102:103], v148 offset:26880
    ds_read_b64_tr_b16 v[104:105], v148 offset:30720
    v_mfma_f32_16x16x32_bf16 v[16:19], v[88:91], v[72:75], v[16:19]
    ds_read_b64_tr_b16 v[106:107], v148 offset:30976
    v_mfma_f32_16x16x32_bf16 v[28:31], v[88:91], v[76:79], v[28:31]
    ds_read_b64_tr_b16 v[108:109], v148 offset:34816
    v_mfma_f32_16x16x32_bf16 v[64:67], v[44:47], v[76:79], v[64:67]
    ds_read_b64_tr_b16 v[110:111], v148 offset:35072
    v_mfma_f32_16x16x32_bf16 v[68:71], v[76:79], v[76:79], v[68:71]
    v_mfma_f32_16x16x32_bf16 v[32:35], v[80:83], v[44:47], v[32:35]
    v_mfma_f32_16x16x32_bf16 v[36:39], v[84:87], v[44:47], v[36:39]
    v_mfma_f32_16x16x32_bf16 v[40:43], v[88:91], v[44:47], v[40:43]
    s_waitcnt lgkmcnt(0)
    v_mfma_f32_16x16x32_bf16 v[8:11], v[100:103], v[92:95], v[8:11]
    v_mfma_f32_16x16x32_bf16 v[20:23], v[100:103], v[96:99], v[20:23]
    v_mfma_f32_16x16x32_bf16 v[12:15], v[104:107], v[92:95], v[12:15]
    v_mfma_f32_16x16x32_bf16 v[24:27], v[104:107], v[96:99], v[24:27]
    v_mfma_f32_16x16x32_bf16 v[16:19], v[108:111], v[92:95], v[16:19]
    v_mfma_f32_16x16x32_bf16 v[28:31], v[108:111], v[96:99], v[28:31]
    v_mfma_f32_16x16x32_bf16 v[64:67], v[44:47], v[96:99], v[64:67]
    v_mfma_f32_16x16x32_bf16 v[68:71], v[96:99], v[96:99], v[68:71]
    v_mfma_f32_16x16x32_bf16 v[32:35], v[100:103], v[44:47], v[32:35]
    v_mfma_f32_16x16x32_bf16 v[36:39], v[104:107], v[44:47], v[36:39]
    v_mfma_f32_16x16x32_bf16 v[40:43], v[108:111], v[44:47], v[40:43]
    s_cmp_lg_u32 s4, 0
    s_cbranch_scc1 Lptc_118
    s_lshl_b32 s76, s5, 4
    s_add_u32 s76, s76, s6
    v_lshlrev_b32 v164, 7, v1
    s_add_u32 s72, s38, 0x600000
    s_addc_u32 s73, s39, 0
    s_mov_b32 s74, 0x200000
    s_mov_b32 s75, 0x00020000
    s_lshl_b32 s76, s76, 13
    s_mov_b32 exec_lo, 0xffffffff
    s_mov_b32 exec_hi, 0xffffffff
    buffer_load_dword v165, v164, s[72:75], s76 offen
    s_mov_b64 exec, -1
    s_nop 3
Lptc_118:
    s_cmp_lg_u32 s4, 1
    s_cbranch_scc1 Lptc_119
    s_lshl_b32 s76, s5, 4
    s_add_u32 s76, s76, s6
    v_lshlrev_b32 v164, 7, v1
    s_add_u32 s72, s38, 0x800000
    s_addc_u32 s73, s39, 0
    s_mov_b32 s74, 0x200000
    s_mov_b32 s75, 0x00020000
    s_lshl_b32 s76, s76, 13
    s_mov_b32 exec_lo, 0xffffffff
    s_mov_b32 exec_hi, 0xffffffff
    buffer_load_dword v165, v164, s[72:75], s76 offen
    s_mov_b64 exec, -1
    s_nop 3
Lptc_119:
    s_cmp_lg_u32 s4, 2
    s_cbranch_scc1 Lptc_120
    s_lshl_b32 s76, s5, 4
    s_add_u32 s76, s76, s6
    v_lshlrev_b32 v164, 7, v1
    s_add_u32 s72, s38, 0xc00000
    s_addc_u32 s73, s39, 0
    s_mov_b32 s74, 0x720000
    s_mov_b32 s75, 0x00020000
    s_mul_i32 s76, s76, 29184
    s_add_u32 s76, s76, 0
    s_mov_b32 exec_lo, 0xffffffff
    s_mov_b32 exec_hi, 0xffffffff
    buffer_load_dword v165, v164, s[72:75], s76 offen
    s_mov_b64 exec, -1
    s_nop 3
Lptc_120:
    s_cmp_lg_u32 s4, 3
    s_cbranch_scc1 Lptc_121
    s_lshl_b32 s76, s5, 4
    s_add_u32 s76, s76, s6
    v_lshlrev_b32 v164, 7, v1
    s_add_u32 s72, s38, 0xc00000
    s_addc_u32 s73, s39, 0
    s_mov_b32 s74, 0x720000
    s_mov_b32 s75, 0x00020000
    s_mul_i32 s76, s76, 29184
    s_add_u32 s76, s76, 8192
    s_mov_b32 exec_lo, 0xffffffff
    s_mov_b32 exec_hi, 0xffffffff
    buffer_load_dword v165, v164, s[72:75], s76 offen
    s_mov_b64 exec, -1
    s_nop 3
Lptc_121:
    s_cmp_lg_u32 s4, 4
    s_cbranch_scc1 Lptc_122
    s_lshl_b32 s76, s5, 4
    s_add_u32 s76, s76, s6
    v_lshlrev_b32 v164, 7, v1
    s_add_u32 s72, s38, 0xc00000
    s_addc_u32 s73, s39, 0
    s_mov_b32 s74, 0x720000
    s_mov_b32 s75, 0x00020000
    s_mul_i32 s76, s76, 29184
    s_add_u32 s76, s76, 16384
    s_mov_b32 exec_lo, 0xffffffff
    s_mov_b32 exec_hi, 0xffffffff
    buffer_load_dword v165, v164, s[72:75], s76 offen
    s_mov_b64 exec, -1
    s_nop 3
Lptc_122:
    s_cmp_lg_u32 s4, 5
    s_cbranch_scc1 Lptc_123
    s_lshl_b32 s76, s5, 4
    s_add_u32 s76, s76, s6
    v_lshlrev_b32 v164, 7, v1
    s_add_u32 s72, s38, 0xc00000
    s_addc_u32 s73, s39, 0
    s_mov_b32 s74, 0x720000
    s_mov_b32 s75, 0x00020000
    s_mul_i32 s76, s76, 29184
    s_add_u32 s76, s76, 24576
    s_mov_b32 exec_lo, 0xffffffff
    s_mov_b32 exec_hi, 0xf
    buffer_load_dword v165, v164, s[72:75], s76 offen
    s_mov_b64 exec, -1
    s_nop 3
Lptc_123:
    s_cmp_lg_u32 s4, 6
    s_cbranch_scc1 Lptc_124
    s_lshl_b32 s76, s5, 4
    s_add_u32 s76, s76, s6
    v_lshlrev_b32 v164, 7, v1
    s_add_u32 s72, s38, 0x1480000
    s_addc_u32 s73, s39, 0
    s_mov_b32 s74, 0x80000
    s_mov_b32 s75, 0x00020000
    s_lshl_b32 s76, s76, 9
    v_lshrrev_b32 v164, 2, v1
    v_add_u32 v164, 1, v164
    v_lshlrev_b32 v164, 17, v164
    v_and_b32 v165, 3, v1
    v_lshl_add_u32 v164, v165, 7, v164
    s_mov_b32 exec_lo, 0xfff
    s_mov_b32 exec_hi, 0x0
    buffer_load_dword v165, v164, s[72:75], s76 offen
    s_mov_b64 exec, -1
    s_nop 3
Lptc_124:
    s_lshl_b32 s79, s8, 10
    s_add_u32 s79, s79, 143360
    v_lshlrev_b32 v150, 4, v2
    v_add_u32 v150, s79, v150
    ds_read_b128 v[72:75], v150 offset:0
    ds_read_b128 v[76:79], v150 offset:64
    ds_read_b128 v[80:83], v150 offset:128
    ds_read_b128 v[88:91], v150 offset:256
    ds_read_b128 v[92:95], v150 offset:320
    ds_read_b128 v[96:99], v150 offset:384
    s_waitcnt lgkmcnt(3)
    v_pk_add_f32 v[32:33], v[32:33], v[72:73]
    v_pk_add_f32 v[34:35], v[34:35], v[74:75]
    v_pk_add_f32 v[36:37], v[36:37], v[76:77]
    v_pk_add_f32 v[38:39], v[38:39], v[78:79]
    v_pk_add_f32 v[40:41], v[40:41], v[80:81]
    v_pk_add_f32 v[42:43], v[42:43], v[82:83]
    ds_read_b128 v[72:75], v150 offset:512
    ds_read_b128 v[76:79], v150 offset:576
    ds_read_b128 v[80:83], v150 offset:640
    s_waitcnt lgkmcnt(3)
    v_pk_add_f32 v[32:33], v[32:33], v[88:89]
    v_pk_add_f32 v[34:35], v[34:35], v[90:91]
    v_pk_add_f32 v[36:37], v[36:37], v[92:93]
    v_pk_add_f32 v[38:39], v[38:39], v[94:95]
    v_pk_add_f32 v[40:41], v[40:41], v[96:97]
    v_pk_add_f32 v[42:43], v[42:43], v[98:99]
    ds_read_b128 v[88:91], v150 offset:768
    ds_read_b128 v[92:95], v150 offset:832
    ds_read_b128 v[96:99], v150 offset:896
    s_waitcnt lgkmcnt(3)
    v_pk_add_f32 v[32:33], v[32:33], v[72:73]
    v_pk_add_f32 v[34:35], v[34:35], v[74:75]
    v_pk_add_f32 v[36:37], v[36:37], v[76:77]
    v_pk_add_f32 v[38:39], v[38:39], v[78:79]
    v_pk_add_f32 v[40:41], v[40:41], v[80:81]
    v_pk_add_f32 v[42:43], v[42:43], v[82:83]
    s_waitcnt lgkmcnt(0)
    v_pk_add_f32 v[32:33], v[32:33], v[88:89]
    v_pk_add_f32 v[34:35], v[34:35], v[90:91]
    v_pk_add_f32 v[36:37], v[36:37], v[92:93]
    v_pk_add_f32 v[38:39], v[38:39], v[94:95]
    v_pk_add_f32 v[40:41], v[40:41], v[96:97]
    v_pk_add_f32 v[42:43], v[42:43], v[98:99]
    v_and_b32 v4, 3, v3
    v_cmp_eq_u32 vcc, 1, v4
    s_nop 1
    v_cndmask_b32 v138, v68, v69, vcc
    v_cmp_eq_u32 vcc, 2, v4
    s_nop 1
    v_cndmask_b32 v138, v138, v70, vcc
    v_cmp_eq_u32 vcc, 3, v4
    s_nop 1
    v_cndmask_b32 v138, v138, v71, vcc
    v_lshrrev_b32 v4, 2, v3
    v_cmp_eq_u32 vcc, v4, v2
    s_nop 1
    v_cndmask_b32 v138, 0, v138, vcc
    v_mul_f32 v134, 0x3e800000, v64
    v_mov_b32 v4, v134
    s_nop 1
    v_permlane16_swap_b32 v134, v4
    v_add_f32 v134, v134, v4
    v_mov_b32 v4, v134
    s_nop 1
    v_permlane32_swap_b32 v134, v4
    v_add_f32 v134, v134, v4
    v_mov_b32 v4, v138
    s_nop 1
    v_permlane16_swap_b32 v138, v4
    v_add_f32 v138, v138, v4
    v_mov_b32 v4, v138
    s_nop 1
    v_permlane32_swap_b32 v138, v4
    v_add_f32 v138, v138, v4
    v_mul_f32 v134, 0x3b000000, v134
    v_mul_f32 v138, 0x3b000000, v138
    v_fma_f32 v138, -v134, v134, v138
    v_max_f32 v138, 0, v138
    v_mov_b32 v5, v138
    v_cvt_pk_bf16_f32 v4, v5, v5
    v_lshlrev_b32 v5, 16, v4
    v_add_f32 v5, 0x3727c5ac, v5
    v_cvt_pk_bf16_f32 v4, v5, v5
    v_lshlrev_b32 v5, 16, v4
    v_sqrt_f32 v5, v5
    s_nop 0
    v_cvt_pk_bf16_f32 v4, v5, v5
    v_lshlrev_b32 v5, 16, v4
    v_cvt_pk_bf16_f32 v4, v134, v134
    v_lshlrev_b32 v4, 16, v4
    v_rcp_f32 v138, v5
    s_nop 0
    v_mul_f32 v134, -v4, v138
    v_mov_b32 v135, v138
    s_lshl_b32 s60, s4, 9
    s_add_u32 s60, s60, 135168
    v_lshlrev_b32 v4, 3, v1
    v_add_u32 v4, s60, v4
    ds_write_b64 v4, v[134:135]
    v_xor_b32 v4, 2048, v4
    s_waitcnt lgkmcnt(0)
    s_barrier
    ds_read_b64 v[132:133], v4
    s_waitcnt lgkmcnt(0)
    v_mov_b32 v136, v133
Ljoin_76:
    s_nop 7
    s_nop 7
    v_pk_mul_f32 v[8:9], v[8:9], v[136:137] op_sel_hi:[1,0]
    v_pk_fma_f32 v[8:9], v[32:33], v[132:133], v[8:9] op_sel_hi:[1,0,1]
    v_pk_mul_f32 v[10:11], v[10:11], v[136:137] op_sel_hi:[1,0]
    v_pk_fma_f32 v[10:11], v[34:35], v[132:133], v[10:11] op_sel_hi:[1,0,1]
    v_cvt_pk_bf16_f32 v72, v8, v9
    v_cvt_pk_bf16_f32 v73, v10, v11
    v_pk_mul_f32 v[12:13], v[12:13], v[136:137] op_sel_hi:[1,0]
    v_pk_fma_f32 v[12:13], v[36:37], v[132:133], v[12:13] op_sel_hi:[1,0,1]
    v_pk_mul_f32 v[14:15], v[14:15], v[136:137] op_sel_hi:[1,0]
    v_pk_fma_f32 v[14:15], v[38:39], v[132:133], v[14:15] op_sel_hi:[1,0,1]
    v_cvt_pk_bf16_f32 v74, v12, v13
    v_cvt_pk_bf16_f32 v75, v14, v15
    v_pk_mul_f32 v[16:17], v[16:17], v[136:137] op_sel_hi:[1,0]
    v_pk_fma_f32 v[16:17], v[40:41], v[132:133], v[16:17] op_sel_hi:[1,0,1]
    v_pk_mul_f32 v[18:19], v[18:19], v[136:137] op_sel_hi:[1,0]
    v_pk_fma_f32 v[18:19], v[42:43], v[132:133], v[18:19] op_sel_hi:[1,0,1]
    v_cvt_pk_bf16_f32 v76, v16, v17
    v_cvt_pk_bf16_f32 v77, v18, v19
    v_pk_mul_f32 v[20:21], v[20:21], v[138:139] op_sel_hi:[1,0]
    v_pk_fma_f32 v[20:21], v[32:33], v[134:135], v[20:21] op_sel_hi:[1,0,1]
    v_pk_mul_f32 v[22:23], v[22:23], v[138:139] op_sel_hi:[1,0]
    v_pk_fma_f32 v[22:23], v[34:35], v[134:135], v[22:23] op_sel_hi:[1,0,1]
    v_cvt_pk_bf16_f32 v80, v20, v21
    v_cvt_pk_bf16_f32 v81, v22, v23
    v_pk_mul_f32 v[24:25], v[24:25], v[138:139] op_sel_hi:[1,0]
    v_pk_fma_f32 v[24:25], v[36:37], v[134:135], v[24:25] op_sel_hi:[1,0,1]
    v_pk_mul_f32 v[26:27], v[26:27], v[138:139] op_sel_hi:[1,0]
    v_pk_fma_f32 v[26:27], v[38:39], v[134:135], v[26:27] op_sel_hi:[1,0,1]
    v_cvt_pk_bf16_f32 v82, v24, v25
    v_cvt_pk_bf16_f32 v83, v26, v27
    v_pk_mul_f32 v[28:29], v[28:29], v[138:139] op_sel_hi:[1,0]
    v_pk_fma_f32 v[28:29], v[40:41], v[134:135], v[28:29] op_sel_hi:[1,0,1]
    v_pk_mul_f32 v[30:31], v[30:31], v[138:139] op_sel_hi:[1,0]
    v_pk_fma_f32 v[30:31], v[42:43], v[134:135], v[30:31] op_sel_hi:[1,0,1]
    v_cvt_pk_bf16_f32 v84, v28, v29
    v_cvt_pk_bf16_f32 v85, v30, v31
    s_add_u32 s67, s6, 128
    v_mov_b32 v65, 0
    buffer_load_ubyte v64, v65, s[12:15], s67 offen sc1
    s_lshl_b32 s60, s7, 5
    v_add_u32 v48, s60, v3
    s_lshl_b32 s60, s8, 12
    s_add_u32 s60, s60, 126976
    v_lshlrev_b32 v49, 5, v48
    v_lshl_add_u32 v49, v2, 3, v49
    v_add_u32 v49, s60, v49
    ds_write_b64 v49, v[76:77] offset:0
    ds_write_b64 v49, v[84:85] offset:512
    v_and_b32 v5, 1, v2
    s_lshl_b32 s60, s8, 13
    s_add_u32 s60, s60, 110592
    v_lshlrev_b32 v50, 6, v48
    v_lshl_add_u32 v50, v5, 4, v50
    v_add_u32 v50, s60, v50
    v_lshlrev_b32 v51, 8, v5
    v_lshl_add_u32 v51, v3, 4, v51
    s_mov_b32 s64, 0x3fb8aa3b
    s_add_u32 s61, s65, 33792
    v_mfma_f32_16x16x32_bf16 v[88:91], v[56:59], v[72:75], 0
    v_mfma_f32_16x16x32_bf16 v[92:95], v[60:63], v[72:75], 0
    v_mfma_f32_16x16x32_bf16 v[8:11], v[56:59], v[80:83], 0
    v_mfma_f32_16x16x32_bf16 v[12:15], v[60:63], v[80:83], 0
    s_nop 4
    v_max3_f32 v32, v88, v89, v90
    s_nop 0
    v_max3_f32 v38, v8, v9, v10
    v_min3_f32 v33, v88, v89, v90
    v_min3_f32 v39, v8, v9, v10
    v_max3_f32 v32, v32, v91, v92
    v_max3_f32 v38, v38, v11, v12
    v_min3_f32 v33, v33, v91, v92
    v_min3_f32 v39, v39, v11, v12
    v_max3_f32 v32, v32, v93, v94
    v_max3_f32 v38, v38, v13, v14
    v_min3_f32 v33, v33, v93, v94
    v_min3_f32 v39, v39, v13, v14
    v_max_f32 v32, v32, v95
    v_max_f32 v38, v38, v15
    v_min_f32 v33, v33, v95
    v_min_f32 v39, v39, v15
    v_mov_b32 v35, v32
    v_mov_b32 v41, v38
    v_mov_b32 v34, v33
    v_mov_b32 v40, v39
    v_permlane16_swap_b32 v32, v35
    v_permlane16_swap_b32 v38, v41
    v_permlane16_swap_b32 v33, v34
    v_permlane16_swap_b32 v39, v40
    v_max_f32 v32, v32, v35
    v_max_f32 v38, v38, v41
    v_min_f32 v33, v33, v34
    v_min_f32 v39, v39, v40
    v_mul_f32 v32, s64, v32
    v_mul_f32 v38, s64, v38
    v_mul_f32 v33, s64, v33
    v_mul_f32 v39, s64, v39
    v_fma_f32 v96, v88, s64, -v32
    v_fma_f32 v16, v8, s64, -v38
    v_fma_f32 v104, -v88, s64, v33
    v_fma_f32 v24, -v8, s64, v39
    v_fma_f32 v97, v89, s64, -v32
    v_fma_f32 v17, v9, s64, -v38
    v_fma_f32 v105, -v89, s64, v33
    v_fma_f32 v25, -v9, s64, v39
    v_fma_f32 v98, v90, s64, -v32
    v_fma_f32 v18, v10, s64, -v38
    v_fma_f32 v106, -v90, s64, v33
    v_fma_f32 v26, -v10, s64, v39
    v_fma_f32 v99, v91, s64, -v32
    v_fma_f32 v19, v11, s64, -v38
    v_fma_f32 v107, -v91, s64, v33
    v_fma_f32 v27, -v11, s64, v39
    v_fma_f32 v100, v92, s64, -v32
    v_fma_f32 v20, v12, s64, -v38
    v_fma_f32 v108, -v92, s64, v33
    v_fma_f32 v28, -v12, s64, v39
    v_fma_f32 v101, v93, s64, -v32
    v_fma_f32 v21, v13, s64, -v38
    v_fma_f32 v109, -v93, s64, v33
    v_fma_f32 v29, -v13, s64, v39
    v_fma_f32 v102, v94, s64, -v32
    v_fma_f32 v22, v14, s64, -v38
    v_fma_f32 v110, -v94, s64, v33
    v_fma_f32 v30, -v14, s64, v39
    v_fma_f32 v103, v95, s64, -v32
    v_fma_f32 v23, v15, s64, -v38
    v_fma_f32 v111, -v95, s64, v33
    v_fma_f32 v31, -v15, s64, v39
    v_exp_f32 v96, v96
    v_exp_f32 v16, v16
    v_exp_f32 v97, v97
    v_exp_f32 v17, v17
    v_exp_f32 v98, v98
    v_exp_f32 v18, v18
    v_exp_f32 v99, v99
    v_exp_f32 v19, v19
    v_exp_f32 v100, v100
    v_exp_f32 v20, v20
    v_exp_f32 v101, v101
    v_exp_f32 v21, v21
    v_exp_f32 v102, v102
    v_exp_f32 v22, v22
    v_exp_f32 v103, v103
    v_exp_f32 v23, v23
    v_exp_f32 v104, v104
    v_exp_f32 v24, v24
    v_exp_f32 v105, v105
    v_exp_f32 v25, v25
    v_exp_f32 v106, v106
    v_exp_f32 v26, v26
    v_exp_f32 v107, v107
    v_exp_f32 v27, v27
    v_exp_f32 v108, v108
    v_exp_f32 v28, v28
    v_exp_f32 v109, v109
    v_exp_f32 v29, v29
    v_exp_f32 v110, v110
    v_exp_f32 v30, v30
    v_exp_f32 v111, v111
    v_exp_f32 v31, v31
    v_pk_add_f32 v[88:89], v[96:97], v[98:99]
    v_pk_add_f32 v[8:9], v[16:17], v[18:19]
    v_pk_add_f32 v[90:91], v[100:101], v[102:103]
    v_pk_add_f32 v[10:11], v[20:21], v[22:23]
    v_pk_add_f32 v[92:93], v[104:105], v[106:107]
    v_pk_add_f32 v[12:13], v[24:25], v[26:27]
    v_pk_add_f32 v[94:95], v[108:109], v[110:111]
    v_pk_add_f32 v[14:15], v[28:29], v[30:31]
    v_pk_add_f32 v[88:89], v[88:89], v[90:91]
    v_pk_add_f32 v[8:9], v[8:9], v[10:11]
    v_pk_add_f32 v[92:93], v[92:93], v[94:95]
    v_pk_add_f32 v[12:13], v[12:13], v[14:15]
    v_add_f32 v34, v88, v89
    v_add_f32 v40, v8, v9
    v_add_f32 v36, v92, v93
    v_add_f32 v42, v12, v13
    v_mov_b32 v35, v34
    v_mov_b32 v41, v40
    v_mov_b32 v32, v36
    v_mov_b32 v38, v42
    v_permlane16_swap_b32 v34, v35
    v_permlane16_swap_b32 v40, v41
    v_permlane16_swap_b32 v36, v32
    v_permlane16_swap_b32 v42, v38
    v_add_f32 v34, v34, v35
    v_add_f32 v40, v40, v41
    v_add_f32 v36, v36, v32
    v_add_f32 v42, v42, v38
    v_rcp_f32 v34, v34
    v_rcp_f32 v40, v40
    v_rcp_f32 v36, v36
    v_rcp_f32 v42, v42
    v_pk_mul_f32 v[96:97], v[96:97], v[34:35] op_sel_hi:[1,0]
    v_pk_mul_f32 v[16:17], v[16:17], v[40:41] op_sel_hi:[1,0]
    v_pk_mul_f32 v[104:105], v[104:105], v[36:37] op_sel_hi:[1,0]
    v_pk_mul_f32 v[24:25], v[24:25], v[42:43] op_sel_hi:[1,0]
    v_pk_mul_f32 v[98:99], v[98:99], v[34:35] op_sel_hi:[1,0]
    v_pk_mul_f32 v[18:19], v[18:19], v[40:41] op_sel_hi:[1,0]
    v_pk_mul_f32 v[106:107], v[106:107], v[36:37] op_sel_hi:[1,0]
    v_pk_mul_f32 v[26:27], v[26:27], v[42:43] op_sel_hi:[1,0]
    v_pk_mul_f32 v[100:101], v[100:101], v[34:35] op_sel_hi:[1,0]
    v_pk_mul_f32 v[20:21], v[20:21], v[40:41] op_sel_hi:[1,0]
    v_pk_mul_f32 v[108:109], v[108:109], v[36:37] op_sel_hi:[1,0]
    v_pk_mul_f32 v[28:29], v[28:29], v[42:43] op_sel_hi:[1,0]
    v_pk_mul_f32 v[102:103], v[102:103], v[34:35] op_sel_hi:[1,0]
    v_pk_mul_f32 v[22:23], v[22:23], v[40:41] op_sel_hi:[1,0]
    v_pk_mul_f32 v[110:111], v[110:111], v[36:37] op_sel_hi:[1,0]
    v_pk_mul_f32 v[30:31], v[30:31], v[42:43] op_sel_hi:[1,0]
    v_cvt_pk_bf16_f32 v112, v96, v97
    v_cvt_pk_bf16_f32 v120, v16, v17
    v_cvt_pk_bf16_f32 v113, v98, v99
    v_cvt_pk_bf16_f32 v121, v18, v19
    v_cvt_pk_bf16_f32 v114, v100, v101
    v_cvt_pk_bf16_f32 v122, v20, v21
    v_cvt_pk_bf16_f32 v115, v102, v103
    v_cvt_pk_bf16_f32 v123, v22, v23
    v_cvt_pk_bf16_f32 v116, v104, v105
    v_cvt_pk_bf16_f32 v124, v24, v25
    v_cvt_pk_bf16_f32 v117, v106, v107
    v_cvt_pk_bf16_f32 v125, v26, v27
    v_cvt_pk_bf16_f32 v118, v108, v109
    v_cvt_pk_bf16_f32 v126, v28, v29
    v_cvt_pk_bf16_f32 v119, v110, v111
    v_cvt_pk_bf16_f32 v127, v30, v31
    s_mov_b32 exec_lo, 0
    s_mov_b32 exec_hi, -1
    ds_write_b128 v50, v[112:115] offset:0
    ds_write_b128 v50, v[116:119] offset:32
    ds_write_b128 v50, v[120:123] offset:1024
    ds_write_b128 v50, v[124:127] offset:1056
    s_not_b64 exec, exec
    buffer_store_dwordx4 v[112:115], v51, s[52:55], s65 offen sc1
    buffer_store_dwordx4 v[116:119], v51, s[52:55], s65 offen offset:512 sc1
    buffer_store_dwordx4 v[120:123], v51, s[52:55], s61 offen sc1
    buffer_store_dwordx4 v[124:127], v51, s[52:55], s61 offen offset:512 sc1
    s_mov_b64 exec, -1
    s_waitcnt lgkmcnt(0)
    s_barrier
    s_cmp_ge_u32 s4, 4
    s_cbranch_scc1 Ladone_125
    v_lshrrev_b32 v4, 2, v1
    v_and_b32 v5, 3, v1
    s_lshr_b32 s60, s4, 1
    s_and_b32 s61, s4, 1
    s_lshl_b32 s62, s60, 12
    s_add_u32 s62, s62, 126976
    v_lshlrev_b32 v49, 5, v4
    v_lshl_add_u32 v49, v5, 3, v49
    v_add_u32 v49, s62, v49
    s_lshl_b32 s62, s60, 13
    s_lshl_b32 s67, s61, 5
    s_add_u32 s62, s62, s67
    s_add_u32 s62, s62, 110592
    v_lshlrev_b32 v50, 6, v4
    v_lshl_add_u32 v50, v5, 3, v50
    v_add_u32 v50, s62, v50
    ds_read_b64_tr_b16 v[72:73], v49 offset:0
    ds_read_b64_tr_b16 v[88:89], v50 offset:0
    ds_read_b64_tr_b16 v[74:75], v49 offset:512
    ds_read_b64_tr_b16 v[90:91], v50 offset:1024
    ds_read_b64_tr_b16 v[76:77], v49 offset:1024
    ds_read_b64_tr_b16 v[92:93], v50 offset:2048
    ds_read_b64_tr_b16 v[78:79], v49 offset:1536
    ds_read_b64_tr_b16 v[94:95], v50 offset:3072
    ds_read_b64_tr_b16 v[80:81], v49 offset:2048
    ds_read_b64_tr_b16 v[96:97], v50 offset:4096
    ds_read_b64_tr_b16 v[82:83], v49 offset:2560
    ds_read_b64_tr_b16 v[98:99], v50 offset:5120
    ds_read_b64_tr_b16 v[84:85], v49 offset:3072
    ds_read_b64_tr_b16 v[100:101], v50 offset:6144
    ds_read_b64_tr_b16 v[86:87], v49 offset:3584
    ds_read_b64_tr_b16 v[102:103], v50 offset:7168
    s_waitcnt lgkmcnt(12)
    v_mfma_f32_16x16x32_bf16 v[108:111], v[72:75], v[88:91], 0
    v_mfma_f32_16x16x32_bf16 v[112:115], v[44:47], v[88:91], 0
    s_waitcnt lgkmcnt(8)
    v_mfma_f32_16x16x32_bf16 v[108:111], v[76:79], v[92:95], v[108:111]
    v_mfma_f32_16x16x32_bf16 v[112:115], v[44:47], v[92:95], v[112:115]
    s_waitcnt lgkmcnt(4)
    v_mfma_f32_16x16x32_bf16 v[108:111], v[80:83], v[96:99], v[108:111]
    v_mfma_f32_16x16x32_bf16 v[112:115], v[44:47], v[96:99], v[112:115]
    s_waitcnt lgkmcnt(0)
    v_mfma_f32_16x16x32_bf16 v[108:111], v[84:87], v[100:103], v[108:111]
    v_mfma_f32_16x16x32_bf16 v[112:115], v[44:47], v[100:103], v[112:115]
    s_lshl_b32 s62, s6, 1
    s_add_u32 s62, s62, s60
    s_mul_i32 s62, s62, 2176
    s_lshl_b32 s61, s61, 6
    s_add_u32 s62, s62, s61
    v_lshlrev_b32 v49, 9, v2
    v_lshl_add_u32 v49, v3, 2, v49
    s_add_u32 s64, s6, 128
    v_mov_b32 v116, 0
    s_mov_b32 s61, 0
    s_waitcnt vmcnt(4)
    v_readfirstlane_b32 s60, v64
    s_nop 3
    s_cmp_lg_u32 s60, 0
    s_cbranch_scc1 Lzp_126_x
Lzp_126:
    buffer_load_ubyte v117, v116, s[12:15], s64 offen sc1
    s_waitcnt vmcnt(0)
    v_readfirstlane_b32 s60, v117
    s_add_u32 s61, s61, 1
    s_cmp_ge_u32 s61, 0x40000
    s_cbranch_scc1 Lzp_126_x
    s_nop 3
    s_cmp_eq_u32 s60, 0
    s_cbranch_scc1 Lzp_126
Lzp_126_x:
    s_nop 7
    s_nop 7
    buffer_atomic_add_f32 v108, v49, s[56:59], s62 offen offset:0
    buffer_atomic_add_f32 v109, v49, s[56:59], s62 offen offset:128
    buffer_atomic_add_f32 v110, v49, s[56:59], s62 offen offset:256
    buffer_atomic_add_f32 v111, v49, s[56:59], s62 offen offset:384
    s_mov_b64 exec, 0xffff
    buffer_atomic_add_f32 v112, v49, s[56:59], s62 offen offset:2048
    s_mov_b64 exec, -1
Ladone_125:
    s_nop 7
    s_nop 7
    v_mov_b32 v4, 163808
    v_mov_b32 v5, 1
    s_add_u32 s72, s38, 0x1580000
    s_addc_u32 s73, s39, 0
    s_mov_b32 s74, 0x3000
    s_mov_b32 s75, 0x00020000
    s_waitcnt vmcnt(0) lgkmcnt(0)
    s_barrier
    s_barrier
    v_mov_b32 v4, 163792
    ds_read_b32 v4, v4
    s_waitcnt lgkmcnt(0)
    v_readfirstlane_b32 s60, v4
    s_nop 3
    s_cmp_eq_u32 s60, 1
    s_cbranch_scc0 mega_kernel_cslow
    s_lshr_b32 s60, s6, 3
    s_lshl_b32 s61, s5, 1
    s_add_u32 s60, s60, s61
    s_and_b32 s61, s6, 7
    v_lshrrev_b32 v6, 3, v1
    v_lshlrev_b32 v6, 10, v6
    v_and_b32 v4, 7, v1
    v_lshl_add_u32 v6, v4, 4, v6
    s_lshl_b32 s64, s60, 3
    s_add_u32 s64, s64, s4
    s_lshl_b32 s64, s64, 13
    s_lshl_b32 s62, s61, 7
    s_add_u32 s64, s64, s62
    v_lshrrev_b32 v7, 3, v1
    v_lshlrev_b32 v7, 4, v7
    v_and_b32 v4, 7, v1
    v_lshl_add_u32 v7, v4, 8, v7
    s_lshl_b32 s65, s60, 2
    s_lshr_b32 s62, s4, 1
    s_add_u32 s65, s65, s62
    s_lshl_b32 s65, s65, 14
    s_lshl_b32 s62, s61, 11
    s_add_u32 s65, s65, s62
    s_and_b32 s62, s4, 1
    s_lshl_b32 s62, s62, 7
    s_add_u32 s65, s65, s62
    s_mov_b32 s52, s16
    s_mov_b32 s53, s17
    s_mov_b32 s54, 0x200000
    s_mov_b32 s55, 0x00020000
    s_add_u32 s56, s38, 0x600000
    s_addc_u32 s57, s39, 0
    s_mov_b32 s58, 0x200000
    s_mov_b32 s59, 0x00020000
    s_lshl_b32 s62, s7, 11
    v_lshrrev_b32 v4, 2, v1
    v_lshlrev_b32 v140, 7, v4
    v_and_b32 v5, 3, v1
    v_lshl_add_u32 v140, v5, 3, v140
    v_add_u32 v140, s62, v140
    v_bfe_u32 v4, v1, 3, 2
    v_lshl_add_u32 v140, v4, 5, v140
    v_xor_b32 v141, 32, v140
    v_xor_b32 v142, 64, v140
    v_xor_b32 v143, 96, v140
    s_lshl_b32 s66, s7, 11
    s_add_u32 s62, s66, 65536
    v_lshlrev_b32 v144, 4, v1
    s_mov_b32 s44, s38
    s_mov_b32 s45, s39
    s_mov_b32 s46, 0x420000
    s_mov_b32 s47, 0x00020000
    s_lshl_b32 s68, s60, 1
    s_add_u32 s68, s68, s8
    s_mul_i32 s68, s68, 67584
    s_lshl_b32 s63, s7, 13
    s_add_u32 s68, s68, s63
    v_lshlrev_b32 v4, 1, v2
    v_and_b32 v5, 7, v3
    v_xor_b32 v5, v5, v4
    v_lshlrev_b32 v5, 4, v5
    v_lshl_add_u32 v5, v3, 7, v5
    v_add_u32 v145, s62, v5
    v_xor_b32 v146, 16, v145
    v_lshlrev_b32 v4, 5, v2
    s_lshl_b32 s62, s7, 10
    s_add_u32 s62, s62, 106496
    v_add_u32 v147, s62, v4
    buffer_load_dwordx4 v[40:43], v6, s[52:55], s64 offen
    s_mov_b32 s67, 0x358637bd
    s_barrier
    s_add_u32 s63, s68, 0
    buffer_load_dwordx4 v[76:79], v144, s[44:47], s63 offen sc1
    s_add_u32 s63, s68, 33792
    buffer_load_dwordx4 v[80:83], v144, s[44:47], s63 offen sc1
    s_add_u32 s63, s68, 1024
    buffer_load_dwordx4 v[84:87], v144, s[44:47], s63 offen sc1
    s_add_u32 s63, s68, 34816
    buffer_load_dwordx4 v[88:91], v144, s[44:47], s63 offen sc1
    s_add_u32 s63, s68, 2048
    buffer_load_dwordx4 v[92:95], v144, s[44:47], s63 offen sc1
    s_add_u32 s63, s68, 35840
    buffer_load_dwordx4 v[96:99], v144, s[44:47], s63 offen sc1
    s_barrier
    ds_read_b128 v[44:47], v145 offset:0
    ds_read_b128 v[48:51], v146 offset:0
    ds_read_b128 v[52:55], v147 offset:0
    ds_read_b128 v[56:59], v147 offset:16
    s_waitcnt lgkmcnt(0)
    s_barrier
    s_waitcnt vmcnt(4)
    v_cvt_pk_bf16_f32 v44, v44, v45
    v_cvt_pk_bf16_f32 v45, v46, v47
    v_cvt_pk_bf16_f32 v46, v48, v49
    ds_read_b128 v[60:63], v145 offset:8192
    v_cvt_pk_bf16_f32 v47, v50, v51
    v_cvt_pk_bf16_f32 v48, v52, v53
    ds_read_b128 v[64:67], v146 offset:8192
    v_cvt_pk_bf16_f32 v49, v54, v55
    v_cvt_pk_bf16_f32 v50, v56, v57
    v_cvt_pk_bf16_f32 v51, v58, v59
    ds_read_b128 v[68:71], v147 offset:128
    v_mfma_f32_16x16x32_bf16 v[100:103], v[44:47], v[76:79], 0
    v_mfma_f32_16x16x32_bf16 v[104:107], v[48:51], v[76:79], 0
    ds_read_b128 v[72:75], v147 offset:144
    v_mfma_f32_16x16x32_bf16 v[108:111], v[44:47], v[80:83], 0
    v_mfma_f32_16x16x32_bf16 v[112:115], v[48:51], v[80:83], 0
    s_add_u32 s63, s68, 3072
    buffer_load_dwordx4 v[76:79], v144, s[44:47], s63 offen sc1
    s_add_u32 s63, s68, 36864
    buffer_load_dwordx4 v[80:83], v144, s[44:47], s63 offen sc1
    s_waitcnt lgkmcnt(0)
    s_barrier
    s_waitcnt vmcnt(4)
    v_add_f32 v104, s67, v104
    v_cvt_pk_bf16_f32 v60, v60, v61
    ds_read_b128 v[44:47], v145 offset:16384
    v_add_f32 v112, s67, v112
    v_cvt_pk_bf16_f32 v61, v62, v63
    ds_read_b128 v[48:51], v146 offset:16384
    v_rcp_f32 v104, v104
    ds_read_b128 v[52:55], v147 offset:256
    v_cvt_pk_bf16_f32 v62, v64, v65
    v_rcp_f32 v112, v112
    ds_read_b128 v[56:59], v147 offset:272
    v_cvt_pk_bf16_f32 v63, v66, v67
    ds_read_b64_tr_b16 v[124:125], v140 offset:0
    v_pk_mul_f32 v[100:101], v[100:101], v[104:105] op_sel_hi:[1,0]
    v_cvt_pk_bf16_f32 v64, v68, v69
    ds_read_b64_tr_b16 v[128:129], v141 offset:0
    v_pk_mul_f32 v[102:103], v[102:103], v[104:105] op_sel_hi:[1,0]
    v_cvt_pk_bf16_f32 v65, v70, v71
    ds_read_b64_tr_b16 v[132:133], v142 offset:0
    v_pk_mul_f32 v[108:109], v[108:109], v[112:113] op_sel_hi:[1,0]
    ds_read_b64_tr_b16 v[136:137], v143 offset:0
    v_cvt_pk_bf16_f32 v66, v72, v73
    v_pk_mul_f32 v[110:111], v[110:111], v[112:113] op_sel_hi:[1,0]
    ds_read_b64_tr_b16 v[126:127], v140 offset:8192
    v_cvt_pk_bf16_f32 v67, v74, v75
    ds_read_b64_tr_b16 v[130:131], v141 offset:8192
    v_cvt_pk_bf16_f32 v116, v100, v101
    v_mfma_f32_16x16x32_bf16 v[148:151], v[60:63], v[84:87], 0
    ds_read_b64_tr_b16 v[134:135], v142 offset:8192
    v_cvt_pk_bf16_f32 v117, v102, v103
    v_mfma_f32_16x16x32_bf16 v[152:155], v[64:67], v[84:87], 0
    ds_read_b64_tr_b16 v[138:139], v143 offset:8192
    v_cvt_pk_bf16_f32 v120, v108, v109
    v_mfma_f32_16x16x32_bf16 v[156:159], v[60:63], v[88:91], 0
    v_cvt_pk_bf16_f32 v121, v110, v111
    v_mfma_f32_16x16x32_bf16 v[160:163], v[64:67], v[88:91], 0
    s_add_u32 s63, s68, 4096
    buffer_load_dwordx4 v[84:87], v144, s[44:47], s63 offen sc1
    s_add_u32 s63, s68, 37888
    buffer_load_dwordx4 v[88:91], v144, s[44:47], s63 offen sc1
    s_waitcnt lgkmcnt(0)
    s_barrier
    s_waitcnt vmcnt(4)
    v_add_f32 v152, s67, v152
    v_cvt_pk_bf16_f32 v44, v44, v45
    v_add_f32 v160, s67, v160
    v_cvt_pk_bf16_f32 v45, v46, v47
    v_rcp_f32 v152, v152
    v_cvt_pk_bf16_f32 v46, v48, v49
    v_rcp_f32 v160, v160
    ds_read_b128 v[60:63], v145 offset:24576
    v_cvt_pk_bf16_f32 v47, v50, v51
    v_pk_mul_f32 v[148:149], v[148:149], v[152:153] op_sel_hi:[1,0]
    v_cvt_pk_bf16_f32 v48, v52, v53
    v_pk_mul_f32 v[150:151], v[150:151], v[152:153] op_sel_hi:[1,0]
    v_cvt_pk_bf16_f32 v49, v54, v55
    v_pk_mul_f32 v[156:157], v[156:157], v[160:161] op_sel_hi:[1,0]
    ds_read_b128 v[64:67], v146 offset:24576
    v_cvt_pk_bf16_f32 v50, v56, v57
    v_pk_mul_f32 v[158:159], v[158:159], v[160:161] op_sel_hi:[1,0]
    v_cvt_pk_bf16_f32 v51, v58, v59
    v_cvt_pk_bf16_f32 v118, v148, v149
    v_mfma_f32_16x16x32_bf16 v[100:103], v[44:47], v[92:95], 0
    v_cvt_pk_bf16_f32 v119, v150, v151
    v_mfma_f32_16x16x32_bf16 v[104:107], v[48:51], v[92:95], 0
    ds_read_b128 v[68:71], v147 offset:384
    v_cvt_pk_bf16_f32 v122, v156, v157
    v_mfma_f32_16x16x32_bf16 v[108:111], v[44:47], v[96:99], 0
    v_cvt_pk_bf16_f32 v123, v158, v159
    v_mfma_f32_16x16x32_bf16 v[112:115], v[48:51], v[96:99], 0
    v_mfma_f32_16x16x32_bf16 v[8:11], v[124:127], v[116:119], 0
    v_mfma_f32_16x16x32_bf16 v[12:15], v[128:131], v[116:119], 0
    ds_read_b128 v[72:75], v147 offset:400
    v_mfma_f32_16x16x32_bf16 v[16:19], v[132:135], v[116:119], 0
    v_mfma_f32_16x16x32_bf16 v[20:23], v[136:139], v[116:119], 0
    v_mfma_f32_16x16x32_bf16 v[24:27], v[124:127], v[120:123], 0
    v_mfma_f32_16x16x32_bf16 v[28:31], v[128:131], v[120:123], 0
    v_mfma_f32_16x16x32_bf16 v[32:35], v[132:135], v[120:123], 0
    v_mfma_f32_16x16x32_bf16 v[36:39], v[136:139], v[120:123], 0
    s_add_u32 s63, s68, 5120
    buffer_load_dwordx4 v[92:95], v144, s[44:47], s63 offen sc1
    s_add_u32 s63, s68, 38912
    buffer_load_dwordx4 v[96:99], v144, s[44:47], s63 offen sc1
    s_waitcnt lgkmcnt(0)
    s_barrier
    s_waitcnt vmcnt(4)
    v_add_f32 v104, s67, v104
    v_cvt_pk_bf16_f32 v60, v60, v61
    ds_read_b128 v[44:47], v145 offset:32768
    v_add_f32 v112, s67, v112
    v_cvt_pk_bf16_f32 v61, v62, v63
    ds_read_b128 v[48:51], v146 offset:32768
    v_rcp_f32 v104, v104
    ds_read_b128 v[52:55], v147 offset:512
    v_cvt_pk_bf16_f32 v62, v64, v65
    v_rcp_f32 v112, v112
    ds_read_b128 v[56:59], v147 offset:528
    v_cvt_pk_bf16_f32 v63, v66, v67
    ds_read_b64_tr_b16 v[124:125], v140 offset:16384
    v_pk_mul_f32 v[100:101], v[100:101], v[104:105] op_sel_hi:[1,0]
    v_cvt_pk_bf16_f32 v64, v68, v69
    ds_read_b64_tr_b16 v[128:129], v141 offset:16384
    v_pk_mul_f32 v[102:103], v[102:103], v[104:105] op_sel_hi:[1,0]
    v_cvt_pk_bf16_f32 v65, v70, v71
    ds_read_b64_tr_b16 v[132:133], v142 offset:16384
    v_pk_mul_f32 v[108:109], v[108:109], v[112:113] op_sel_hi:[1,0]
    ds_read_b64_tr_b16 v[136:137], v143 offset:16384
    v_cvt_pk_bf16_f32 v66, v72, v73
    v_pk_mul_f32 v[110:111], v[110:111], v[112:113] op_sel_hi:[1,0]
    ds_read_b64_tr_b16 v[126:127], v140 offset:24576
    v_cvt_pk_bf16_f32 v67, v74, v75
    ds_read_b64_tr_b16 v[130:131], v141 offset:24576
    v_cvt_pk_bf16_f32 v116, v100, v101
    v_mfma_f32_16x16x32_bf16 v[148:151], v[60:63], v[76:79], 0
    ds_read_b64_tr_b16 v[134:135], v142 offset:24576
    v_cvt_pk_bf16_f32 v117, v102, v103
    v_mfma_f32_16x16x32_bf16 v[152:155], v[64:67], v[76:79], 0
    ds_read_b64_tr_b16 v[138:139], v143 offset:24576
    v_cvt_pk_bf16_f32 v120, v108, v109
    v_mfma_f32_16x16x32_bf16 v[156:159], v[60:63], v[80:83], 0
    v_cvt_pk_bf16_f32 v121, v110, v111
    v_mfma_f32_16x16x32_bf16 v[160:163], v[64:67], v[80:83], 0
    s_add_u32 s63, s68, 6144
    buffer_load_dwordx4 v[76:79], v144, s[44:47], s63 offen sc1
    s_add_u32 s63, s68, 39936
    buffer_load_dwordx4 v[80:83], v144, s[44:47], s63 offen sc1
    s_waitcnt lgkmcnt(0)
    s_barrier
    s_waitcnt vmcnt(4)
    v_add_f32 v152, s67, v152
    v_cvt_pk_bf16_f32 v44, v44, v45
    v_add_f32 v160, s67, v160
    v_cvt_pk_bf16_f32 v45, v46, v47
    v_rcp_f32 v152, v152
    v_cvt_pk_bf16_f32 v46, v48, v49
    v_rcp_f32 v160, v160
    ds_read_b128 v[60:63], v145 offset:0
    v_cvt_pk_bf16_f32 v47, v50, v51
    v_pk_mul_f32 v[148:149], v[148:149], v[152:153] op_sel_hi:[1,0]
    v_cvt_pk_bf16_f32 v48, v52, v53
    v_pk_mul_f32 v[150:151], v[150:151], v[152:153] op_sel_hi:[1,0]
    v_cvt_pk_bf16_f32 v49, v54, v55
    v_pk_mul_f32 v[156:157], v[156:157], v[160:161] op_sel_hi:[1,0]
    ds_read_b128 v[64:67], v146 offset:0
    v_cvt_pk_bf16_f32 v50, v56, v57
    v_pk_mul_f32 v[158:159], v[158:159], v[160:161] op_sel_hi:[1,0]
    v_cvt_pk_bf16_f32 v51, v58, v59
    v_cvt_pk_bf16_f32 v118, v148, v149
    v_mfma_f32_16x16x32_bf16 v[100:103], v[44:47], v[84:87], 0
    v_cvt_pk_bf16_f32 v119, v150, v151
    v_mfma_f32_16x16x32_bf16 v[104:107], v[48:51], v[84:87], 0
    ds_read_b128 v[68:71], v147 offset:640
    v_cvt_pk_bf16_f32 v122, v156, v157
    v_mfma_f32_16x16x32_bf16 v[108:111], v[44:47], v[88:91], 0
    v_cvt_pk_bf16_f32 v123, v158, v159
    v_mfma_f32_16x16x32_bf16 v[112:115], v[48:51], v[88:91], 0
    v_mfma_f32_16x16x32_bf16 v[8:11], v[124:127], v[116:119], v[8:11]
    v_mfma_f32_16x16x32_bf16 v[12:15], v[128:131], v[116:119], v[12:15]
    ds_read_b128 v[72:75], v147 offset:656
    v_mfma_f32_16x16x32_bf16 v[16:19], v[132:135], v[116:119], v[16:19]
    v_mfma_f32_16x16x32_bf16 v[20:23], v[136:139], v[116:119], v[20:23]
    v_mfma_f32_16x16x32_bf16 v[24:27], v[124:127], v[120:123], v[24:27]
    v_mfma_f32_16x16x32_bf16 v[28:31], v[128:131], v[120:123], v[28:31]
    v_mfma_f32_16x16x32_bf16 v[32:35], v[132:135], v[120:123], v[32:35]
    v_mfma_f32_16x16x32_bf16 v[36:39], v[136:139], v[120:123], v[36:39]
    s_add_u32 s63, s68, 7168
    buffer_load_dwordx4 v[84:87], v144, s[44:47], s63 offen sc1
    s_add_u32 s63, s68, 40960
    buffer_load_dwordx4 v[88:91], v144, s[44:47], s63 offen sc1
    s_waitcnt lgkmcnt(0)
    s_barrier
    s_waitcnt vmcnt(4)
    v_add_f32 v104, s67, v104
    v_cvt_pk_bf16_f32 v60, v60, v61
    ds_read_b128 v[44:47], v145 offset:8192
    v_add_f32 v112, s67, v112
    v_cvt_pk_bf16_f32 v61, v62, v63
    ds_read_b128 v[48:51], v146 offset:8192
    v_rcp_f32 v104, v104
    ds_read_b128 v[52:55], v147 offset:768
    v_cvt_pk_bf16_f32 v62, v64, v65
    v_rcp_f32 v112, v112
    ds_read_b128 v[56:59], v147 offset:784
    v_cvt_pk_bf16_f32 v63, v66, v67
    ds_read_b64_tr_b16 v[124:125], v140 offset:32768
    v_pk_mul_f32 v[100:101], v[100:101], v[104:105] op_sel_hi:[1,0]
    v_cvt_pk_bf16_f32 v64, v68, v69
    ds_read_b64_tr_b16 v[128:129], v141 offset:32768
    v_pk_mul_f32 v[102:103], v[102:103], v[104:105] op_sel_hi:[1,0]
    v_cvt_pk_bf16_f32 v65, v70, v71
    ds_read_b64_tr_b16 v[132:133], v142 offset:32768
    v_pk_mul_f32 v[108:109], v[108:109], v[112:113] op_sel_hi:[1,0]
    ds_read_b64_tr_b16 v[136:137], v143 offset:32768
    v_cvt_pk_bf16_f32 v66, v72, v73
    v_pk_mul_f32 v[110:111], v[110:111], v[112:113] op_sel_hi:[1,0]
    ds_read_b64_tr_b16 v[126:127], v140 offset:40960
    v_cvt_pk_bf16_f32 v67, v74, v75
    ds_read_b64_tr_b16 v[130:131], v141 offset:40960
    v_cvt_pk_bf16_f32 v116, v100, v101
    v_mfma_f32_16x16x32_bf16 v[148:151], v[60:63], v[92:95], 0
    ds_read_b64_tr_b16 v[134:135], v142 offset:40960
    v_cvt_pk_bf16_f32 v117, v102, v103
    v_mfma_f32_16x16x32_bf16 v[152:155], v[64:67], v[92:95], 0
    ds_read_b64_tr_b16 v[138:139], v143 offset:40960
    v_cvt_pk_bf16_f32 v120, v108, v109
    v_mfma_f32_16x16x32_bf16 v[156:159], v[60:63], v[96:99], 0
    v_cvt_pk_bf16_f32 v121, v110, v111
    v_mfma_f32_16x16x32_bf16 v[160:163], v[64:67], v[96:99], 0
    s_waitcnt lgkmcnt(0)
    s_barrier
    s_waitcnt vmcnt(2)
    v_add_f32 v152, s67, v152
    v_cvt_pk_bf16_f32 v44, v44, v45
    s_nop 2
    v_add_f32 v160, s67, v160
    v_cvt_pk_bf16_f32 v45, v46, v47
    v_rcp_f32 v152, v152
    v_cvt_pk_bf16_f32 v46, v48, v49
    v_rcp_f32 v160, v160
    ds_read_b128 v[60:63], v145 offset:16384
    v_cvt_pk_bf16_f32 v47, v50, v51
    v_pk_mul_f32 v[148:149], v[148:149], v[152:153] op_sel_hi:[1,0]
    v_cvt_pk_bf16_f32 v48, v52, v53
    v_pk_mul_f32 v[150:151], v[150:151], v[152:153] op_sel_hi:[1,0]
    v_cvt_pk_bf16_f32 v49, v54, v55
    v_pk_mul_f32 v[156:157], v[156:157], v[160:161] op_sel_hi:[1,0]
    ds_read_b128 v[64:67], v146 offset:16384
    v_cvt_pk_bf16_f32 v50, v56, v57
    v_pk_mul_f32 v[158:159], v[158:159], v[160:161] op_sel_hi:[1,0]
    v_cvt_pk_bf16_f32 v51, v58, v59
    v_cvt_pk_bf16_f32 v118, v148, v149
    v_mfma_f32_16x16x32_bf16 v[100:103], v[44:47], v[76:79], 0
    v_cvt_pk_bf16_f32 v119, v150, v151
    v_mfma_f32_16x16x32_bf16 v[104:107], v[48:51], v[76:79], 0
    ds_read_b128 v[68:71], v147 offset:896
    v_cvt_pk_bf16_f32 v122, v156, v157
    v_mfma_f32_16x16x32_bf16 v[108:111], v[44:47], v[80:83], 0
    v_cvt_pk_bf16_f32 v123, v158, v159
    v_mfma_f32_16x16x32_bf16 v[112:115], v[48:51], v[80:83], 0
    v_mfma_f32_16x16x32_bf16 v[8:11], v[124:127], v[116:119], v[8:11]
    v_mfma_f32_16x16x32_bf16 v[12:15], v[128:131], v[116:119], v[12:15]
    ds_read_b128 v[72:75], v147 offset:912
    v_mfma_f32_16x16x32_bf16 v[16:19], v[132:135], v[116:119], v[16:19]
    v_mfma_f32_16x16x32_bf16 v[20:23], v[136:139], v[116:119], v[20:23]
    v_mfma_f32_16x16x32_bf16 v[24:27], v[124:127], v[120:123], v[24:27]
    v_mfma_f32_16x16x32_bf16 v[28:31], v[128:131], v[120:123], v[28:31]
    v_mfma_f32_16x16x32_bf16 v[32:35], v[132:135], v[120:123], v[32:35]
    v_mfma_f32_16x16x32_bf16 v[36:39], v[136:139], v[120:123], v[36:39]
    s_waitcnt lgkmcnt(0)
    s_waitcnt vmcnt(0)
    v_add_f32 v104, s67, v104
    v_cvt_pk_bf16_f32 v60, v60, v61
    v_add_f32 v112, s67, v112
    ds_read_b64_tr_b16 v[124:125], v140 offset:49152
    v_cvt_pk_bf16_f32 v61, v62, v63
    v_rcp_f32 v104, v104
    ds_read_b64_tr_b16 v[128:129], v141 offset:49152
    v_cvt_pk_bf16_f32 v62, v64, v65
    v_rcp_f32 v112, v112
    v_cvt_pk_bf16_f32 v63, v66, v67
    ds_read_b64_tr_b16 v[132:133], v142 offset:49152
    v_pk_mul_f32 v[100:101], v[100:101], v[104:105] op_sel_hi:[1,0]
    v_cvt_pk_bf16_f32 v64, v68, v69
    ds_read_b64_tr_b16 v[136:137], v143 offset:49152
    v_pk_mul_f32 v[102:103], v[102:103], v[104:105] op_sel_hi:[1,0]
    v_cvt_pk_bf16_f32 v65, v70, v71
    ds_read_b64_tr_b16 v[126:127], v140 offset:57344
    v_pk_mul_f32 v[108:109], v[108:109], v[112:113] op_sel_hi:[1,0]
    v_cvt_pk_bf16_f32 v66, v72, v73
    v_pk_mul_f32 v[110:111], v[110:111], v[112:113] op_sel_hi:[1,0]
    ds_read_b64_tr_b16 v[130:131], v141 offset:57344
    v_cvt_pk_bf16_f32 v67, v74, v75
    v_cvt_pk_bf16_f32 v116, v100, v101
    ds_read_b64_tr_b16 v[134:135], v142 offset:57344
    v_mfma_f32_16x16x32_bf16 v[148:151], v[60:63], v[84:87], 0
    v_cvt_pk_bf16_f32 v117, v102, v103
    v_mfma_f32_16x16x32_bf16 v[152:155], v[64:67], v[84:87], 0
    ds_read_b64_tr_b16 v[138:139], v143 offset:57344
    v_cvt_pk_bf16_f32 v120, v108, v109
    v_mfma_f32_16x16x32_bf16 v[156:159], v[60:63], v[88:91], 0
    v_cvt_pk_bf16_f32 v121, v110, v111
    v_mfma_f32_16x16x32_bf16 v[160:163], v[64:67], v[88:91], 0
    s_waitcnt lgkmcnt(0)
    s_nop 1
    v_add_f32 v152, s67, v152
    s_nop 3
    v_add_f32 v160, s67, v160
    v_rcp_f32 v152, v152
    v_rcp_f32 v160, v160
    v_pk_mul_f32 v[148:149], v[148:149], v[152:153] op_sel_hi:[1,0]
    v_pk_mul_f32 v[150:151], v[150:151], v[152:153] op_sel_hi:[1,0]
    v_pk_mul_f32 v[156:157], v[156:157], v[160:161] op_sel_hi:[1,0]
    v_pk_mul_f32 v[158:159], v[158:159], v[160:161] op_sel_hi:[1,0]
    v_cvt_pk_bf16_f32 v118, v148, v149
    v_cvt_pk_bf16_f32 v119, v150, v151
    v_cvt_pk_bf16_f32 v122, v156, v157
    v_cvt_pk_bf16_f32 v123, v158, v159
    v_mfma_f32_16x16x32_bf16 v[8:11], v[124:127], v[116:119], v[8:11]
    v_mfma_f32_16x16x32_bf16 v[12:15], v[128:131], v[116:119], v[12:15]
    v_mfma_f32_16x16x32_bf16 v[16:19], v[132:135], v[116:119], v[16:19]
    v_mfma_f32_16x16x32_bf16 v[20:23], v[136:139], v[116:119], v[20:23]
    v_mfma_f32_16x16x32_bf16 v[24:27], v[124:127], v[120:123], v[24:27]
    v_mfma_f32_16x16x32_bf16 v[28:31], v[128:131], v[120:123], v[28:31]
    v_mfma_f32_16x16x32_bf16 v[32:35], v[132:135], v[120:123], v[32:35]
    v_mfma_f32_16x16x32_bf16 v[36:39], v[136:139], v[120:123], v[36:39]
    s_waitcnt lgkmcnt(0)
    s_barrier
    s_lshl_b32 s62, s7, 1
    s_add_u32 s62, s62, s8
    s_mul_i32 s62, s62, 8704
    s_add_u32 s62, s62, 65536
    v_mul_u32_u24 v124, 272, v3
    v_lshl_add_u32 v124, v2, 4, v124
    v_add_u32 v124, s62, v124
    ds_write_b128 v124, v[8:11] offset:0
    ds_write_b128 v124, v[12:15] offset:64
    ds_write_b128 v124, v[16:19] offset:128
    ds_write_b128 v124, v[20:23] offset:192
    ds_write_b128 v124, v[24:27] offset:4352
    ds_write_b128 v124, v[28:31] offset:4416
    ds_write_b128 v124, v[32:35] offset:4480
    ds_write_b128 v124, v[36:39] offset:4544
    s_mul_i32 s62, s8, 8704
    s_add_u32 s62, s62, 65536
    v_lshrrev_b32 v125, 3, v1
    s_lshl_b32 s63, s7, 3
    v_add_u32 v125, s63, v125
    v_mul_u32_u24 v125, 272, v125
    v_and_b32 v124, 7, v1
    v_lshl_add_u32 v125, v124, 5, v125
    v_add_u32 v125, s62, v125
    s_waitcnt lgkmcnt(0)
    s_barrier
    ds_read_b128 v[44:47], v125 offset:0
    ds_read_b128 v[48:51], v125 offset:16
    ds_read_b128 v[52:55], v125 offset:17408
    ds_read_b128 v[56:59], v125 offset:17424
    ds_read_b128 v[60:63], v125 offset:34816
    ds_read_b128 v[64:67], v125 offset:34832
    ds_read_b128 v[68:71], v125 offset:52224
    ds_read_b128 v[72:75], v125 offset:52240
    s_waitcnt lgkmcnt(4)
    v_pk_add_f32 v[44:45], v[44:45], v[52:53]
    v_pk_add_f32 v[46:47], v[46:47], v[54:55]
    v_pk_add_f32 v[48:49], v[48:49], v[56:57]
    v_pk_add_f32 v[50:51], v[50:51], v[58:59]
    s_waitcnt lgkmcnt(0)
    v_pk_add_f32 v[60:61], v[60:61], v[68:69]
    v_pk_add_f32 v[62:63], v[62:63], v[70:71]
    v_pk_add_f32 v[64:65], v[64:65], v[72:73]
    v_pk_add_f32 v[66:67], v[66:67], v[74:75]
    v_pk_add_f32 v[44:45], v[44:45], v[60:61]
    v_pk_add_f32 v[46:47], v[46:47], v[62:63]
    v_pk_add_f32 v[48:49], v[48:49], v[64:65]
    v_pk_add_f32 v[50:51], v[50:51], v[66:67]
    s_waitcnt vmcnt(0)
    v_cvt_pk_bf16_f32 v60, v44, v45
    v_cvt_pk_bf16_f32 v61, v46, v47
    v_cvt_pk_bf16_f32 v62, v48, v49
    v_cvt_pk_bf16_f32 v63, v50, v51
    v_lshlrev_b32 v44, 16, v60
    v_and_b32 v45, 0xffff0000, v60
    v_lshlrev_b32 v52, 16, v40
    v_and_b32 v53, 0xffff0000, v40
    v_lshlrev_b32 v46, 16, v61
    v_and_b32 v47, 0xffff0000, v61
    v_lshlrev_b32 v54, 16, v41
    v_and_b32 v55, 0xffff0000, v41
    v_lshlrev_b32 v48, 16, v62
    v_and_b32 v49, 0xffff0000, v62
    v_lshlrev_b32 v56, 16, v42
    v_and_b32 v57, 0xffff0000, v42
    v_lshlrev_b32 v50, 16, v63
    v_and_b32 v51, 0xffff0000, v63
    v_lshlrev_b32 v58, 16, v43
    v_and_b32 v59, 0xffff0000, v43
    v_pk_add_f32 v[44:45], v[44:45], v[52:53]
    v_pk_add_f32 v[46:47], v[46:47], v[54:55]
    v_pk_add_f32 v[48:49], v[48:49], v[56:57]
    v_pk_add_f32 v[50:51], v[50:51], v[58:59]
    v_cvt_pk_bf16_f32 v60, v44, v45
    v_cvt_pk_bf16_f32 v61, v46, v47
    v_cvt_pk_bf16_f32 v62, v48, v49
    v_cvt_pk_bf16_f32 v63, v50, v51
    buffer_store_dwordx4 v[60:63], v7, s[56:59], s65 offen
    s_mov_b32 s62, 0x3f803f80
    v_mov_b32 v68, 0
    v_mov_b32 v69, 0
    v_dot2c_f32_bf16 v68, s62, v60
    v_dot2c_f32_bf16 v69, v60, v60
    v_dot2c_f32_bf16 v68, s62, v61
    v_dot2c_f32_bf16 v69, v61, v61
    v_dot2c_f32_bf16 v68, s62, v62
    v_dot2c_f32_bf16 v69, v62, v62
    v_dot2c_f32_bf16 v68, s62, v63
    v_dot2c_f32_bf16 v69, v63, v63
    s_nop 1
    v_add_f32_dpp v68, v68, v68 quad_perm:[1,0,3,2] row_mask:0xf bank_mask:0xf
    v_add_f32_dpp v69, v69, v69 quad_perm:[1,0,3,2] row_mask:0xf bank_mask:0xf
    s_nop 0
    v_add_f32_dpp v68, v68, v68 quad_perm:[2,3,0,1] row_mask:0xf bank_mask:0xf
    v_add_f32_dpp v69, v69, v69 quad_perm:[2,3,0,1] row_mask:0xf bank_mask:0xf
    s_nop 0
    v_add_f32_dpp v68, v68, v68 row_half_mirror row_mask:0xf bank_mask:0xf
    v_add_f32_dpp v69, v69, v69 row_half_mirror row_mask:0xf bank_mask:0xf
    s_add_u32 s40, s38, 0x14a0000
    s_addc_u32 s41, s39, 0
    s_mov_b32 s42, 0x20000
    s_mov_b32 s43, 0x00020000
    v_lshrrev_b32 v124, 3, v1
    v_lshlrev_b32 v124, 6, v124
    s_lshl_b32 s62, s60, 3
    s_add_u32 s62, s62, s4
    s_lshl_b32 s62, s62, 6
    s_add_u32 s62, s62, s61
    s_lshl_b32 s62, s62, 3
    s_mov_b32 exec_lo, 0x01010101
    s_mov_b32 exec_hi, 0x01010101
    buffer_store_dwordx2 v[68:69], v124, s[40:43], s62 offen
    s_mov_b64 exec, -1
    v_mov_b32 v4, 163808
    v_mov_b32 v5, 1
    s_add_u32 s72, s38, 0x1580000
    s_addc_u32 s73, s39, 0
    s_mov_b32 s74, 0x3000
    s_mov_b32 s75, 0x00020000
    s_waitcnt vmcnt(0) lgkmcnt(0)
    s_mov_b64 exec, 1
    ds_add_rtn_u32 v5, v4, v5
    s_waitcnt lgkmcnt(0)
    s_mov_b64 exec, -1
    v_readfirstlane_b32 s70, v5
    s_nop 3
    s_and_b32 s70, s70, 7
    s_cmp_lg_u32 s70, 7
    s_cbranch_scc1 Lsg_128
    s_lshl_b32 s70, s5, 6
    s_add_u32 s70, s70, s6
    s_lshl_b32 s70, s70, 2
    v_mov_b32 v4, 3
    v_mov_b32 v5, 0
    s_mov_b64 exec, 1
    buffer_store_dword v4, v5, s[72:75], s70 offen
    s_mov_b64 exec, -1
    s_nop 1
Lsg_128:
    s_nop 7
    s_nop 7
    s_barrier
    s_lshl_b32 s63, s5, 2
    s_add_u32 s63, s63, s7
    s_mul_i32 s64, s63, 116736
    s_lshl_b32 s63, s63, 11
    s_add_u32 s48, s38, 0x14a0000
    s_addc_u32 s49, s39, 0
    s_mov_b32 s50, 0x20000
    s_mov_b32 s51, 0x00020000
    s_mov_b32 s52, s28
    s_mov_b32 s53, s29
    s_mov_b32 s54, 0xe00
    s_mov_b32 s55, 0x00020000
    s_add_u32 s56, s38, 0xc00000
    s_addc_u32 s57, s39, 0
    s_mov_b32 s58, 0x720000
    s_mov_b32 s59, 0x00020000
    s_mul_i32 s62, s6, 112
    s_lshl_b32 s60, s8, 6
    s_add_u32 s62, s62, s60
    s_lshl_b32 s60, s62, 1
    v_lshlrev_b32 v5, 3, v2
    buffer_load_dwordx2 v[56:57], v5, s[52:55], s60 offen offset:0
    buffer_load_dwordx2 v[58:59], v5, s[52:55], s60 offen offset:32
    buffer_load_dwordx2 v[60:61], v5, s[52:55], s60 offen offset:64
    buffer_load_dwordx2 v[62:63], v5, s[52:55], s60 offen offset:96
    s_lshr_b32 s60, s6, 1
    s_mul_i32 s60, s60, 7168
    s_add_u32 s64, s64, s60
    s_and_b32 s60, s6, 1
    s_lshl_b32 s65, s60, 3
    s_add_u32 s65, s65, s64
    s_add_u32 s65, s65, 6144
    s_mul_i32 s60, s60, 3072
    s_add_u32 s64, s64, s60
    s_lshl_b32 s60, s8, 11
    s_add_u32 s64, s64, s60
    v_lshlrev_b32 v144, 4, v1
    v_mov_b32 v146, 0xbdd2d3e8
    v_mov_b32 v148, 0xc0135761
    v_mov_b32 v150, 1.0
    s_cmp_lg_u32 s8, 0
    s_cbranch_scc1 Lnh1_129
    s_lshl_b32 s79, s7, 12
    v_lshlrev_b32 v152, 4, v1
    v_add_u32 v154, s79, v152
    v_add_u32 v155, 0x10000, v154
    v_add_u32 v156, 0x20000, v154
    v_lshlrev_b32 v152, 4, v1
    v_add_u32 v157, 0, v152
    v_add_u32 v158, 0x10000, v157
    s_lshl_b32 s79, s4, 8
    s_add_u32 s79, s79, 0
    v_lshlrev_b32 v159, 4, v2
    v_add_u32 v159, s79, v159
    s_barrier
    ds_read_b128 v[64:67], v155 offset:20480
    ds_read_b128 v[68:71], v155 offset:22528
    ds_read_b128 v[72:75], v157 offset:0
    ds_read_b128 v[76:79], v157 offset:1024
    ds_read_b128 v[80:83], v157 offset:2048
    ds_read_b128 v[84:87], v157 offset:3072
    ds_read_b128 v[88:91], v155 offset:21504
    ds_read_b128 v[92:95], v155 offset:23552
    ds_read_b128 v[96:99], v157 offset:7168
    ds_read_b128 v[100:103], v157 offset:8192
    ds_read_b128 v[104:107], v157 offset:9216
    ds_read_b128 v[108:111], v157 offset:10240
    s_waitcnt lgkmcnt(6)
    s_waitcnt lgkmcnt(0)
    s_barrier
    v_mfma_f32_16x16x32_bf16 v[8:11], v[72:75], v[64:67], 0
    v_mfma_f32_16x16x32_bf16 v[24:27], v[72:75], v[68:71], 0
    ds_read_b128 v[112:115], v155 offset:36864
    v_mfma_f32_16x16x32_bf16 v[12:15], v[76:79], v[64:67], 0
    ds_read_b128 v[116:119], v155 offset:38912
    v_mfma_f32_16x16x32_bf16 v[28:31], v[76:79], v[68:71], 0
    ds_read_b128 v[120:123], v157 offset:14336
    v_mfma_f32_16x16x32_bf16 v[16:19], v[80:83], v[64:67], 0
    ds_read_b128 v[124:127], v157 offset:15360
    v_mfma_f32_16x16x32_bf16 v[32:35], v[80:83], v[68:71], 0
    ds_read_b128 v[128:131], v157 offset:16384
    v_mfma_f32_16x16x32_bf16 v[20:23], v[84:87], v[64:67], 0
    ds_read_b128 v[132:135], v157 offset:17408
    v_mfma_f32_16x16x32_bf16 v[36:39], v[84:87], v[68:71], 0
    v_mfma_f32_16x16x32_bf16 v[8:11], v[96:99], v[88:91], v[8:11]
    v_mfma_f32_16x16x32_bf16 v[24:27], v[96:99], v[92:95], v[24:27]
    ds_read_b128 v[64:67], v155 offset:37888
    v_mfma_f32_16x16x32_bf16 v[12:15], v[100:103], v[88:91], v[12:15]
    ds_read_b128 v[68:71], v155 offset:39936
    v_mfma_f32_16x16x32_bf16 v[28:31], v[100:103], v[92:95], v[28:31]
    ds_read_b128 v[72:75], v157 offset:21504
    v_mfma_f32_16x16x32_bf16 v[16:19], v[104:107], v[88:91], v[16:19]
    ds_read_b128 v[76:79], v157 offset:22528
    v_mfma_f32_16x16x32_bf16 v[32:35], v[104:107], v[92:95], v[32:35]
    ds_read_b128 v[80:83], v157 offset:23552
    v_mfma_f32_16x16x32_bf16 v[20:23], v[108:111], v[88:91], v[20:23]
    ds_read_b128 v[84:87], v157 offset:24576
    v_mfma_f32_16x16x32_bf16 v[36:39], v[108:111], v[92:95], v[36:39]
    s_waitcnt lgkmcnt(6)
    s_waitcnt lgkmcnt(0)
    s_barrier
    v_mfma_f32_16x16x32_bf16 v[8:11], v[120:123], v[112:115], v[8:11]
    v_mfma_f32_16x16x32_bf16 v[24:27], v[120:123], v[116:119], v[24:27]
    ds_read_b128 v[88:91], v155 offset:53248
    v_mfma_f32_16x16x32_bf16 v[12:15], v[124:127], v[112:115], v[12:15]
    ds_read_b128 v[92:95], v155 offset:55296
    v_mfma_f32_16x16x32_bf16 v[28:31], v[124:127], v[116:119], v[28:31]
    ds_read_b128 v[96:99], v157 offset:28672
    v_mfma_f32_16x16x32_bf16 v[16:19], v[128:131], v[112:115], v[16:19]
    ds_read_b128 v[100:103], v157 offset:29696
    v_mfma_f32_16x16x32_bf16 v[32:35], v[128:131], v[116:119], v[32:35]
    ds_read_b128 v[104:107], v157 offset:30720
    v_mfma_f32_16x16x32_bf16 v[20:23], v[132:135], v[112:115], v[20:23]
    ds_read_b128 v[108:111], v157 offset:31744
    v_mfma_f32_16x16x32_bf16 v[36:39], v[132:135], v[116:119], v[36:39]
    v_mfma_f32_16x16x32_bf16 v[8:11], v[72:75], v[64:67], v[8:11]
    v_mfma_f32_16x16x32_bf16 v[24:27], v[72:75], v[68:71], v[24:27]
    ds_read_b128 v[112:115], v155 offset:54272
    v_mfma_f32_16x16x32_bf16 v[12:15], v[76:79], v[64:67], v[12:15]
    ds_read_b128 v[116:119], v155 offset:56320
    v_mfma_f32_16x16x32_bf16 v[28:31], v[76:79], v[68:71], v[28:31]
    ds_read_b128 v[120:123], v157 offset:35840
    v_mfma_f32_16x16x32_bf16 v[16:19], v[80:83], v[64:67], v[16:19]
    ds_read_b128 v[124:127], v157 offset:36864
    v_mfma_f32_16x16x32_bf16 v[32:35], v[80:83], v[68:71], v[32:35]
    ds_read_b128 v[128:131], v157 offset:37888
    v_mfma_f32_16x16x32_bf16 v[20:23], v[84:87], v[64:67], v[20:23]
    ds_read_b128 v[132:135], v157 offset:38912
    v_mfma_f32_16x16x32_bf16 v[36:39], v[84:87], v[68:71], v[36:39]
    s_waitcnt lgkmcnt(6)
    s_waitcnt lgkmcnt(0)
    s_barrier
    v_mfma_f32_16x16x32_bf16 v[8:11], v[96:99], v[88:91], v[8:11]
    v_mfma_f32_16x16x32_bf16 v[24:27], v[96:99], v[92:95], v[24:27]
    ds_read_b128 v[64:67], v156 offset:4096
    v_mfma_f32_16x16x32_bf16 v[12:15], v[100:103], v[88:91], v[12:15]
    ds_read_b128 v[68:71], v156 offset:6144
    v_mfma_f32_16x16x32_bf16 v[28:31], v[100:103], v[92:95], v[28:31]
    ds_read_b128 v[72:75], v157 offset:43008
    v_mfma_f32_16x16x32_bf16 v[16:19], v[104:107], v[88:91], v[16:19]
    ds_read_b128 v[76:79], v157 offset:44032
    v_mfma_f32_16x16x32_bf16 v[32:35], v[104:107], v[92:95], v[32:35]
    ds_read_b128 v[80:83], v157 offset:45056
    v_mfma_f32_16x16x32_bf16 v[20:23], v[108:111], v[88:91], v[20:23]
    ds_read_b128 v[84:87], v157 offset:46080
    v_mfma_f32_16x16x32_bf16 v[36:39], v[108:111], v[92:95], v[36:39]
    v_mfma_f32_16x16x32_bf16 v[8:11], v[120:123], v[112:115], v[8:11]
    v_mfma_f32_16x16x32_bf16 v[24:27], v[120:123], v[116:119], v[24:27]
    ds_read_b128 v[88:91], v156 offset:5120
    v_mfma_f32_16x16x32_bf16 v[12:15], v[124:127], v[112:115], v[12:15]
    ds_read_b128 v[92:95], v156 offset:7168
    v_mfma_f32_16x16x32_bf16 v[28:31], v[124:127], v[116:119], v[28:31]
    ds_read_b128 v[96:99], v157 offset:50176
    v_mfma_f32_16x16x32_bf16 v[16:19], v[128:131], v[112:115], v[16:19]
    ds_read_b128 v[100:103], v157 offset:51200
    v_mfma_f32_16x16x32_bf16 v[32:35], v[128:131], v[116:119], v[32:35]
    ds_read_b128 v[104:107], v157 offset:52224
    v_mfma_f32_16x16x32_bf16 v[20:23], v[132:135], v[112:115], v[20:23]
    ds_read_b128 v[108:111], v157 offset:53248
    v_mfma_f32_16x16x32_bf16 v[36:39], v[132:135], v[116:119], v[36:39]
    s_waitcnt lgkmcnt(6)
    s_waitcnt lgkmcnt(0)
    s_barrier
    v_mfma_f32_16x16x32_bf16 v[8:11], v[72:75], v[64:67], v[8:11]
    v_mfma_f32_16x16x32_bf16 v[24:27], v[72:75], v[68:71], v[24:27]
    ds_read_b128 v[112:115], v155 offset:20480
    v_mfma_f32_16x16x32_bf16 v[12:15], v[76:79], v[64:67], v[12:15]
    ds_read_b128 v[116:119], v155 offset:22528
    v_mfma_f32_16x16x32_bf16 v[28:31], v[76:79], v[68:71], v[28:31]
    ds_read_b128 v[120:123], v157 offset:57344
    v_mfma_f32_16x16x32_bf16 v[16:19], v[80:83], v[64:67], v[16:19]
    ds_read_b128 v[124:127], v157 offset:58368
    v_mfma_f32_16x16x32_bf16 v[32:35], v[80:83], v[68:71], v[32:35]
    ds_read_b128 v[128:131], v157 offset:59392
    v_mfma_f32_16x16x32_bf16 v[20:23], v[84:87], v[64:67], v[20:23]
    ds_read_b128 v[132:135], v157 offset:60416
    v_mfma_f32_16x16x32_bf16 v[36:39], v[84:87], v[68:71], v[36:39]
    v_mfma_f32_16x16x32_bf16 v[8:11], v[96:99], v[88:91], v[8:11]
    v_mfma_f32_16x16x32_bf16 v[24:27], v[96:99], v[92:95], v[24:27]
    ds_read_b128 v[64:67], v155 offset:21504
    v_mfma_f32_16x16x32_bf16 v[12:15], v[100:103], v[88:91], v[12:15]
    ds_read_b128 v[68:71], v155 offset:23552
    v_mfma_f32_16x16x32_bf16 v[28:31], v[100:103], v[92:95], v[28:31]
    ds_read_b128 v[72:75], v157 offset:64512
    v_mfma_f32_16x16x32_bf16 v[16:19], v[104:107], v[88:91], v[16:19]
    ds_read_b128 v[76:79], v158 offset:0
    v_mfma_f32_16x16x32_bf16 v[32:35], v[104:107], v[92:95], v[32:35]
    ds_read_b128 v[80:83], v158 offset:1024
    v_mfma_f32_16x16x32_bf16 v[20:23], v[108:111], v[88:91], v[20:23]
    ds_read_b128 v[84:87], v158 offset:2048
    v_mfma_f32_16x16x32_bf16 v[36:39], v[108:111], v[92:95], v[36:39]
    s_waitcnt lgkmcnt(6)
    s_waitcnt lgkmcnt(0)
    s_barrier
    v_mfma_f32_16x16x32_bf16 v[8:11], v[120:123], v[112:115], v[8:11]
    v_mfma_f32_16x16x32_bf16 v[24:27], v[120:123], v[116:119], v[24:27]
    ds_read_b128 v[88:91], v155 offset:36864
    v_mfma_f32_16x16x32_bf16 v[12:15], v[124:127], v[112:115], v[12:15]
    ds_read_b128 v[92:95], v155 offset:38912
    v_mfma_f32_16x16x32_bf16 v[28:31], v[124:127], v[116:119], v[28:31]
    ds_read_b128 v[96:99], v158 offset:6144
    v_mfma_f32_16x16x32_bf16 v[16:19], v[128:131], v[112:115], v[16:19]
    ds_read_b128 v[100:103], v158 offset:7168
    v_mfma_f32_16x16x32_bf16 v[32:35], v[128:131], v[116:119], v[32:35]
    ds_read_b128 v[104:107], v158 offset:8192
    v_mfma_f32_16x16x32_bf16 v[20:23], v[132:135], v[112:115], v[20:23]
    ds_read_b128 v[108:111], v158 offset:9216
    v_mfma_f32_16x16x32_bf16 v[36:39], v[132:135], v[116:119], v[36:39]
    v_mfma_f32_16x16x32_bf16 v[8:11], v[72:75], v[64:67], v[8:11]
    v_mfma_f32_16x16x32_bf16 v[24:27], v[72:75], v[68:71], v[24:27]
    ds_read_b128 v[112:115], v155 offset:37888
    v_mfma_f32_16x16x32_bf16 v[12:15], v[76:79], v[64:67], v[12:15]
    ds_read_b128 v[116:119], v155 offset:39936
    v_mfma_f32_16x16x32_bf16 v[28:31], v[76:79], v[68:71], v[28:31]
    ds_read_b128 v[120:123], v158 offset:13312
    v_mfma_f32_16x16x32_bf16 v[16:19], v[80:83], v[64:67], v[16:19]
    ds_read_b128 v[124:127], v158 offset:14336
    v_mfma_f32_16x16x32_bf16 v[32:35], v[80:83], v[68:71], v[32:35]
    ds_read_b128 v[128:131], v158 offset:15360
    v_mfma_f32_16x16x32_bf16 v[20:23], v[84:87], v[64:67], v[20:23]
    ds_read_b128 v[132:135], v158 offset:16384
    v_mfma_f32_16x16x32_bf16 v[36:39], v[84:87], v[68:71], v[36:39]
    s_waitcnt lgkmcnt(6)
    s_waitcnt lgkmcnt(0)
    s_barrier
    v_mfma_f32_16x16x32_bf16 v[8:11], v[96:99], v[88:91], v[8:11]
    v_mfma_f32_16x16x32_bf16 v[24:27], v[96:99], v[92:95], v[24:27]
    ds_read_b128 v[64:67], v155 offset:53248
    v_mfma_f32_16x16x32_bf16 v[12:15], v[100:103], v[88:91], v[12:15]
    ds_read_b128 v[68:71], v155 offset:55296
    v_mfma_f32_16x16x32_bf16 v[28:31], v[100:103], v[92:95], v[28:31]
    ds_read_b128 v[72:75], v157 offset:0
    v_mfma_f32_16x16x32_bf16 v[16:19], v[104:107], v[88:91], v[16:19]
    ds_read_b128 v[76:79], v157 offset:1024
    v_mfma_f32_16x16x32_bf16 v[32:35], v[104:107], v[92:95], v[32:35]
    ds_read_b128 v[80:83], v157 offset:2048
    v_mfma_f32_16x16x32_bf16 v[20:23], v[108:111], v[88:91], v[20:23]
    ds_read_b128 v[84:87], v157 offset:3072
    v_mfma_f32_16x16x32_bf16 v[36:39], v[108:111], v[92:95], v[36:39]
    v_mfma_f32_16x16x32_bf16 v[8:11], v[120:123], v[112:115], v[8:11]
    v_mfma_f32_16x16x32_bf16 v[24:27], v[120:123], v[116:119], v[24:27]
    ds_read_b128 v[88:91], v155 offset:54272
    v_mfma_f32_16x16x32_bf16 v[12:15], v[124:127], v[112:115], v[12:15]
    ds_read_b128 v[92:95], v155 offset:56320
    v_mfma_f32_16x16x32_bf16 v[28:31], v[124:127], v[116:119], v[28:31]
    ds_read_b128 v[96:99], v157 offset:7168
    v_mfma_f32_16x16x32_bf16 v[16:19], v[128:131], v[112:115], v[16:19]
    ds_read_b128 v[100:103], v157 offset:8192
    v_mfma_f32_16x16x32_bf16 v[32:35], v[128:131], v[116:119], v[32:35]
    ds_read_b128 v[104:107], v157 offset:9216
    v_mfma_f32_16x16x32_bf16 v[20:23], v[132:135], v[112:115], v[20:23]
    ds_read_b128 v[108:111], v157 offset:10240
    v_mfma_f32_16x16x32_bf16 v[36:39], v[132:135], v[116:119], v[36:39]
    s_waitcnt lgkmcnt(6)
    s_waitcnt lgkmcnt(0)
    s_barrier
    v_mfma_f32_16x16x32_bf16 v[8:11], v[72:75], v[64:67], v[8:11]
    v_mfma_f32_16x16x32_bf16 v[24:27], v[72:75], v[68:71], v[24:27]
    ds_read_b128 v[112:115], v156 offset:4096
    v_mfma_f32_16x16x32_bf16 v[12:15], v[76:79], v[64:67], v[12:15]
    ds_read_b128 v[116:119], v156 offset:6144
    v_mfma_f32_16x16x32_bf16 v[28:31], v[76:79], v[68:71], v[28:31]
    ds_read_b128 v[120:123], v157 offset:14336
    v_mfma_f32_16x16x32_bf16 v[16:19], v[80:83], v[64:67], v[16:19]
    ds_read_b128 v[124:127], v157 offset:15360
    v_mfma_f32_16x16x32_bf16 v[32:35], v[80:83], v[68:71], v[32:35]
    ds_read_b128 v[128:131], v157 offset:16384
    v_mfma_f32_16x16x32_bf16 v[20:23], v[84:87], v[64:67], v[20:23]
    ds_read_b128 v[132:135], v157 offset:17408
    v_mfma_f32_16x16x32_bf16 v[36:39], v[84:87], v[68:71], v[36:39]
    v_mfma_f32_16x16x32_bf16 v[8:11], v[96:99], v[88:91], v[8:11]
    v_mfma_f32_16x16x32_bf16 v[24:27], v[96:99], v[92:95], v[24:27]
    ds_read_b128 v[64:67], v156 offset:5120
    v_mfma_f32_16x16x32_bf16 v[12:15], v[100:103], v[88:91], v[12:15]
    ds_read_b128 v[68:71], v156 offset:7168
    v_mfma_f32_16x16x32_bf16 v[28:31], v[100:103], v[92:95], v[28:31]
    ds_read_b128 v[72:75], v157 offset:21504
    v_mfma_f32_16x16x32_bf16 v[16:19], v[104:107], v[88:91], v[16:19]
    ds_read_b128 v[76:79], v157 offset:22528
    v_mfma_f32_16x16x32_bf16 v[32:35], v[104:107], v[92:95], v[32:35]
    ds_read_b128 v[80:83], v157 offset:23552
    v_mfma_f32_16x16x32_bf16 v[20:23], v[108:111], v[88:91], v[20:23]
    ds_read_b128 v[84:87], v157 offset:24576
    v_mfma_f32_16x16x32_bf16 v[36:39], v[108:111], v[92:95], v[36:39]
    s_lshl_b32 s60, s7, 8
    s_add_u32 s60, s60, 161792
    v_lshlrev_b32 v4, 3, v3
    v_add_u32 v4, s60, v4
    ds_read_b64 v[136:137], v4 offset:0
    ds_read_b64 v[138:139], v4 offset:128
    s_lshl_b32 s60, s8, 8
    s_add_u32 s60, s60, 163200
    v_lshlrev_b32 v4, 4, v2
    v_add_u32 v4, s60, v4
    ds_read_b128 v[40:43], v4 offset:0
    ds_read_b128 v[44:47], v4 offset:64
    ds_read_b128 v[48:51], v4 offset:128
    ds_read_b128 v[52:55], v4 offset:192
    s_waitcnt lgkmcnt(12)
    v_mfma_f32_16x16x32_bf16 v[8:11], v[120:123], v[112:115], v[8:11]
    v_mfma_f32_16x16x32_bf16 v[24:27], v[120:123], v[116:119], v[24:27]
    v_mfma_f32_16x16x32_bf16 v[12:15], v[124:127], v[112:115], v[12:15]
    v_mfma_f32_16x16x32_bf16 v[28:31], v[124:127], v[116:119], v[28:31]
    v_mfma_f32_16x16x32_bf16 v[16:19], v[128:131], v[112:115], v[16:19]
    v_mfma_f32_16x16x32_bf16 v[32:35], v[128:131], v[116:119], v[32:35]
    v_mfma_f32_16x16x32_bf16 v[20:23], v[132:135], v[112:115], v[20:23]
    v_mfma_f32_16x16x32_bf16 v[36:39], v[132:135], v[116:119], v[36:39]
    s_waitcnt lgkmcnt(6)
    v_mfma_f32_16x16x32_bf16 v[8:11], v[72:75], v[64:67], v[8:11]
    v_mfma_f32_16x16x32_bf16 v[24:27], v[72:75], v[68:71], v[24:27]
    v_mfma_f32_16x16x32_bf16 v[12:15], v[76:79], v[64:67], v[12:15]
    v_mfma_f32_16x16x32_bf16 v[28:31], v[76:79], v[68:71], v[28:31]
    v_mfma_f32_16x16x32_bf16 v[16:19], v[80:83], v[64:67], v[16:19]
    v_mfma_f32_16x16x32_bf16 v[32:35], v[80:83], v[68:71], v[32:35]
    v_mfma_f32_16x16x32_bf16 v[20:23], v[84:87], v[64:67], v[20:23]
    v_mfma_f32_16x16x32_bf16 v[36:39], v[84:87], v[68:71], v[36:39]
    s_waitcnt vmcnt(0) lgkmcnt(0)
    s_barrier
    v_mov_b32 v140, v137
    v_mov_b32 v142, v139
    v_lshlrev_b32 v96, 16, v56
    v_and_b32 v97, 0xffff0000, v56
    v_lshlrev_b32 v98, 16, v57
    v_and_b32 v99, 0xffff0000, v57
    v_lshlrev_b32 v100, 16, v58
    v_and_b32 v101, 0xffff0000, v58
    v_lshlrev_b32 v102, 16, v59
    v_and_b32 v103, 0xffff0000, v59
    v_lshlrev_b32 v104, 16, v60
    v_and_b32 v105, 0xffff0000, v60
    v_lshlrev_b32 v106, 16, v61
    v_and_b32 v107, 0xffff0000, v61
    v_lshlrev_b32 v108, 16, v62
    v_and_b32 v109, 0xffff0000, v62
    v_lshlrev_b32 v110, 16, v63
    v_and_b32 v111, 0xffff0000, v63
    v_pk_fma_f32 v[8:9], v[8:9], v[140:141], v[96:97] op_sel_hi:[1,0,1]
    v_pk_fma_f32 v[10:11], v[10:11], v[140:141], v[98:99] op_sel_hi:[1,0,1]
    v_pk_fma_f32 v[12:13], v[12:13], v[140:141], v[100:101] op_sel_hi:[1,0,1]
    v_pk_fma_f32 v[14:15], v[14:15], v[140:141], v[102:103] op_sel_hi:[1,0,1]
    v_pk_fma_f32 v[16:17], v[16:17], v[140:141], v[104:105] op_sel_hi:[1,0,1]
    v_pk_fma_f32 v[18:19], v[18:19], v[140:141], v[106:107] op_sel_hi:[1,0,1]
    v_pk_fma_f32 v[20:21], v[20:21], v[140:141], v[108:109] op_sel_hi:[1,0,1]
    v_pk_fma_f32 v[22:23], v[22:23], v[140:141], v[110:111] op_sel_hi:[1,0,1]
    v_pk_fma_f32 v[8:9], v[40:41], v[136:137], v[8:9] op_sel_hi:[1,0,1]
    v_pk_fma_f32 v[10:11], v[42:43], v[136:137], v[10:11] op_sel_hi:[1,0,1]
    v_pk_fma_f32 v[12:13], v[44:45], v[136:137], v[12:13] op_sel_hi:[1,0,1]
    v_pk_fma_f32 v[14:15], v[46:47], v[136:137], v[14:15] op_sel_hi:[1,0,1]
    v_pk_fma_f32 v[16:17], v[48:49], v[136:137], v[16:17] op_sel_hi:[1,0,1]
    v_pk_fma_f32 v[18:19], v[50:51], v[136:137], v[18:19] op_sel_hi:[1,0,1]
    v_pk_fma_f32 v[20:21], v[52:53], v[136:137], v[20:21] op_sel_hi:[1,0,1]
    v_pk_fma_f32 v[22:23], v[54:55], v[136:137], v[22:23] op_sel_hi:[1,0,1]
    v_pk_mul_f32 v[64:65], v[8:9], v[8:9]
    v_pk_mul_f32 v[66:67], v[10:11], v[10:11]
    v_pk_mul_f32 v[68:69], v[12:13], v[12:13]
    v_pk_mul_f32 v[70:71], v[14:15], v[14:15]
    v_pk_mul_f32 v[72:73], v[16:17], v[16:17]
    v_pk_mul_f32 v[74:75], v[18:19], v[18:19]
    v_pk_mul_f32 v[76:77], v[20:21], v[20:21]
    v_pk_mul_f32 v[78:79], v[22:23], v[22:23]
    v_pk_fma_f32 v[64:65], v[64:65], v[146:147], v[148:149] op_sel_hi:[1,0,0]
    v_pk_fma_f32 v[66:67], v[66:67], v[146:147], v[148:149] op_sel_hi:[1,0,0]
    v_pk_fma_f32 v[68:69], v[68:69], v[146:147], v[148:149] op_sel_hi:[1,0,0]
    v_pk_fma_f32 v[70:71], v[70:71], v[146:147], v[148:149] op_sel_hi:[1,0,0]
    v_pk_fma_f32 v[72:73], v[72:73], v[146:147], v[148:149] op_sel_hi:[1,0,0]
    v_pk_fma_f32 v[74:75], v[74:75], v[146:147], v[148:149] op_sel_hi:[1,0,0]
    v_pk_fma_f32 v[76:77], v[76:77], v[146:147], v[148:149] op_sel_hi:[1,0,0]
    v_pk_fma_f32 v[78:79], v[78:79], v[146:147], v[148:149] op_sel_hi:[1,0,0]
    v_pk_mul_f32 v[64:65], v[64:65], v[8:9]
    v_pk_mul_f32 v[66:67], v[66:67], v[10:11]
    v_pk_mul_f32 v[68:69], v[68:69], v[12:13]
    v_pk_mul_f32 v[70:71], v[70:71], v[14:15]
    v_pk_mul_f32 v[72:73], v[72:73], v[16:17]
    v_pk_mul_f32 v[74:75], v[74:75], v[18:19]
    v_pk_mul_f32 v[76:77], v[76:77], v[20:21]
    v_pk_mul_f32 v[78:79], v[78:79], v[22:23]
    v_exp_f32 v64, v64
    v_exp_f32 v65, v65
    v_exp_f32 v66, v66
    v_exp_f32 v67, v67
    v_exp_f32 v68, v68
    v_exp_f32 v69, v69
    v_exp_f32 v70, v70
    v_exp_f32 v71, v71
    v_exp_f32 v72, v72
    v_exp_f32 v73, v73
    v_exp_f32 v74, v74
    v_exp_f32 v75, v75
    v_exp_f32 v76, v76
    v_exp_f32 v77, v77
    v_exp_f32 v78, v78
    v_exp_f32 v79, v79
    v_pk_add_f32 v[64:65], v[64:65], v[150:151] op_sel_hi:[1,0]
    v_pk_add_f32 v[66:67], v[66:67], v[150:151] op_sel_hi:[1,0]
    v_pk_add_f32 v[68:69], v[68:69], v[150:151] op_sel_hi:[1,0]
    v_pk_add_f32 v[70:71], v[70:71], v[150:151] op_sel_hi:[1,0]
    v_pk_add_f32 v[72:73], v[72:73], v[150:151] op_sel_hi:[1,0]
    v_pk_add_f32 v[74:75], v[74:75], v[150:151] op_sel_hi:[1,0]
    v_pk_add_f32 v[76:77], v[76:77], v[150:151] op_sel_hi:[1,0]
    v_pk_add_f32 v[78:79], v[78:79], v[150:151] op_sel_hi:[1,0]
    v_rcp_f32 v64, v64
    v_rcp_f32 v65, v65
    v_rcp_f32 v66, v66
    v_rcp_f32 v67, v67
    v_rcp_f32 v68, v68
    v_rcp_f32 v69, v69
    v_rcp_f32 v70, v70
    v_rcp_f32 v71, v71
    v_rcp_f32 v72, v72
    v_rcp_f32 v73, v73
    v_rcp_f32 v74, v74
    v_rcp_f32 v75, v75
    v_rcp_f32 v76, v76
    v_rcp_f32 v77, v77
    v_rcp_f32 v78, v78
    v_rcp_f32 v79, v79
    v_pk_mul_f32 v[8:9], v[8:9], v[64:65]
    v_pk_mul_f32 v[10:11], v[10:11], v[66:67]
    v_pk_mul_f32 v[12:13], v[12:13], v[68:69]
    v_pk_mul_f32 v[14:15], v[14:15], v[70:71]
    v_pk_mul_f32 v[16:17], v[16:17], v[72:73]
    v_pk_mul_f32 v[18:19], v[18:19], v[74:75]
    v_pk_mul_f32 v[20:21], v[20:21], v[76:77]
    v_pk_mul_f32 v[22:23], v[22:23], v[78:79]
    v_cvt_pk_bf16_f32 v128, v8, v9
    v_cvt_pk_bf16_f32 v129, v10, v11
    v_cvt_pk_bf16_f32 v130, v12, v13
    v_cvt_pk_bf16_f32 v131, v14, v15
    v_cvt_pk_bf16_f32 v132, v16, v17
    v_cvt_pk_bf16_f32 v133, v18, v19
    v_cvt_pk_bf16_f32 v134, v20, v21
    v_cvt_pk_bf16_f32 v135, v22, v23
    buffer_store_dwordx4 v[128:131], v144, s[56:59], s64 offen
    buffer_store_dwordx4 v[132:135], v144, s[56:59], s64 offen offset:1024
    v_pk_fma_f32 v[24:25], v[24:25], v[142:143], v[96:97] op_sel_hi:[1,0,1]
    v_pk_fma_f32 v[26:27], v[26:27], v[142:143], v[98:99] op_sel_hi:[1,0,1]
    v_pk_fma_f32 v[28:29], v[28:29], v[142:143], v[100:101] op_sel_hi:[1,0,1]
    v_pk_fma_f32 v[30:31], v[30:31], v[142:143], v[102:103] op_sel_hi:[1,0,1]
    v_pk_fma_f32 v[32:33], v[32:33], v[142:143], v[104:105] op_sel_hi:[1,0,1]
    v_pk_fma_f32 v[34:35], v[34:35], v[142:143], v[106:107] op_sel_hi:[1,0,1]
    v_pk_fma_f32 v[36:37], v[36:37], v[142:143], v[108:109] op_sel_hi:[1,0,1]
    v_pk_fma_f32 v[38:39], v[38:39], v[142:143], v[110:111] op_sel_hi:[1,0,1]
    v_pk_fma_f32 v[24:25], v[40:41], v[138:139], v[24:25] op_sel_hi:[1,0,1]
    v_pk_fma_f32 v[26:27], v[42:43], v[138:139], v[26:27] op_sel_hi:[1,0,1]
    v_pk_fma_f32 v[28:29], v[44:45], v[138:139], v[28:29] op_sel_hi:[1,0,1]
    v_pk_fma_f32 v[30:31], v[46:47], v[138:139], v[30:31] op_sel_hi:[1,0,1]
    v_pk_fma_f32 v[32:33], v[48:49], v[138:139], v[32:33] op_sel_hi:[1,0,1]
    v_pk_fma_f32 v[34:35], v[50:51], v[138:139], v[34:35] op_sel_hi:[1,0,1]
    v_pk_fma_f32 v[36:37], v[52:53], v[138:139], v[36:37] op_sel_hi:[1,0,1]
    v_pk_fma_f32 v[38:39], v[54:55], v[138:139], v[38:39] op_sel_hi:[1,0,1]
    v_pk_mul_f32 v[80:81], v[24:25], v[24:25]
    v_pk_mul_f32 v[82:83], v[26:27], v[26:27]
    v_pk_mul_f32 v[84:85], v[28:29], v[28:29]
    v_pk_mul_f32 v[86:87], v[30:31], v[30:31]
    v_pk_mul_f32 v[88:89], v[32:33], v[32:33]
    v_pk_mul_f32 v[90:91], v[34:35], v[34:35]
    v_pk_mul_f32 v[92:93], v[36:37], v[36:37]
    v_pk_mul_f32 v[94:95], v[38:39], v[38:39]
    v_pk_fma_f32 v[80:81], v[80:81], v[146:147], v[148:149] op_sel_hi:[1,0,0]
    v_pk_fma_f32 v[82:83], v[82:83], v[146:147], v[148:149] op_sel_hi:[1,0,0]
    v_pk_fma_f32 v[84:85], v[84:85], v[146:147], v[148:149] op_sel_hi:[1,0,0]
    v_pk_fma_f32 v[86:87], v[86:87], v[146:147], v[148:149] op_sel_hi:[1,0,0]
    v_pk_fma_f32 v[88:89], v[88:89], v[146:147], v[148:149] op_sel_hi:[1,0,0]
    v_pk_fma_f32 v[90:91], v[90:91], v[146:147], v[148:149] op_sel_hi:[1,0,0]
    v_pk_fma_f32 v[92:93], v[92:93], v[146:147], v[148:149] op_sel_hi:[1,0,0]
    v_pk_fma_f32 v[94:95], v[94:95], v[146:147], v[148:149] op_sel_hi:[1,0,0]
    v_pk_mul_f32 v[80:81], v[80:81], v[24:25]
    v_pk_mul_f32 v[82:83], v[82:83], v[26:27]
    v_pk_mul_f32 v[84:85], v[84:85], v[28:29]
    v_pk_mul_f32 v[86:87], v[86:87], v[30:31]
    v_pk_mul_f32 v[88:89], v[88:89], v[32:33]
    v_pk_mul_f32 v[90:91], v[90:91], v[34:35]
    v_pk_mul_f32 v[92:93], v[92:93], v[36:37]
    v_pk_mul_f32 v[94:95], v[94:95], v[38:39]
    v_exp_f32 v80, v80
    v_exp_f32 v81, v81
    v_exp_f32 v82, v82
    v_exp_f32 v83, v83
    v_exp_f32 v84, v84
    v_exp_f32 v85, v85
    v_exp_f32 v86, v86
    v_exp_f32 v87, v87
    v_exp_f32 v88, v88
    v_exp_f32 v89, v89
    v_exp_f32 v90, v90
    v_exp_f32 v91, v91
    v_exp_f32 v92, v92
    v_exp_f32 v93, v93
    v_exp_f32 v94, v94
    v_exp_f32 v95, v95
    v_pk_add_f32 v[80:81], v[80:81], v[150:151] op_sel_hi:[1,0]
    v_pk_add_f32 v[82:83], v[82:83], v[150:151] op_sel_hi:[1,0]
    v_pk_add_f32 v[84:85], v[84:85], v[150:151] op_sel_hi:[1,0]
    v_pk_add_f32 v[86:87], v[86:87], v[150:151] op_sel_hi:[1,0]
    v_pk_add_f32 v[88:89], v[88:89], v[150:151] op_sel_hi:[1,0]
    v_pk_add_f32 v[90:91], v[90:91], v[150:151] op_sel_hi:[1,0]
    v_pk_add_f32 v[92:93], v[92:93], v[150:151] op_sel_hi:[1,0]
    v_pk_add_f32 v[94:95], v[94:95], v[150:151] op_sel_hi:[1,0]
    v_rcp_f32 v80, v80
    v_rcp_f32 v81, v81
    v_rcp_f32 v82, v82
    v_rcp_f32 v83, v83
    v_rcp_f32 v84, v84
    v_rcp_f32 v85, v85
    v_rcp_f32 v86, v86
    v_rcp_f32 v87, v87
    v_rcp_f32 v88, v88
    v_rcp_f32 v89, v89
    v_rcp_f32 v90, v90
    v_rcp_f32 v91, v91
    v_rcp_f32 v92, v92
    v_rcp_f32 v93, v93
    v_rcp_f32 v94, v94
    v_rcp_f32 v95, v95
    v_pk_mul_f32 v[24:25], v[24:25], v[80:81]
    v_pk_mul_f32 v[26:27], v[26:27], v[82:83]
    v_pk_mul_f32 v[28:29], v[28:29], v[84:85]
    v_pk_mul_f32 v[30:31], v[30:31], v[86:87]
    v_pk_mul_f32 v[32:33], v[32:33], v[88:89]
    v_pk_mul_f32 v[34:35], v[34:35], v[90:91]
    v_pk_mul_f32 v[36:37], v[36:37], v[92:93]
    v_pk_mul_f32 v[38:39], v[38:39], v[94:95]
    v_cvt_pk_bf16_f32 v56, v24, v25
    v_cvt_pk_bf16_f32 v57, v26, v27
    v_cvt_pk_bf16_f32 v58, v28, v29
    v_cvt_pk_bf16_f32 v59, v30, v31
    v_cvt_pk_bf16_f32 v60, v32, v33
    v_cvt_pk_bf16_f32 v61, v34, v35
    v_cvt_pk_bf16_f32 v62, v36, v37
    v_cvt_pk_bf16_f32 v63, v38, v39
    s_add_u32 s64, s64, 58368
    s_add_u32 s65, s65, 58368
    buffer_store_dwordx4 v[56:59], v144, s[56:59], s64 offen
    buffer_store_dwordx4 v[60:63], v144, s[56:59], s64 offen offset:1024
    s_branch Lcj_130
Lnh1_129:
    s_nop 7
    s_nop 7
    s_lshl_b32 s79, s7, 12
    v_lshlrev_b32 v152, 4, v1
    v_add_u32 v154, s79, v152
    v_add_u32 v155, 0x10000, v154
    v_add_u32 v156, 0x20000, v154
    v_lshlrev_b32 v152, 4, v1
    v_add_u32 v157, 0x1000, v152
    v_add_u32 v158, 0x10000, v157
    s_lshl_b32 s79, s4, 8
    s_add_u32 s79, s79, 0
    v_lshlrev_b32 v159, 4, v2
    v_add_u32 v159, s79, v159
    s_barrier
    ds_read_b128 v[64:67], v155 offset:20480
    ds_read_b128 v[68:71], v155 offset:22528
    ds_read_b128 v[72:75], v157 offset:0
    ds_read_b128 v[76:79], v157 offset:1024
    ds_read_b128 v[80:83], v157 offset:2048
    ds_read_b128 v[84:87], v155 offset:21504
    ds_read_b128 v[88:91], v155 offset:23552
    ds_read_b128 v[92:95], v157 offset:7168
    ds_read_b128 v[96:99], v157 offset:8192
    ds_read_b128 v[100:103], v157 offset:9216
    s_waitcnt lgkmcnt(5)
    s_waitcnt lgkmcnt(0)
    s_barrier
    v_mfma_f32_16x16x32_bf16 v[8:11], v[72:75], v[64:67], 0
    ds_read_b128 v[104:107], v155 offset:36864
    v_mfma_f32_16x16x32_bf16 v[20:23], v[72:75], v[68:71], 0
    ds_read_b128 v[108:111], v155 offset:38912
    v_mfma_f32_16x16x32_bf16 v[12:15], v[76:79], v[64:67], 0
    ds_read_b128 v[112:115], v157 offset:14336
    v_mfma_f32_16x16x32_bf16 v[24:27], v[76:79], v[68:71], 0
    ds_read_b128 v[116:119], v157 offset:15360
    v_mfma_f32_16x16x32_bf16 v[16:19], v[80:83], v[64:67], 0
    ds_read_b128 v[120:123], v157 offset:16384
    v_mfma_f32_16x16x32_bf16 v[28:31], v[80:83], v[68:71], 0
    v_mfma_f32_16x16x32_bf16 v[8:11], v[92:95], v[84:87], v[8:11]
    ds_read_b128 v[64:67], v155 offset:37888
    v_mfma_f32_16x16x32_bf16 v[20:23], v[92:95], v[88:91], v[20:23]
    ds_read_b128 v[68:71], v155 offset:39936
    v_mfma_f32_16x16x32_bf16 v[12:15], v[96:99], v[84:87], v[12:15]
    ds_read_b128 v[72:75], v157 offset:21504
    v_mfma_f32_16x16x32_bf16 v[24:27], v[96:99], v[88:91], v[24:27]
    ds_read_b128 v[76:79], v157 offset:22528
    v_mfma_f32_16x16x32_bf16 v[16:19], v[100:103], v[84:87], v[16:19]
    ds_read_b128 v[80:83], v157 offset:23552
    v_mfma_f32_16x16x32_bf16 v[28:31], v[100:103], v[88:91], v[28:31]
    s_waitcnt lgkmcnt(5)
    s_waitcnt lgkmcnt(0)
    s_barrier
    v_mfma_f32_16x16x32_bf16 v[8:11], v[112:115], v[104:107], v[8:11]
    ds_read_b128 v[84:87], v155 offset:53248
    v_mfma_f32_16x16x32_bf16 v[20:23], v[112:115], v[108:111], v[20:23]
    ds_read_b128 v[88:91], v155 offset:55296
    v_mfma_f32_16x16x32_bf16 v[12:15], v[116:119], v[104:107], v[12:15]
    ds_read_b128 v[92:95], v157 offset:28672
    v_mfma_f32_16x16x32_bf16 v[24:27], v[116:119], v[108:111], v[24:27]
    ds_read_b128 v[96:99], v157 offset:29696
    v_mfma_f32_16x16x32_bf16 v[16:19], v[120:123], v[104:107], v[16:19]
    ds_read_b128 v[100:103], v157 offset:30720
    v_mfma_f32_16x16x32_bf16 v[28:31], v[120:123], v[108:111], v[28:31]
    v_mfma_f32_16x16x32_bf16 v[8:11], v[72:75], v[64:67], v[8:11]
    ds_read_b128 v[104:107], v155 offset:54272
    v_mfma_f32_16x16x32_bf16 v[20:23], v[72:75], v[68:71], v[20:23]
    ds_read_b128 v[108:111], v155 offset:56320
    v_mfma_f32_16x16x32_bf16 v[12:15], v[76:79], v[64:67], v[12:15]
    ds_read_b128 v[112:115], v157 offset:35840
    v_mfma_f32_16x16x32_bf16 v[24:27], v[76:79], v[68:71], v[24:27]
    ds_read_b128 v[116:119], v157 offset:36864
    v_mfma_f32_16x16x32_bf16 v[16:19], v[80:83], v[64:67], v[16:19]
    ds_read_b128 v[120:123], v157 offset:37888
    v_mfma_f32_16x16x32_bf16 v[28:31], v[80:83], v[68:71], v[28:31]
    s_waitcnt lgkmcnt(5)
    s_waitcnt lgkmcnt(0)
    s_barrier
    v_mfma_f32_16x16x32_bf16 v[8:11], v[92:95], v[84:87], v[8:11]
    ds_read_b128 v[64:67], v156 offset:4096
    v_mfma_f32_16x16x32_bf16 v[20:23], v[92:95], v[88:91], v[20:23]
    ds_read_b128 v[68:71], v156 offset:6144
    v_mfma_f32_16x16x32_bf16 v[12:15], v[96:99], v[84:87], v[12:15]
    ds_read_b128 v[72:75], v157 offset:43008
    v_mfma_f32_16x16x32_bf16 v[24:27], v[96:99], v[88:91], v[24:27]
    ds_read_b128 v[76:79], v157 offset:44032
    v_mfma_f32_16x16x32_bf16 v[16:19], v[100:103], v[84:87], v[16:19]
    ds_read_b128 v[80:83], v157 offset:45056
    v_mfma_f32_16x16x32_bf16 v[28:31], v[100:103], v[88:91], v[28:31]
    v_mfma_f32_16x16x32_bf16 v[8:11], v[112:115], v[104:107], v[8:11]
    ds_read_b128 v[84:87], v156 offset:5120
    v_mfma_f32_16x16x32_bf16 v[20:23], v[112:115], v[108:111], v[20:23]
    ds_read_b128 v[88:91], v156 offset:7168
    v_mfma_f32_16x16x32_bf16 v[12:15], v[116:119], v[104:107], v[12:15]
    ds_read_b128 v[92:95], v157 offset:50176
    v_mfma_f32_16x16x32_bf16 v[24:27], v[116:119], v[108:111], v[24:27]
    ds_read_b128 v[96:99], v157 offset:51200
    v_mfma_f32_16x16x32_bf16 v[16:19], v[120:123], v[104:107], v[16:19]
    ds_read_b128 v[100:103], v157 offset:52224
    v_mfma_f32_16x16x32_bf16 v[28:31], v[120:123], v[108:111], v[28:31]
    s_waitcnt lgkmcnt(5)
    s_waitcnt lgkmcnt(0)
    s_barrier
    v_mfma_f32_16x16x32_bf16 v[8:11], v[72:75], v[64:67], v[8:11]
    ds_read_b128 v[104:107], v155 offset:20480
    v_mfma_f32_16x16x32_bf16 v[20:23], v[72:75], v[68:71], v[20:23]
    ds_read_b128 v[108:111], v155 offset:22528
    v_mfma_f32_16x16x32_bf16 v[12:15], v[76:79], v[64:67], v[12:15]
    ds_read_b128 v[112:115], v157 offset:57344
    v_mfma_f32_16x16x32_bf16 v[24:27], v[76:79], v[68:71], v[24:27]
    ds_read_b128 v[116:119], v157 offset:58368
    v_mfma_f32_16x16x32_bf16 v[16:19], v[80:83], v[64:67], v[16:19]
    ds_read_b128 v[120:123], v157 offset:59392
    v_mfma_f32_16x16x32_bf16 v[28:31], v[80:83], v[68:71], v[28:31]
    v_mfma_f32_16x16x32_bf16 v[8:11], v[92:95], v[84:87], v[8:11]
    ds_read_b128 v[64:67], v155 offset:21504
    v_mfma_f32_16x16x32_bf16 v[20:23], v[92:95], v[88:91], v[20:23]
    ds_read_b128 v[68:71], v155 offset:23552
    v_mfma_f32_16x16x32_bf16 v[12:15], v[96:99], v[84:87], v[12:15]
    ds_read_b128 v[72:75], v157 offset:64512
    v_mfma_f32_16x16x32_bf16 v[24:27], v[96:99], v[88:91], v[24:27]
    ds_read_b128 v[76:79], v158 offset:0
    v_mfma_f32_16x16x32_bf16 v[16:19], v[100:103], v[84:87], v[16:19]
    ds_read_b128 v[80:83], v158 offset:1024
    v_mfma_f32_16x16x32_bf16 v[28:31], v[100:103], v[88:91], v[28:31]
    s_waitcnt lgkmcnt(5)
    s_waitcnt lgkmcnt(0)
    s_barrier
    v_mfma_f32_16x16x32_bf16 v[8:11], v[112:115], v[104:107], v[8:11]
    ds_read_b128 v[84:87], v155 offset:36864
    v_mfma_f32_16x16x32_bf16 v[20:23], v[112:115], v[108:111], v[20:23]
    ds_read_b128 v[88:91], v155 offset:38912
    v_mfma_f32_16x16x32_bf16 v[12:15], v[116:119], v[104:107], v[12:15]
    ds_read_b128 v[92:95], v158 offset:6144
    v_mfma_f32_16x16x32_bf16 v[24:27], v[116:119], v[108:111], v[24:27]
    ds_read_b128 v[96:99], v158 offset:7168
    v_mfma_f32_16x16x32_bf16 v[16:19], v[120:123], v[104:107], v[16:19]
    ds_read_b128 v[100:103], v158 offset:8192
    v_mfma_f32_16x16x32_bf16 v[28:31], v[120:123], v[108:111], v[28:31]
    v_mfma_f32_16x16x32_bf16 v[8:11], v[72:75], v[64:67], v[8:11]
    ds_read_b128 v[104:107], v155 offset:37888
    v_mfma_f32_16x16x32_bf16 v[20:23], v[72:75], v[68:71], v[20:23]
    ds_read_b128 v[108:111], v155 offset:39936
    v_mfma_f32_16x16x32_bf16 v[12:15], v[76:79], v[64:67], v[12:15]
    ds_read_b128 v[112:115], v158 offset:13312
    v_mfma_f32_16x16x32_bf16 v[24:27], v[76:79], v[68:71], v[24:27]
    ds_read_b128 v[116:119], v158 offset:14336
    v_mfma_f32_16x16x32_bf16 v[16:19], v[80:83], v[64:67], v[16:19]
    ds_read_b128 v[120:123], v158 offset:15360
    v_mfma_f32_16x16x32_bf16 v[28:31], v[80:83], v[68:71], v[28:31]
    s_waitcnt lgkmcnt(5)
    s_waitcnt lgkmcnt(0)
    s_barrier
    v_mfma_f32_16x16x32_bf16 v[8:11], v[92:95], v[84:87], v[8:11]
    ds_read_b128 v[64:67], v155 offset:53248
    v_mfma_f32_16x16x32_bf16 v[20:23], v[92:95], v[88:91], v[20:23]
    ds_read_b128 v[68:71], v155 offset:55296
    v_mfma_f32_16x16x32_bf16 v[12:15], v[96:99], v[84:87], v[12:15]
    ds_read_b128 v[72:75], v157 offset:0
    v_mfma_f32_16x16x32_bf16 v[24:27], v[96:99], v[88:91], v[24:27]
    ds_read_b128 v[76:79], v157 offset:1024
    v_mfma_f32_16x16x32_bf16 v[16:19], v[100:103], v[84:87], v[16:19]
    ds_read_b128 v[80:83], v157 offset:2048
    v_mfma_f32_16x16x32_bf16 v[28:31], v[100:103], v[88:91], v[28:31]
    v_mfma_f32_16x16x32_bf16 v[8:11], v[112:115], v[104:107], v[8:11]
    ds_read_b128 v[84:87], v155 offset:54272
    v_mfma_f32_16x16x32_bf16 v[20:23], v[112:115], v[108:111], v[20:23]
    ds_read_b128 v[88:91], v155 offset:56320
    v_mfma_f32_16x16x32_bf16 v[12:15], v[116:119], v[104:107], v[12:15]
    ds_read_b128 v[92:95], v157 offset:7168
    v_mfma_f32_16x16x32_bf16 v[24:27], v[116:119], v[108:111], v[24:27]
    ds_read_b128 v[96:99], v157 offset:8192
    v_mfma_f32_16x16x32_bf16 v[16:19], v[120:123], v[104:107], v[16:19]
    ds_read_b128 v[100:103], v157 offset:9216
    v_mfma_f32_16x16x32_bf16 v[28:31], v[120:123], v[108:111], v[28:31]
    s_waitcnt lgkmcnt(5)
    s_waitcnt lgkmcnt(0)
    s_barrier
    v_mfma_f32_16x16x32_bf16 v[8:11], v[72:75], v[64:67], v[8:11]
    ds_read_b128 v[104:107], v156 offset:4096
    v_mfma_f32_16x16x32_bf16 v[20:23], v[72:75], v[68:71], v[20:23]
    ds_read_b128 v[108:111], v156 offset:6144
    v_mfma_f32_16x16x32_bf16 v[12:15], v[76:79], v[64:67], v[12:15]
    ds_read_b128 v[112:115], v157 offset:14336
    v_mfma_f32_16x16x32_bf16 v[24:27], v[76:79], v[68:71], v[24:27]
    ds_read_b128 v[116:119], v157 offset:15360
    v_mfma_f32_16x16x32_bf16 v[16:19], v[80:83], v[64:67], v[16:19]
    ds_read_b128 v[120:123], v157 offset:16384
    v_mfma_f32_16x16x32_bf16 v[28:31], v[80:83], v[68:71], v[28:31]
    v_mfma_f32_16x16x32_bf16 v[8:11], v[92:95], v[84:87], v[8:11]
    ds_read_b128 v[64:67], v156 offset:5120
    v_mfma_f32_16x16x32_bf16 v[20:23], v[92:95], v[88:91], v[20:23]
    ds_read_b128 v[68:71], v156 offset:7168
    v_mfma_f32_16x16x32_bf16 v[12:15], v[96:99], v[84:87], v[12:15]
    ds_read_b128 v[72:75], v157 offset:21504
    v_mfma_f32_16x16x32_bf16 v[24:27], v[96:99], v[88:91], v[24:27]
    ds_read_b128 v[76:79], v157 offset:22528
    v_mfma_f32_16x16x32_bf16 v[16:19], v[100:103], v[84:87], v[16:19]
    ds_read_b128 v[80:83], v157 offset:23552
    v_mfma_f32_16x16x32_bf16 v[28:31], v[100:103], v[88:91], v[28:31]
    s_lshl_b32 s60, s7, 8
    s_add_u32 s60, s60, 161792
    v_lshlrev_b32 v4, 3, v3
    v_add_u32 v4, s60, v4
    ds_read_b64 v[136:137], v4 offset:0
    ds_read_b64 v[138:139], v4 offset:128
    s_lshl_b32 s60, s8, 8
    s_add_u32 s60, s60, 163200
    v_lshlrev_b32 v4, 4, v2
    v_add_u32 v4, s60, v4
    ds_read_b128 v[40:43], v4 offset:0
    ds_read_b128 v[44:47], v4 offset:64
    ds_read_b128 v[48:51], v4 offset:128
    s_waitcnt lgkmcnt(10)
    v_mfma_f32_16x16x32_bf16 v[8:11], v[112:115], v[104:107], v[8:11]
    v_mfma_f32_16x16x32_bf16 v[20:23], v[112:115], v[108:111], v[20:23]
    v_mfma_f32_16x16x32_bf16 v[12:15], v[116:119], v[104:107], v[12:15]
    v_mfma_f32_16x16x32_bf16 v[24:27], v[116:119], v[108:111], v[24:27]
    v_mfma_f32_16x16x32_bf16 v[16:19], v[120:123], v[104:107], v[16:19]
    v_mfma_f32_16x16x32_bf16 v[28:31], v[120:123], v[108:111], v[28:31]
    s_waitcnt lgkmcnt(5)
    v_mfma_f32_16x16x32_bf16 v[8:11], v[72:75], v[64:67], v[8:11]
    v_mfma_f32_16x16x32_bf16 v[20:23], v[72:75], v[68:71], v[20:23]
    v_mfma_f32_16x16x32_bf16 v[12:15], v[76:79], v[64:67], v[12:15]
    v_mfma_f32_16x16x32_bf16 v[24:27], v[76:79], v[68:71], v[24:27]
    v_mfma_f32_16x16x32_bf16 v[16:19], v[80:83], v[64:67], v[16:19]
    v_mfma_f32_16x16x32_bf16 v[28:31], v[80:83], v[68:71], v[28:31]
    s_waitcnt vmcnt(0) lgkmcnt(0)
    s_barrier
    v_mov_b32 v140, v137
    v_mov_b32 v142, v139
    v_lshlrev_b32 v96, 16, v56
    v_and_b32 v97, 0xffff0000, v56
    v_lshlrev_b32 v98, 16, v57
    v_and_b32 v99, 0xffff0000, v57
    v_lshlrev_b32 v100, 16, v58
    v_and_b32 v101, 0xffff0000, v58
    v_lshlrev_b32 v102, 16, v59
    v_and_b32 v103, 0xffff0000, v59
    v_lshlrev_b32 v104, 16, v60
    v_and_b32 v105, 0xffff0000, v60
    v_lshlrev_b32 v106, 16, v61
    v_and_b32 v107, 0xffff0000, v61
    v_pk_fma_f32 v[8:9], v[8:9], v[140:141], v[96:97] op_sel_hi:[1,0,1]
    v_pk_fma_f32 v[10:11], v[10:11], v[140:141], v[98:99] op_sel_hi:[1,0,1]
    v_pk_fma_f32 v[12:13], v[12:13], v[140:141], v[100:101] op_sel_hi:[1,0,1]
    v_pk_fma_f32 v[14:15], v[14:15], v[140:141], v[102:103] op_sel_hi:[1,0,1]
    v_pk_fma_f32 v[16:17], v[16:17], v[140:141], v[104:105] op_sel_hi:[1,0,1]
    v_pk_fma_f32 v[18:19], v[18:19], v[140:141], v[106:107] op_sel_hi:[1,0,1]
    v_pk_fma_f32 v[8:9], v[40:41], v[136:137], v[8:9] op_sel_hi:[1,0,1]
    v_pk_fma_f32 v[10:11], v[42:43], v[136:137], v[10:11] op_sel_hi:[1,0,1]
    v_pk_fma_f32 v[12:13], v[44:45], v[136:137], v[12:13] op_sel_hi:[1,0,1]
    v_pk_fma_f32 v[14:15], v[46:47], v[136:137], v[14:15] op_sel_hi:[1,0,1]
    v_pk_fma_f32 v[16:17], v[48:49], v[136:137], v[16:17] op_sel_hi:[1,0,1]
    v_pk_fma_f32 v[18:19], v[50:51], v[136:137], v[18:19] op_sel_hi:[1,0,1]
    v_pk_mul_f32 v[64:65], v[8:9], v[8:9]
    v_pk_mul_f32 v[66:67], v[10:11], v[10:11]
    v_pk_mul_f32 v[68:69], v[12:13], v[12:13]
    v_pk_mul_f32 v[70:71], v[14:15], v[14:15]
    v_pk_mul_f32 v[72:73], v[16:17], v[16:17]
    v_pk_mul_f32 v[74:75], v[18:19], v[18:19]
    v_pk_fma_f32 v[64:65], v[64:65], v[146:147], v[148:149] op_sel_hi:[1,0,0]
    v_pk_fma_f32 v[66:67], v[66:67], v[146:147], v[148:149] op_sel_hi:[1,0,0]
    v_pk_fma_f32 v[68:69], v[68:69], v[146:147], v[148:149] op_sel_hi:[1,0,0]
    v_pk_fma_f32 v[70:71], v[70:71], v[146:147], v[148:149] op_sel_hi:[1,0,0]
    v_pk_fma_f32 v[72:73], v[72:73], v[146:147], v[148:149] op_sel_hi:[1,0,0]
    v_pk_fma_f32 v[74:75], v[74:75], v[146:147], v[148:149] op_sel_hi:[1,0,0]
    v_pk_mul_f32 v[64:65], v[64:65], v[8:9]
    v_pk_mul_f32 v[66:67], v[66:67], v[10:11]
    v_pk_mul_f32 v[68:69], v[68:69], v[12:13]
    v_pk_mul_f32 v[70:71], v[70:71], v[14:15]
    v_pk_mul_f32 v[72:73], v[72:73], v[16:17]
    v_pk_mul_f32 v[74:75], v[74:75], v[18:19]
    v_exp_f32 v64, v64
    v_exp_f32 v65, v65
    v_exp_f32 v66, v66
    v_exp_f32 v67, v67
    v_exp_f32 v68, v68
    v_exp_f32 v69, v69
    v_exp_f32 v70, v70
    v_exp_f32 v71, v71
    v_exp_f32 v72, v72
    v_exp_f32 v73, v73
    v_exp_f32 v74, v74
    v_exp_f32 v75, v75
    v_pk_add_f32 v[64:65], v[64:65], v[150:151] op_sel_hi:[1,0]
    v_pk_add_f32 v[66:67], v[66:67], v[150:151] op_sel_hi:[1,0]
    v_pk_add_f32 v[68:69], v[68:69], v[150:151] op_sel_hi:[1,0]
    v_pk_add_f32 v[70:71], v[70:71], v[150:151] op_sel_hi:[1,0]
    v_pk_add_f32 v[72:73], v[72:73], v[150:151] op_sel_hi:[1,0]
    v_pk_add_f32 v[74:75], v[74:75], v[150:151] op_sel_hi:[1,0]
    v_rcp_f32 v64, v64
    v_rcp_f32 v65, v65
    v_rcp_f32 v66, v66
    v_rcp_f32 v67, v67
    v_rcp_f32 v68, v68
    v_rcp_f32 v69, v69
    v_rcp_f32 v70, v70
    v_rcp_f32 v71, v71
    v_rcp_f32 v72, v72
    v_rcp_f32 v73, v73
    v_rcp_f32 v74, v74
    v_rcp_f32 v75, v75
    v_pk_mul_f32 v[8:9], v[8:9], v[64:65]
    v_pk_mul_f32 v[10:11], v[10:11], v[66:67]
    v_pk_mul_f32 v[12:13], v[12:13], v[68:69]
    v_pk_mul_f32 v[14:15], v[14:15], v[70:71]
    v_pk_mul_f32 v[16:17], v[16:17], v[72:73]
    v_pk_mul_f32 v[18:19], v[18:19], v[74:75]
    v_cvt_pk_bf16_f32 v128, v8, v9
    v_cvt_pk_bf16_f32 v129, v10, v11
    v_cvt_pk_bf16_f32 v130, v12, v13
    v_cvt_pk_bf16_f32 v131, v14, v15
    v_cvt_pk_bf16_f32 v132, v16, v17
    v_cvt_pk_bf16_f32 v133, v18, v19
    buffer_store_dwordx4 v[128:131], v144, s[56:59], s64 offen
    buffer_store_dwordx2 v[132:133], v144, s[56:59], s65 offen
    v_pk_fma_f32 v[20:21], v[20:21], v[142:143], v[96:97] op_sel_hi:[1,0,1]
    v_pk_fma_f32 v[22:23], v[22:23], v[142:143], v[98:99] op_sel_hi:[1,0,1]
    v_pk_fma_f32 v[24:25], v[24:25], v[142:143], v[100:101] op_sel_hi:[1,0,1]
    v_pk_fma_f32 v[26:27], v[26:27], v[142:143], v[102:103] op_sel_hi:[1,0,1]
    v_pk_fma_f32 v[28:29], v[28:29], v[142:143], v[104:105] op_sel_hi:[1,0,1]
    v_pk_fma_f32 v[30:31], v[30:31], v[142:143], v[106:107] op_sel_hi:[1,0,1]
    v_pk_fma_f32 v[20:21], v[40:41], v[138:139], v[20:21] op_sel_hi:[1,0,1]
    v_pk_fma_f32 v[22:23], v[42:43], v[138:139], v[22:23] op_sel_hi:[1,0,1]
    v_pk_fma_f32 v[24:25], v[44:45], v[138:139], v[24:25] op_sel_hi:[1,0,1]
    v_pk_fma_f32 v[26:27], v[46:47], v[138:139], v[26:27] op_sel_hi:[1,0,1]
    v_pk_fma_f32 v[28:29], v[48:49], v[138:139], v[28:29] op_sel_hi:[1,0,1]
    v_pk_fma_f32 v[30:31], v[50:51], v[138:139], v[30:31] op_sel_hi:[1,0,1]
    v_pk_mul_f32 v[80:81], v[20:21], v[20:21]
    v_pk_mul_f32 v[82:83], v[22:23], v[22:23]
    v_pk_mul_f32 v[84:85], v[24:25], v[24:25]
    v_pk_mul_f32 v[86:87], v[26:27], v[26:27]
    v_pk_mul_f32 v[88:89], v[28:29], v[28:29]
    v_pk_mul_f32 v[90:91], v[30:31], v[30:31]
    v_pk_fma_f32 v[80:81], v[80:81], v[146:147], v[148:149] op_sel_hi:[1,0,0]
    v_pk_fma_f32 v[82:83], v[82:83], v[146:147], v[148:149] op_sel_hi:[1,0,0]
    v_pk_fma_f32 v[84:85], v[84:85], v[146:147], v[148:149] op_sel_hi:[1,0,0]
    v_pk_fma_f32 v[86:87], v[86:87], v[146:147], v[148:149] op_sel_hi:[1,0,0]
    v_pk_fma_f32 v[88:89], v[88:89], v[146:147], v[148:149] op_sel_hi:[1,0,0]
    v_pk_fma_f32 v[90:91], v[90:91], v[146:147], v[148:149] op_sel_hi:[1,0,0]
    v_pk_mul_f32 v[80:81], v[80:81], v[20:21]
    v_pk_mul_f32 v[82:83], v[82:83], v[22:23]
    v_pk_mul_f32 v[84:85], v[84:85], v[24:25]
    v_pk_mul_f32 v[86:87], v[86:87], v[26:27]
    v_pk_mul_f32 v[88:89], v[88:89], v[28:29]
    v_pk_mul_f32 v[90:91], v[90:91], v[30:31]
    v_exp_f32 v80, v80
    v_exp_f32 v81, v81
    v_exp_f32 v82, v82
    v_exp_f32 v83, v83
    v_exp_f32 v84, v84
    v_exp_f32 v85, v85
    v_exp_f32 v86, v86
    v_exp_f32 v87, v87
    v_exp_f32 v88, v88
    v_exp_f32 v89, v89
    v_exp_f32 v90, v90
    v_exp_f32 v91, v91
    v_pk_add_f32 v[80:81], v[80:81], v[150:151] op_sel_hi:[1,0]
    v_pk_add_f32 v[82:83], v[82:83], v[150:151] op_sel_hi:[1,0]
    v_pk_add_f32 v[84:85], v[84:85], v[150:151] op_sel_hi:[1,0]
    v_pk_add_f32 v[86:87], v[86:87], v[150:151] op_sel_hi:[1,0]
    v_pk_add_f32 v[88:89], v[88:89], v[150:151] op_sel_hi:[1,0]
    v_pk_add_f32 v[90:91], v[90:91], v[150:151] op_sel_hi:[1,0]
    v_rcp_f32 v80, v80
    v_rcp_f32 v81, v81
    v_rcp_f32 v82, v82
    v_rcp_f32 v83, v83
    v_rcp_f32 v84, v84
    v_rcp_f32 v85, v85
    v_rcp_f32 v86, v86
    v_rcp_f32 v87, v87
    v_rcp_f32 v88, v88
    v_rcp_f32 v89, v89
    v_rcp_f32 v90, v90
    v_rcp_f32 v91, v91
    v_pk_mul_f32 v[20:21], v[20:21], v[80:81]
    v_pk_mul_f32 v[22:23], v[22:23], v[82:83]
    v_pk_mul_f32 v[24:25], v[24:25], v[84:85]
    v_pk_mul_f32 v[26:27], v[26:27], v[86:87]
    v_pk_mul_f32 v[28:29], v[28:29], v[88:89]
    v_pk_mul_f32 v[30:31], v[30:31], v[90:91]
    v_cvt_pk_bf16_f32 v56, v20, v21
    v_cvt_pk_bf16_f32 v57, v22, v23
    v_cvt_pk_bf16_f32 v58, v24, v25
    v_cvt_pk_bf16_f32 v59, v26, v27
    v_cvt_pk_bf16_f32 v60, v28, v29
    v_cvt_pk_bf16_f32 v61, v30, v31
    s_add_u32 s64, s64, 58368
    s_add_u32 s65, s65, 58368
    buffer_store_dwordx4 v[56:59], v144, s[56:59], s64 offen
    buffer_store_dwordx2 v[60:61], v144, s[56:59], s65 offen
Lcj_130:
    s_nop 7
    s_nop 7
    v_mov_b32 v4, 163808
    v_mov_b32 v5, 1
    s_add_u32 s72, s38, 0x1580000
    s_addc_u32 s73, s39, 0
    s_mov_b32 s74, 0x3000
    s_mov_b32 s75, 0x00020000
    s_waitcnt vmcnt(0) lgkmcnt(0)
    s_mov_b64 exec, 1
    ds_add_rtn_u32 v5, v4, v5
    s_waitcnt lgkmcnt(0)
    s_mov_b64 exec, -1
    v_readfirstlane_b32 s70, v5
    s_nop 3
    s_and_b32 s70, s70, 7
    s_cmp_lg_u32 s70, 7
    s_cbranch_scc1 Lsg_131
    s_lshl_b32 s70, s5, 6
    s_add_u32 s70, s70, s6
    s_lshl_b32 s70, s70, 2
    v_mov_b32 v4, 4
    v_mov_b32 v5, 0
    s_mov_b64 exec, 1
    buffer_store_dword v4, v5, s[72:75], s70 offen
    s_mov_b64 exec, -1
    s_nop 1
Lsg_131:
    s_nop 7
    s_nop 7
    s_barrier
    s_lshr_b32 s60, s6, 3
    s_lshl_b32 s61, s5, 1
    s_add_u32 s60, s60, s61
    s_and_b32 s61, s6, 7
    v_lshrrev_b32 v6, 3, v1
    v_lshlrev_b32 v6, 4, v6
    v_and_b32 v4, 7, v1
    v_lshl_add_u32 v6, v4, 8, v6
    s_lshl_b32 s64, s60, 2
    s_lshr_b32 s62, s4, 1
    s_add_u32 s64, s64, s62
    s_lshl_b32 s64, s64, 14
    s_lshl_b32 s62, s61, 11
    s_add_u32 s64, s64, s62
    s_and_b32 s62, s4, 1
    s_lshl_b32 s62, s62, 7
    s_add_u32 s64, s64, s62
    v_lshrrev_b32 v7, 3, v1
    v_lshlrev_b32 v7, 4, v7
    v_and_b32 v4, 7, v1
    v_lshl_add_u32 v7, v4, 8, v7
    s_lshl_b32 s65, s60, 2
    s_lshr_b32 s62, s4, 1
    s_add_u32 s65, s65, s62
    s_lshl_b32 s65, s65, 14
    s_lshl_b32 s62, s61, 11
    s_add_u32 s65, s65, s62
    s_and_b32 s62, s4, 1
    s_lshl_b32 s62, s62, 7
    s_add_u32 s65, s65, s62
    s_mov_b32 s48, s32
    s_mov_b32 s49, s33
    s_mov_b32 s50, 0x400
    s_mov_b32 s51, 0x00020000
    s_add_u32 s52, s38, 0x600000
    s_addc_u32 s53, s39, 0
    s_mov_b32 s54, 0x200000
    s_mov_b32 s55, 0x00020000
    s_add_u32 s56, s38, 0x800000
    s_addc_u32 s57, s39, 0
    s_mov_b32 s58, 0x200000
    s_mov_b32 s59, 0x00020000
    s_lshl_b32 s66, s7, 12
    v_lshrrev_b32 v4, 2, v1
    v_lshlrev_b32 v124, 7, v4
    v_and_b32 v5, 3, v1
    v_lshl_add_u32 v124, v5, 3, v124
    v_add_u32 v124, s66, v124
    v_bfe_u32 v4, v1, 3, 2
    v_lshl_add_u32 v124, v4, 5, v124
    v_xor_b32 v125, 32, v124
    v_xor_b32 v126, 64, v124
    v_xor_b32 v127, 96, v124
    v_add_u32 v129, 0x10000, v124
    v_add_u32 v130, 0x20000, v124
    v_add_u32 v131, 0x10000, v125
    v_add_u32 v132, 0x20000, v125
    v_add_u32 v133, 0x10000, v126
    v_add_u32 v134, 0x20000, v126
    v_add_u32 v135, 0x10000, v127
    v_add_u32 v136, 0x20000, v127
    v_lshlrev_b32 v128, 4, v1
    s_add_u32 s44, s38, 0xc00000
    s_addc_u32 s45, s39, 0
    s_mov_b32 s46, 0x720000
    s_mov_b32 s47, 0x00020000
    s_lshl_b32 s67, s60, 1
    s_add_u32 s67, s67, s8
    s_mul_i32 s67, s67, 116736
    s_mul_i32 s62, s7, 14336
    s_add_u32 s67, s67, s62
    v_and_b32 v8, 7, v1
    v_lshlrev_b32 v8, 4, v8
    s_lshl_b32 s63, s61, 7
    buffer_load_dwordx4 v[80:83], v8, s[48:51], s63 offen
    buffer_load_dwordx4 v[76:79], v6, s[52:55], s64 offen sc1
    s_barrier
    s_add_u32 s62, s67, 0
    buffer_load_dwordx4 v[84:87], v128, s[44:47], s62 offen sc1
    s_add_u32 s62, s67, 58368
    buffer_load_dwordx4 v[88:91], v128, s[44:47], s62 offen sc1
    s_add_u32 s62, s67, 1024
    buffer_load_dwordx4 v[92:95], v128, s[44:47], s62 offen sc1
    s_add_u32 s62, s67, 59392
    buffer_load_dwordx4 v[96:99], v128, s[44:47], s62 offen sc1
    s_add_u32 s62, s67, 2048
    buffer_load_dwordx4 v[100:103], v128, s[44:47], s62 offen sc1
    s_add_u32 s62, s67, 60416
    buffer_load_dwordx4 v[104:107], v128, s[44:47], s62 offen sc1
    s_add_u32 s62, s67, 3072
    buffer_load_dwordx4 v[108:111], v128, s[44:47], s62 offen sc1
    s_add_u32 s62, s67, 61440
    buffer_load_dwordx4 v[112:115], v128, s[44:47], s62 offen sc1
    s_add_u32 s62, s67, 4096
    buffer_load_dwordx4 v[116:119], v128, s[44:47], s62 offen sc1
    s_add_u32 s62, s67, 62464
    buffer_load_dwordx4 v[120:123], v128, s[44:47], s62 offen sc1
    s_barrier
    ds_read_b64_tr_b16 v[44:45], v124 offset:0
    ds_read_b64_tr_b16 v[46:47], v124 offset:2048
    ds_read_b64_tr_b16 v[48:49], v125 offset:0
    ds_read_b64_tr_b16 v[50:51], v125 offset:2048
    ds_read_b64_tr_b16 v[52:53], v126 offset:0
    ds_read_b64_tr_b16 v[54:55], v126 offset:2048
    ds_read_b64_tr_b16 v[56:57], v127 offset:0
    ds_read_b64_tr_b16 v[58:59], v127 offset:2048
    s_waitcnt lgkmcnt(0)
    s_barrier
    s_waitcnt vmcnt(8)
    v_mfma_f32_16x16x32_bf16 v[12:15], v[44:47], v[84:87], 0
    ds_read_b64_tr_b16 v[60:61], v124 offset:16384
    v_mfma_f32_16x16x32_bf16 v[28:31], v[44:47], v[88:91], 0
    ds_read_b64_tr_b16 v[62:63], v124 offset:18432
    v_mfma_f32_16x16x32_bf16 v[16:19], v[48:51], v[84:87], 0
    ds_read_b64_tr_b16 v[64:65], v125 offset:16384
    v_mfma_f32_16x16x32_bf16 v[32:35], v[48:51], v[88:91], 0
    ds_read_b64_tr_b16 v[66:67], v125 offset:18432
    ds_read_b64_tr_b16 v[68:69], v126 offset:16384
    v_mfma_f32_16x16x32_bf16 v[20:23], v[52:55], v[84:87], 0
    ds_read_b64_tr_b16 v[70:71], v126 offset:18432
    v_mfma_f32_16x16x32_bf16 v[36:39], v[52:55], v[88:91], 0
    ds_read_b64_tr_b16 v[72:73], v127 offset:16384
    v_mfma_f32_16x16x32_bf16 v[24:27], v[56:59], v[84:87], 0
    ds_read_b64_tr_b16 v[74:75], v127 offset:18432
    v_mfma_f32_16x16x32_bf16 v[40:43], v[56:59], v[88:91], 0
    s_add_u32 s62, s67, 5120
    buffer_load_dwordx4 v[84:87], v128, s[44:47], s62 offen sc1
    s_add_u32 s62, s67, 63488
    buffer_load_dwordx4 v[88:91], v128, s[44:47], s62 offen sc1
    s_waitcnt lgkmcnt(0)
    s_barrier
    s_waitcnt vmcnt(8)
    v_mfma_f32_16x16x32_bf16 v[12:15], v[60:63], v[92:95], v[12:15]
    ds_read_b64_tr_b16 v[44:45], v124 offset:32768
    v_mfma_f32_16x16x32_bf16 v[28:31], v[60:63], v[96:99], v[28:31]
    ds_read_b64_tr_b16 v[46:47], v124 offset:34816
    v_mfma_f32_16x16x32_bf16 v[16:19], v[64:67], v[92:95], v[16:19]
    ds_read_b64_tr_b16 v[48:49], v125 offset:32768
    v_mfma_f32_16x16x32_bf16 v[32:35], v[64:67], v[96:99], v[32:35]
    ds_read_b64_tr_b16 v[50:51], v125 offset:34816
    ds_read_b64_tr_b16 v[52:53], v126 offset:32768
    v_mfma_f32_16x16x32_bf16 v[20:23], v[68:71], v[92:95], v[20:23]
    ds_read_b64_tr_b16 v[54:55], v126 offset:34816
    v_mfma_f32_16x16x32_bf16 v[36:39], v[68:71], v[96:99], v[36:39]
    ds_read_b64_tr_b16 v[56:57], v127 offset:32768
    v_mfma_f32_16x16x32_bf16 v[24:27], v[72:75], v[92:95], v[24:27]
    ds_read_b64_tr_b16 v[58:59], v127 offset:34816
    v_mfma_f32_16x16x32_bf16 v[40:43], v[72:75], v[96:99], v[40:43]
    s_add_u32 s62, s67, 6144
    buffer_load_dwordx4 v[92:95], v128, s[44:47], s62 offen sc1
    s_add_u32 s62, s67, 64512
    buffer_load_dwordx4 v[96:99], v128, s[44:47], s62 offen sc1
    s_waitcnt lgkmcnt(0)
    s_barrier
    s_waitcnt vmcnt(8)
    v_mfma_f32_16x16x32_bf16 v[12:15], v[44:47], v[100:103], v[12:15]
    ds_read_b64_tr_b16 v[60:61], v124 offset:49152
    v_mfma_f32_16x16x32_bf16 v[28:31], v[44:47], v[104:107], v[28:31]
    ds_read_b64_tr_b16 v[62:63], v124 offset:51200
    v_mfma_f32_16x16x32_bf16 v[16:19], v[48:51], v[100:103], v[16:19]
    ds_read_b64_tr_b16 v[64:65], v125 offset:49152
    v_mfma_f32_16x16x32_bf16 v[32:35], v[48:51], v[104:107], v[32:35]
    ds_read_b64_tr_b16 v[66:67], v125 offset:51200
    ds_read_b64_tr_b16 v[68:69], v126 offset:49152
    v_mfma_f32_16x16x32_bf16 v[20:23], v[52:55], v[100:103], v[20:23]
    ds_read_b64_tr_b16 v[70:71], v126 offset:51200
    v_mfma_f32_16x16x32_bf16 v[36:39], v[52:55], v[104:107], v[36:39]
    ds_read_b64_tr_b16 v[72:73], v127 offset:49152
    v_mfma_f32_16x16x32_bf16 v[24:27], v[56:59], v[100:103], v[24:27]
    ds_read_b64_tr_b16 v[74:75], v127 offset:51200
    v_mfma_f32_16x16x32_bf16 v[40:43], v[56:59], v[104:107], v[40:43]
    s_add_u32 s62, s67, 7168
    buffer_load_dwordx4 v[100:103], v128, s[44:47], s62 offen sc1
    s_add_u32 s62, s67, 65536
    buffer_load_dwordx4 v[104:107], v128, s[44:47], s62 offen sc1
    s_waitcnt lgkmcnt(0)
    s_barrier
    s_waitcnt vmcnt(8)
    v_mfma_f32_16x16x32_bf16 v[12:15], v[60:63], v[108:111], v[12:15]
    ds_read_b64_tr_b16 v[44:45], v129 offset:0
    v_mfma_f32_16x16x32_bf16 v[28:31], v[60:63], v[112:115], v[28:31]
    ds_read_b64_tr_b16 v[46:47], v129 offset:2048
    v_mfma_f32_16x16x32_bf16 v[16:19], v[64:67], v[108:111], v[16:19]
    ds_read_b64_tr_b16 v[48:49], v131 offset:0
    v_mfma_f32_16x16x32_bf16 v[32:35], v[64:67], v[112:115], v[32:35]
    ds_read_b64_tr_b16 v[50:51], v131 offset:2048
    ds_read_b64_tr_b16 v[52:53], v133 offset:0
    v_mfma_f32_16x16x32_bf16 v[20:23], v[68:71], v[108:111], v[20:23]
    ds_read_b64_tr_b16 v[54:55], v133 offset:2048
    v_mfma_f32_16x16x32_bf16 v[36:39], v[68:71], v[112:115], v[36:39]
    ds_read_b64_tr_b16 v[56:57], v135 offset:0
    v_mfma_f32_16x16x32_bf16 v[24:27], v[72:75], v[108:111], v[24:27]
    ds_read_b64_tr_b16 v[58:59], v135 offset:2048
    v_mfma_f32_16x16x32_bf16 v[40:43], v[72:75], v[112:115], v[40:43]
    s_add_u32 s62, s67, 8192
    buffer_load_dwordx4 v[108:111], v128, s[44:47], s62 offen sc1
    s_add_u32 s62, s67, 66560
    buffer_load_dwordx4 v[112:115], v128, s[44:47], s62 offen sc1
    s_waitcnt lgkmcnt(0)
    s_barrier
    s_waitcnt vmcnt(8)
    v_mfma_f32_16x16x32_bf16 v[12:15], v[44:47], v[116:119], v[12:15]
    ds_read_b64_tr_b16 v[60:61], v129 offset:16384
    v_mfma_f32_16x16x32_bf16 v[28:31], v[44:47], v[120:123], v[28:31]
    ds_read_b64_tr_b16 v[62:63], v129 offset:18432
    v_mfma_f32_16x16x32_bf16 v[16:19], v[48:51], v[116:119], v[16:19]
    ds_read_b64_tr_b16 v[64:65], v131 offset:16384
    v_mfma_f32_16x16x32_bf16 v[32:35], v[48:51], v[120:123], v[32:35]
    ds_read_b64_tr_b16 v[66:67], v131 offset:18432
    ds_read_b64_tr_b16 v[68:69], v133 offset:16384
    v_mfma_f32_16x16x32_bf16 v[20:23], v[52:55], v[116:119], v[20:23]
    ds_read_b64_tr_b16 v[70:71], v133 offset:18432
    v_mfma_f32_16x16x32_bf16 v[36:39], v[52:55], v[120:123], v[36:39]
    ds_read_b64_tr_b16 v[72:73], v135 offset:16384
    v_mfma_f32_16x16x32_bf16 v[24:27], v[56:59], v[116:119], v[24:27]
    ds_read_b64_tr_b16 v[74:75], v135 offset:18432
    v_mfma_f32_16x16x32_bf16 v[40:43], v[56:59], v[120:123], v[40:43]
    s_add_u32 s62, s67, 9216
    buffer_load_dwordx4 v[116:119], v128, s[44:47], s62 offen sc1
    s_add_u32 s62, s67, 67584
    buffer_load_dwordx4 v[120:123], v128, s[44:47], s62 offen sc1
    s_waitcnt lgkmcnt(0)
    s_barrier
    s_waitcnt vmcnt(8)
    v_mfma_f32_16x16x32_bf16 v[12:15], v[60:63], v[84:87], v[12:15]
    ds_read_b64_tr_b16 v[44:45], v129 offset:32768
    v_mfma_f32_16x16x32_bf16 v[28:31], v[60:63], v[88:91], v[28:31]
    ds_read_b64_tr_b16 v[46:47], v129 offset:34816
    v_mfma_f32_16x16x32_bf16 v[16:19], v[64:67], v[84:87], v[16:19]
    ds_read_b64_tr_b16 v[48:49], v131 offset:32768
    v_mfma_f32_16x16x32_bf16 v[32:35], v[64:67], v[88:91], v[32:35]
    ds_read_b64_tr_b16 v[50:51], v131 offset:34816
    ds_read_b64_tr_b16 v[52:53], v133 offset:32768
    v_mfma_f32_16x16x32_bf16 v[20:23], v[68:71], v[84:87], v[20:23]
    ds_read_b64_tr_b16 v[54:55], v133 offset:34816
    v_mfma_f32_16x16x32_bf16 v[36:39], v[68:71], v[88:91], v[36:39]
    ds_read_b64_tr_b16 v[56:57], v135 offset:32768
    v_mfma_f32_16x16x32_bf16 v[24:27], v[72:75], v[84:87], v[24:27]
    ds_read_b64_tr_b16 v[58:59], v135 offset:34816
    v_mfma_f32_16x16x32_bf16 v[40:43], v[72:75], v[88:91], v[40:43]
    s_add_u32 s62, s67, 10240
    buffer_load_dwordx4 v[84:87], v128, s[44:47], s62 offen sc1
    s_add_u32 s62, s67, 68608
    buffer_load_dwordx4 v[88:91], v128, s[44:47], s62 offen sc1
    s_waitcnt lgkmcnt(0)
    s_barrier
    s_waitcnt vmcnt(8)
    v_mfma_f32_16x16x32_bf16 v[12:15], v[44:47], v[92:95], v[12:15]
    ds_read_b64_tr_b16 v[60:61], v129 offset:49152
    v_mfma_f32_16x16x32_bf16 v[28:31], v[44:47], v[96:99], v[28:31]
    ds_read_b64_tr_b16 v[62:63], v129 offset:51200
    v_mfma_f32_16x16x32_bf16 v[16:19], v[48:51], v[92:95], v[16:19]
    ds_read_b64_tr_b16 v[64:65], v131 offset:49152
    v_mfma_f32_16x16x32_bf16 v[32:35], v[48:51], v[96:99], v[32:35]
    ds_read_b64_tr_b16 v[66:67], v131 offset:51200
    ds_read_b64_tr_b16 v[68:69], v133 offset:49152
    v_mfma_f32_16x16x32_bf16 v[20:23], v[52:55], v[92:95], v[20:23]
    ds_read_b64_tr_b16 v[70:71], v133 offset:51200
    v_mfma_f32_16x16x32_bf16 v[36:39], v[52:55], v[96:99], v[36:39]
    ds_read_b64_tr_b16 v[72:73], v135 offset:49152
    v_mfma_f32_16x16x32_bf16 v[24:27], v[56:59], v[92:95], v[24:27]
    ds_read_b64_tr_b16 v[74:75], v135 offset:51200
    v_mfma_f32_16x16x32_bf16 v[40:43], v[56:59], v[96:99], v[40:43]
    s_add_u32 s62, s67, 11264
    buffer_load_dwordx4 v[92:95], v128, s[44:47], s62 offen sc1
    s_add_u32 s62, s67, 69632
    buffer_load_dwordx4 v[96:99], v128, s[44:47], s62 offen sc1
    s_waitcnt lgkmcnt(0)
    s_barrier
    s_waitcnt vmcnt(8)
    v_mfma_f32_16x16x32_bf16 v[12:15], v[60:63], v[100:103], v[12:15]
    ds_read_b64_tr_b16 v[44:45], v130 offset:0
    v_mfma_f32_16x16x32_bf16 v[28:31], v[60:63], v[104:107], v[28:31]
    ds_read_b64_tr_b16 v[46:47], v130 offset:2048
    v_mfma_f32_16x16x32_bf16 v[16:19], v[64:67], v[100:103], v[16:19]
    ds_read_b64_tr_b16 v[48:49], v132 offset:0
    v_mfma_f32_16x16x32_bf16 v[32:35], v[64:67], v[104:107], v[32:35]
    ds_read_b64_tr_b16 v[50:51], v132 offset:2048
    ds_read_b64_tr_b16 v[52:53], v134 offset:0
    v_mfma_f32_16x16x32_bf16 v[20:23], v[68:71], v[100:103], v[20:23]
    ds_read_b64_tr_b16 v[54:55], v134 offset:2048
    v_mfma_f32_16x16x32_bf16 v[36:39], v[68:71], v[104:107], v[36:39]
    ds_read_b64_tr_b16 v[56:57], v136 offset:0
    v_mfma_f32_16x16x32_bf16 v[24:27], v[72:75], v[100:103], v[24:27]
    ds_read_b64_tr_b16 v[58:59], v136 offset:2048
    v_mfma_f32_16x16x32_bf16 v[40:43], v[72:75], v[104:107], v[40:43]
    s_add_u32 s62, s67, 12288
    buffer_load_dwordx4 v[100:103], v128, s[44:47], s62 offen sc1
    s_add_u32 s62, s67, 70656
    buffer_load_dwordx4 v[104:107], v128, s[44:47], s62 offen sc1
    s_waitcnt lgkmcnt(0)
    s_barrier
    s_waitcnt vmcnt(8)
    v_mfma_f32_16x16x32_bf16 v[12:15], v[44:47], v[108:111], v[12:15]
    ds_read_b64_tr_b16 v[60:61], v124 offset:0
    v_mfma_f32_16x16x32_bf16 v[28:31], v[44:47], v[112:115], v[28:31]
    ds_read_b64_tr_b16 v[62:63], v124 offset:2048
    v_mfma_f32_16x16x32_bf16 v[16:19], v[48:51], v[108:111], v[16:19]
    ds_read_b64_tr_b16 v[64:65], v125 offset:0
    v_mfma_f32_16x16x32_bf16 v[32:35], v[48:51], v[112:115], v[32:35]
    ds_read_b64_tr_b16 v[66:67], v125 offset:2048
    ds_read_b64_tr_b16 v[68:69], v126 offset:0
    v_mfma_f32_16x16x32_bf16 v[20:23], v[52:55], v[108:111], v[20:23]
    ds_read_b64_tr_b16 v[70:71], v126 offset:2048
    v_mfma_f32_16x16x32_bf16 v[36:39], v[52:55], v[112:115], v[36:39]
    ds_read_b64_tr_b16 v[72:73], v127 offset:0
    v_mfma_f32_16x16x32_bf16 v[24:27], v[56:59], v[108:111], v[24:27]
    ds_read_b64_tr_b16 v[74:75], v127 offset:2048
    v_mfma_f32_16x16x32_bf16 v[40:43], v[56:59], v[112:115], v[40:43]
    s_add_u32 s62, s67, 13312
    buffer_load_dwordx4 v[108:111], v128, s[44:47], s62 offen sc1
    s_add_u32 s62, s67, 71680
    buffer_load_dwordx4 v[112:115], v128, s[44:47], s62 offen sc1
    s_waitcnt lgkmcnt(0)
    s_barrier
    s_waitcnt vmcnt(8)
    v_mfma_f32_16x16x32_bf16 v[12:15], v[60:63], v[116:119], v[12:15]
    ds_read_b64_tr_b16 v[44:45], v124 offset:16384
    v_mfma_f32_16x16x32_bf16 v[28:31], v[60:63], v[120:123], v[28:31]
    ds_read_b64_tr_b16 v[46:47], v124 offset:18432
    v_mfma_f32_16x16x32_bf16 v[16:19], v[64:67], v[116:119], v[16:19]
    ds_read_b64_tr_b16 v[48:49], v125 offset:16384
    v_mfma_f32_16x16x32_bf16 v[32:35], v[64:67], v[120:123], v[32:35]
    ds_read_b64_tr_b16 v[50:51], v125 offset:18432
    ds_read_b64_tr_b16 v[52:53], v126 offset:16384
    v_mfma_f32_16x16x32_bf16 v[20:23], v[68:71], v[116:119], v[20:23]
    ds_read_b64_tr_b16 v[54:55], v126 offset:18432
    v_mfma_f32_16x16x32_bf16 v[36:39], v[68:71], v[120:123], v[36:39]
    ds_read_b64_tr_b16 v[56:57], v127 offset:16384
    v_mfma_f32_16x16x32_bf16 v[24:27], v[72:75], v[116:119], v[24:27]
    ds_read_b64_tr_b16 v[58:59], v127 offset:18432
    v_mfma_f32_16x16x32_bf16 v[40:43], v[72:75], v[120:123], v[40:43]
    s_waitcnt lgkmcnt(0)
    s_barrier
    s_waitcnt vmcnt(6)
    v_mfma_f32_16x16x32_bf16 v[12:15], v[44:47], v[84:87], v[12:15]
    ds_read_b64_tr_b16 v[60:61], v124 offset:32768
    v_mfma_f32_16x16x32_bf16 v[28:31], v[44:47], v[88:91], v[28:31]
    ds_read_b64_tr_b16 v[62:63], v124 offset:34816
    v_mfma_f32_16x16x32_bf16 v[16:19], v[48:51], v[84:87], v[16:19]
    ds_read_b64_tr_b16 v[64:65], v125 offset:32768
    v_mfma_f32_16x16x32_bf16 v[32:35], v[48:51], v[88:91], v[32:35]
    ds_read_b64_tr_b16 v[66:67], v125 offset:34816
    ds_read_b64_tr_b16 v[68:69], v126 offset:32768
    v_mfma_f32_16x16x32_bf16 v[20:23], v[52:55], v[84:87], v[20:23]
    ds_read_b64_tr_b16 v[70:71], v126 offset:34816
    v_mfma_f32_16x16x32_bf16 v[36:39], v[52:55], v[88:91], v[36:39]
    ds_read_b64_tr_b16 v[72:73], v127 offset:32768
    v_mfma_f32_16x16x32_bf16 v[24:27], v[56:59], v[84:87], v[24:27]
    ds_read_b64_tr_b16 v[74:75], v127 offset:34816
    v_mfma_f32_16x16x32_bf16 v[40:43], v[56:59], v[88:91], v[40:43]
    s_waitcnt lgkmcnt(0)
    s_barrier
    s_waitcnt vmcnt(4)
    v_mfma_f32_16x16x32_bf16 v[12:15], v[60:63], v[92:95], v[12:15]
    ds_read_b64_tr_b16 v[44:45], v124 offset:49152
    v_mfma_f32_16x16x32_bf16 v[28:31], v[60:63], v[96:99], v[28:31]
    ds_read_b64_tr_b16 v[46:47], v124 offset:51200
    v_mfma_f32_16x16x32_bf16 v[16:19], v[64:67], v[92:95], v[16:19]
    ds_read_b64_tr_b16 v[48:49], v125 offset:49152
    v_mfma_f32_16x16x32_bf16 v[32:35], v[64:67], v[96:99], v[32:35]
    ds_read_b64_tr_b16 v[50:51], v125 offset:51200
    ds_read_b64_tr_b16 v[52:53], v126 offset:49152
    v_mfma_f32_16x16x32_bf16 v[20:23], v[68:71], v[92:95], v[20:23]
    ds_read_b64_tr_b16 v[54:55], v126 offset:51200
    v_mfma_f32_16x16x32_bf16 v[36:39], v[68:71], v[96:99], v[36:39]
    ds_read_b64_tr_b16 v[56:57], v127 offset:49152
    v_mfma_f32_16x16x32_bf16 v[24:27], v[72:75], v[92:95], v[24:27]
    ds_read_b64_tr_b16 v[58:59], v127 offset:51200
    v_mfma_f32_16x16x32_bf16 v[40:43], v[72:75], v[96:99], v[40:43]
    s_waitcnt lgkmcnt(0)
    s_barrier
    s_waitcnt vmcnt(2)
    v_mfma_f32_16x16x32_bf16 v[12:15], v[44:47], v[100:103], v[12:15]
    ds_read_b64_tr_b16 v[60:61], v129 offset:0
    v_mfma_f32_16x16x32_bf16 v[28:31], v[44:47], v[104:107], v[28:31]
    ds_read_b64_tr_b16 v[62:63], v129 offset:2048
    v_mfma_f32_16x16x32_bf16 v[16:19], v[48:51], v[100:103], v[16:19]
    ds_read_b64_tr_b16 v[64:65], v131 offset:0
    v_mfma_f32_16x16x32_bf16 v[32:35], v[48:51], v[104:107], v[32:35]
    ds_read_b64_tr_b16 v[66:67], v131 offset:2048
    ds_read_b64_tr_b16 v[68:69], v133 offset:0
    v_mfma_f32_16x16x32_bf16 v[20:23], v[52:55], v[100:103], v[20:23]
    ds_read_b64_tr_b16 v[70:71], v133 offset:2048
    v_mfma_f32_16x16x32_bf16 v[36:39], v[52:55], v[104:107], v[36:39]
    ds_read_b64_tr_b16 v[72:73], v135 offset:0
    v_mfma_f32_16x16x32_bf16 v[24:27], v[56:59], v[100:103], v[24:27]
    ds_read_b64_tr_b16 v[74:75], v135 offset:2048
    v_mfma_f32_16x16x32_bf16 v[40:43], v[56:59], v[104:107], v[40:43]
    s_waitcnt lgkmcnt(0)
    s_waitcnt vmcnt(0)
    v_mfma_f32_16x16x32_bf16 v[12:15], v[60:63], v[108:111], v[12:15]
    v_mfma_f32_16x16x32_bf16 v[28:31], v[60:63], v[112:115], v[28:31]
    v_mfma_f32_16x16x32_bf16 v[16:19], v[64:67], v[108:111], v[16:19]
    v_mfma_f32_16x16x32_bf16 v[32:35], v[64:67], v[112:115], v[32:35]
    v_mfma_f32_16x16x32_bf16 v[20:23], v[68:71], v[108:111], v[20:23]
    v_mfma_f32_16x16x32_bf16 v[36:39], v[68:71], v[112:115], v[36:39]
    v_mfma_f32_16x16x32_bf16 v[24:27], v[72:75], v[108:111], v[24:27]
    v_mfma_f32_16x16x32_bf16 v[40:43], v[72:75], v[112:115], v[40:43]
    s_waitcnt lgkmcnt(0)
    s_barrier
    s_lshl_b32 s62, s7, 1
    s_add_u32 s62, s62, s8
    s_mul_i32 s62, s62, 8704
    s_add_u32 s62, s62, 90112
    v_mul_u32_u24 v137, 272, v3
    v_lshl_add_u32 v137, v2, 4, v137
    v_add_u32 v137, s62, v137
    ds_write_b128 v137, v[12:15] offset:0
    ds_write_b128 v137, v[16:19] offset:64
    ds_write_b128 v137, v[20:23] offset:128
    ds_write_b128 v137, v[24:27] offset:192
    ds_write_b128 v137, v[28:31] offset:4352
    ds_write_b128 v137, v[32:35] offset:4416
    ds_write_b128 v137, v[36:39] offset:4480
    ds_write_b128 v137, v[40:43] offset:4544
    s_mul_i32 s62, s8, 8704
    s_add_u32 s62, s62, 90112
    v_lshrrev_b32 v138, 3, v1
    s_lshl_b32 s63, s7, 3
    v_add_u32 v138, s63, v138
    v_mul_u32_u24 v138, 272, v138
    v_and_b32 v137, 7, v1
    v_lshl_add_u32 v138, v137, 5, v138
    v_add_u32 v138, s62, v138
    s_waitcnt lgkmcnt(0)
    s_barrier
    ds_read_b128 v[44:47], v138 offset:0
    ds_read_b128 v[48:51], v138 offset:16
    ds_read_b128 v[52:55], v138 offset:17408
    ds_read_b128 v[56:59], v138 offset:17424
    ds_read_b128 v[60:63], v138 offset:34816
    ds_read_b128 v[64:67], v138 offset:34832
    ds_read_b128 v[68:71], v138 offset:52224
    ds_read_b128 v[72:75], v138 offset:52240
    s_waitcnt lgkmcnt(4)
    v_pk_add_f32 v[44:45], v[44:45], v[52:53]
    v_pk_add_f32 v[46:47], v[46:47], v[54:55]
    v_pk_add_f32 v[48:49], v[48:49], v[56:57]
    v_pk_add_f32 v[50:51], v[50:51], v[58:59]
    s_waitcnt lgkmcnt(0)
    v_pk_add_f32 v[60:61], v[60:61], v[68:69]
    v_pk_add_f32 v[62:63], v[62:63], v[70:71]
    v_pk_add_f32 v[64:65], v[64:65], v[72:73]
    v_pk_add_f32 v[66:67], v[66:67], v[74:75]
    v_pk_add_f32 v[44:45], v[44:45], v[60:61]
    v_pk_add_f32 v[46:47], v[46:47], v[62:63]
    v_pk_add_f32 v[48:49], v[48:49], v[64:65]
    v_pk_add_f32 v[50:51], v[50:51], v[66:67]
    s_waitcnt vmcnt(0)
    v_lshlrev_b32 v52, 16, v80
    v_and_b32 v53, 0xffff0000, v80
    v_lshlrev_b32 v54, 16, v81
    v_and_b32 v55, 0xffff0000, v81
    v_lshlrev_b32 v56, 16, v82
    v_and_b32 v57, 0xffff0000, v82
    v_lshlrev_b32 v58, 16, v83
    v_and_b32 v59, 0xffff0000, v83
    v_pk_add_f32 v[44:45], v[44:45], v[52:53]
    v_pk_add_f32 v[46:47], v[46:47], v[54:55]
    v_pk_add_f32 v[48:49], v[48:49], v[56:57]
    v_pk_add_f32 v[50:51], v[50:51], v[58:59]
    v_cvt_pk_bf16_f32 v60, v44, v45
    v_cvt_pk_bf16_f32 v61, v46, v47
    v_cvt_pk_bf16_f32 v62, v48, v49
    v_cvt_pk_bf16_f32 v63, v50, v51
    v_lshlrev_b32 v44, 16, v60
    v_and_b32 v45, 0xffff0000, v60
    v_lshlrev_b32 v52, 16, v76
    v_and_b32 v53, 0xffff0000, v76
    v_lshlrev_b32 v46, 16, v61
    v_and_b32 v47, 0xffff0000, v61
    v_lshlrev_b32 v54, 16, v77
    v_and_b32 v55, 0xffff0000, v77
    v_lshlrev_b32 v48, 16, v62
    v_and_b32 v49, 0xffff0000, v62
    v_lshlrev_b32 v56, 16, v78
    v_and_b32 v57, 0xffff0000, v78
    v_lshlrev_b32 v50, 16, v63
    v_and_b32 v51, 0xffff0000, v63
    v_lshlrev_b32 v58, 16, v79
    v_and_b32 v59, 0xffff0000, v79
    v_pk_add_f32 v[44:45], v[44:45], v[52:53]
    v_pk_add_f32 v[46:47], v[46:47], v[54:55]
    v_pk_add_f32 v[48:49], v[48:49], v[56:57]
    v_pk_add_f32 v[50:51], v[50:51], v[58:59]
    v_cvt_pk_bf16_f32 v60, v44, v45
    v_cvt_pk_bf16_f32 v61, v46, v47
    v_cvt_pk_bf16_f32 v62, v48, v49
    v_cvt_pk_bf16_f32 v63, v50, v51
    buffer_store_dwordx4 v[60:63], v7, s[56:59], s65 offen
    s_mov_b32 s62, 0x3f803f80
    v_mov_b32 v68, 0
    v_mov_b32 v69, 0
    v_dot2c_f32_bf16 v68, s62, v60
    v_dot2c_f32_bf16 v69, v60, v60
    v_dot2c_f32_bf16 v68, s62, v61
    v_dot2c_f32_bf16 v69, v61, v61
    v_dot2c_f32_bf16 v68, s62, v62
    v_dot2c_f32_bf16 v69, v62, v62
    v_dot2c_f32_bf16 v68, s62, v63
    v_dot2c_f32_bf16 v69, v63, v63
    s_nop 1
    v_add_f32_dpp v68, v68, v68 quad_perm:[1,0,3,2] row_mask:0xf bank_mask:0xf
    v_add_f32_dpp v69, v69, v69 quad_perm:[1,0,3,2] row_mask:0xf bank_mask:0xf
    s_nop 0
    v_add_f32_dpp v68, v68, v68 quad_perm:[2,3,0,1] row_mask:0xf bank_mask:0xf
    v_add_f32_dpp v69, v69, v69 quad_perm:[2,3,0,1] row_mask:0xf bank_mask:0xf
    s_nop 0
    v_add_f32_dpp v68, v68, v68 row_half_mirror row_mask:0xf bank_mask:0xf
    v_add_f32_dpp v69, v69, v69 row_half_mirror row_mask:0xf bank_mask:0xf
    s_add_u32 s40, s38, 0x14c0000
    s_addc_u32 s41, s39, 0
    s_mov_b32 s42, 0x20000
    s_mov_b32 s43, 0x00020000
    v_lshrrev_b32 v137, 3, v1
    v_lshlrev_b32 v137, 6, v137
    s_lshl_b32 s62, s60, 3
    s_add_u32 s62, s62, s4
    s_lshl_b32 s62, s62, 6
    s_add_u32 s62, s62, s61
    s_lshl_b32 s62, s62, 3
    s_mov_b32 exec_lo, 0x01010101
    s_mov_b32 exec_hi, 0x01010101
    buffer_store_dwordx2 v[68:69], v137, s[40:43], s62 offen
    s_mov_b64 exec, -1
    v_mov_b32 v4, 163808
    v_mov_b32 v5, 1
    s_add_u32 s72, s38, 0x1580000
    s_addc_u32 s73, s39, 0
    s_mov_b32 s74, 0x3000
    s_mov_b32 s75, 0x00020000
    s_waitcnt vmcnt(0) lgkmcnt(0)
    s_mov_b64 exec, 1
    ds_add_rtn_u32 v5, v4, v5
    s_waitcnt lgkmcnt(0)
    s_mov_b64 exec, -1
    v_readfirstlane_b32 s70, v5
    s_nop 3
    s_and_b32 s70, s70, 7
    s_cmp_lg_u32 s70, 7
    s_cbranch_scc1 Lsg_132
    s_lshl_b32 s70, s5, 6
    s_add_u32 s70, s70, s6
    s_lshl_b32 s70, s70, 2
    v_mov_b32 v4, 5
    v_mov_b32 v5, 0
    s_mov_b64 exec, 1
    buffer_store_dword v4, v5, s[72:75], s70 offen
    s_mov_b64 exec, -1
    s_nop 1
Lsg_132:
    s_nop 7
    s_nop 7
    s_barrier
    s_lshl_b32 s63, s5, 2
    s_add_u32 s63, s63, s7
    s_mul_i32 s65, s63, 67584
    s_lshl_b32 s63, s63, 11
    s_lshl_b32 s62, s6, 1
    s_add_u32 s62, s62, s8
    s_lshl_b32 s60, s62, 10
    s_add_u32 s65, s65, s60
    v_mov_b32 v44, 0x3f803f80
    v_mov_b32 v45, 0x3f803f80
    v_mov_b32 v46, 0x3f803f80
    v_mov_b32 v47, 0x3f803f80
    v_lshlrev_b32 v5, 7, v2
    v_and_b32 v4, 4, v3
    v_lshl_add_u32 v5, v4, 2, v5
    v_and_b32 v4, 3, v3
    v_lshl_add_u32 v5, v4, 1, v5
    s_mov_b32 s48, s20
    s_mov_b32 s49, s21
    s_mov_b32 s50, 0x4000
    s_mov_b32 s51, 0x00020000
    s_mov_b32 s52, s38
    s_mov_b32 s53, s39
    s_mov_b32 s54, 0x420000
    s_mov_b32 s55, 0x00020000
    s_add_u32 s56, s38, 0x1411000
    s_addc_u32 s57, s39, 0
    s_mov_b32 s58, 0x11000
    s_mov_b32 s59, 0x00020000
    s_lshl_b32 s60, s62, 9
    buffer_load_ushort v48, v5, s[48:51], s60 offen offset:0
    buffer_load_ushort v49, v5, s[48:51], s60 offen offset:32
    buffer_load_ushort v50, v5, s[48:51], s60 offen offset:64
    buffer_load_ushort v51, v5, s[48:51], s60 offen offset:96
    buffer_load_ushort v52, v5, s[48:51], s60 offen offset:8
    buffer_load_ushort v53, v5, s[48:51], s60 offen offset:40
    buffer_load_ushort v54, v5, s[48:51], s60 offen offset:72
    buffer_load_ushort v55, v5, s[48:51], s60 offen offset:104
    s_add_u32 s40, s38, 0x14c0000
    s_addc_u32 s41, s39, 0
    s_mov_b32 s42, 0x20000
    s_mov_b32 s43, 0x00020000
    s_mul_i32 s66, s8, 3072
    s_lshl_b32 s79, s7, 12
    v_lshlrev_b32 v140, 4, v1
    v_add_u32 v142, s79, v140
    v_add_u32 v143, 0x10000, v142
    v_add_u32 v144, 0x20000, v142
    v_lshlrev_b32 v140, 4, v1
    v_add_u32 v145, s66, v140
    v_add_u32 v146, 0x10000, v145
    s_lshl_b32 s79, s4, 8
    s_add_u32 s79, s79, 143360
    v_lshlrev_b32 v147, 4, v2
    v_add_u32 v147, s79, v147
    s_barrier
    ds_read_b128 v[72:75], v143 offset:20480
    ds_read_b128 v[76:79], v143 offset:22528
    ds_read_b128 v[80:83], v145 offset:0
    ds_read_b128 v[84:87], v145 offset:1024
    ds_read_b128 v[88:91], v145 offset:2048
    ds_read_b128 v[92:95], v143 offset:21504
    ds_read_b128 v[96:99], v143 offset:23552
    ds_read_b128 v[100:103], v145 offset:6144
    ds_read_b128 v[104:107], v145 offset:7168
    ds_read_b128 v[108:111], v145 offset:8192
    s_waitcnt lgkmcnt(5)
    s_waitcnt lgkmcnt(0)
    s_barrier
    v_mfma_f32_16x16x32_bf16 v[8:11], v[80:83], v[72:75], 0
    ds_read_b128 v[112:115], v143 offset:36864
    v_mfma_f32_16x16x32_bf16 v[20:23], v[80:83], v[76:79], 0
    ds_read_b128 v[116:119], v143 offset:38912
    v_mfma_f32_16x16x32_bf16 v[12:15], v[84:87], v[72:75], 0
    ds_read_b128 v[120:123], v145 offset:12288
    v_mfma_f32_16x16x32_bf16 v[24:27], v[84:87], v[76:79], 0
    ds_read_b128 v[124:127], v145 offset:13312
    v_mfma_f32_16x16x32_bf16 v[16:19], v[88:91], v[72:75], 0
    ds_read_b128 v[128:131], v145 offset:14336
    v_mfma_f32_16x16x32_bf16 v[28:31], v[88:91], v[76:79], 0
    v_mfma_f32_16x16x32_bf16 v[8:11], v[100:103], v[92:95], v[8:11]
    ds_read_b128 v[72:75], v143 offset:37888
    v_mfma_f32_16x16x32_bf16 v[20:23], v[100:103], v[96:99], v[20:23]
    ds_read_b128 v[76:79], v143 offset:39936
    v_mfma_f32_16x16x32_bf16 v[12:15], v[104:107], v[92:95], v[12:15]
    ds_read_b128 v[80:83], v145 offset:18432
    v_mfma_f32_16x16x32_bf16 v[24:27], v[104:107], v[96:99], v[24:27]
    ds_read_b128 v[84:87], v145 offset:19456
    v_mfma_f32_16x16x32_bf16 v[16:19], v[108:111], v[92:95], v[16:19]
    ds_read_b128 v[88:91], v145 offset:20480
    v_mfma_f32_16x16x32_bf16 v[28:31], v[108:111], v[96:99], v[28:31]
    s_waitcnt lgkmcnt(5)
    s_waitcnt lgkmcnt(0)
    s_barrier
    v_mfma_f32_16x16x32_bf16 v[8:11], v[120:123], v[112:115], v[8:11]
    ds_read_b128 v[92:95], v143 offset:53248
    v_mfma_f32_16x16x32_bf16 v[20:23], v[120:123], v[116:119], v[20:23]
    ds_read_b128 v[96:99], v143 offset:55296
    v_mfma_f32_16x16x32_bf16 v[12:15], v[124:127], v[112:115], v[12:15]
    ds_read_b128 v[100:103], v145 offset:24576
    v_mfma_f32_16x16x32_bf16 v[24:27], v[124:127], v[116:119], v[24:27]
    ds_read_b128 v[104:107], v145 offset:25600
    v_mfma_f32_16x16x32_bf16 v[16:19], v[128:131], v[112:115], v[16:19]
    ds_read_b128 v[108:111], v145 offset:26624
    v_mfma_f32_16x16x32_bf16 v[28:31], v[128:131], v[116:119], v[28:31]
    v_mfma_f32_16x16x32_bf16 v[8:11], v[80:83], v[72:75], v[8:11]
    ds_read_b128 v[112:115], v143 offset:54272
    v_mfma_f32_16x16x32_bf16 v[20:23], v[80:83], v[76:79], v[20:23]
    ds_read_b128 v[116:119], v143 offset:56320
    v_mfma_f32_16x16x32_bf16 v[12:15], v[84:87], v[72:75], v[12:15]
    ds_read_b128 v[120:123], v145 offset:30720
    v_mfma_f32_16x16x32_bf16 v[24:27], v[84:87], v[76:79], v[24:27]
    ds_read_b128 v[124:127], v145 offset:31744
    v_mfma_f32_16x16x32_bf16 v[16:19], v[88:91], v[72:75], v[16:19]
    ds_read_b128 v[128:131], v145 offset:32768
    v_mfma_f32_16x16x32_bf16 v[28:31], v[88:91], v[76:79], v[28:31]
    s_waitcnt lgkmcnt(5)
    s_waitcnt lgkmcnt(0)
    s_barrier
    v_mfma_f32_16x16x32_bf16 v[8:11], v[100:103], v[92:95], v[8:11]
    ds_read_b128 v[72:75], v144 offset:4096
    v_mfma_f32_16x16x32_bf16 v[20:23], v[100:103], v[96:99], v[20:23]
    ds_read_b128 v[76:79], v144 offset:6144
    v_mfma_f32_16x16x32_bf16 v[12:15], v[104:107], v[92:95], v[12:15]
    ds_read_b128 v[80:83], v145 offset:36864
    v_mfma_f32_16x16x32_bf16 v[24:27], v[104:107], v[96:99], v[24:27]
    ds_read_b128 v[84:87], v145 offset:37888
    v_mfma_f32_16x16x32_bf16 v[16:19], v[108:111], v[92:95], v[16:19]
    ds_read_b128 v[88:91], v145 offset:38912
    v_mfma_f32_16x16x32_bf16 v[28:31], v[108:111], v[96:99], v[28:31]
    v_mfma_f32_16x16x32_bf16 v[8:11], v[120:123], v[112:115], v[8:11]
    ds_read_b128 v[92:95], v144 offset:5120
    v_mfma_f32_16x16x32_bf16 v[20:23], v[120:123], v[116:119], v[20:23]
    ds_read_b128 v[96:99], v144 offset:7168
    v_mfma_f32_16x16x32_bf16 v[12:15], v[124:127], v[112:115], v[12:15]
    ds_read_b128 v[100:103], v145 offset:43008
    v_mfma_f32_16x16x32_bf16 v[24:27], v[124:127], v[116:119], v[24:27]
    ds_read_b128 v[104:107], v145 offset:44032
    v_mfma_f32_16x16x32_bf16 v[16:19], v[128:131], v[112:115], v[16:19]
    ds_read_b128 v[108:111], v145 offset:45056
    v_mfma_f32_16x16x32_bf16 v[28:31], v[128:131], v[116:119], v[28:31]
    s_waitcnt lgkmcnt(5)
    s_waitcnt lgkmcnt(0)
    s_barrier
    v_mfma_f32_16x16x32_bf16 v[8:11], v[80:83], v[72:75], v[8:11]
    ds_read_b128 v[112:115], v143 offset:20480
    v_mfma_f32_16x16x32_bf16 v[20:23], v[80:83], v[76:79], v[20:23]
    ds_read_b128 v[116:119], v143 offset:22528
    v_mfma_f32_16x16x32_bf16 v[12:15], v[84:87], v[72:75], v[12:15]
    ds_read_b128 v[120:123], v145 offset:49152
    v_mfma_f32_16x16x32_bf16 v[24:27], v[84:87], v[76:79], v[24:27]
    ds_read_b128 v[124:127], v145 offset:50176
    v_mfma_f32_16x16x32_bf16 v[16:19], v[88:91], v[72:75], v[16:19]
    ds_read_b128 v[128:131], v145 offset:51200
    v_mfma_f32_16x16x32_bf16 v[28:31], v[88:91], v[76:79], v[28:31]
    v_mfma_f32_16x16x32_bf16 v[8:11], v[100:103], v[92:95], v[8:11]
    ds_read_b128 v[72:75], v143 offset:21504
    v_mfma_f32_16x16x32_bf16 v[20:23], v[100:103], v[96:99], v[20:23]
    ds_read_b128 v[76:79], v143 offset:23552
    v_mfma_f32_16x16x32_bf16 v[12:15], v[104:107], v[92:95], v[12:15]
    ds_read_b128 v[80:83], v145 offset:55296
    v_mfma_f32_16x16x32_bf16 v[24:27], v[104:107], v[96:99], v[24:27]
    ds_read_b128 v[84:87], v145 offset:56320
    v_mfma_f32_16x16x32_bf16 v[16:19], v[108:111], v[92:95], v[16:19]
    ds_read_b128 v[88:91], v145 offset:57344
    v_mfma_f32_16x16x32_bf16 v[28:31], v[108:111], v[96:99], v[28:31]
    s_waitcnt vmcnt(0)
    v_cmp_gt_u32 vcc, 8, v3
    v_lshl_or_b32 v4, v49, 16, v48
    v_lshl_or_b32 v5, v51, 16, v50
    v_cndmask_b32 v56, 0, v4, vcc
    v_cndmask_b32 v57, 0, v5, vcc
    v_cndmask_b32 v58, v4, 0, vcc
    v_cndmask_b32 v59, v5, 0, vcc
    v_lshl_or_b32 v4, v53, 16, v52
    v_lshl_or_b32 v5, v55, 16, v54
    v_cndmask_b32 v60, 0, v4, vcc
    v_cndmask_b32 v61, 0, v5, vcc
    v_cndmask_b32 v62, v4, 0, vcc
    v_cndmask_b32 v63, v5, 0, vcc
    s_waitcnt lgkmcnt(5)
    s_waitcnt lgkmcnt(0)
    s_barrier
    v_mfma_f32_16x16x32_bf16 v[8:11], v[120:123], v[112:115], v[8:11]
    ds_read_b128 v[92:95], v143 offset:36864
    v_mfma_f32_16x16x32_bf16 v[20:23], v[120:123], v[116:119], v[20:23]
    ds_read_b128 v[96:99], v143 offset:38912
    v_mfma_f32_16x16x32_bf16 v[12:15], v[124:127], v[112:115], v[12:15]
    ds_read_b128 v[100:103], v145 offset:61440
    v_mfma_f32_16x16x32_bf16 v[24:27], v[124:127], v[116:119], v[24:27]
    ds_read_b128 v[104:107], v145 offset:62464
    v_mfma_f32_16x16x32_bf16 v[16:19], v[128:131], v[112:115], v[16:19]
    ds_read_b128 v[108:111], v145 offset:63488
    v_mfma_f32_16x16x32_bf16 v[28:31], v[128:131], v[116:119], v[28:31]
    v_mfma_f32_16x16x32_bf16 v[8:11], v[80:83], v[72:75], v[8:11]
    ds_read_b128 v[112:115], v143 offset:37888
    v_mfma_f32_16x16x32_bf16 v[20:23], v[80:83], v[76:79], v[20:23]
    ds_read_b128 v[116:119], v143 offset:39936
    v_mfma_f32_16x16x32_bf16 v[12:15], v[84:87], v[72:75], v[12:15]
    ds_read_b128 v[120:123], v146 offset:2048
    v_mfma_f32_16x16x32_bf16 v[24:27], v[84:87], v[76:79], v[24:27]
    ds_read_b128 v[124:127], v146 offset:3072
    v_mfma_f32_16x16x32_bf16 v[16:19], v[88:91], v[72:75], v[16:19]
    ds_read_b128 v[128:131], v146 offset:4096
    v_mfma_f32_16x16x32_bf16 v[28:31], v[88:91], v[76:79], v[28:31]
    s_waitcnt lgkmcnt(5)
    s_waitcnt lgkmcnt(0)
    s_barrier
    v_mfma_f32_16x16x32_bf16 v[8:11], v[100:103], v[92:95], v[8:11]
    ds_read_b128 v[72:75], v143 offset:53248
    v_mfma_f32_16x16x32_bf16 v[20:23], v[100:103], v[96:99], v[20:23]
    ds_read_b128 v[76:79], v143 offset:55296
    v_mfma_f32_16x16x32_bf16 v[12:15], v[104:107], v[92:95], v[12:15]
    ds_read_b128 v[80:83], v146 offset:8192
    v_mfma_f32_16x16x32_bf16 v[24:27], v[104:107], v[96:99], v[24:27]
    ds_read_b128 v[84:87], v146 offset:9216
    v_mfma_f32_16x16x32_bf16 v[16:19], v[108:111], v[92:95], v[16:19]
    ds_read_b128 v[88:91], v146 offset:10240
    v_mfma_f32_16x16x32_bf16 v[28:31], v[108:111], v[96:99], v[28:31]
    v_mfma_f32_16x16x32_bf16 v[8:11], v[120:123], v[112:115], v[8:11]
    ds_read_b128 v[92:95], v143 offset:54272
    v_mfma_f32_16x16x32_bf16 v[20:23], v[120:123], v[116:119], v[20:23]
    ds_read_b128 v[96:99], v143 offset:56320
    v_mfma_f32_16x16x32_bf16 v[12:15], v[124:127], v[112:115], v[12:15]
    ds_read_b128 v[100:103], v146 offset:14336
    v_mfma_f32_16x16x32_bf16 v[24:27], v[124:127], v[116:119], v[24:27]
    ds_read_b128 v[104:107], v146 offset:15360
    v_mfma_f32_16x16x32_bf16 v[16:19], v[128:131], v[112:115], v[16:19]
    ds_read_b128 v[108:111], v146 offset:16384
    v_mfma_f32_16x16x32_bf16 v[28:31], v[128:131], v[116:119], v[28:31]
    s_waitcnt lgkmcnt(5)
    s_waitcnt lgkmcnt(0)
    s_barrier
    v_mfma_f32_16x16x32_bf16 v[8:11], v[80:83], v[72:75], v[8:11]
    ds_read_b128 v[112:115], v144 offset:4096
    v_mfma_f32_16x16x32_bf16 v[20:23], v[80:83], v[76:79], v[20:23]
    ds_read_b128 v[116:119], v144 offset:6144
    v_mfma_f32_16x16x32_bf16 v[12:15], v[84:87], v[72:75], v[12:15]
    ds_read_b128 v[120:123], v145 offset:0
    v_mfma_f32_16x16x32_bf16 v[24:27], v[84:87], v[76:79], v[24:27]
    ds_read_b128 v[124:127], v145 offset:1024
    v_mfma_f32_16x16x32_bf16 v[16:19], v[88:91], v[72:75], v[16:19]
    ds_read_b128 v[128:131], v145 offset:2048
    v_mfma_f32_16x16x32_bf16 v[28:31], v[88:91], v[76:79], v[28:31]
    v_mfma_f32_16x16x32_bf16 v[8:11], v[100:103], v[92:95], v[8:11]
    ds_read_b128 v[72:75], v144 offset:5120
    v_mfma_f32_16x16x32_bf16 v[20:23], v[100:103], v[96:99], v[20:23]
    ds_read_b128 v[76:79], v144 offset:7168
    v_mfma_f32_16x16x32_bf16 v[12:15], v[104:107], v[92:95], v[12:15]
    ds_read_b128 v[80:83], v145 offset:6144
    v_mfma_f32_16x16x32_bf16 v[24:27], v[104:107], v[96:99], v[24:27]
    ds_read_b128 v[84:87], v145 offset:7168
    v_mfma_f32_16x16x32_bf16 v[16:19], v[108:111], v[92:95], v[16:19]
    ds_read_b128 v[88:91], v145 offset:8192
    v_mfma_f32_16x16x32_bf16 v[28:31], v[108:111], v[96:99], v[28:31]
    s_lshl_b32 s60, s7, 8
    s_add_u32 s60, s60, 161792
    v_lshlrev_b32 v4, 3, v3
    v_add_u32 v4, s60, v4
    ds_read_b64 v[132:133], v4 offset:0
    ds_read_b64 v[134:135], v4 offset:128
    s_mul_i32 s60, s8, 192
    s_add_u32 s60, s60, 162816
    v_lshlrev_b32 v4, 4, v2
    v_add_u32 v4, s60, v4
    ds_read_b128 v[32:35], v4 offset:0
    ds_read_b128 v[36:39], v4 offset:64
    ds_read_b128 v[40:43], v4 offset:128
    s_waitcnt lgkmcnt(10)
    v_mfma_f32_16x16x32_bf16 v[8:11], v[120:123], v[112:115], v[8:11]
    v_mfma_f32_16x16x32_bf16 v[20:23], v[120:123], v[116:119], v[20:23]
    v_mfma_f32_16x16x32_bf16 v[12:15], v[124:127], v[112:115], v[12:15]
    v_mfma_f32_16x16x32_bf16 v[24:27], v[124:127], v[116:119], v[24:27]
    v_mfma_f32_16x16x32_bf16 v[16:19], v[128:131], v[112:115], v[16:19]
    v_mfma_f32_16x16x32_bf16 v[28:31], v[128:131], v[116:119], v[28:31]
    s_waitcnt lgkmcnt(5)
    v_mfma_f32_16x16x32_bf16 v[8:11], v[80:83], v[72:75], v[8:11]
    v_mfma_f32_16x16x32_bf16 v[20:23], v[80:83], v[76:79], v[20:23]
    v_mfma_f32_16x16x32_bf16 v[12:15], v[84:87], v[72:75], v[12:15]
    v_mfma_f32_16x16x32_bf16 v[24:27], v[84:87], v[76:79], v[24:27]
    v_mfma_f32_16x16x32_bf16 v[16:19], v[88:91], v[72:75], v[16:19]
    v_mfma_f32_16x16x32_bf16 v[28:31], v[88:91], v[76:79], v[28:31]
    s_waitcnt lgkmcnt(0)
    s_barrier
    s_waitcnt lgkmcnt(0)
    v_mov_b32 v136, v133
    v_mov_b32 v138, v135
    v_pk_mul_f32 v[8:9], v[8:9], v[136:137] op_sel_hi:[1,0]
    v_pk_fma_f32 v[8:9], v[32:33], v[132:133], v[8:9] op_sel_hi:[1,0,1]
    v_pk_mul_f32 v[10:11], v[10:11], v[136:137] op_sel_hi:[1,0]
    v_pk_fma_f32 v[10:11], v[34:35], v[132:133], v[10:11] op_sel_hi:[1,0,1]
    v_cvt_pk_bf16_f32 v72, v8, v9
    v_cvt_pk_bf16_f32 v73, v10, v11
    v_pk_mul_f32 v[12:13], v[12:13], v[136:137] op_sel_hi:[1,0]
    v_pk_fma_f32 v[12:13], v[36:37], v[132:133], v[12:13] op_sel_hi:[1,0,1]
    v_pk_mul_f32 v[14:15], v[14:15], v[136:137] op_sel_hi:[1,0]
    v_pk_fma_f32 v[14:15], v[38:39], v[132:133], v[14:15] op_sel_hi:[1,0,1]
    v_cvt_pk_bf16_f32 v74, v12, v13
    v_cvt_pk_bf16_f32 v75, v14, v15
    v_pk_mul_f32 v[16:17], v[16:17], v[136:137] op_sel_hi:[1,0]
    v_pk_fma_f32 v[16:17], v[40:41], v[132:133], v[16:17] op_sel_hi:[1,0,1]
    v_pk_mul_f32 v[18:19], v[18:19], v[136:137] op_sel_hi:[1,0]
    v_pk_fma_f32 v[18:19], v[42:43], v[132:133], v[18:19] op_sel_hi:[1,0,1]
    v_cvt_pk_bf16_f32 v76, v16, v17
    v_cvt_pk_bf16_f32 v77, v18, v19
    v_pk_mul_f32 v[20:21], v[20:21], v[138:139] op_sel_hi:[1,0]
    v_pk_fma_f32 v[20:21], v[32:33], v[134:135], v[20:21] op_sel_hi:[1,0,1]
    v_pk_mul_f32 v[22:23], v[22:23], v[138:139] op_sel_hi:[1,0]
    v_pk_fma_f32 v[22:23], v[34:35], v[134:135], v[22:23] op_sel_hi:[1,0,1]
    v_cvt_pk_bf16_f32 v80, v20, v21
    v_cvt_pk_bf16_f32 v81, v22, v23
    v_pk_mul_f32 v[24:25], v[24:25], v[138:139] op_sel_hi:[1,0]
    v_pk_fma_f32 v[24:25], v[36:37], v[134:135], v[24:25] op_sel_hi:[1,0,1]
    v_pk_mul_f32 v[26:27], v[26:27], v[138:139] op_sel_hi:[1,0]
    v_pk_fma_f32 v[26:27], v[38:39], v[134:135], v[26:27] op_sel_hi:[1,0,1]
    v_cvt_pk_bf16_f32 v82, v24, v25
    v_cvt_pk_bf16_f32 v83, v26, v27
    v_pk_mul_f32 v[28:29], v[28:29], v[138:139] op_sel_hi:[1,0]
    v_pk_fma_f32 v[28:29], v[40:41], v[134:135], v[28:29] op_sel_hi:[1,0,1]
    v_pk_mul_f32 v[30:31], v[30:31], v[138:139] op_sel_hi:[1,0]
    v_pk_fma_f32 v[30:31], v[42:43], v[134:135], v[30:31] op_sel_hi:[1,0,1]
    v_cvt_pk_bf16_f32 v84, v28, v29
    v_cvt_pk_bf16_f32 v85, v30, v31
    s_lshl_b32 s60, s7, 5
    v_add_u32 v48, s60, v3
    s_lshl_b32 s60, s8, 12
    s_add_u32 s60, s60, 114688
    v_lshlrev_b32 v49, 5, v48
    v_lshl_add_u32 v49, v2, 3, v49
    v_add_u32 v49, s60, v49
    ds_write_b64 v49, v[76:77] offset:0
    ds_write_b64 v49, v[84:85] offset:512
    v_and_b32 v5, 1, v2
    s_lshl_b32 s60, s8, 13
    s_add_u32 s60, s60, 98304
    v_lshlrev_b32 v50, 6, v48
    v_lshl_add_u32 v50, v5, 4, v50
    v_add_u32 v50, s60, v50
    v_lshlrev_b32 v51, 8, v5
    v_lshl_add_u32 v51, v3, 4, v51
    s_mov_b32 s64, 0x3fb8aa3b
    s_add_u32 s61, s65, 33792
    v_mfma_f32_16x16x32_bf16 v[88:91], v[56:59], v[72:75], 0
    v_mfma_f32_16x16x32_bf16 v[92:95], v[60:63], v[72:75], 0
    v_mfma_f32_16x16x32_bf16 v[8:11], v[56:59], v[80:83], 0
    v_mfma_f32_16x16x32_bf16 v[12:15], v[60:63], v[80:83], 0
    s_nop 4
    v_max3_f32 v32, v88, v89, v90
    s_nop 0
    v_max3_f32 v38, v8, v9, v10
    v_min3_f32 v33, v88, v89, v90
    v_min3_f32 v39, v8, v9, v10
    v_max3_f32 v32, v32, v91, v92
    v_max3_f32 v38, v38, v11, v12
    v_min3_f32 v33, v33, v91, v92
    v_min3_f32 v39, v39, v11, v12
    v_max3_f32 v32, v32, v93, v94
    v_max3_f32 v38, v38, v13, v14
    v_min3_f32 v33, v33, v93, v94
    v_min3_f32 v39, v39, v13, v14
    v_max_f32 v32, v32, v95
    v_max_f32 v38, v38, v15
    v_min_f32 v33, v33, v95
    v_min_f32 v39, v39, v15
    v_mov_b32 v35, v32
    v_mov_b32 v41, v38
    v_mov_b32 v34, v33
    v_mov_b32 v40, v39
    v_permlane16_swap_b32 v32, v35
    v_permlane16_swap_b32 v38, v41
    v_permlane16_swap_b32 v33, v34
    v_permlane16_swap_b32 v39, v40
    v_max_f32 v32, v32, v35
    v_max_f32 v38, v38, v41
    v_min_f32 v33, v33, v34
    v_min_f32 v39, v39, v40
    v_mul_f32 v32, s64, v32
    v_mul_f32 v38, s64, v38
    v_mul_f32 v33, s64, v33
    v_mul_f32 v39, s64, v39
    v_fma_f32 v96, v88, s64, -v32
    v_fma_f32 v16, v8, s64, -v38
    v_fma_f32 v104, -v88, s64, v33
    v_fma_f32 v24, -v8, s64, v39
    v_fma_f32 v97, v89, s64, -v32
    v_fma_f32 v17, v9, s64, -v38
    v_fma_f32 v105, -v89, s64, v33
    v_fma_f32 v25, -v9, s64, v39
    v_fma_f32 v98, v90, s64, -v32
    v_fma_f32 v18, v10, s64, -v38
    v_fma_f32 v106, -v90, s64, v33
    v_fma_f32 v26, -v10, s64, v39
    v_fma_f32 v99, v91, s64, -v32
    v_fma_f32 v19, v11, s64, -v38
    v_fma_f32 v107, -v91, s64, v33
    v_fma_f32 v27, -v11, s64, v39
    v_fma_f32 v100, v92, s64, -v32
    v_fma_f32 v20, v12, s64, -v38
    v_fma_f32 v108, -v92, s64, v33
    v_fma_f32 v28, -v12, s64, v39
    v_fma_f32 v101, v93, s64, -v32
    v_fma_f32 v21, v13, s64, -v38
    v_fma_f32 v109, -v93, s64, v33
    v_fma_f32 v29, -v13, s64, v39
    v_fma_f32 v102, v94, s64, -v32
    v_fma_f32 v22, v14, s64, -v38
    v_fma_f32 v110, -v94, s64, v33
    v_fma_f32 v30, -v14, s64, v39
    v_fma_f32 v103, v95, s64, -v32
    v_fma_f32 v23, v15, s64, -v38
    v_fma_f32 v111, -v95, s64, v33
    v_fma_f32 v31, -v15, s64, v39
    v_exp_f32 v96, v96
    v_exp_f32 v16, v16
    v_exp_f32 v97, v97
    v_exp_f32 v17, v17
    v_exp_f32 v98, v98
    v_exp_f32 v18, v18
    v_exp_f32 v99, v99
    v_exp_f32 v19, v19
    v_exp_f32 v100, v100
    v_exp_f32 v20, v20
    v_exp_f32 v101, v101
    v_exp_f32 v21, v21
    v_exp_f32 v102, v102
    v_exp_f32 v22, v22
    v_exp_f32 v103, v103
    v_exp_f32 v23, v23
    v_exp_f32 v104, v104
    v_exp_f32 v24, v24
    v_exp_f32 v105, v105
    v_exp_f32 v25, v25
    v_exp_f32 v106, v106
    v_exp_f32 v26, v26
    v_exp_f32 v107, v107
    v_exp_f32 v27, v27
    v_exp_f32 v108, v108
    v_exp_f32 v28, v28
    v_exp_f32 v109, v109
    v_exp_f32 v29, v29
    v_exp_f32 v110, v110
    v_exp_f32 v30, v30
    v_exp_f32 v111, v111
    v_exp_f32 v31, v31
    v_pk_add_f32 v[88:89], v[96:97], v[98:99]
    v_pk_add_f32 v[8:9], v[16:17], v[18:19]
    v_pk_add_f32 v[90:91], v[100:101], v[102:103]
    v_pk_add_f32 v[10:11], v[20:21], v[22:23]
    v_pk_add_f32 v[92:93], v[104:105], v[106:107]
    v_pk_add_f32 v[12:13], v[24:25], v[26:27]
    v_pk_add_f32 v[94:95], v[108:109], v[110:111]
    v_pk_add_f32 v[14:15], v[28:29], v[30:31]
    v_pk_add_f32 v[88:89], v[88:89], v[90:91]
    v_pk_add_f32 v[8:9], v[8:9], v[10:11]
    v_pk_add_f32 v[92:93], v[92:93], v[94:95]
    v_pk_add_f32 v[12:13], v[12:13], v[14:15]
    v_add_f32 v34, v88, v89
    v_add_f32 v40, v8, v9
    v_add_f32 v36, v92, v93
    v_add_f32 v42, v12, v13
    v_mov_b32 v35, v34
    v_mov_b32 v41, v40
    v_mov_b32 v32, v36
    v_mov_b32 v38, v42
    v_permlane16_swap_b32 v34, v35
    v_permlane16_swap_b32 v40, v41
    v_permlane16_swap_b32 v36, v32
    v_permlane16_swap_b32 v42, v38
    v_add_f32 v34, v34, v35
    v_add_f32 v40, v40, v41
    v_add_f32 v36, v36, v32
    v_add_f32 v42, v42, v38
    v_rcp_f32 v34, v34
    v_rcp_f32 v40, v40
    v_rcp_f32 v36, v36
    v_rcp_f32 v42, v42
    v_pk_mul_f32 v[96:97], v[96:97], v[34:35] op_sel_hi:[1,0]
    v_pk_mul_f32 v[16:17], v[16:17], v[40:41] op_sel_hi:[1,0]
    v_pk_mul_f32 v[104:105], v[104:105], v[36:37] op_sel_hi:[1,0]
    v_pk_mul_f32 v[24:25], v[24:25], v[42:43] op_sel_hi:[1,0]
    v_pk_mul_f32 v[98:99], v[98:99], v[34:35] op_sel_hi:[1,0]
    v_pk_mul_f32 v[18:19], v[18:19], v[40:41] op_sel_hi:[1,0]
    v_pk_mul_f32 v[106:107], v[106:107], v[36:37] op_sel_hi:[1,0]
    v_pk_mul_f32 v[26:27], v[26:27], v[42:43] op_sel_hi:[1,0]
    v_pk_mul_f32 v[100:101], v[100:101], v[34:35] op_sel_hi:[1,0]
    v_pk_mul_f32 v[20:21], v[20:21], v[40:41] op_sel_hi:[1,0]
    v_pk_mul_f32 v[108:109], v[108:109], v[36:37] op_sel_hi:[1,0]
    v_pk_mul_f32 v[28:29], v[28:29], v[42:43] op_sel_hi:[1,0]
    v_pk_mul_f32 v[102:103], v[102:103], v[34:35] op_sel_hi:[1,0]
    v_pk_mul_f32 v[22:23], v[22:23], v[40:41] op_sel_hi:[1,0]
    v_pk_mul_f32 v[110:111], v[110:111], v[36:37] op_sel_hi:[1,0]
    v_pk_mul_f32 v[30:31], v[30:31], v[42:43] op_sel_hi:[1,0]
    v_cvt_pk_bf16_f32 v112, v96, v97
    v_cvt_pk_bf16_f32 v120, v16, v17
    v_cvt_pk_bf16_f32 v113, v98, v99
    v_cvt_pk_bf16_f32 v121, v18, v19
    v_cvt_pk_bf16_f32 v114, v100, v101
    v_cvt_pk_bf16_f32 v122, v20, v21
    v_cvt_pk_bf16_f32 v115, v102, v103
    v_cvt_pk_bf16_f32 v123, v22, v23
    v_cvt_pk_bf16_f32 v116, v104, v105
    v_cvt_pk_bf16_f32 v124, v24, v25
    v_cvt_pk_bf16_f32 v117, v106, v107
    v_cvt_pk_bf16_f32 v125, v26, v27
    v_cvt_pk_bf16_f32 v118, v108, v109
    v_cvt_pk_bf16_f32 v126, v28, v29
    v_cvt_pk_bf16_f32 v119, v110, v111
    v_cvt_pk_bf16_f32 v127, v30, v31
    s_mov_b32 exec_lo, 0
    s_mov_b32 exec_hi, -1
    ds_write_b128 v50, v[112:115] offset:0
    ds_write_b128 v50, v[116:119] offset:32
    ds_write_b128 v50, v[120:123] offset:1024
    ds_write_b128 v50, v[124:127] offset:1056
    s_not_b64 exec, exec
    buffer_store_dwordx4 v[112:115], v51, s[52:55], s65 offen
    buffer_store_dwordx4 v[116:119], v51, s[52:55], s65 offen offset:512
    buffer_store_dwordx4 v[120:123], v51, s[52:55], s61 offen
    buffer_store_dwordx4 v[124:127], v51, s[52:55], s61 offen offset:512
    s_mov_b64 exec, -1
    s_waitcnt lgkmcnt(0)
    s_barrier
    s_cmp_ge_u32 s4, 4
    s_cbranch_scc1 Ladone_133
    v_lshrrev_b32 v4, 2, v1
    v_and_b32 v5, 3, v1
    s_lshr_b32 s60, s4, 1
    s_and_b32 s61, s4, 1
    s_lshl_b32 s62, s60, 12
    s_add_u32 s62, s62, 114688
    v_lshlrev_b32 v49, 5, v4
    v_lshl_add_u32 v49, v5, 3, v49
    v_add_u32 v49, s62, v49
    s_lshl_b32 s62, s60, 13
    s_lshl_b32 s67, s61, 5
    s_add_u32 s62, s62, s67
    s_add_u32 s62, s62, 98304
    v_lshlrev_b32 v50, 6, v4
    v_lshl_add_u32 v50, v5, 3, v50
    v_add_u32 v50, s62, v50
    ds_read_b64_tr_b16 v[72:73], v49 offset:0
    ds_read_b64_tr_b16 v[88:89], v50 offset:0
    ds_read_b64_tr_b16 v[74:75], v49 offset:512
    ds_read_b64_tr_b16 v[90:91], v50 offset:1024
    ds_read_b64_tr_b16 v[76:77], v49 offset:1024
    ds_read_b64_tr_b16 v[92:93], v50 offset:2048
    ds_read_b64_tr_b16 v[78:79], v49 offset:1536
    ds_read_b64_tr_b16 v[94:95], v50 offset:3072
    ds_read_b64_tr_b16 v[80:81], v49 offset:2048
    ds_read_b64_tr_b16 v[96:97], v50 offset:4096
    ds_read_b64_tr_b16 v[82:83], v49 offset:2560
    ds_read_b64_tr_b16 v[98:99], v50 offset:5120
    ds_read_b64_tr_b16 v[84:85], v49 offset:3072
    ds_read_b64_tr_b16 v[100:101], v50 offset:6144
    ds_read_b64_tr_b16 v[86:87], v49 offset:3584
    ds_read_b64_tr_b16 v[102:103], v50 offset:7168
    s_waitcnt lgkmcnt(12)
    v_mfma_f32_16x16x32_bf16 v[108:111], v[72:75], v[88:91], 0
    v_mfma_f32_16x16x32_bf16 v[112:115], v[44:47], v[88:91], 0
    s_waitcnt lgkmcnt(8)
    v_mfma_f32_16x16x32_bf16 v[108:111], v[76:79], v[92:95], v[108:111]
    v_mfma_f32_16x16x32_bf16 v[112:115], v[44:47], v[92:95], v[112:115]
    s_waitcnt lgkmcnt(4)
    v_mfma_f32_16x16x32_bf16 v[108:111], v[80:83], v[96:99], v[108:111]
    v_mfma_f32_16x16x32_bf16 v[112:115], v[44:47], v[96:99], v[112:115]
    s_waitcnt lgkmcnt(0)
    v_mfma_f32_16x16x32_bf16 v[108:111], v[84:87], v[100:103], v[108:111]
    v_mfma_f32_16x16x32_bf16 v[112:115], v[44:47], v[100:103], v[112:115]
    s_lshl_b32 s62, s6, 1
    s_add_u32 s62, s62, s60
    s_mul_i32 s62, s62, 2176
    s_lshl_b32 s61, s61, 6
    s_add_u32 s62, s62, s61
    v_lshlrev_b32 v49, 9, v2
    v_lshl_add_u32 v49, v3, 2, v49
    buffer_atomic_add_f32 v108, v49, s[56:59], s62 offen offset:0
    buffer_atomic_add_f32 v109, v49, s[56:59], s62 offen offset:128
    buffer_atomic_add_f32 v110, v49, s[56:59], s62 offen offset:256
    buffer_atomic_add_f32 v111, v49, s[56:59], s62 offen offset:384
    s_mov_b64 exec, 0xffff
    buffer_atomic_add_f32 v112, v49, s[56:59], s62 offen offset:2048
    s_mov_b64 exec, -1
Ladone_133:
    s_nop 7
    s_nop 7
    v_mov_b32 v4, 163808
    v_mov_b32 v5, 1
    s_add_u32 s72, s38, 0x1580000
    s_addc_u32 s73, s39, 0
    s_mov_b32 s74, 0x3000
    s_mov_b32 s75, 0x00020000
    s_waitcnt vmcnt(0) lgkmcnt(0)
    s_mov_b64 exec, 1
    ds_add_rtn_u32 v5, v4, v5
    s_waitcnt lgkmcnt(0)
    s_mov_b64 exec, -1
    v_readfirstlane_b32 s70, v5
    s_nop 3
    s_and_b32 s70, s70, 7
    s_cmp_lg_u32 s70, 7
    s_cbranch_scc1 Lsg_134
    s_lshl_b32 s70, s5, 6
    s_add_u32 s70, s70, s6
    s_lshl_b32 s70, s70, 2
    v_mov_b32 v4, 6
    v_mov_b32 v5, 0
    s_mov_b64 exec, 1
    buffer_store_dword v4, v5, s[72:75], s70 offen
    s_mov_b64 exec, -1
    s_nop 1
Lsg_134:
    s_nop 7
    s_nop 7
    s_barrier
    s_lshr_b32 s60, s6, 3
    s_lshl_b32 s61, s5, 1
    s_add_u32 s60, s60, s61
    s_and_b32 s61, s6, 7
    v_lshrrev_b32 v6, 3, v1
    v_lshlrev_b32 v6, 4, v6
    v_and_b32 v4, 7, v1
    v_lshl_add_u32 v6, v4, 8, v6
    s_lshl_b32 s64, s60, 2
    s_lshr_b32 s62, s4, 1
    s_add_u32 s64, s64, s62
    s_lshl_b32 s64, s64, 14
    s_lshl_b32 s62, s61, 11
    s_add_u32 s64, s64, s62
    s_and_b32 s62, s4, 1
    s_lshl_b32 s62, s62, 7
    s_add_u32 s64, s64, s62
    v_lshrrev_b32 v7, 3, v1
    v_lshlrev_b32 v7, 4, v7
    v_and_b32 v4, 7, v1
    v_lshl_add_u32 v7, v4, 8, v7
    s_lshl_b32 s65, s60, 2
    s_lshr_b32 s62, s4, 1
    s_add_u32 s65, s65, s62
    s_lshl_b32 s65, s65, 14
    s_lshl_b32 s62, s61, 11
    s_add_u32 s65, s65, s62
    s_and_b32 s62, s4, 1
    s_lshl_b32 s62, s62, 7
    s_add_u32 s65, s65, s62
    s_add_u32 s52, s38, 0x800000
    s_addc_u32 s53, s39, 0
    s_mov_b32 s54, 0x200000
    s_mov_b32 s55, 0x00020000
    s_add_u32 s56, s38, 0x600000
    s_addc_u32 s57, s39, 0
    s_mov_b32 s58, 0x200000
    s_mov_b32 s59, 0x00020000
    s_lshl_b32 s62, s7, 11
    v_lshrrev_b32 v4, 2, v1
    v_lshlrev_b32 v140, 7, v4
    v_and_b32 v5, 3, v1
    v_lshl_add_u32 v140, v5, 3, v140
    v_add_u32 v140, s62, v140
    v_bfe_u32 v4, v1, 3, 2
    v_lshl_add_u32 v140, v4, 5, v140
    v_xor_b32 v141, 32, v140
    v_xor_b32 v142, 64, v140
    v_xor_b32 v143, 96, v140
    s_lshl_b32 s66, s7, 11
    s_add_u32 s62, s66, 65536
    v_lshlrev_b32 v144, 4, v1
    s_mov_b32 s44, s38
    s_mov_b32 s45, s39
    s_mov_b32 s46, 0x420000
    s_mov_b32 s47, 0x00020000
    s_lshl_b32 s68, s60, 1
    s_add_u32 s68, s68, s8
    s_mul_i32 s68, s68, 67584
    s_lshl_b32 s63, s7, 13
    s_add_u32 s68, s68, s63
    v_lshlrev_b32 v4, 1, v2
    v_and_b32 v5, 7, v3
    v_xor_b32 v5, v5, v4
    v_lshlrev_b32 v5, 4, v5
    v_lshl_add_u32 v5, v3, 7, v5
    v_add_u32 v145, s62, v5
    v_xor_b32 v146, 16, v145
    v_lshlrev_b32 v4, 5, v2
    s_lshl_b32 s62, s7, 10
    s_add_u32 s62, s62, 106496
    v_add_u32 v147, s62, v4
    buffer_load_dwordx4 v[40:43], v6, s[52:55], s64 offen sc1
    s_mov_b32 s67, 0x358637bd
    s_barrier
    s_add_u32 s63, s68, 0
    buffer_load_dwordx4 v[76:79], v144, s[44:47], s63 offen sc1
    s_add_u32 s63, s68, 33792
    buffer_load_dwordx4 v[80:83], v144, s[44:47], s63 offen sc1
    s_add_u32 s63, s68, 1024
    buffer_load_dwordx4 v[84:87], v144, s[44:47], s63 offen sc1
    s_add_u32 s63, s68, 34816
    buffer_load_dwordx4 v[88:91], v144, s[44:47], s63 offen sc1
    s_add_u32 s63, s68, 2048
    buffer_load_dwordx4 v[92:95], v144, s[44:47], s63 offen sc1
    s_add_u32 s63, s68, 35840
    buffer_load_dwordx4 v[96:99], v144, s[44:47], s63 offen sc1
    s_barrier
    ds_read_b128 v[44:47], v145 offset:0
    ds_read_b128 v[48:51], v146 offset:0
    ds_read_b128 v[52:55], v147 offset:0
    ds_read_b128 v[56:59], v147 offset:16
    s_waitcnt lgkmcnt(0)
    s_barrier
    s_waitcnt vmcnt(4)
    v_cvt_pk_bf16_f32 v44, v44, v45
    v_cvt_pk_bf16_f32 v45, v46, v47
    v_cvt_pk_bf16_f32 v46, v48, v49
    ds_read_b128 v[60:63], v145 offset:8192
    v_cvt_pk_bf16_f32 v47, v50, v51
    v_cvt_pk_bf16_f32 v48, v52, v53
    ds_read_b128 v[64:67], v146 offset:8192
    v_cvt_pk_bf16_f32 v49, v54, v55
    v_cvt_pk_bf16_f32 v50, v56, v57
    v_cvt_pk_bf16_f32 v51, v58, v59
    ds_read_b128 v[68:71], v147 offset:128
    v_mfma_f32_16x16x32_bf16 v[100:103], v[44:47], v[76:79], 0
    v_mfma_f32_16x16x32_bf16 v[104:107], v[48:51], v[76:79], 0
    ds_read_b128 v[72:75], v147 offset:144
    v_mfma_f32_16x16x32_bf16 v[108:111], v[44:47], v[80:83], 0
    v_mfma_f32_16x16x32_bf16 v[112:115], v[48:51], v[80:83], 0
    s_add_u32 s63, s68, 3072
    buffer_load_dwordx4 v[76:79], v144, s[44:47], s63 offen sc1
    s_add_u32 s63, s68, 36864
    buffer_load_dwordx4 v[80:83], v144, s[44:47], s63 offen sc1
    s_waitcnt lgkmcnt(0)
    s_barrier
    s_waitcnt vmcnt(4)
    v_add_f32 v104, s67, v104
    v_cvt_pk_bf16_f32 v60, v60, v61
    ds_read_b128 v[44:47], v145 offset:16384
    v_add_f32 v112, s67, v112
    v_cvt_pk_bf16_f32 v61, v62, v63
    ds_read_b128 v[48:51], v146 offset:16384
    v_rcp_f32 v104, v104
    ds_read_b128 v[52:55], v147 offset:256
    v_cvt_pk_bf16_f32 v62, v64, v65
    v_rcp_f32 v112, v112
    ds_read_b128 v[56:59], v147 offset:272
    v_cvt_pk_bf16_f32 v63, v66, v67
    ds_read_b64_tr_b16 v[124:125], v140 offset:0
    v_pk_mul_f32 v[100:101], v[100:101], v[104:105] op_sel_hi:[1,0]
    v_cvt_pk_bf16_f32 v64, v68, v69
    ds_read_b64_tr_b16 v[128:129], v141 offset:0
    v_pk_mul_f32 v[102:103], v[102:103], v[104:105] op_sel_hi:[1,0]
    v_cvt_pk_bf16_f32 v65, v70, v71
    ds_read_b64_tr_b16 v[132:133], v142 offset:0
    v_pk_mul_f32 v[108:109], v[108:109], v[112:113] op_sel_hi:[1,0]
    ds_read_b64_tr_b16 v[136:137], v143 offset:0
    v_cvt_pk_bf16_f32 v66, v72, v73
    v_pk_mul_f32 v[110:111], v[110:111], v[112:113] op_sel_hi:[1,0]
    ds_read_b64_tr_b16 v[126:127], v140 offset:8192
    v_cvt_pk_bf16_f32 v67, v74, v75
    ds_read_b64_tr_b16 v[130:131], v141 offset:8192
    v_cvt_pk_bf16_f32 v116, v100, v101
    v_mfma_f32_16x16x32_bf16 v[148:151], v[60:63], v[84:87], 0
    ds_read_b64_tr_b16 v[134:135], v142 offset:8192
    v_cvt_pk_bf16_f32 v117, v102, v103
    v_mfma_f32_16x16x32_bf16 v[152:155], v[64:67], v[84:87], 0
    ds_read_b64_tr_b16 v[138:139], v143 offset:8192
    v_cvt_pk_bf16_f32 v120, v108, v109
    v_mfma_f32_16x16x32_bf16 v[156:159], v[60:63], v[88:91], 0
    v_cvt_pk_bf16_f32 v121, v110, v111
    v_mfma_f32_16x16x32_bf16 v[160:163], v[64:67], v[88:91], 0
    s_add_u32 s63, s68, 4096
    buffer_load_dwordx4 v[84:87], v144, s[44:47], s63 offen sc1
    s_add_u32 s63, s68, 37888
    buffer_load_dwordx4 v[88:91], v144, s[44:47], s63 offen sc1
    s_waitcnt lgkmcnt(0)
    s_barrier
    s_waitcnt vmcnt(4)
    v_add_f32 v152, s67, v152
    v_cvt_pk_bf16_f32 v44, v44, v45
    v_add_f32 v160, s67, v160
    v_cvt_pk_bf16_f32 v45, v46, v47
    v_rcp_f32 v152, v152
    v_cvt_pk_bf16_f32 v46, v48, v49
    v_rcp_f32 v160, v160
    ds_read_b128 v[60:63], v145 offset:24576
    v_cvt_pk_bf16_f32 v47, v50, v51
    v_pk_mul_f32 v[148:149], v[148:149], v[152:153] op_sel_hi:[1,0]
    v_cvt_pk_bf16_f32 v48, v52, v53
    v_pk_mul_f32 v[150:151], v[150:151], v[152:153] op_sel_hi:[1,0]
    v_cvt_pk_bf16_f32 v49, v54, v55
    v_pk_mul_f32 v[156:157], v[156:157], v[160:161] op_sel_hi:[1,0]
    ds_read_b128 v[64:67], v146 offset:24576
    v_cvt_pk_bf16_f32 v50, v56, v57
    v_pk_mul_f32 v[158:159], v[158:159], v[160:161] op_sel_hi:[1,0]
    v_cvt_pk_bf16_f32 v51, v58, v59
    v_cvt_pk_bf16_f32 v118, v148, v149
    v_mfma_f32_16x16x32_bf16 v[100:103], v[44:47], v[92:95], 0
    v_cvt_pk_bf16_f32 v119, v150, v151
    v_mfma_f32_16x16x32_bf16 v[104:107], v[48:51], v[92:95], 0
    ds_read_b128 v[68:71], v147 offset:384
    v_cvt_pk_bf16_f32 v122, v156, v157
    v_mfma_f32_16x16x32_bf16 v[108:111], v[44:47], v[96:99], 0
    v_cvt_pk_bf16_f32 v123, v158, v159
    v_mfma_f32_16x16x32_bf16 v[112:115], v[48:51], v[96:99], 0
    v_mfma_f32_16x16x32_bf16 v[8:11], v[124:127], v[116:119], 0
    v_mfma_f32_16x16x32_bf16 v[12:15], v[128:131], v[116:119], 0
    ds_read_b128 v[72:75], v147 offset:400
    v_mfma_f32_16x16x32_bf16 v[16:19], v[132:135], v[116:119], 0
    v_mfma_f32_16x16x32_bf16 v[20:23], v[136:139], v[116:119], 0
    v_mfma_f32_16x16x32_bf16 v[24:27], v[124:127], v[120:123], 0
    v_mfma_f32_16x16x32_bf16 v[28:31], v[128:131], v[120:123], 0
    v_mfma_f32_16x16x32_bf16 v[32:35], v[132:135], v[120:123], 0
    v_mfma_f32_16x16x32_bf16 v[36:39], v[136:139], v[120:123], 0
    s_add_u32 s63, s68, 5120
    buffer_load_dwordx4 v[92:95], v144, s[44:47], s63 offen sc1
    s_add_u32 s63, s68, 38912
    buffer_load_dwordx4 v[96:99], v144, s[44:47], s63 offen sc1
    s_waitcnt lgkmcnt(0)
    s_barrier
    s_waitcnt vmcnt(4)
    v_add_f32 v104, s67, v104
    v_cvt_pk_bf16_f32 v60, v60, v61
    ds_read_b128 v[44:47], v145 offset:32768
    v_add_f32 v112, s67, v112
    v_cvt_pk_bf16_f32 v61, v62, v63
    ds_read_b128 v[48:51], v146 offset:32768
    v_rcp_f32 v104, v104
    ds_read_b128 v[52:55], v147 offset:512
    v_cvt_pk_bf16_f32 v62, v64, v65
    v_rcp_f32 v112, v112
    ds_read_b128 v[56:59], v147 offset:528
    v_cvt_pk_bf16_f32 v63, v66, v67
    ds_read_b64_tr_b16 v[124:125], v140 offset:16384
    v_pk_mul_f32 v[100:101], v[100:101], v[104:105] op_sel_hi:[1,0]
    v_cvt_pk_bf16_f32 v64, v68, v69
    ds_read_b64_tr_b16 v[128:129], v141 offset:16384
    v_pk_mul_f32 v[102:103], v[102:103], v[104:105] op_sel_hi:[1,0]
    v_cvt_pk_bf16_f32 v65, v70, v71
    ds_read_b64_tr_b16 v[132:133], v142 offset:16384
    v_pk_mul_f32 v[108:109], v[108:109], v[112:113] op_sel_hi:[1,0]
    ds_read_b64_tr_b16 v[136:137], v143 offset:16384
    v_cvt_pk_bf16_f32 v66, v72, v73
    v_pk_mul_f32 v[110:111], v[110:111], v[112:113] op_sel_hi:[1,0]
    ds_read_b64_tr_b16 v[126:127], v140 offset:24576
    v_cvt_pk_bf16_f32 v67, v74, v75
    ds_read_b64_tr_b16 v[130:131], v141 offset:24576
    v_cvt_pk_bf16_f32 v116, v100, v101
    v_mfma_f32_16x16x32_bf16 v[148:151], v[60:63], v[76:79], 0
    ds_read_b64_tr_b16 v[134:135], v142 offset:24576
    v_cvt_pk_bf16_f32 v117, v102, v103
    v_mfma_f32_16x16x32_bf16 v[152:155], v[64:67], v[76:79], 0
    ds_read_b64_tr_b16 v[138:139], v143 offset:24576
    v_cvt_pk_bf16_f32 v120, v108, v109
    v_mfma_f32_16x16x32_bf16 v[156:159], v[60:63], v[80:83], 0
    v_cvt_pk_bf16_f32 v121, v110, v111
    v_mfma_f32_16x16x32_bf16 v[160:163], v[64:67], v[80:83], 0
    s_add_u32 s63, s68, 6144
    buffer_load_dwordx4 v[76:79], v144, s[44:47], s63 offen sc1
    s_add_u32 s63, s68, 39936
    buffer_load_dwordx4 v[80:83], v144, s[44:47], s63 offen sc1
    s_waitcnt lgkmcnt(0)
    s_barrier
    s_waitcnt vmcnt(4)
    v_add_f32 v152, s67, v152
    v_cvt_pk_bf16_f32 v44, v44, v45
    v_add_f32 v160, s67, v160
    v_cvt_pk_bf16_f32 v45, v46, v47
    v_rcp_f32 v152, v152
    v_cvt_pk_bf16_f32 v46, v48, v49
    v_rcp_f32 v160, v160
    ds_read_b128 v[60:63], v145 offset:0
    v_cvt_pk_bf16_f32 v47, v50, v51
    v_pk_mul_f32 v[148:149], v[148:149], v[152:153] op_sel_hi:[1,0]
    v_cvt_pk_bf16_f32 v48, v52, v53
    v_pk_mul_f32 v[150:151], v[150:151], v[152:153] op_sel_hi:[1,0]
    v_cvt_pk_bf16_f32 v49, v54, v55
    v_pk_mul_f32 v[156:157], v[156:157], v[160:161] op_sel_hi:[1,0]
    ds_read_b128 v[64:67], v146 offset:0
    v_cvt_pk_bf16_f32 v50, v56, v57
    v_pk_mul_f32 v[158:159], v[158:159], v[160:161] op_sel_hi:[1,0]
    v_cvt_pk_bf16_f32 v51, v58, v59
    v_cvt_pk_bf16_f32 v118, v148, v149
    v_mfma_f32_16x16x32_bf16 v[100:103], v[44:47], v[84:87], 0
    v_cvt_pk_bf16_f32 v119, v150, v151
    v_mfma_f32_16x16x32_bf16 v[104:107], v[48:51], v[84:87], 0
    ds_read_b128 v[68:71], v147 offset:640
    v_cvt_pk_bf16_f32 v122, v156, v157
    v_mfma_f32_16x16x32_bf16 v[108:111], v[44:47], v[88:91], 0
    v_cvt_pk_bf16_f32 v123, v158, v159
    v_mfma_f32_16x16x32_bf16 v[112:115], v[48:51], v[88:91], 0
    v_mfma_f32_16x16x32_bf16 v[8:11], v[124:127], v[116:119], v[8:11]
    v_mfma_f32_16x16x32_bf16 v[12:15], v[128:131], v[116:119], v[12:15]
    ds_read_b128 v[72:75], v147 offset:656
    v_mfma_f32_16x16x32_bf16 v[16:19], v[132:135], v[116:119], v[16:19]
    v_mfma_f32_16x16x32_bf16 v[20:23], v[136:139], v[116:119], v[20:23]
    v_mfma_f32_16x16x32_bf16 v[24:27], v[124:127], v[120:123], v[24:27]
    v_mfma_f32_16x16x32_bf16 v[28:31], v[128:131], v[120:123], v[28:31]
    v_mfma_f32_16x16x32_bf16 v[32:35], v[132:135], v[120:123], v[32:35]
    v_mfma_f32_16x16x32_bf16 v[36:39], v[136:139], v[120:123], v[36:39]
    s_add_u32 s63, s68, 7168
    buffer_load_dwordx4 v[84:87], v144, s[44:47], s63 offen sc1
    s_add_u32 s63, s68, 40960
    buffer_load_dwordx4 v[88:91], v144, s[44:47], s63 offen sc1
    s_waitcnt lgkmcnt(0)
    s_barrier
    s_waitcnt vmcnt(4)
    v_add_f32 v104, s67, v104
    v_cvt_pk_bf16_f32 v60, v60, v61
    ds_read_b128 v[44:47], v145 offset:8192
    v_add_f32 v112, s67, v112
    v_cvt_pk_bf16_f32 v61, v62, v63
    ds_read_b128 v[48:51], v146 offset:8192
    v_rcp_f32 v104, v104
    ds_read_b128 v[52:55], v147 offset:768
    v_cvt_pk_bf16_f32 v62, v64, v65
    v_rcp_f32 v112, v112
    ds_read_b128 v[56:59], v147 offset:784
    v_cvt_pk_bf16_f32 v63, v66, v67
    ds_read_b64_tr_b16 v[124:125], v140 offset:32768
    v_pk_mul_f32 v[100:101], v[100:101], v[104:105] op_sel_hi:[1,0]
    v_cvt_pk_bf16_f32 v64, v68, v69
    ds_read_b64_tr_b16 v[128:129], v141 offset:32768
    v_pk_mul_f32 v[102:103], v[102:103], v[104:105] op_sel_hi:[1,0]
    v_cvt_pk_bf16_f32 v65, v70, v71
    ds_read_b64_tr_b16 v[132:133], v142 offset:32768
    v_pk_mul_f32 v[108:109], v[108:109], v[112:113] op_sel_hi:[1,0]
    ds_read_b64_tr_b16 v[136:137], v143 offset:32768
    v_cvt_pk_bf16_f32 v66, v72, v73
    v_pk_mul_f32 v[110:111], v[110:111], v[112:113] op_sel_hi:[1,0]
    ds_read_b64_tr_b16 v[126:127], v140 offset:40960
    v_cvt_pk_bf16_f32 v67, v74, v75
    ds_read_b64_tr_b16 v[130:131], v141 offset:40960
    v_cvt_pk_bf16_f32 v116, v100, v101
    v_mfma_f32_16x16x32_bf16 v[148:151], v[60:63], v[92:95], 0
    ds_read_b64_tr_b16 v[134:135], v142 offset:40960
    v_cvt_pk_bf16_f32 v117, v102, v103
    v_mfma_f32_16x16x32_bf16 v[152:155], v[64:67], v[92:95], 0
    ds_read_b64_tr_b16 v[138:139], v143 offset:40960
    v_cvt_pk_bf16_f32 v120, v108, v109
    v_mfma_f32_16x16x32_bf16 v[156:159], v[60:63], v[96:99], 0
    v_cvt_pk_bf16_f32 v121, v110, v111
    v_mfma_f32_16x16x32_bf16 v[160:163], v[64:67], v[96:99], 0
    s_waitcnt lgkmcnt(0)
    s_barrier
    s_waitcnt vmcnt(2)
    v_add_f32 v152, s67, v152
    v_cvt_pk_bf16_f32 v44, v44, v45
    s_nop 2
    v_add_f32 v160, s67, v160
    v_cvt_pk_bf16_f32 v45, v46, v47
    v_rcp_f32 v152, v152
    v_cvt_pk_bf16_f32 v46, v48, v49
    v_rcp_f32 v160, v160
    ds_read_b128 v[60:63], v145 offset:16384
    v_cvt_pk_bf16_f32 v47, v50, v51
    v_pk_mul_f32 v[148:149], v[148:149], v[152:153] op_sel_hi:[1,0]
    v_cvt_pk_bf16_f32 v48, v52, v53
    v_pk_mul_f32 v[150:151], v[150:151], v[152:153] op_sel_hi:[1,0]
    v_cvt_pk_bf16_f32 v49, v54, v55
    v_pk_mul_f32 v[156:157], v[156:157], v[160:161] op_sel_hi:[1,0]
    ds_read_b128 v[64:67], v146 offset:16384
    v_cvt_pk_bf16_f32 v50, v56, v57
    v_pk_mul_f32 v[158:159], v[158:159], v[160:161] op_sel_hi:[1,0]
    v_cvt_pk_bf16_f32 v51, v58, v59
    v_cvt_pk_bf16_f32 v118, v148, v149
    v_mfma_f32_16x16x32_bf16 v[100:103], v[44:47], v[76:79], 0
    v_cvt_pk_bf16_f32 v119, v150, v151
    v_mfma_f32_16x16x32_bf16 v[104:107], v[48:51], v[76:79], 0
    ds_read_b128 v[68:71], v147 offset:896
    v_cvt_pk_bf16_f32 v122, v156, v157
    v_mfma_f32_16x16x32_bf16 v[108:111], v[44:47], v[80:83], 0
    v_cvt_pk_bf16_f32 v123, v158, v159
    v_mfma_f32_16x16x32_bf16 v[112:115], v[48:51], v[80:83], 0
    v_mfma_f32_16x16x32_bf16 v[8:11], v[124:127], v[116:119], v[8:11]
    v_mfma_f32_16x16x32_bf16 v[12:15], v[128:131], v[116:119], v[12:15]
    ds_read_b128 v[72:75], v147 offset:912
    v_mfma_f32_16x16x32_bf16 v[16:19], v[132:135], v[116:119], v[16:19]
    v_mfma_f32_16x16x32_bf16 v[20:23], v[136:139], v[116:119], v[20:23]
    v_mfma_f32_16x16x32_bf16 v[24:27], v[124:127], v[120:123], v[24:27]
    v_mfma_f32_16x16x32_bf16 v[28:31], v[128:131], v[120:123], v[28:31]
    v_mfma_f32_16x16x32_bf16 v[32:35], v[132:135], v[120:123], v[32:35]
    v_mfma_f32_16x16x32_bf16 v[36:39], v[136:139], v[120:123], v[36:39]
    s_waitcnt lgkmcnt(0)
    s_waitcnt vmcnt(0)
    v_add_f32 v104, s67, v104
    v_cvt_pk_bf16_f32 v60, v60, v61
    v_add_f32 v112, s67, v112
    ds_read_b64_tr_b16 v[124:125], v140 offset:49152
    v_cvt_pk_bf16_f32 v61, v62, v63
    v_rcp_f32 v104, v104
    ds_read_b64_tr_b16 v[128:129], v141 offset:49152
    v_cvt_pk_bf16_f32 v62, v64, v65
    v_rcp_f32 v112, v112
    v_cvt_pk_bf16_f32 v63, v66, v67
    ds_read_b64_tr_b16 v[132:133], v142 offset:49152
    v_pk_mul_f32 v[100:101], v[100:101], v[104:105] op_sel_hi:[1,0]
    v_cvt_pk_bf16_f32 v64, v68, v69
    ds_read_b64_tr_b16 v[136:137], v143 offset:49152
    v_pk_mul_f32 v[102:103], v[102:103], v[104:105] op_sel_hi:[1,0]
    v_cvt_pk_bf16_f32 v65, v70, v71
    ds_read_b64_tr_b16 v[126:127], v140 offset:57344
    v_pk_mul_f32 v[108:109], v[108:109], v[112:113] op_sel_hi:[1,0]
    v_cvt_pk_bf16_f32 v66, v72, v73
    v_pk_mul_f32 v[110:111], v[110:111], v[112:113] op_sel_hi:[1,0]
    ds_read_b64_tr_b16 v[130:131], v141 offset:57344
    v_cvt_pk_bf16_f32 v67, v74, v75
    v_cvt_pk_bf16_f32 v116, v100, v101
    ds_read_b64_tr_b16 v[134:135], v142 offset:57344
    v_mfma_f32_16x16x32_bf16 v[148:151], v[60:63], v[84:87], 0
    v_cvt_pk_bf16_f32 v117, v102, v103
    v_mfma_f32_16x16x32_bf16 v[152:155], v[64:67], v[84:87], 0
    ds_read_b64_tr_b16 v[138:139], v143 offset:57344
    v_cvt_pk_bf16_f32 v120, v108, v109
    v_mfma_f32_16x16x32_bf16 v[156:159], v[60:63], v[88:91], 0
    v_cvt_pk_bf16_f32 v121, v110, v111
    v_mfma_f32_16x16x32_bf16 v[160:163], v[64:67], v[88:91], 0
    s_waitcnt lgkmcnt(0)
    s_nop 1
    v_add_f32 v152, s67, v152
    s_nop 3
    v_add_f32 v160, s67, v160
    v_rcp_f32 v152, v152
    v_rcp_f32 v160, v160
    v_pk_mul_f32 v[148:149], v[148:149], v[152:153] op_sel_hi:[1,0]
    v_pk_mul_f32 v[150:151], v[150:151], v[152:153] op_sel_hi:[1,0]
    v_pk_mul_f32 v[156:157], v[156:157], v[160:161] op_sel_hi:[1,0]
    v_pk_mul_f32 v[158:159], v[158:159], v[160:161] op_sel_hi:[1,0]
    v_cvt_pk_bf16_f32 v118, v148, v149
    v_cvt_pk_bf16_f32 v119, v150, v151
    v_cvt_pk_bf16_f32 v122, v156, v157
    v_cvt_pk_bf16_f32 v123, v158, v159
    v_mfma_f32_16x16x32_bf16 v[8:11], v[124:127], v[116:119], v[8:11]
    v_mfma_f32_16x16x32_bf16 v[12:15], v[128:131], v[116:119], v[12:15]
    v_mfma_f32_16x16x32_bf16 v[16:19], v[132:135], v[116:119], v[16:19]
    v_mfma_f32_16x16x32_bf16 v[20:23], v[136:139], v[116:119], v[20:23]
    v_mfma_f32_16x16x32_bf16 v[24:27], v[124:127], v[120:123], v[24:27]
    v_mfma_f32_16x16x32_bf16 v[28:31], v[128:131], v[120:123], v[28:31]
    v_mfma_f32_16x16x32_bf16 v[32:35], v[132:135], v[120:123], v[32:35]
    v_mfma_f32_16x16x32_bf16 v[36:39], v[136:139], v[120:123], v[36:39]
    s_waitcnt lgkmcnt(0)
    s_barrier
    s_lshl_b32 s62, s7, 1
    s_add_u32 s62, s62, s8
    s_mul_i32 s62, s62, 8704
    s_add_u32 s62, s62, 65536
    v_mul_u32_u24 v124, 272, v3
    v_lshl_add_u32 v124, v2, 4, v124
    v_add_u32 v124, s62, v124
    ds_write_b128 v124, v[8:11] offset:0
    ds_write_b128 v124, v[12:15] offset:64
    ds_write_b128 v124, v[16:19] offset:128
    ds_write_b128 v124, v[20:23] offset:192
    ds_write_b128 v124, v[24:27] offset:4352
    ds_write_b128 v124, v[28:31] offset:4416
    ds_write_b128 v124, v[32:35] offset:4480
    ds_write_b128 v124, v[36:39] offset:4544
    s_mul_i32 s62, s8, 8704
    s_add_u32 s62, s62, 65536
    v_lshrrev_b32 v125, 3, v1
    s_lshl_b32 s63, s7, 3
    v_add_u32 v125, s63, v125
    v_mul_u32_u24 v125, 272, v125
    v_and_b32 v124, 7, v1
    v_lshl_add_u32 v125, v124, 5, v125
    v_add_u32 v125, s62, v125
    s_waitcnt lgkmcnt(0)
    s_barrier
    ds_read_b128 v[44:47], v125 offset:0
    ds_read_b128 v[48:51], v125 offset:16
    ds_read_b128 v[52:55], v125 offset:17408
    ds_read_b128 v[56:59], v125 offset:17424
    ds_read_b128 v[60:63], v125 offset:34816
    ds_read_b128 v[64:67], v125 offset:34832
    ds_read_b128 v[68:71], v125 offset:52224
    ds_read_b128 v[72:75], v125 offset:52240
    s_waitcnt lgkmcnt(4)
    v_pk_add_f32 v[44:45], v[44:45], v[52:53]
    v_pk_add_f32 v[46:47], v[46:47], v[54:55]
    v_pk_add_f32 v[48:49], v[48:49], v[56:57]
    v_pk_add_f32 v[50:51], v[50:51], v[58:59]
    s_waitcnt lgkmcnt(0)
    v_pk_add_f32 v[60:61], v[60:61], v[68:69]
    v_pk_add_f32 v[62:63], v[62:63], v[70:71]
    v_pk_add_f32 v[64:65], v[64:65], v[72:73]
    v_pk_add_f32 v[66:67], v[66:67], v[74:75]
    v_pk_add_f32 v[44:45], v[44:45], v[60:61]
    v_pk_add_f32 v[46:47], v[46:47], v[62:63]
    v_pk_add_f32 v[48:49], v[48:49], v[64:65]
    v_pk_add_f32 v[50:51], v[50:51], v[66:67]
    s_waitcnt vmcnt(0)
    v_cvt_pk_bf16_f32 v60, v44, v45
    v_cvt_pk_bf16_f32 v61, v46, v47
    v_cvt_pk_bf16_f32 v62, v48, v49
    v_cvt_pk_bf16_f32 v63, v50, v51
    v_lshlrev_b32 v44, 16, v60
    v_and_b32 v45, 0xffff0000, v60
    v_lshlrev_b32 v52, 16, v40
    v_and_b32 v53, 0xffff0000, v40
    v_lshlrev_b32 v46, 16, v61
    v_and_b32 v47, 0xffff0000, v61
    v_lshlrev_b32 v54, 16, v41
    v_and_b32 v55, 0xffff0000, v41
    v_lshlrev_b32 v48, 16, v62
    v_and_b32 v49, 0xffff0000, v62
    v_lshlrev_b32 v56, 16, v42
    v_and_b32 v57, 0xffff0000, v42
    v_lshlrev_b32 v50, 16, v63
    v_and_b32 v51, 0xffff0000, v63
    v_lshlrev_b32 v58, 16, v43
    v_and_b32 v59, 0xffff0000, v43
    v_pk_add_f32 v[44:45], v[44:45], v[52:53]
    v_pk_add_f32 v[46:47], v[46:47], v[54:55]
    v_pk_add_f32 v[48:49], v[48:49], v[56:57]
    v_pk_add_f32 v[50:51], v[50:51], v[58:59]
    v_cvt_pk_bf16_f32 v60, v44, v45
    v_cvt_pk_bf16_f32 v61, v46, v47
    v_cvt_pk_bf16_f32 v62, v48, v49
    v_cvt_pk_bf16_f32 v63, v50, v51
    buffer_store_dwordx4 v[60:63], v7, s[56:59], s65 offen
    s_mov_b32 s62, 0x3f803f80
    v_mov_b32 v68, 0
    v_mov_b32 v69, 0
    v_dot2c_f32_bf16 v68, s62, v60
    v_dot2c_f32_bf16 v69, v60, v60
    v_dot2c_f32_bf16 v68, s62, v61
    v_dot2c_f32_bf16 v69, v61, v61
    v_dot2c_f32_bf16 v68, s62, v62
    v_dot2c_f32_bf16 v69, v62, v62
    v_dot2c_f32_bf16 v68, s62, v63
    v_dot2c_f32_bf16 v69, v63, v63
    s_nop 1
    v_add_f32_dpp v68, v68, v68 quad_perm:[1,0,3,2] row_mask:0xf bank_mask:0xf
    v_add_f32_dpp v69, v69, v69 quad_perm:[1,0,3,2] row_mask:0xf bank_mask:0xf
    s_nop 0
    v_add_f32_dpp v68, v68, v68 quad_perm:[2,3,0,1] row_mask:0xf bank_mask:0xf
    v_add_f32_dpp v69, v69, v69 quad_perm:[2,3,0,1] row_mask:0xf bank_mask:0xf
    s_nop 0
    v_add_f32_dpp v68, v68, v68 row_half_mirror row_mask:0xf bank_mask:0xf
    v_add_f32_dpp v69, v69, v69 row_half_mirror row_mask:0xf bank_mask:0xf
    s_add_u32 s40, s38, 0x14e0000
    s_addc_u32 s41, s39, 0
    s_mov_b32 s42, 0x20000
    s_mov_b32 s43, 0x00020000
    v_lshrrev_b32 v124, 3, v1
    v_lshlrev_b32 v124, 6, v124
    s_lshl_b32 s62, s60, 3
    s_add_u32 s62, s62, s4
    s_lshl_b32 s62, s62, 6
    s_add_u32 s62, s62, s61
    s_lshl_b32 s62, s62, 3
    s_mov_b32 exec_lo, 0x01010101
    s_mov_b32 exec_hi, 0x01010101
    buffer_store_dwordx2 v[68:69], v124, s[40:43], s62 offen
    s_mov_b64 exec, -1
    v_mov_b32 v4, 163808
    v_mov_b32 v5, 1
    s_add_u32 s72, s38, 0x1580000
    s_addc_u32 s73, s39, 0
    s_mov_b32 s74, 0x3000
    s_mov_b32 s75, 0x00020000
    s_waitcnt vmcnt(0) lgkmcnt(0)
    s_mov_b64 exec, 1
    ds_add_rtn_u32 v5, v4, v5
    s_waitcnt lgkmcnt(0)
    s_mov_b64 exec, -1
    v_readfirstlane_b32 s70, v5
    s_nop 3
    s_and_b32 s70, s70, 7
    s_cmp_lg_u32 s70, 7
    s_cbranch_scc1 Lsg_135
    s_lshl_b32 s70, s5, 6
    s_add_u32 s70, s70, s6
    s_lshl_b32 s70, s70, 2
    v_mov_b32 v4, 7
    v_mov_b32 v5, 0
    s_mov_b64 exec, 1
    buffer_store_dword v4, v5, s[72:75], s70 offen
    s_mov_b64 exec, -1
    s_nop 1
Lsg_135:
    s_nop 7
    s_nop 7
    s_barrier
    s_lshl_b32 s63, s5, 2
    s_add_u32 s63, s63, s7
    s_mul_i32 s64, s63, 116736
    s_lshl_b32 s63, s63, 11
    s_add_u32 s48, s38, 0x14e0000
    s_addc_u32 s49, s39, 0
    s_mov_b32 s50, 0x20000
    s_mov_b32 s51, 0x00020000
    s_mov_b32 s52, s28
    s_mov_b32 s53, s29
    s_mov_b32 s54, 0xe00
    s_mov_b32 s55, 0x00020000
    s_add_u32 s56, s38, 0xc00000
    s_addc_u32 s57, s39, 0
    s_mov_b32 s58, 0x720000
    s_mov_b32 s59, 0x00020000
    s_mul_i32 s62, s6, 112
    s_lshl_b32 s60, s8, 6
    s_add_u32 s62, s62, s60
    s_lshl_b32 s60, s62, 1
    v_lshlrev_b32 v5, 3, v2
    buffer_load_dwordx2 v[56:57], v5, s[52:55], s60 offen offset:0
    buffer_load_dwordx2 v[58:59], v5, s[52:55], s60 offen offset:32
    buffer_load_dwordx2 v[60:61], v5, s[52:55], s60 offen offset:64
    buffer_load_dwordx2 v[62:63], v5, s[52:55], s60 offen offset:96
    s_lshr_b32 s60, s6, 1
    s_mul_i32 s60, s60, 7168
    s_add_u32 s64, s64, s60
    s_and_b32 s60, s6, 1
    s_lshl_b32 s65, s60, 3
    s_add_u32 s65, s65, s64
    s_add_u32 s65, s65, 6144
    s_mul_i32 s60, s60, 3072
    s_add_u32 s64, s64, s60
    s_lshl_b32 s60, s8, 11
    s_add_u32 s64, s64, s60
    v_lshlrev_b32 v144, 4, v1
    v_mov_b32 v146, 0xbdd2d3e8
    v_mov_b32 v148, 0xc0135761
    v_mov_b32 v150, 1.0
    s_cmp_lg_u32 s8, 0
    s_cbranch_scc1 Lnh1_136
    s_lshl_b32 s79, s7, 12
    v_lshlrev_b32 v152, 4, v1
    v_add_u32 v154, s79, v152
    v_add_u32 v155, 0x10000, v154
    v_add_u32 v156, 0x20000, v154
    v_lshlrev_b32 v152, 4, v1
    v_add_u32 v157, 0, v152
    v_add_u32 v158, 0x10000, v157
    s_lshl_b32 s79, s4, 8
    s_add_u32 s79, s79, 0
    v_lshlrev_b32 v159, 4, v2
    v_add_u32 v159, s79, v159
    s_barrier
    ds_read_b128 v[64:67], v155 offset:20480
    ds_read_b128 v[68:71], v155 offset:22528
    ds_read_b128 v[72:75], v157 offset:0
    ds_read_b128 v[76:79], v157 offset:1024
    ds_read_b128 v[80:83], v157 offset:2048
    ds_read_b128 v[84:87], v157 offset:3072
    ds_read_b128 v[88:91], v155 offset:21504
    ds_read_b128 v[92:95], v155 offset:23552
    ds_read_b128 v[96:99], v157 offset:7168
    ds_read_b128 v[100:103], v157 offset:8192
    ds_read_b128 v[104:107], v157 offset:9216
    ds_read_b128 v[108:111], v157 offset:10240
    s_waitcnt lgkmcnt(6)
    s_waitcnt lgkmcnt(0)
    s_barrier
    v_mfma_f32_16x16x32_bf16 v[8:11], v[72:75], v[64:67], 0
    v_mfma_f32_16x16x32_bf16 v[24:27], v[72:75], v[68:71], 0
    ds_read_b128 v[112:115], v155 offset:36864
    v_mfma_f32_16x16x32_bf16 v[12:15], v[76:79], v[64:67], 0
    ds_read_b128 v[116:119], v155 offset:38912
    v_mfma_f32_16x16x32_bf16 v[28:31], v[76:79], v[68:71], 0
    ds_read_b128 v[120:123], v157 offset:14336
    v_mfma_f32_16x16x32_bf16 v[16:19], v[80:83], v[64:67], 0
    ds_read_b128 v[124:127], v157 offset:15360
    v_mfma_f32_16x16x32_bf16 v[32:35], v[80:83], v[68:71], 0
    ds_read_b128 v[128:131], v157 offset:16384
    v_mfma_f32_16x16x32_bf16 v[20:23], v[84:87], v[64:67], 0
    ds_read_b128 v[132:135], v157 offset:17408
    v_mfma_f32_16x16x32_bf16 v[36:39], v[84:87], v[68:71], 0
    v_mfma_f32_16x16x32_bf16 v[8:11], v[96:99], v[88:91], v[8:11]
    v_mfma_f32_16x16x32_bf16 v[24:27], v[96:99], v[92:95], v[24:27]
    ds_read_b128 v[64:67], v155 offset:37888
    v_mfma_f32_16x16x32_bf16 v[12:15], v[100:103], v[88:91], v[12:15]
    ds_read_b128 v[68:71], v155 offset:39936
    v_mfma_f32_16x16x32_bf16 v[28:31], v[100:103], v[92:95], v[28:31]
    ds_read_b128 v[72:75], v157 offset:21504
    v_mfma_f32_16x16x32_bf16 v[16:19], v[104:107], v[88:91], v[16:19]
    ds_read_b128 v[76:79], v157 offset:22528
    v_mfma_f32_16x16x32_bf16 v[32:35], v[104:107], v[92:95], v[32:35]
    ds_read_b128 v[80:83], v157 offset:23552
    v_mfma_f32_16x16x32_bf16 v[20:23], v[108:111], v[88:91], v[20:23]
    ds_read_b128 v[84:87], v157 offset:24576
    v_mfma_f32_16x16x32_bf16 v[36:39], v[108:111], v[92:95], v[36:39]
    s_waitcnt lgkmcnt(6)
    s_waitcnt lgkmcnt(0)
    s_barrier
    v_mfma_f32_16x16x32_bf16 v[8:11], v[120:123], v[112:115], v[8:11]
    v_mfma_f32_16x16x32_bf16 v[24:27], v[120:123], v[116:119], v[24:27]
    ds_read_b128 v[88:91], v155 offset:53248
    v_mfma_f32_16x16x32_bf16 v[12:15], v[124:127], v[112:115], v[12:15]
    ds_read_b128 v[92:95], v155 offset:55296
    v_mfma_f32_16x16x32_bf16 v[28:31], v[124:127], v[116:119], v[28:31]
    ds_read_b128 v[96:99], v157 offset:28672
    v_mfma_f32_16x16x32_bf16 v[16:19], v[128:131], v[112:115], v[16:19]
    ds_read_b128 v[100:103], v157 offset:29696
    v_mfma_f32_16x16x32_bf16 v[32:35], v[128:131], v[116:119], v[32:35]
    ds_read_b128 v[104:107], v157 offset:30720
    v_mfma_f32_16x16x32_bf16 v[20:23], v[132:135], v[112:115], v[20:23]
    ds_read_b128 v[108:111], v157 offset:31744
    v_mfma_f32_16x16x32_bf16 v[36:39], v[132:135], v[116:119], v[36:39]
    v_mfma_f32_16x16x32_bf16 v[8:11], v[72:75], v[64:67], v[8:11]
    v_mfma_f32_16x16x32_bf16 v[24:27], v[72:75], v[68:71], v[24:27]
    ds_read_b128 v[112:115], v155 offset:54272
    v_mfma_f32_16x16x32_bf16 v[12:15], v[76:79], v[64:67], v[12:15]
    ds_read_b128 v[116:119], v155 offset:56320
    v_mfma_f32_16x16x32_bf16 v[28:31], v[76:79], v[68:71], v[28:31]
    ds_read_b128 v[120:123], v157 offset:35840
    v_mfma_f32_16x16x32_bf16 v[16:19], v[80:83], v[64:67], v[16:19]
    ds_read_b128 v[124:127], v157 offset:36864
    v_mfma_f32_16x16x32_bf16 v[32:35], v[80:83], v[68:71], v[32:35]
    ds_read_b128 v[128:131], v157 offset:37888
    v_mfma_f32_16x16x32_bf16 v[20:23], v[84:87], v[64:67], v[20:23]
    ds_read_b128 v[132:135], v157 offset:38912
    v_mfma_f32_16x16x32_bf16 v[36:39], v[84:87], v[68:71], v[36:39]
    s_waitcnt lgkmcnt(6)
    s_waitcnt lgkmcnt(0)
    s_barrier
    v_mfma_f32_16x16x32_bf16 v[8:11], v[96:99], v[88:91], v[8:11]
    v_mfma_f32_16x16x32_bf16 v[24:27], v[96:99], v[92:95], v[24:27]
    ds_read_b128 v[64:67], v156 offset:4096
    v_mfma_f32_16x16x32_bf16 v[12:15], v[100:103], v[88:91], v[12:15]
    ds_read_b128 v[68:71], v156 offset:6144
    v_mfma_f32_16x16x32_bf16 v[28:31], v[100:103], v[92:95], v[28:31]
    ds_read_b128 v[72:75], v157 offset:43008
    v_mfma_f32_16x16x32_bf16 v[16:19], v[104:107], v[88:91], v[16:19]
    ds_read_b128 v[76:79], v157 offset:44032
    v_mfma_f32_16x16x32_bf16 v[32:35], v[104:107], v[92:95], v[32:35]
    ds_read_b128 v[80:83], v157 offset:45056
    v_mfma_f32_16x16x32_bf16 v[20:23], v[108:111], v[88:91], v[20:23]
    ds_read_b128 v[84:87], v157 offset:46080
    v_mfma_f32_16x16x32_bf16 v[36:39], v[108:111], v[92:95], v[36:39]
    v_mfma_f32_16x16x32_bf16 v[8:11], v[120:123], v[112:115], v[8:11]
    v_mfma_f32_16x16x32_bf16 v[24:27], v[120:123], v[116:119], v[24:27]
    ds_read_b128 v[88:91], v156 offset:5120
    v_mfma_f32_16x16x32_bf16 v[12:15], v[124:127], v[112:115], v[12:15]
    ds_read_b128 v[92:95], v156 offset:7168
    v_mfma_f32_16x16x32_bf16 v[28:31], v[124:127], v[116:119], v[28:31]
    ds_read_b128 v[96:99], v157 offset:50176
    v_mfma_f32_16x16x32_bf16 v[16:19], v[128:131], v[112:115], v[16:19]
    ds_read_b128 v[100:103], v157 offset:51200
    v_mfma_f32_16x16x32_bf16 v[32:35], v[128:131], v[116:119], v[32:35]
    ds_read_b128 v[104:107], v157 offset:52224
    v_mfma_f32_16x16x32_bf16 v[20:23], v[132:135], v[112:115], v[20:23]
    ds_read_b128 v[108:111], v157 offset:53248
    v_mfma_f32_16x16x32_bf16 v[36:39], v[132:135], v[116:119], v[36:39]
    s_waitcnt lgkmcnt(6)
    s_waitcnt lgkmcnt(0)
    s_barrier
    v_mfma_f32_16x16x32_bf16 v[8:11], v[72:75], v[64:67], v[8:11]
    v_mfma_f32_16x16x32_bf16 v[24:27], v[72:75], v[68:71], v[24:27]
    ds_read_b128 v[112:115], v155 offset:20480
    v_mfma_f32_16x16x32_bf16 v[12:15], v[76:79], v[64:67], v[12:15]
    ds_read_b128 v[116:119], v155 offset:22528
    v_mfma_f32_16x16x32_bf16 v[28:31], v[76:79], v[68:71], v[28:31]
    ds_read_b128 v[120:123], v157 offset:57344
    v_mfma_f32_16x16x32_bf16 v[16:19], v[80:83], v[64:67], v[16:19]
    ds_read_b128 v[124:127], v157 offset:58368
    v_mfma_f32_16x16x32_bf16 v[32:35], v[80:83], v[68:71], v[32:35]
    ds_read_b128 v[128:131], v157 offset:59392
    v_mfma_f32_16x16x32_bf16 v[20:23], v[84:87], v[64:67], v[20:23]
    ds_read_b128 v[132:135], v157 offset:60416
    v_mfma_f32_16x16x32_bf16 v[36:39], v[84:87], v[68:71], v[36:39]
    v_mfma_f32_16x16x32_bf16 v[8:11], v[96:99], v[88:91], v[8:11]
    v_mfma_f32_16x16x32_bf16 v[24:27], v[96:99], v[92:95], v[24:27]
    ds_read_b128 v[64:67], v155 offset:21504
    v_mfma_f32_16x16x32_bf16 v[12:15], v[100:103], v[88:91], v[12:15]
    ds_read_b128 v[68:71], v155 offset:23552
    v_mfma_f32_16x16x32_bf16 v[28:31], v[100:103], v[92:95], v[28:31]
    ds_read_b128 v[72:75], v157 offset:64512
    v_mfma_f32_16x16x32_bf16 v[16:19], v[104:107], v[88:91], v[16:19]
    ds_read_b128 v[76:79], v158 offset:0
    v_mfma_f32_16x16x32_bf16 v[32:35], v[104:107], v[92:95], v[32:35]
    ds_read_b128 v[80:83], v158 offset:1024
    v_mfma_f32_16x16x32_bf16 v[20:23], v[108:111], v[88:91], v[20:23]
    ds_read_b128 v[84:87], v158 offset:2048
    v_mfma_f32_16x16x32_bf16 v[36:39], v[108:111], v[92:95], v[36:39]
    s_waitcnt lgkmcnt(6)
    s_waitcnt lgkmcnt(0)
    s_barrier
    v_mfma_f32_16x16x32_bf16 v[8:11], v[120:123], v[112:115], v[8:11]
    v_mfma_f32_16x16x32_bf16 v[24:27], v[120:123], v[116:119], v[24:27]
    ds_read_b128 v[88:91], v155 offset:36864
    v_mfma_f32_16x16x32_bf16 v[12:15], v[124:127], v[112:115], v[12:15]
    ds_read_b128 v[92:95], v155 offset:38912
    v_mfma_f32_16x16x32_bf16 v[28:31], v[124:127], v[116:119], v[28:31]
    ds_read_b128 v[96:99], v158 offset:6144
    v_mfma_f32_16x16x32_bf16 v[16:19], v[128:131], v[112:115], v[16:19]
    ds_read_b128 v[100:103], v158 offset:7168
    v_mfma_f32_16x16x32_bf16 v[32:35], v[128:131], v[116:119], v[32:35]
    ds_read_b128 v[104:107], v158 offset:8192
    v_mfma_f32_16x16x32_bf16 v[20:23], v[132:135], v[112:115], v[20:23]
    ds_read_b128 v[108:111], v158 offset:9216
    v_mfma_f32_16x16x32_bf16 v[36:39], v[132:135], v[116:119], v[36:39]
    v_mfma_f32_16x16x32_bf16 v[8:11], v[72:75], v[64:67], v[8:11]
    v_mfma_f32_16x16x32_bf16 v[24:27], v[72:75], v[68:71], v[24:27]
    ds_read_b128 v[112:115], v155 offset:37888
    v_mfma_f32_16x16x32_bf16 v[12:15], v[76:79], v[64:67], v[12:15]
    ds_read_b128 v[116:119], v155 offset:39936
    v_mfma_f32_16x16x32_bf16 v[28:31], v[76:79], v[68:71], v[28:31]
    ds_read_b128 v[120:123], v158 offset:13312
    v_mfma_f32_16x16x32_bf16 v[16:19], v[80:83], v[64:67], v[16:19]
    ds_read_b128 v[124:127], v158 offset:14336
    v_mfma_f32_16x16x32_bf16 v[32:35], v[80:83], v[68:71], v[32:35]
    ds_read_b128 v[128:131], v158 offset:15360
    v_mfma_f32_16x16x32_bf16 v[20:23], v[84:87], v[64:67], v[20:23]
    ds_read_b128 v[132:135], v158 offset:16384
    v_mfma_f32_16x16x32_bf16 v[36:39], v[84:87], v[68:71], v[36:39]
    s_waitcnt lgkmcnt(6)
    s_waitcnt lgkmcnt(0)
    s_barrier
    v_mfma_f32_16x16x32_bf16 v[8:11], v[96:99], v[88:91], v[8:11]
    v_mfma_f32_16x16x32_bf16 v[24:27], v[96:99], v[92:95], v[24:27]
    ds_read_b128 v[64:67], v155 offset:53248
    v_mfma_f32_16x16x32_bf16 v[12:15], v[100:103], v[88:91], v[12:15]
    ds_read_b128 v[68:71], v155 offset:55296
    v_mfma_f32_16x16x32_bf16 v[28:31], v[100:103], v[92:95], v[28:31]
    ds_read_b128 v[72:75], v157 offset:0
    v_mfma_f32_16x16x32_bf16 v[16:19], v[104:107], v[88:91], v[16:19]
    ds_read_b128 v[76:79], v157 offset:1024
    v_mfma_f32_16x16x32_bf16 v[32:35], v[104:107], v[92:95], v[32:35]
    ds_read_b128 v[80:83], v157 offset:2048
    v_mfma_f32_16x16x32_bf16 v[20:23], v[108:111], v[88:91], v[20:23]
    ds_read_b128 v[84:87], v157 offset:3072
    v_mfma_f32_16x16x32_bf16 v[36:39], v[108:111], v[92:95], v[36:39]
    v_mfma_f32_16x16x32_bf16 v[8:11], v[120:123], v[112:115], v[8:11]
    v_mfma_f32_16x16x32_bf16 v[24:27], v[120:123], v[116:119], v[24:27]
    ds_read_b128 v[88:91], v155 offset:54272
    v_mfma_f32_16x16x32_bf16 v[12:15], v[124:127], v[112:115], v[12:15]
    ds_read_b128 v[92:95], v155 offset:56320
    v_mfma_f32_16x16x32_bf16 v[28:31], v[124:127], v[116:119], v[28:31]
    ds_read_b128 v[96:99], v157 offset:7168
    v_mfma_f32_16x16x32_bf16 v[16:19], v[128:131], v[112:115], v[16:19]
    ds_read_b128 v[100:103], v157 offset:8192
    v_mfma_f32_16x16x32_bf16 v[32:35], v[128:131], v[116:119], v[32:35]
    ds_read_b128 v[104:107], v157 offset:9216
    v_mfma_f32_16x16x32_bf16 v[20:23], v[132:135], v[112:115], v[20:23]
    ds_read_b128 v[108:111], v157 offset:10240
    v_mfma_f32_16x16x32_bf16 v[36:39], v[132:135], v[116:119], v[36:39]
    s_waitcnt lgkmcnt(6)
    s_waitcnt lgkmcnt(0)
    s_barrier
    v_mfma_f32_16x16x32_bf16 v[8:11], v[72:75], v[64:67], v[8:11]
    v_mfma_f32_16x16x32_bf16 v[24:27], v[72:75], v[68:71], v[24:27]
    ds_read_b128 v[112:115], v156 offset:4096
    v_mfma_f32_16x16x32_bf16 v[12:15], v[76:79], v[64:67], v[12:15]
    ds_read_b128 v[116:119], v156 offset:6144
    v_mfma_f32_16x16x32_bf16 v[28:31], v[76:79], v[68:71], v[28:31]
    ds_read_b128 v[120:123], v157 offset:14336
    v_mfma_f32_16x16x32_bf16 v[16:19], v[80:83], v[64:67], v[16:19]
    ds_read_b128 v[124:127], v157 offset:15360
    v_mfma_f32_16x16x32_bf16 v[32:35], v[80:83], v[68:71], v[32:35]
    ds_read_b128 v[128:131], v157 offset:16384
    v_mfma_f32_16x16x32_bf16 v[20:23], v[84:87], v[64:67], v[20:23]
    ds_read_b128 v[132:135], v157 offset:17408
    v_mfma_f32_16x16x32_bf16 v[36:39], v[84:87], v[68:71], v[36:39]
    v_mfma_f32_16x16x32_bf16 v[8:11], v[96:99], v[88:91], v[8:11]
    v_mfma_f32_16x16x32_bf16 v[24:27], v[96:99], v[92:95], v[24:27]
    ds_read_b128 v[64:67], v156 offset:5120
    v_mfma_f32_16x16x32_bf16 v[12:15], v[100:103], v[88:91], v[12:15]
    ds_read_b128 v[68:71], v156 offset:7168
    v_mfma_f32_16x16x32_bf16 v[28:31], v[100:103], v[92:95], v[28:31]
    ds_read_b128 v[72:75], v157 offset:21504
    v_mfma_f32_16x16x32_bf16 v[16:19], v[104:107], v[88:91], v[16:19]
    ds_read_b128 v[76:79], v157 offset:22528
    v_mfma_f32_16x16x32_bf16 v[32:35], v[104:107], v[92:95], v[32:35]
    ds_read_b128 v[80:83], v157 offset:23552
    v_mfma_f32_16x16x32_bf16 v[20:23], v[108:111], v[88:91], v[20:23]
    ds_read_b128 v[84:87], v157 offset:24576
    v_mfma_f32_16x16x32_bf16 v[36:39], v[108:111], v[92:95], v[36:39]
    s_lshl_b32 s60, s7, 8
    s_add_u32 s60, s60, 161792
    v_lshlrev_b32 v4, 3, v3
    v_add_u32 v4, s60, v4
    ds_read_b64 v[136:137], v4 offset:0
    ds_read_b64 v[138:139], v4 offset:128
    s_lshl_b32 s60, s8, 8
    s_add_u32 s60, s60, 163200
    v_lshlrev_b32 v4, 4, v2
    v_add_u32 v4, s60, v4
    ds_read_b128 v[40:43], v4 offset:0
    ds_read_b128 v[44:47], v4 offset:64
    ds_read_b128 v[48:51], v4 offset:128
    ds_read_b128 v[52:55], v4 offset:192
    s_waitcnt lgkmcnt(12)
    v_mfma_f32_16x16x32_bf16 v[8:11], v[120:123], v[112:115], v[8:11]
    v_mfma_f32_16x16x32_bf16 v[24:27], v[120:123], v[116:119], v[24:27]
    v_mfma_f32_16x16x32_bf16 v[12:15], v[124:127], v[112:115], v[12:15]
    v_mfma_f32_16x16x32_bf16 v[28:31], v[124:127], v[116:119], v[28:31]
    v_mfma_f32_16x16x32_bf16 v[16:19], v[128:131], v[112:115], v[16:19]
    v_mfma_f32_16x16x32_bf16 v[32:35], v[128:131], v[116:119], v[32:35]
    v_mfma_f32_16x16x32_bf16 v[20:23], v[132:135], v[112:115], v[20:23]
    v_mfma_f32_16x16x32_bf16 v[36:39], v[132:135], v[116:119], v[36:39]
    s_waitcnt lgkmcnt(6)
    v_mfma_f32_16x16x32_bf16 v[8:11], v[72:75], v[64:67], v[8:11]
    v_mfma_f32_16x16x32_bf16 v[24:27], v[72:75], v[68:71], v[24:27]
    v_mfma_f32_16x16x32_bf16 v[12:15], v[76:79], v[64:67], v[12:15]
    v_mfma_f32_16x16x32_bf16 v[28:31], v[76:79], v[68:71], v[28:31]
    v_mfma_f32_16x16x32_bf16 v[16:19], v[80:83], v[64:67], v[16:19]
    v_mfma_f32_16x16x32_bf16 v[32:35], v[80:83], v[68:71], v[32:35]
    v_mfma_f32_16x16x32_bf16 v[20:23], v[84:87], v[64:67], v[20:23]
    v_mfma_f32_16x16x32_bf16 v[36:39], v[84:87], v[68:71], v[36:39]
    s_waitcnt vmcnt(0) lgkmcnt(0)
    s_barrier
    v_mov_b32 v140, v137
    v_mov_b32 v142, v139
    v_lshlrev_b32 v96, 16, v56
    v_and_b32 v97, 0xffff0000, v56
    v_lshlrev_b32 v98, 16, v57
    v_and_b32 v99, 0xffff0000, v57
    v_lshlrev_b32 v100, 16, v58
    v_and_b32 v101, 0xffff0000, v58
    v_lshlrev_b32 v102, 16, v59
    v_and_b32 v103, 0xffff0000, v59
    v_lshlrev_b32 v104, 16, v60
    v_and_b32 v105, 0xffff0000, v60
    v_lshlrev_b32 v106, 16, v61
    v_and_b32 v107, 0xffff0000, v61
    v_lshlrev_b32 v108, 16, v62
    v_and_b32 v109, 0xffff0000, v62
    v_lshlrev_b32 v110, 16, v63
    v_and_b32 v111, 0xffff0000, v63
    v_pk_fma_f32 v[8:9], v[8:9], v[140:141], v[96:97] op_sel_hi:[1,0,1]
    v_pk_fma_f32 v[10:11], v[10:11], v[140:141], v[98:99] op_sel_hi:[1,0,1]
    v_pk_fma_f32 v[12:13], v[12:13], v[140:141], v[100:101] op_sel_hi:[1,0,1]
    v_pk_fma_f32 v[14:15], v[14:15], v[140:141], v[102:103] op_sel_hi:[1,0,1]
    v_pk_fma_f32 v[16:17], v[16:17], v[140:141], v[104:105] op_sel_hi:[1,0,1]
    v_pk_fma_f32 v[18:19], v[18:19], v[140:141], v[106:107] op_sel_hi:[1,0,1]
    v_pk_fma_f32 v[20:21], v[20:21], v[140:141], v[108:109] op_sel_hi:[1,0,1]
    v_pk_fma_f32 v[22:23], v[22:23], v[140:141], v[110:111] op_sel_hi:[1,0,1]
    v_pk_fma_f32 v[8:9], v[40:41], v[136:137], v[8:9] op_sel_hi:[1,0,1]
    v_pk_fma_f32 v[10:11], v[42:43], v[136:137], v[10:11] op_sel_hi:[1,0,1]
    v_pk_fma_f32 v[12:13], v[44:45], v[136:137], v[12:13] op_sel_hi:[1,0,1]
    v_pk_fma_f32 v[14:15], v[46:47], v[136:137], v[14:15] op_sel_hi:[1,0,1]
    v_pk_fma_f32 v[16:17], v[48:49], v[136:137], v[16:17] op_sel_hi:[1,0,1]
    v_pk_fma_f32 v[18:19], v[50:51], v[136:137], v[18:19] op_sel_hi:[1,0,1]
    v_pk_fma_f32 v[20:21], v[52:53], v[136:137], v[20:21] op_sel_hi:[1,0,1]
    v_pk_fma_f32 v[22:23], v[54:55], v[136:137], v[22:23] op_sel_hi:[1,0,1]
    v_pk_mul_f32 v[64:65], v[8:9], v[8:9]
    v_pk_mul_f32 v[66:67], v[10:11], v[10:11]
    v_pk_mul_f32 v[68:69], v[12:13], v[12:13]
    v_pk_mul_f32 v[70:71], v[14:15], v[14:15]
    v_pk_mul_f32 v[72:73], v[16:17], v[16:17]
    v_pk_mul_f32 v[74:75], v[18:19], v[18:19]
    v_pk_mul_f32 v[76:77], v[20:21], v[20:21]
    v_pk_mul_f32 v[78:79], v[22:23], v[22:23]
    v_pk_fma_f32 v[64:65], v[64:65], v[146:147], v[148:149] op_sel_hi:[1,0,0]
    v_pk_fma_f32 v[66:67], v[66:67], v[146:147], v[148:149] op_sel_hi:[1,0,0]
    v_pk_fma_f32 v[68:69], v[68:69], v[146:147], v[148:149] op_sel_hi:[1,0,0]
    v_pk_fma_f32 v[70:71], v[70:71], v[146:147], v[148:149] op_sel_hi:[1,0,0]
    v_pk_fma_f32 v[72:73], v[72:73], v[146:147], v[148:149] op_sel_hi:[1,0,0]
    v_pk_fma_f32 v[74:75], v[74:75], v[146:147], v[148:149] op_sel_hi:[1,0,0]
    v_pk_fma_f32 v[76:77], v[76:77], v[146:147], v[148:149] op_sel_hi:[1,0,0]
    v_pk_fma_f32 v[78:79], v[78:79], v[146:147], v[148:149] op_sel_hi:[1,0,0]
    v_pk_mul_f32 v[64:65], v[64:65], v[8:9]
    v_pk_mul_f32 v[66:67], v[66:67], v[10:11]
    v_pk_mul_f32 v[68:69], v[68:69], v[12:13]
    v_pk_mul_f32 v[70:71], v[70:71], v[14:15]
    v_pk_mul_f32 v[72:73], v[72:73], v[16:17]
    v_pk_mul_f32 v[74:75], v[74:75], v[18:19]
    v_pk_mul_f32 v[76:77], v[76:77], v[20:21]
    v_pk_mul_f32 v[78:79], v[78:79], v[22:23]
    v_exp_f32 v64, v64
    v_exp_f32 v65, v65
    v_exp_f32 v66, v66
    v_exp_f32 v67, v67
    v_exp_f32 v68, v68
    v_exp_f32 v69, v69
    v_exp_f32 v70, v70
    v_exp_f32 v71, v71
    v_exp_f32 v72, v72
    v_exp_f32 v73, v73
    v_exp_f32 v74, v74
    v_exp_f32 v75, v75
    v_exp_f32 v76, v76
    v_exp_f32 v77, v77
    v_exp_f32 v78, v78
    v_exp_f32 v79, v79
    v_pk_add_f32 v[64:65], v[64:65], v[150:151] op_sel_hi:[1,0]
    v_pk_add_f32 v[66:67], v[66:67], v[150:151] op_sel_hi:[1,0]
    v_pk_add_f32 v[68:69], v[68:69], v[150:151] op_sel_hi:[1,0]
    v_pk_add_f32 v[70:71], v[70:71], v[150:151] op_sel_hi:[1,0]
    v_pk_add_f32 v[72:73], v[72:73], v[150:151] op_sel_hi:[1,0]
    v_pk_add_f32 v[74:75], v[74:75], v[150:151] op_sel_hi:[1,0]
    v_pk_add_f32 v[76:77], v[76:77], v[150:151] op_sel_hi:[1,0]
    v_pk_add_f32 v[78:79], v[78:79], v[150:151] op_sel_hi:[1,0]
    v_rcp_f32 v64, v64
    v_rcp_f32 v65, v65
    v_rcp_f32 v66, v66
    v_rcp_f32 v67, v67
    v_rcp_f32 v68, v68
    v_rcp_f32 v69, v69
    v_rcp_f32 v70, v70
    v_rcp_f32 v71, v71
    v_rcp_f32 v72, v72
    v_rcp_f32 v73, v73
    v_rcp_f32 v74, v74
    v_rcp_f32 v75, v75
    v_rcp_f32 v76, v76
    v_rcp_f32 v77, v77
    v_rcp_f32 v78, v78
    v_rcp_f32 v79, v79
    v_pk_mul_f32 v[8:9], v[8:9], v[64:65]
    v_pk_mul_f32 v[10:11], v[10:11], v[66:67]
    v_pk_mul_f32 v[12:13], v[12:13], v[68:69]
    v_pk_mul_f32 v[14:15], v[14:15], v[70:71]
    v_pk_mul_f32 v[16:17], v[16:17], v[72:73]
    v_pk_mul_f32 v[18:19], v[18:19], v[74:75]
    v_pk_mul_f32 v[20:21], v[20:21], v[76:77]
    v_pk_mul_f32 v[22:23], v[22:23], v[78:79]
    v_cvt_pk_bf16_f32 v128, v8, v9
    v_cvt_pk_bf16_f32 v129, v10, v11
    v_cvt_pk_bf16_f32 v130, v12, v13
    v_cvt_pk_bf16_f32 v131, v14, v15
    v_cvt_pk_bf16_f32 v132, v16, v17
    v_cvt_pk_bf16_f32 v133, v18, v19
    v_cvt_pk_bf16_f32 v134, v20, v21
    v_cvt_pk_bf16_f32 v135, v22, v23
    buffer_store_dwordx4 v[128:131], v144, s[56:59], s64 offen
    buffer_store_dwordx4 v[132:135], v144, s[56:59], s64 offen offset:1024
    v_pk_fma_f32 v[24:25], v[24:25], v[142:143], v[96:97] op_sel_hi:[1,0,1]
    v_pk_fma_f32 v[26:27], v[26:27], v[142:143], v[98:99] op_sel_hi:[1,0,1]
    v_pk_fma_f32 v[28:29], v[28:29], v[142:143], v[100:101] op_sel_hi:[1,0,1]
    v_pk_fma_f32 v[30:31], v[30:31], v[142:143], v[102:103] op_sel_hi:[1,0,1]
    v_pk_fma_f32 v[32:33], v[32:33], v[142:143], v[104:105] op_sel_hi:[1,0,1]
    v_pk_fma_f32 v[34:35], v[34:35], v[142:143], v[106:107] op_sel_hi:[1,0,1]
    v_pk_fma_f32 v[36:37], v[36:37], v[142:143], v[108:109] op_sel_hi:[1,0,1]
    v_pk_fma_f32 v[38:39], v[38:39], v[142:143], v[110:111] op_sel_hi:[1,0,1]
    v_pk_fma_f32 v[24:25], v[40:41], v[138:139], v[24:25] op_sel_hi:[1,0,1]
    v_pk_fma_f32 v[26:27], v[42:43], v[138:139], v[26:27] op_sel_hi:[1,0,1]
    v_pk_fma_f32 v[28:29], v[44:45], v[138:139], v[28:29] op_sel_hi:[1,0,1]
    v_pk_fma_f32 v[30:31], v[46:47], v[138:139], v[30:31] op_sel_hi:[1,0,1]
    v_pk_fma_f32 v[32:33], v[48:49], v[138:139], v[32:33] op_sel_hi:[1,0,1]
    v_pk_fma_f32 v[34:35], v[50:51], v[138:139], v[34:35] op_sel_hi:[1,0,1]
    v_pk_fma_f32 v[36:37], v[52:53], v[138:139], v[36:37] op_sel_hi:[1,0,1]
    v_pk_fma_f32 v[38:39], v[54:55], v[138:139], v[38:39] op_sel_hi:[1,0,1]
    v_pk_mul_f32 v[80:81], v[24:25], v[24:25]
    v_pk_mul_f32 v[82:83], v[26:27], v[26:27]
    v_pk_mul_f32 v[84:85], v[28:29], v[28:29]
    v_pk_mul_f32 v[86:87], v[30:31], v[30:31]
    v_pk_mul_f32 v[88:89], v[32:33], v[32:33]
    v_pk_mul_f32 v[90:91], v[34:35], v[34:35]
    v_pk_mul_f32 v[92:93], v[36:37], v[36:37]
    v_pk_mul_f32 v[94:95], v[38:39], v[38:39]
    v_pk_fma_f32 v[80:81], v[80:81], v[146:147], v[148:149] op_sel_hi:[1,0,0]
    v_pk_fma_f32 v[82:83], v[82:83], v[146:147], v[148:149] op_sel_hi:[1,0,0]
    v_pk_fma_f32 v[84:85], v[84:85], v[146:147], v[148:149] op_sel_hi:[1,0,0]
    v_pk_fma_f32 v[86:87], v[86:87], v[146:147], v[148:149] op_sel_hi:[1,0,0]
    v_pk_fma_f32 v[88:89], v[88:89], v[146:147], v[148:149] op_sel_hi:[1,0,0]
    v_pk_fma_f32 v[90:91], v[90:91], v[146:147], v[148:149] op_sel_hi:[1,0,0]
    v_pk_fma_f32 v[92:93], v[92:93], v[146:147], v[148:149] op_sel_hi:[1,0,0]
    v_pk_fma_f32 v[94:95], v[94:95], v[146:147], v[148:149] op_sel_hi:[1,0,0]
    v_pk_mul_f32 v[80:81], v[80:81], v[24:25]
    v_pk_mul_f32 v[82:83], v[82:83], v[26:27]
    v_pk_mul_f32 v[84:85], v[84:85], v[28:29]
    v_pk_mul_f32 v[86:87], v[86:87], v[30:31]
    v_pk_mul_f32 v[88:89], v[88:89], v[32:33]
    v_pk_mul_f32 v[90:91], v[90:91], v[34:35]
    v_pk_mul_f32 v[92:93], v[92:93], v[36:37]
    v_pk_mul_f32 v[94:95], v[94:95], v[38:39]
    v_exp_f32 v80, v80
    v_exp_f32 v81, v81
    v_exp_f32 v82, v82
    v_exp_f32 v83, v83
    v_exp_f32 v84, v84
    v_exp_f32 v85, v85
    v_exp_f32 v86, v86
    v_exp_f32 v87, v87
    v_exp_f32 v88, v88
    v_exp_f32 v89, v89
    v_exp_f32 v90, v90
    v_exp_f32 v91, v91
    v_exp_f32 v92, v92
    v_exp_f32 v93, v93
    v_exp_f32 v94, v94
    v_exp_f32 v95, v95
    v_pk_add_f32 v[80:81], v[80:81], v[150:151] op_sel_hi:[1,0]
    v_pk_add_f32 v[82:83], v[82:83], v[150:151] op_sel_hi:[1,0]
    v_pk_add_f32 v[84:85], v[84:85], v[150:151] op_sel_hi:[1,0]
    v_pk_add_f32 v[86:87], v[86:87], v[150:151] op_sel_hi:[1,0]
    v_pk_add_f32 v[88:89], v[88:89], v[150:151] op_sel_hi:[1,0]
    v_pk_add_f32 v[90:91], v[90:91], v[150:151] op_sel_hi:[1,0]
    v_pk_add_f32 v[92:93], v[92:93], v[150:151] op_sel_hi:[1,0]
    v_pk_add_f32 v[94:95], v[94:95], v[150:151] op_sel_hi:[1,0]
    v_rcp_f32 v80, v80
    v_rcp_f32 v81, v81
    v_rcp_f32 v82, v82
    v_rcp_f32 v83, v83
    v_rcp_f32 v84, v84
    v_rcp_f32 v85, v85
    v_rcp_f32 v86, v86
    v_rcp_f32 v87, v87
    v_rcp_f32 v88, v88
    v_rcp_f32 v89, v89
    v_rcp_f32 v90, v90
    v_rcp_f32 v91, v91
    v_rcp_f32 v92, v92
    v_rcp_f32 v93, v93
    v_rcp_f32 v94, v94
    v_rcp_f32 v95, v95
    v_pk_mul_f32 v[24:25], v[24:25], v[80:81]
    v_pk_mul_f32 v[26:27], v[26:27], v[82:83]
    v_pk_mul_f32 v[28:29], v[28:29], v[84:85]
    v_pk_mul_f32 v[30:31], v[30:31], v[86:87]
    v_pk_mul_f32 v[32:33], v[32:33], v[88:89]
    v_pk_mul_f32 v[34:35], v[34:35], v[90:91]
    v_pk_mul_f32 v[36:37], v[36:37], v[92:93]
    v_pk_mul_f32 v[38:39], v[38:39], v[94:95]
    v_cvt_pk_bf16_f32 v56, v24, v25
    v_cvt_pk_bf16_f32 v57, v26, v27
    v_cvt_pk_bf16_f32 v58, v28, v29
    v_cvt_pk_bf16_f32 v59, v30, v31
    v_cvt_pk_bf16_f32 v60, v32, v33
    v_cvt_pk_bf16_f32 v61, v34, v35
    v_cvt_pk_bf16_f32 v62, v36, v37
    v_cvt_pk_bf16_f32 v63, v38, v39
    s_add_u32 s64, s64, 58368
    s_add_u32 s65, s65, 58368
    buffer_store_dwordx4 v[56:59], v144, s[56:59], s64 offen
    buffer_store_dwordx4 v[60:63], v144, s[56:59], s64 offen offset:1024
    s_branch Lcj_137
Lnh1_136:
    s_nop 7
    s_nop 7
    s_lshl_b32 s79, s7, 12
    v_lshlrev_b32 v152, 4, v1
    v_add_u32 v154, s79, v152
    v_add_u32 v155, 0x10000, v154
    v_add_u32 v156, 0x20000, v154
    v_lshlrev_b32 v152, 4, v1
    v_add_u32 v157, 0x1000, v152
    v_add_u32 v158, 0x10000, v157
    s_lshl_b32 s79, s4, 8
    s_add_u32 s79, s79, 0
    v_lshlrev_b32 v159, 4, v2
    v_add_u32 v159, s79, v159
    s_barrier
    ds_read_b128 v[64:67], v155 offset:20480
    ds_read_b128 v[68:71], v155 offset:22528
    ds_read_b128 v[72:75], v157 offset:0
    ds_read_b128 v[76:79], v157 offset:1024
    ds_read_b128 v[80:83], v157 offset:2048
    ds_read_b128 v[84:87], v155 offset:21504
    ds_read_b128 v[88:91], v155 offset:23552
    ds_read_b128 v[92:95], v157 offset:7168
    ds_read_b128 v[96:99], v157 offset:8192
    ds_read_b128 v[100:103], v157 offset:9216
    s_waitcnt lgkmcnt(5)
    s_waitcnt lgkmcnt(0)
    s_barrier
    v_mfma_f32_16x16x32_bf16 v[8:11], v[72:75], v[64:67], 0
    ds_read_b128 v[104:107], v155 offset:36864
    v_mfma_f32_16x16x32_bf16 v[20:23], v[72:75], v[68:71], 0
    ds_read_b128 v[108:111], v155 offset:38912
    v_mfma_f32_16x16x32_bf16 v[12:15], v[76:79], v[64:67], 0
    ds_read_b128 v[112:115], v157 offset:14336
    v_mfma_f32_16x16x32_bf16 v[24:27], v[76:79], v[68:71], 0
    ds_read_b128 v[116:119], v157 offset:15360
    v_mfma_f32_16x16x32_bf16 v[16:19], v[80:83], v[64:67], 0
    ds_read_b128 v[120:123], v157 offset:16384
    v_mfma_f32_16x16x32_bf16 v[28:31], v[80:83], v[68:71], 0
    v_mfma_f32_16x16x32_bf16 v[8:11], v[92:95], v[84:87], v[8:11]
    ds_read_b128 v[64:67], v155 offset:37888
    v_mfma_f32_16x16x32_bf16 v[20:23], v[92:95], v[88:91], v[20:23]
    ds_read_b128 v[68:71], v155 offset:39936
    v_mfma_f32_16x16x32_bf16 v[12:15], v[96:99], v[84:87], v[12:15]
    ds_read_b128 v[72:75], v157 offset:21504
    v_mfma_f32_16x16x32_bf16 v[24:27], v[96:99], v[88:91], v[24:27]
    ds_read_b128 v[76:79], v157 offset:22528
    v_mfma_f32_16x16x32_bf16 v[16:19], v[100:103], v[84:87], v[16:19]
    ds_read_b128 v[80:83], v157 offset:23552
    v_mfma_f32_16x16x32_bf16 v[28:31], v[100:103], v[88:91], v[28:31]
    s_waitcnt lgkmcnt(5)
    s_waitcnt lgkmcnt(0)
    s_barrier
    v_mfma_f32_16x16x32_bf16 v[8:11], v[112:115], v[104:107], v[8:11]
    ds_read_b128 v[84:87], v155 offset:53248
    v_mfma_f32_16x16x32_bf16 v[20:23], v[112:115], v[108:111], v[20:23]
    ds_read_b128 v[88:91], v155 offset:55296
    v_mfma_f32_16x16x32_bf16 v[12:15], v[116:119], v[104:107], v[12:15]
    ds_read_b128 v[92:95], v157 offset:28672
    v_mfma_f32_16x16x32_bf16 v[24:27], v[116:119], v[108:111], v[24:27]
    ds_read_b128 v[96:99], v157 offset:29696
    v_mfma_f32_16x16x32_bf16 v[16:19], v[120:123], v[104:107], v[16:19]
    ds_read_b128 v[100:103], v157 offset:30720
    v_mfma_f32_16x16x32_bf16 v[28:31], v[120:123], v[108:111], v[28:31]
    v_mfma_f32_16x16x32_bf16 v[8:11], v[72:75], v[64:67], v[8:11]
    ds_read_b128 v[104:107], v155 offset:54272
    v_mfma_f32_16x16x32_bf16 v[20:23], v[72:75], v[68:71], v[20:23]
    ds_read_b128 v[108:111], v155 offset:56320
    v_mfma_f32_16x16x32_bf16 v[12:15], v[76:79], v[64:67], v[12:15]
    ds_read_b128 v[112:115], v157 offset:35840
    v_mfma_f32_16x16x32_bf16 v[24:27], v[76:79], v[68:71], v[24:27]
    ds_read_b128 v[116:119], v157 offset:36864
    v_mfma_f32_16x16x32_bf16 v[16:19], v[80:83], v[64:67], v[16:19]
    ds_read_b128 v[120:123], v157 offset:37888
    v_mfma_f32_16x16x32_bf16 v[28:31], v[80:83], v[68:71], v[28:31]
    s_waitcnt lgkmcnt(5)
    s_waitcnt lgkmcnt(0)
    s_barrier
    v_mfma_f32_16x16x32_bf16 v[8:11], v[92:95], v[84:87], v[8:11]
    ds_read_b128 v[64:67], v156 offset:4096
    v_mfma_f32_16x16x32_bf16 v[20:23], v[92:95], v[88:91], v[20:23]
    ds_read_b128 v[68:71], v156 offset:6144
    v_mfma_f32_16x16x32_bf16 v[12:15], v[96:99], v[84:87], v[12:15]
    ds_read_b128 v[72:75], v157 offset:43008
    v_mfma_f32_16x16x32_bf16 v[24:27], v[96:99], v[88:91], v[24:27]
    ds_read_b128 v[76:79], v157 offset:44032
    v_mfma_f32_16x16x32_bf16 v[16:19], v[100:103], v[84:87], v[16:19]
    ds_read_b128 v[80:83], v157 offset:45056
    v_mfma_f32_16x16x32_bf16 v[28:31], v[100:103], v[88:91], v[28:31]
    v_mfma_f32_16x16x32_bf16 v[8:11], v[112:115], v[104:107], v[8:11]
    ds_read_b128 v[84:87], v156 offset:5120
    v_mfma_f32_16x16x32_bf16 v[20:23], v[112:115], v[108:111], v[20:23]
    ds_read_b128 v[88:91], v156 offset:7168
    v_mfma_f32_16x16x32_bf16 v[12:15], v[116:119], v[104:107], v[12:15]
    ds_read_b128 v[92:95], v157 offset:50176
    v_mfma_f32_16x16x32_bf16 v[24:27], v[116:119], v[108:111], v[24:27]
    ds_read_b128 v[96:99], v157 offset:51200
    v_mfma_f32_16x16x32_bf16 v[16:19], v[120:123], v[104:107], v[16:19]
    ds_read_b128 v[100:103], v157 offset:52224
    v_mfma_f32_16x16x32_bf16 v[28:31], v[120:123], v[108:111], v[28:31]
    s_waitcnt lgkmcnt(5)
    s_waitcnt lgkmcnt(0)
    s_barrier
    v_mfma_f32_16x16x32_bf16 v[8:11], v[72:75], v[64:67], v[8:11]
    ds_read_b128 v[104:107], v155 offset:20480
    v_mfma_f32_16x16x32_bf16 v[20:23], v[72:75], v[68:71], v[20:23]
    ds_read_b128 v[108:111], v155 offset:22528
    v_mfma_f32_16x16x32_bf16 v[12:15], v[76:79], v[64:67], v[12:15]
    ds_read_b128 v[112:115], v157 offset:57344
    v_mfma_f32_16x16x32_bf16 v[24:27], v[76:79], v[68:71], v[24:27]
    ds_read_b128 v[116:119], v157 offset:58368
    v_mfma_f32_16x16x32_bf16 v[16:19], v[80:83], v[64:67], v[16:19]
    ds_read_b128 v[120:123], v157 offset:59392
    v_mfma_f32_16x16x32_bf16 v[28:31], v[80:83], v[68:71], v[28:31]
    v_mfma_f32_16x16x32_bf16 v[8:11], v[92:95], v[84:87], v[8:11]
    ds_read_b128 v[64:67], v155 offset:21504
    v_mfma_f32_16x16x32_bf16 v[20:23], v[92:95], v[88:91], v[20:23]
    ds_read_b128 v[68:71], v155 offset:23552
    v_mfma_f32_16x16x32_bf16 v[12:15], v[96:99], v[84:87], v[12:15]
    ds_read_b128 v[72:75], v157 offset:64512
    v_mfma_f32_16x16x32_bf16 v[24:27], v[96:99], v[88:91], v[24:27]
    ds_read_b128 v[76:79], v158 offset:0
    v_mfma_f32_16x16x32_bf16 v[16:19], v[100:103], v[84:87], v[16:19]
    ds_read_b128 v[80:83], v158 offset:1024
    v_mfma_f32_16x16x32_bf16 v[28:31], v[100:103], v[88:91], v[28:31]
    s_waitcnt lgkmcnt(5)
    s_waitcnt lgkmcnt(0)
    s_barrier
    v_mfma_f32_16x16x32_bf16 v[8:11], v[112:115], v[104:107], v[8:11]
    ds_read_b128 v[84:87], v155 offset:36864
    v_mfma_f32_16x16x32_bf16 v[20:23], v[112:115], v[108:111], v[20:23]
    ds_read_b128 v[88:91], v155 offset:38912
    v_mfma_f32_16x16x32_bf16 v[12:15], v[116:119], v[104:107], v[12:15]
    ds_read_b128 v[92:95], v158 offset:6144
    v_mfma_f32_16x16x32_bf16 v[24:27], v[116:119], v[108:111], v[24:27]
    ds_read_b128 v[96:99], v158 offset:7168
    v_mfma_f32_16x16x32_bf16 v[16:19], v[120:123], v[104:107], v[16:19]
    ds_read_b128 v[100:103], v158 offset:8192
    v_mfma_f32_16x16x32_bf16 v[28:31], v[120:123], v[108:111], v[28:31]
    v_mfma_f32_16x16x32_bf16 v[8:11], v[72:75], v[64:67], v[8:11]
    ds_read_b128 v[104:107], v155 offset:37888
    v_mfma_f32_16x16x32_bf16 v[20:23], v[72:75], v[68:71], v[20:23]
    ds_read_b128 v[108:111], v155 offset:39936
    v_mfma_f32_16x16x32_bf16 v[12:15], v[76:79], v[64:67], v[12:15]
    ds_read_b128 v[112:115], v158 offset:13312
    v_mfma_f32_16x16x32_bf16 v[24:27], v[76:79], v[68:71], v[24:27]
    ds_read_b128 v[116:119], v158 offset:14336
    v_mfma_f32_16x16x32_bf16 v[16:19], v[80:83], v[64:67], v[16:19]
    ds_read_b128 v[120:123], v158 offset:15360
    v_mfma_f32_16x16x32_bf16 v[28:31], v[80:83], v[68:71], v[28:31]
    s_waitcnt lgkmcnt(5)
    s_waitcnt lgkmcnt(0)
    s_barrier
    v_mfma_f32_16x16x32_bf16 v[8:11], v[92:95], v[84:87], v[8:11]
    ds_read_b128 v[64:67], v155 offset:53248
    v_mfma_f32_16x16x32_bf16 v[20:23], v[92:95], v[88:91], v[20:23]
    ds_read_b128 v[68:71], v155 offset:55296
    v_mfma_f32_16x16x32_bf16 v[12:15], v[96:99], v[84:87], v[12:15]
    ds_read_b128 v[72:75], v157 offset:0
    v_mfma_f32_16x16x32_bf16 v[24:27], v[96:99], v[88:91], v[24:27]
    ds_read_b128 v[76:79], v157 offset:1024
    v_mfma_f32_16x16x32_bf16 v[16:19], v[100:103], v[84:87], v[16:19]
    ds_read_b128 v[80:83], v157 offset:2048
    v_mfma_f32_16x16x32_bf16 v[28:31], v[100:103], v[88:91], v[28:31]
    v_mfma_f32_16x16x32_bf16 v[8:11], v[112:115], v[104:107], v[8:11]
    ds_read_b128 v[84:87], v155 offset:54272
    v_mfma_f32_16x16x32_bf16 v[20:23], v[112:115], v[108:111], v[20:23]
    ds_read_b128 v[88:91], v155 offset:56320
    v_mfma_f32_16x16x32_bf16 v[12:15], v[116:119], v[104:107], v[12:15]
    ds_read_b128 v[92:95], v157 offset:7168
    v_mfma_f32_16x16x32_bf16 v[24:27], v[116:119], v[108:111], v[24:27]
    ds_read_b128 v[96:99], v157 offset:8192
    v_mfma_f32_16x16x32_bf16 v[16:19], v[120:123], v[104:107], v[16:19]
    ds_read_b128 v[100:103], v157 offset:9216
    v_mfma_f32_16x16x32_bf16 v[28:31], v[120:123], v[108:111], v[28:31]
    s_waitcnt lgkmcnt(5)
    s_waitcnt lgkmcnt(0)
    s_barrier
    v_mfma_f32_16x16x32_bf16 v[8:11], v[72:75], v[64:67], v[8:11]
    ds_read_b128 v[104:107], v156 offset:4096
    v_mfma_f32_16x16x32_bf16 v[20:23], v[72:75], v[68:71], v[20:23]
    ds_read_b128 v[108:111], v156 offset:6144
    v_mfma_f32_16x16x32_bf16 v[12:15], v[76:79], v[64:67], v[12:15]
    ds_read_b128 v[112:115], v157 offset:14336
    v_mfma_f32_16x16x32_bf16 v[24:27], v[76:79], v[68:71], v[24:27]
    ds_read_b128 v[116:119], v157 offset:15360
    v_mfma_f32_16x16x32_bf16 v[16:19], v[80:83], v[64:67], v[16:19]
    ds_read_b128 v[120:123], v157 offset:16384
    v_mfma_f32_16x16x32_bf16 v[28:31], v[80:83], v[68:71], v[28:31]
    v_mfma_f32_16x16x32_bf16 v[8:11], v[92:95], v[84:87], v[8:11]
    ds_read_b128 v[64:67], v156 offset:5120
    v_mfma_f32_16x16x32_bf16 v[20:23], v[92:95], v[88:91], v[20:23]
    ds_read_b128 v[68:71], v156 offset:7168
    v_mfma_f32_16x16x32_bf16 v[12:15], v[96:99], v[84:87], v[12:15]
    ds_read_b128 v[72:75], v157 offset:21504
    v_mfma_f32_16x16x32_bf16 v[24:27], v[96:99], v[88:91], v[24:27]
    ds_read_b128 v[76:79], v157 offset:22528
    v_mfma_f32_16x16x32_bf16 v[16:19], v[100:103], v[84:87], v[16:19]
    ds_read_b128 v[80:83], v157 offset:23552
    v_mfma_f32_16x16x32_bf16 v[28:31], v[100:103], v[88:91], v[28:31]
    s_lshl_b32 s60, s7, 8
    s_add_u32 s60, s60, 161792
    v_lshlrev_b32 v4, 3, v3
    v_add_u32 v4, s60, v4
    ds_read_b64 v[136:137], v4 offset:0
    ds_read_b64 v[138:139], v4 offset:128
    s_lshl_b32 s60, s8, 8
    s_add_u32 s60, s60, 163200
    v_lshlrev_b32 v4, 4, v2
    v_add_u32 v4, s60, v4
    ds_read_b128 v[40:43], v4 offset:0
    ds_read_b128 v[44:47], v4 offset:64
    ds_read_b128 v[48:51], v4 offset:128
    s_waitcnt lgkmcnt(10)
    v_mfma_f32_16x16x32_bf16 v[8:11], v[112:115], v[104:107], v[8:11]
    v_mfma_f32_16x16x32_bf16 v[20:23], v[112:115], v[108:111], v[20:23]
    v_mfma_f32_16x16x32_bf16 v[12:15], v[116:119], v[104:107], v[12:15]
    v_mfma_f32_16x16x32_bf16 v[24:27], v[116:119], v[108:111], v[24:27]
    v_mfma_f32_16x16x32_bf16 v[16:19], v[120:123], v[104:107], v[16:19]
    v_mfma_f32_16x16x32_bf16 v[28:31], v[120:123], v[108:111], v[28:31]
    s_waitcnt lgkmcnt(5)
    v_mfma_f32_16x16x32_bf16 v[8:11], v[72:75], v[64:67], v[8:11]
    v_mfma_f32_16x16x32_bf16 v[20:23], v[72:75], v[68:71], v[20:23]
    v_mfma_f32_16x16x32_bf16 v[12:15], v[76:79], v[64:67], v[12:15]
    v_mfma_f32_16x16x32_bf16 v[24:27], v[76:79], v[68:71], v[24:27]
    v_mfma_f32_16x16x32_bf16 v[16:19], v[80:83], v[64:67], v[16:19]
    v_mfma_f32_16x16x32_bf16 v[28:31], v[80:83], v[68:71], v[28:31]
    s_waitcnt vmcnt(0) lgkmcnt(0)
    s_barrier
    v_mov_b32 v140, v137
    v_mov_b32 v142, v139
    v_lshlrev_b32 v96, 16, v56
    v_and_b32 v97, 0xffff0000, v56
    v_lshlrev_b32 v98, 16, v57
    v_and_b32 v99, 0xffff0000, v57
    v_lshlrev_b32 v100, 16, v58
    v_and_b32 v101, 0xffff0000, v58
    v_lshlrev_b32 v102, 16, v59
    v_and_b32 v103, 0xffff0000, v59
    v_lshlrev_b32 v104, 16, v60
    v_and_b32 v105, 0xffff0000, v60
    v_lshlrev_b32 v106, 16, v61
    v_and_b32 v107, 0xffff0000, v61
    v_pk_fma_f32 v[8:9], v[8:9], v[140:141], v[96:97] op_sel_hi:[1,0,1]
    v_pk_fma_f32 v[10:11], v[10:11], v[140:141], v[98:99] op_sel_hi:[1,0,1]
    v_pk_fma_f32 v[12:13], v[12:13], v[140:141], v[100:101] op_sel_hi:[1,0,1]
    v_pk_fma_f32 v[14:15], v[14:15], v[140:141], v[102:103] op_sel_hi:[1,0,1]
    v_pk_fma_f32 v[16:17], v[16:17], v[140:141], v[104:105] op_sel_hi:[1,0,1]
    v_pk_fma_f32 v[18:19], v[18:19], v[140:141], v[106:107] op_sel_hi:[1,0,1]
    v_pk_fma_f32 v[8:9], v[40:41], v[136:137], v[8:9] op_sel_hi:[1,0,1]
    v_pk_fma_f32 v[10:11], v[42:43], v[136:137], v[10:11] op_sel_hi:[1,0,1]
    v_pk_fma_f32 v[12:13], v[44:45], v[136:137], v[12:13] op_sel_hi:[1,0,1]
    v_pk_fma_f32 v[14:15], v[46:47], v[136:137], v[14:15] op_sel_hi:[1,0,1]
    v_pk_fma_f32 v[16:17], v[48:49], v[136:137], v[16:17] op_sel_hi:[1,0,1]
    v_pk_fma_f32 v[18:19], v[50:51], v[136:137], v[18:19] op_sel_hi:[1,0,1]
    v_pk_mul_f32 v[64:65], v[8:9], v[8:9]
    v_pk_mul_f32 v[66:67], v[10:11], v[10:11]
    v_pk_mul_f32 v[68:69], v[12:13], v[12:13]
    v_pk_mul_f32 v[70:71], v[14:15], v[14:15]
    v_pk_mul_f32 v[72:73], v[16:17], v[16:17]
    v_pk_mul_f32 v[74:75], v[18:19], v[18:19]
    v_pk_fma_f32 v[64:65], v[64:65], v[146:147], v[148:149] op_sel_hi:[1,0,0]
    v_pk_fma_f32 v[66:67], v[66:67], v[146:147], v[148:149] op_sel_hi:[1,0,0]
    v_pk_fma_f32 v[68:69], v[68:69], v[146:147], v[148:149] op_sel_hi:[1,0,0]
    v_pk_fma_f32 v[70:71], v[70:71], v[146:147], v[148:149] op_sel_hi:[1,0,0]
    v_pk_fma_f32 v[72:73], v[72:73], v[146:147], v[148:149] op_sel_hi:[1,0,0]
    v_pk_fma_f32 v[74:75], v[74:75], v[146:147], v[148:149] op_sel_hi:[1,0,0]
    v_pk_mul_f32 v[64:65], v[64:65], v[8:9]
    v_pk_mul_f32 v[66:67], v[66:67], v[10:11]
    v_pk_mul_f32 v[68:69], v[68:69], v[12:13]
    v_pk_mul_f32 v[70:71], v[70:71], v[14:15]
    v_pk_mul_f32 v[72:73], v[72:73], v[16:17]
    v_pk_mul_f32 v[74:75], v[74:75], v[18:19]
    v_exp_f32 v64, v64
    v_exp_f32 v65, v65
    v_exp_f32 v66, v66
    v_exp_f32 v67, v67
    v_exp_f32 v68, v68
    v_exp_f32 v69, v69
    v_exp_f32 v70, v70
    v_exp_f32 v71, v71
    v_exp_f32 v72, v72
    v_exp_f32 v73, v73
    v_exp_f32 v74, v74
    v_exp_f32 v75, v75
    v_pk_add_f32 v[64:65], v[64:65], v[150:151] op_sel_hi:[1,0]
    v_pk_add_f32 v[66:67], v[66:67], v[150:151] op_sel_hi:[1,0]
    v_pk_add_f32 v[68:69], v[68:69], v[150:151] op_sel_hi:[1,0]
    v_pk_add_f32 v[70:71], v[70:71], v[150:151] op_sel_hi:[1,0]
    v_pk_add_f32 v[72:73], v[72:73], v[150:151] op_sel_hi:[1,0]
    v_pk_add_f32 v[74:75], v[74:75], v[150:151] op_sel_hi:[1,0]
    v_rcp_f32 v64, v64
    v_rcp_f32 v65, v65
    v_rcp_f32 v66, v66
    v_rcp_f32 v67, v67
    v_rcp_f32 v68, v68
    v_rcp_f32 v69, v69
    v_rcp_f32 v70, v70
    v_rcp_f32 v71, v71
    v_rcp_f32 v72, v72
    v_rcp_f32 v73, v73
    v_rcp_f32 v74, v74
    v_rcp_f32 v75, v75
    v_pk_mul_f32 v[8:9], v[8:9], v[64:65]
    v_pk_mul_f32 v[10:11], v[10:11], v[66:67]
    v_pk_mul_f32 v[12:13], v[12:13], v[68:69]
    v_pk_mul_f32 v[14:15], v[14:15], v[70:71]
    v_pk_mul_f32 v[16:17], v[16:17], v[72:73]
    v_pk_mul_f32 v[18:19], v[18:19], v[74:75]
    v_cvt_pk_bf16_f32 v128, v8, v9
    v_cvt_pk_bf16_f32 v129, v10, v11
    v_cvt_pk_bf16_f32 v130, v12, v13
    v_cvt_pk_bf16_f32 v131, v14, v15
    v_cvt_pk_bf16_f32 v132, v16, v17
    v_cvt_pk_bf16_f32 v133, v18, v19
    buffer_store_dwordx4 v[128:131], v144, s[56:59], s64 offen
    buffer_store_dwordx2 v[132:133], v144, s[56:59], s65 offen
    v_pk_fma_f32 v[20:21], v[20:21], v[142:143], v[96:97] op_sel_hi:[1,0,1]
    v_pk_fma_f32 v[22:23], v[22:23], v[142:143], v[98:99] op_sel_hi:[1,0,1]
    v_pk_fma_f32 v[24:25], v[24:25], v[142:143], v[100:101] op_sel_hi:[1,0,1]
    v_pk_fma_f32 v[26:27], v[26:27], v[142:143], v[102:103] op_sel_hi:[1,0,1]
    v_pk_fma_f32 v[28:29], v[28:29], v[142:143], v[104:105] op_sel_hi:[1,0,1]
    v_pk_fma_f32 v[30:31], v[30:31], v[142:143], v[106:107] op_sel_hi:[1,0,1]
    v_pk_fma_f32 v[20:21], v[40:41], v[138:139], v[20:21] op_sel_hi:[1,0,1]
    v_pk_fma_f32 v[22:23], v[42:43], v[138:139], v[22:23] op_sel_hi:[1,0,1]
    v_pk_fma_f32 v[24:25], v[44:45], v[138:139], v[24:25] op_sel_hi:[1,0,1]
    v_pk_fma_f32 v[26:27], v[46:47], v[138:139], v[26:27] op_sel_hi:[1,0,1]
    v_pk_fma_f32 v[28:29], v[48:49], v[138:139], v[28:29] op_sel_hi:[1,0,1]
    v_pk_fma_f32 v[30:31], v[50:51], v[138:139], v[30:31] op_sel_hi:[1,0,1]
    v_pk_mul_f32 v[80:81], v[20:21], v[20:21]
    v_pk_mul_f32 v[82:83], v[22:23], v[22:23]
    v_pk_mul_f32 v[84:85], v[24:25], v[24:25]
    v_pk_mul_f32 v[86:87], v[26:27], v[26:27]
    v_pk_mul_f32 v[88:89], v[28:29], v[28:29]
    v_pk_mul_f32 v[90:91], v[30:31], v[30:31]
    v_pk_fma_f32 v[80:81], v[80:81], v[146:147], v[148:149] op_sel_hi:[1,0,0]
    v_pk_fma_f32 v[82:83], v[82:83], v[146:147], v[148:149] op_sel_hi:[1,0,0]
    v_pk_fma_f32 v[84:85], v[84:85], v[146:147], v[148:149] op_sel_hi:[1,0,0]
    v_pk_fma_f32 v[86:87], v[86:87], v[146:147], v[148:149] op_sel_hi:[1,0,0]
    v_pk_fma_f32 v[88:89], v[88:89], v[146:147], v[148:149] op_sel_hi:[1,0,0]
    v_pk_fma_f32 v[90:91], v[90:91], v[146:147], v[148:149] op_sel_hi:[1,0,0]
    v_pk_mul_f32 v[80:81], v[80:81], v[20:21]
    v_pk_mul_f32 v[82:83], v[82:83], v[22:23]
    v_pk_mul_f32 v[84:85], v[84:85], v[24:25]
    v_pk_mul_f32 v[86:87], v[86:87], v[26:27]
    v_pk_mul_f32 v[88:89], v[88:89], v[28:29]
    v_pk_mul_f32 v[90:91], v[90:91], v[30:31]
    v_exp_f32 v80, v80
    v_exp_f32 v81, v81
    v_exp_f32 v82, v82
    v_exp_f32 v83, v83
    v_exp_f32 v84, v84
    v_exp_f32 v85, v85
    v_exp_f32 v86, v86
    v_exp_f32 v87, v87
    v_exp_f32 v88, v88
    v_exp_f32 v89, v89
    v_exp_f32 v90, v90
    v_exp_f32 v91, v91
    v_pk_add_f32 v[80:81], v[80:81], v[150:151] op_sel_hi:[1,0]
    v_pk_add_f32 v[82:83], v[82:83], v[150:151] op_sel_hi:[1,0]
    v_pk_add_f32 v[84:85], v[84:85], v[150:151] op_sel_hi:[1,0]
    v_pk_add_f32 v[86:87], v[86:87], v[150:151] op_sel_hi:[1,0]
    v_pk_add_f32 v[88:89], v[88:89], v[150:151] op_sel_hi:[1,0]
    v_pk_add_f32 v[90:91], v[90:91], v[150:151] op_sel_hi:[1,0]
    v_rcp_f32 v80, v80
    v_rcp_f32 v81, v81
    v_rcp_f32 v82, v82
    v_rcp_f32 v83, v83
    v_rcp_f32 v84, v84
    v_rcp_f32 v85, v85
    v_rcp_f32 v86, v86
    v_rcp_f32 v87, v87
    v_rcp_f32 v88, v88
    v_rcp_f32 v89, v89
    v_rcp_f32 v90, v90
    v_rcp_f32 v91, v91
    v_pk_mul_f32 v[20:21], v[20:21], v[80:81]
    v_pk_mul_f32 v[22:23], v[22:23], v[82:83]
    v_pk_mul_f32 v[24:25], v[24:25], v[84:85]
    v_pk_mul_f32 v[26:27], v[26:27], v[86:87]
    v_pk_mul_f32 v[28:29], v[28:29], v[88:89]
    v_pk_mul_f32 v[30:31], v[30:31], v[90:91]
    v_cvt_pk_bf16_f32 v56, v20, v21
    v_cvt_pk_bf16_f32 v57, v22, v23
    v_cvt_pk_bf16_f32 v58, v24, v25
    v_cvt_pk_bf16_f32 v59, v26, v27
    v_cvt_pk_bf16_f32 v60, v28, v29
    v_cvt_pk_bf16_f32 v61, v30, v31
    s_add_u32 s64, s64, 58368
    s_add_u32 s65, s65, 58368
    buffer_store_dwordx4 v[56:59], v144, s[56:59], s64 offen
    buffer_store_dwordx2 v[60:61], v144, s[56:59], s65 offen
Lcj_137:
    s_nop 7
    s_nop 7
    v_mov_b32 v4, 163808
    v_mov_b32 v5, 1
    s_add_u32 s72, s38, 0x1580000
    s_addc_u32 s73, s39, 0
    s_mov_b32 s74, 0x3000
    s_mov_b32 s75, 0x00020000
    s_waitcnt vmcnt(0) lgkmcnt(0)
    s_mov_b64 exec, 1
    ds_add_rtn_u32 v5, v4, v5
    s_waitcnt lgkmcnt(0)
    s_mov_b64 exec, -1
    v_readfirstlane_b32 s70, v5
    s_nop 3
    s_and_b32 s70, s70, 7
    s_cmp_lg_u32 s70, 7
    s_cbranch_scc1 Lsg_138
    s_lshl_b32 s70, s5, 6
    s_add_u32 s70, s70, s6
    s_lshl_b32 s70, s70, 2
    v_mov_b32 v4, 8
    v_mov_b32 v5, 0
    s_mov_b64 exec, 1
    buffer_store_dword v4, v5, s[72:75], s70 offen
    s_mov_b64 exec, -1
    s_nop 1
Lsg_138:
    s_nop 7
    s_nop 7
    s_barrier
    s_lshr_b32 s60, s6, 3
    s_lshl_b32 s61, s5, 1
    s_add_u32 s60, s60, s61
    s_and_b32 s61, s6, 7
    v_lshrrev_b32 v6, 3, v1
    v_lshlrev_b32 v6, 4, v6
    v_and_b32 v4, 7, v1
    v_lshl_add_u32 v6, v4, 8, v6
    s_lshl_b32 s64, s60, 2
    s_lshr_b32 s62, s4, 1
    s_add_u32 s64, s64, s62
    s_lshl_b32 s64, s64, 14
    s_lshl_b32 s62, s61, 11
    s_add_u32 s64, s64, s62
    s_and_b32 s62, s4, 1
    s_lshl_b32 s62, s62, 7
    s_add_u32 s64, s64, s62
    v_lshrrev_b32 v7, 3, v1
    v_lshlrev_b32 v7, 10, v7
    v_and_b32 v4, 7, v1
    v_lshl_add_u32 v7, v4, 4, v7
    s_lshl_b32 s65, s60, 3
    s_add_u32 s65, s65, s4
    s_lshl_b32 s65, s65, 13
    s_lshl_b32 s62, s61, 7
    s_add_u32 s65, s65, s62
    s_mov_b32 s48, s32
    s_mov_b32 s49, s33
    s_mov_b32 s50, 0x400
    s_mov_b32 s51, 0x00020000
    s_add_u32 s52, s38, 0x600000
    s_addc_u32 s53, s39, 0
    s_mov_b32 s54, 0x200000
    s_mov_b32 s55, 0x00020000
    s_mov_b32 s56, s34
    s_mov_b32 s57, s35
    s_mov_b32 s58, 0x200000
    s_mov_b32 s59, 0x00020000
    s_lshl_b32 s66, s7, 12
    v_lshrrev_b32 v4, 2, v1
    v_lshlrev_b32 v124, 7, v4
    v_and_b32 v5, 3, v1
    v_lshl_add_u32 v124, v5, 3, v124
    v_add_u32 v124, s66, v124
    v_bfe_u32 v4, v1, 3, 2
    v_lshl_add_u32 v124, v4, 5, v124
    v_xor_b32 v125, 32, v124
    v_xor_b32 v126, 64, v124
    v_xor_b32 v127, 96, v124
    v_add_u32 v129, 0x10000, v124
    v_add_u32 v130, 0x20000, v124
    v_add_u32 v131, 0x10000, v125
    v_add_u32 v132, 0x20000, v125
    v_add_u32 v133, 0x10000, v126
    v_add_u32 v134, 0x20000, v126
    v_add_u32 v135, 0x10000, v127
    v_add_u32 v136, 0x20000, v127
    v_lshlrev_b32 v128, 4, v1
    s_add_u32 s44, s38, 0xc00000
    s_addc_u32 s45, s39, 0
    s_mov_b32 s46, 0x720000
    s_mov_b32 s47, 0x00020000
    s_lshl_b32 s67, s60, 1
    s_add_u32 s67, s67, s8
    s_mul_i32 s67, s67, 116736
    s_mul_i32 s62, s7, 14336
    s_add_u32 s67, s67, s62
    v_and_b32 v8, 7, v1
    v_lshlrev_b32 v8, 4, v8
    s_lshl_b32 s63, s61, 7
    buffer_load_dwordx4 v[80:83], v8, s[48:51], s63 offen
    buffer_load_dwordx4 v[76:79], v6, s[52:55], s64 offen sc1
    s_barrier
    s_add_u32 s62, s67, 0
    buffer_load_dwordx4 v[84:87], v128, s[44:47], s62 offen sc1
    s_add_u32 s62, s67, 58368
    buffer_load_dwordx4 v[88:91], v128, s[44:47], s62 offen sc1
    s_add_u32 s62, s67, 1024
    buffer_load_dwordx4 v[92:95], v128, s[44:47], s62 offen sc1
    s_add_u32 s62, s67, 59392
    buffer_load_dwordx4 v[96:99], v128, s[44:47], s62 offen sc1
    s_add_u32 s62, s67, 2048
    buffer_load_dwordx4 v[100:103], v128, s[44:47], s62 offen sc1
    s_add_u32 s62, s67, 60416
    buffer_load_dwordx4 v[104:107], v128, s[44:47], s62 offen sc1
    s_add_u32 s62, s67, 3072
    buffer_load_dwordx4 v[108:111], v128, s[44:47], s62 offen sc1
    s_add_u32 s62, s67, 61440
    buffer_load_dwordx4 v[112:115], v128, s[44:47], s62 offen sc1
    s_add_u32 s62, s67, 4096
    buffer_load_dwordx4 v[116:119], v128, s[44:47], s62 offen sc1
    s_add_u32 s62, s67, 62464
    buffer_load_dwordx4 v[120:123], v128, s[44:47], s62 offen sc1
    s_barrier
    ds_read_b64_tr_b16 v[44:45], v124 offset:0
    ds_read_b64_tr_b16 v[46:47], v124 offset:2048
    ds_read_b64_tr_b16 v[48:49], v125 offset:0
    ds_read_b64_tr_b16 v[50:51], v125 offset:2048
    ds_read_b64_tr_b16 v[52:53], v126 offset:0
    ds_read_b64_tr_b16 v[54:55], v126 offset:2048
    ds_read_b64_tr_b16 v[56:57], v127 offset:0
    ds_read_b64_tr_b16 v[58:59], v127 offset:2048
    s_waitcnt lgkmcnt(0)
    s_barrier
    s_waitcnt vmcnt(8)
    v_mfma_f32_16x16x32_bf16 v[12:15], v[44:47], v[84:87], 0
    ds_read_b64_tr_b16 v[60:61], v124 offset:16384
    v_mfma_f32_16x16x32_bf16 v[28:31], v[44:47], v[88:91], 0
    ds_read_b64_tr_b16 v[62:63], v124 offset:18432
    v_mfma_f32_16x16x32_bf16 v[16:19], v[48:51], v[84:87], 0
    ds_read_b64_tr_b16 v[64:65], v125 offset:16384
    v_mfma_f32_16x16x32_bf16 v[32:35], v[48:51], v[88:91], 0
    ds_read_b64_tr_b16 v[66:67], v125 offset:18432
    ds_read_b64_tr_b16 v[68:69], v126 offset:16384
    v_mfma_f32_16x16x32_bf16 v[20:23], v[52:55], v[84:87], 0
    ds_read_b64_tr_b16 v[70:71], v126 offset:18432
    v_mfma_f32_16x16x32_bf16 v[36:39], v[52:55], v[88:91], 0
    ds_read_b64_tr_b16 v[72:73], v127 offset:16384
    v_mfma_f32_16x16x32_bf16 v[24:27], v[56:59], v[84:87], 0
    ds_read_b64_tr_b16 v[74:75], v127 offset:18432
    v_mfma_f32_16x16x32_bf16 v[40:43], v[56:59], v[88:91], 0
    s_add_u32 s62, s67, 5120
    buffer_load_dwordx4 v[84:87], v128, s[44:47], s62 offen sc1
    s_add_u32 s62, s67, 63488
    buffer_load_dwordx4 v[88:91], v128, s[44:47], s62 offen sc1
    s_waitcnt lgkmcnt(0)
    s_barrier
    s_waitcnt vmcnt(8)
    v_mfma_f32_16x16x32_bf16 v[12:15], v[60:63], v[92:95], v[12:15]
    ds_read_b64_tr_b16 v[44:45], v124 offset:32768
    v_mfma_f32_16x16x32_bf16 v[28:31], v[60:63], v[96:99], v[28:31]
    ds_read_b64_tr_b16 v[46:47], v124 offset:34816
    v_mfma_f32_16x16x32_bf16 v[16:19], v[64:67], v[92:95], v[16:19]
    ds_read_b64_tr_b16 v[48:49], v125 offset:32768
    v_mfma_f32_16x16x32_bf16 v[32:35], v[64:67], v[96:99], v[32:35]
    ds_read_b64_tr_b16 v[50:51], v125 offset:34816
    ds_read_b64_tr_b16 v[52:53], v126 offset:32768
    v_mfma_f32_16x16x32_bf16 v[20:23], v[68:71], v[92:95], v[20:23]
    ds_read_b64_tr_b16 v[54:55], v126 offset:34816
    v_mfma_f32_16x16x32_bf16 v[36:39], v[68:71], v[96:99], v[36:39]
    ds_read_b64_tr_b16 v[56:57], v127 offset:32768
    v_mfma_f32_16x16x32_bf16 v[24:27], v[72:75], v[92:95], v[24:27]
    ds_read_b64_tr_b16 v[58:59], v127 offset:34816
    v_mfma_f32_16x16x32_bf16 v[40:43], v[72:75], v[96:99], v[40:43]
    s_add_u32 s62, s67, 6144
    buffer_load_dwordx4 v[92:95], v128, s[44:47], s62 offen sc1
    s_add_u32 s62, s67, 64512
    buffer_load_dwordx4 v[96:99], v128, s[44:47], s62 offen sc1
    s_waitcnt lgkmcnt(0)
    s_barrier
    s_waitcnt vmcnt(8)
    v_mfma_f32_16x16x32_bf16 v[12:15], v[44:47], v[100:103], v[12:15]
    ds_read_b64_tr_b16 v[60:61], v124 offset:49152
    v_mfma_f32_16x16x32_bf16 v[28:31], v[44:47], v[104:107], v[28:31]
    ds_read_b64_tr_b16 v[62:63], v124 offset:51200
    v_mfma_f32_16x16x32_bf16 v[16:19], v[48:51], v[100:103], v[16:19]
    ds_read_b64_tr_b16 v[64:65], v125 offset:49152
    v_mfma_f32_16x16x32_bf16 v[32:35], v[48:51], v[104:107], v[32:35]
    ds_read_b64_tr_b16 v[66:67], v125 offset:51200
    ds_read_b64_tr_b16 v[68:69], v126 offset:49152
    v_mfma_f32_16x16x32_bf16 v[20:23], v[52:55], v[100:103], v[20:23]
    ds_read_b64_tr_b16 v[70:71], v126 offset:51200
    v_mfma_f32_16x16x32_bf16 v[36:39], v[52:55], v[104:107], v[36:39]
    ds_read_b64_tr_b16 v[72:73], v127 offset:49152
    v_mfma_f32_16x16x32_bf16 v[24:27], v[56:59], v[100:103], v[24:27]
    ds_read_b64_tr_b16 v[74:75], v127 offset:51200
    v_mfma_f32_16x16x32_bf16 v[40:43], v[56:59], v[104:107], v[40:43]
    s_add_u32 s62, s67, 7168
    buffer_load_dwordx4 v[100:103], v128, s[44:47], s62 offen sc1
    s_add_u32 s62, s67, 65536
    buffer_load_dwordx4 v[104:107], v128, s[44:47], s62 offen sc1
    s_waitcnt lgkmcnt(0)
    s_barrier
    s_waitcnt vmcnt(8)
    v_mfma_f32_16x16x32_bf16 v[12:15], v[60:63], v[108:111], v[12:15]
    ds_read_b64_tr_b16 v[44:45], v129 offset:0
    v_mfma_f32_16x16x32_bf16 v[28:31], v[60:63], v[112:115], v[28:31]
    ds_read_b64_tr_b16 v[46:47], v129 offset:2048
    v_mfma_f32_16x16x32_bf16 v[16:19], v[64:67], v[108:111], v[16:19]
    ds_read_b64_tr_b16 v[48:49], v131 offset:0
    v_mfma_f32_16x16x32_bf16 v[32:35], v[64:67], v[112:115], v[32:35]
    ds_read_b64_tr_b16 v[50:51], v131 offset:2048
    ds_read_b64_tr_b16 v[52:53], v133 offset:0
    v_mfma_f32_16x16x32_bf16 v[20:23], v[68:71], v[108:111], v[20:23]
    ds_read_b64_tr_b16 v[54:55], v133 offset:2048
    v_mfma_f32_16x16x32_bf16 v[36:39], v[68:71], v[112:115], v[36:39]
    ds_read_b64_tr_b16 v[56:57], v135 offset:0
    v_mfma_f32_16x16x32_bf16 v[24:27], v[72:75], v[108:111], v[24:27]
    ds_read_b64_tr_b16 v[58:59], v135 offset:2048
    v_mfma_f32_16x16x32_bf16 v[40:43], v[72:75], v[112:115], v[40:43]
    s_add_u32 s62, s67, 8192
    buffer_load_dwordx4 v[108:111], v128, s[44:47], s62 offen sc1
    s_add_u32 s62, s67, 66560
    buffer_load_dwordx4 v[112:115], v128, s[44:47], s62 offen sc1
    s_waitcnt lgkmcnt(0)
    s_barrier
    s_waitcnt vmcnt(8)
    v_mfma_f32_16x16x32_bf16 v[12:15], v[44:47], v[116:119], v[12:15]
    ds_read_b64_tr_b16 v[60:61], v129 offset:16384
    v_mfma_f32_16x16x32_bf16 v[28:31], v[44:47], v[120:123], v[28:31]
    ds_read_b64_tr_b16 v[62:63], v129 offset:18432
    v_mfma_f32_16x16x32_bf16 v[16:19], v[48:51], v[116:119], v[16:19]
    ds_read_b64_tr_b16 v[64:65], v131 offset:16384
    v_mfma_f32_16x16x32_bf16 v[32:35], v[48:51], v[120:123], v[32:35]
    ds_read_b64_tr_b16 v[66:67], v131 offset:18432
    ds_read_b64_tr_b16 v[68:69], v133 offset:16384
    v_mfma_f32_16x16x32_bf16 v[20:23], v[52:55], v[116:119], v[20:23]
    ds_read_b64_tr_b16 v[70:71], v133 offset:18432
    v_mfma_f32_16x16x32_bf16 v[36:39], v[52:55], v[120:123], v[36:39]
    ds_read_b64_tr_b16 v[72:73], v135 offset:16384
    v_mfma_f32_16x16x32_bf16 v[24:27], v[56:59], v[116:119], v[24:27]
    ds_read_b64_tr_b16 v[74:75], v135 offset:18432
    v_mfma_f32_16x16x32_bf16 v[40:43], v[56:59], v[120:123], v[40:43]
    s_add_u32 s62, s67, 9216
    buffer_load_dwordx4 v[116:119], v128, s[44:47], s62 offen sc1
    s_add_u32 s62, s67, 67584
    buffer_load_dwordx4 v[120:123], v128, s[44:47], s62 offen sc1
    s_waitcnt lgkmcnt(0)
    s_barrier
    s_waitcnt vmcnt(8)
    v_mfma_f32_16x16x32_bf16 v[12:15], v[60:63], v[84:87], v[12:15]
    ds_read_b64_tr_b16 v[44:45], v129 offset:32768
    v_mfma_f32_16x16x32_bf16 v[28:31], v[60:63], v[88:91], v[28:31]
    ds_read_b64_tr_b16 v[46:47], v129 offset:34816
    v_mfma_f32_16x16x32_bf16 v[16:19], v[64:67], v[84:87], v[16:19]
    ds_read_b64_tr_b16 v[48:49], v131 offset:32768
    v_mfma_f32_16x16x32_bf16 v[32:35], v[64:67], v[88:91], v[32:35]
    ds_read_b64_tr_b16 v[50:51], v131 offset:34816
    ds_read_b64_tr_b16 v[52:53], v133 offset:32768
    v_mfma_f32_16x16x32_bf16 v[20:23], v[68:71], v[84:87], v[20:23]
    ds_read_b64_tr_b16 v[54:55], v133 offset:34816
    v_mfma_f32_16x16x32_bf16 v[36:39], v[68:71], v[88:91], v[36:39]
    ds_read_b64_tr_b16 v[56:57], v135 offset:32768
    v_mfma_f32_16x16x32_bf16 v[24:27], v[72:75], v[84:87], v[24:27]
    ds_read_b64_tr_b16 v[58:59], v135 offset:34816
    v_mfma_f32_16x16x32_bf16 v[40:43], v[72:75], v[88:91], v[40:43]
    s_add_u32 s62, s67, 10240
    buffer_load_dwordx4 v[84:87], v128, s[44:47], s62 offen sc1
    s_add_u32 s62, s67, 68608
    buffer_load_dwordx4 v[88:91], v128, s[44:47], s62 offen sc1
    s_waitcnt lgkmcnt(0)
    s_barrier
    s_waitcnt vmcnt(8)
    v_mfma_f32_16x16x32_bf16 v[12:15], v[44:47], v[92:95], v[12:15]
    ds_read_b64_tr_b16 v[60:61], v129 offset:49152
    v_mfma_f32_16x16x32_bf16 v[28:31], v[44:47], v[96:99], v[28:31]
    ds_read_b64_tr_b16 v[62:63], v129 offset:51200
    v_mfma_f32_16x16x32_bf16 v[16:19], v[48:51], v[92:95], v[16:19]
    ds_read_b64_tr_b16 v[64:65], v131 offset:49152
    v_mfma_f32_16x16x32_bf16 v[32:35], v[48:51], v[96:99], v[32:35]
    ds_read_b64_tr_b16 v[66:67], v131 offset:51200
    ds_read_b64_tr_b16 v[68:69], v133 offset:49152
    v_mfma_f32_16x16x32_bf16 v[20:23], v[52:55], v[92:95], v[20:23]
    ds_read_b64_tr_b16 v[70:71], v133 offset:51200
    v_mfma_f32_16x16x32_bf16 v[36:39], v[52:55], v[96:99], v[36:39]
    ds_read_b64_tr_b16 v[72:73], v135 offset:49152
    v_mfma_f32_16x16x32_bf16 v[24:27], v[56:59], v[92:95], v[24:27]
    ds_read_b64_tr_b16 v[74:75], v135 offset:51200
    v_mfma_f32_16x16x32_bf16 v[40:43], v[56:59], v[96:99], v[40:43]
    s_add_u32 s62, s67, 11264
    buffer_load_dwordx4 v[92:95], v128, s[44:47], s62 offen sc1
    s_add_u32 s62, s67, 69632
    buffer_load_dwordx4 v[96:99], v128, s[44:47], s62 offen sc1
    s_waitcnt lgkmcnt(0)
    s_barrier
    s_waitcnt vmcnt(8)
    v_mfma_f32_16x16x32_bf16 v[12:15], v[60:63], v[100:103], v[12:15]
    ds_read_b64_tr_b16 v[44:45], v130 offset:0
    v_mfma_f32_16x16x32_bf16 v[28:31], v[60:63], v[104:107], v[28:31]
    ds_read_b64_tr_b16 v[46:47], v130 offset:2048
    v_mfma_f32_16x16x32_bf16 v[16:19], v[64:67], v[100:103], v[16:19]
    ds_read_b64_tr_b16 v[48:49], v132 offset:0
    v_mfma_f32_16x16x32_bf16 v[32:35], v[64:67], v[104:107], v[32:35]
    ds_read_b64_tr_b16 v[50:51], v132 offset:2048
    ds_read_b64_tr_b16 v[52:53], v134 offset:0
    v_mfma_f32_16x16x32_bf16 v[20:23], v[68:71], v[100:103], v[20:23]
    ds_read_b64_tr_b16 v[54:55], v134 offset:2048
    v_mfma_f32_16x16x32_bf16 v[36:39], v[68:71], v[104:107], v[36:39]
    ds_read_b64_tr_b16 v[56:57], v136 offset:0
    v_mfma_f32_16x16x32_bf16 v[24:27], v[72:75], v[100:103], v[24:27]
    ds_read_b64_tr_b16 v[58:59], v136 offset:2048
    v_mfma_f32_16x16x32_bf16 v[40:43], v[72:75], v[104:107], v[40:43]
    s_add_u32 s62, s67, 12288
    buffer_load_dwordx4 v[100:103], v128, s[44:47], s62 offen sc1
    s_add_u32 s62, s67, 70656
    buffer_load_dwordx4 v[104:107], v128, s[44:47], s62 offen sc1
    s_waitcnt lgkmcnt(0)
    s_barrier
    s_waitcnt vmcnt(8)
    v_mfma_f32_16x16x32_bf16 v[12:15], v[44:47], v[108:111], v[12:15]
    ds_read_b64_tr_b16 v[60:61], v124 offset:0
    v_mfma_f32_16x16x32_bf16 v[28:31], v[44:47], v[112:115], v[28:31]
    ds_read_b64_tr_b16 v[62:63], v124 offset:2048
    v_mfma_f32_16x16x32_bf16 v[16:19], v[48:51], v[108:111], v[16:19]
    ds_read_b64_tr_b16 v[64:65], v125 offset:0
    v_mfma_f32_16x16x32_bf16 v[32:35], v[48:51], v[112:115], v[32:35]
    ds_read_b64_tr_b16 v[66:67], v125 offset:2048
    ds_read_b64_tr_b16 v[68:69], v126 offset:0
    v_mfma_f32_16x16x32_bf16 v[20:23], v[52:55], v[108:111], v[20:23]
    ds_read_b64_tr_b16 v[70:71], v126 offset:2048
    v_mfma_f32_16x16x32_bf16 v[36:39], v[52:55], v[112:115], v[36:39]
    ds_read_b64_tr_b16 v[72:73], v127 offset:0
    v_mfma_f32_16x16x32_bf16 v[24:27], v[56:59], v[108:111], v[24:27]
    ds_read_b64_tr_b16 v[74:75], v127 offset:2048
    v_mfma_f32_16x16x32_bf16 v[40:43], v[56:59], v[112:115], v[40:43]
    s_add_u32 s62, s67, 13312
    buffer_load_dwordx4 v[108:111], v128, s[44:47], s62 offen sc1
    s_add_u32 s62, s67, 71680
    buffer_load_dwordx4 v[112:115], v128, s[44:47], s62 offen sc1
    s_waitcnt lgkmcnt(0)
    s_barrier
    s_waitcnt vmcnt(8)
    v_mfma_f32_16x16x32_bf16 v[12:15], v[60:63], v[116:119], v[12:15]
    ds_read_b64_tr_b16 v[44:45], v124 offset:16384
    v_mfma_f32_16x16x32_bf16 v[28:31], v[60:63], v[120:123], v[28:31]
    ds_read_b64_tr_b16 v[46:47], v124 offset:18432
    v_mfma_f32_16x16x32_bf16 v[16:19], v[64:67], v[116:119], v[16:19]
    ds_read_b64_tr_b16 v[48:49], v125 offset:16384
    v_mfma_f32_16x16x32_bf16 v[32:35], v[64:67], v[120:123], v[32:35]
    ds_read_b64_tr_b16 v[50:51], v125 offset:18432
    ds_read_b64_tr_b16 v[52:53], v126 offset:16384
    v_mfma_f32_16x16x32_bf16 v[20:23], v[68:71], v[116:119], v[20:23]
    ds_read_b64_tr_b16 v[54:55], v126 offset:18432
    v_mfma_f32_16x16x32_bf16 v[36:39], v[68:71], v[120:123], v[36:39]
    ds_read_b64_tr_b16 v[56:57], v127 offset:16384
    v_mfma_f32_16x16x32_bf16 v[24:27], v[72:75], v[116:119], v[24:27]
    ds_read_b64_tr_b16 v[58:59], v127 offset:18432
    v_mfma_f32_16x16x32_bf16 v[40:43], v[72:75], v[120:123], v[40:43]
    s_waitcnt lgkmcnt(0)
    s_barrier
    s_waitcnt vmcnt(6)
    v_mfma_f32_16x16x32_bf16 v[12:15], v[44:47], v[84:87], v[12:15]
    ds_read_b64_tr_b16 v[60:61], v124 offset:32768
    v_mfma_f32_16x16x32_bf16 v[28:31], v[44:47], v[88:91], v[28:31]
    ds_read_b64_tr_b16 v[62:63], v124 offset:34816
    v_mfma_f32_16x16x32_bf16 v[16:19], v[48:51], v[84:87], v[16:19]
    ds_read_b64_tr_b16 v[64:65], v125 offset:32768
    v_mfma_f32_16x16x32_bf16 v[32:35], v[48:51], v[88:91], v[32:35]
    ds_read_b64_tr_b16 v[66:67], v125 offset:34816
    ds_read_b64_tr_b16 v[68:69], v126 offset:32768
    v_mfma_f32_16x16x32_bf16 v[20:23], v[52:55], v[84:87], v[20:23]
    ds_read_b64_tr_b16 v[70:71], v126 offset:34816
    v_mfma_f32_16x16x32_bf16 v[36:39], v[52:55], v[88:91], v[36:39]
    ds_read_b64_tr_b16 v[72:73], v127 offset:32768
    v_mfma_f32_16x16x32_bf16 v[24:27], v[56:59], v[84:87], v[24:27]
    ds_read_b64_tr_b16 v[74:75], v127 offset:34816
    v_mfma_f32_16x16x32_bf16 v[40:43], v[56:59], v[88:91], v[40:43]
    s_waitcnt lgkmcnt(0)
    s_barrier
    s_waitcnt vmcnt(4)
    v_mfma_f32_16x16x32_bf16 v[12:15], v[60:63], v[92:95], v[12:15]
    ds_read_b64_tr_b16 v[44:45], v124 offset:49152
    v_mfma_f32_16x16x32_bf16 v[28:31], v[60:63], v[96:99], v[28:31]
    ds_read_b64_tr_b16 v[46:47], v124 offset:51200
    v_mfma_f32_16x16x32_bf16 v[16:19], v[64:67], v[92:95], v[16:19]
    ds_read_b64_tr_b16 v[48:49], v125 offset:49152
    v_mfma_f32_16x16x32_bf16 v[32:35], v[64:67], v[96:99], v[32:35]
    ds_read_b64_tr_b16 v[50:51], v125 offset:51200
    ds_read_b64_tr_b16 v[52:53], v126 offset:49152
    v_mfma_f32_16x16x32_bf16 v[20:23], v[68:71], v[92:95], v[20:23]
    ds_read_b64_tr_b16 v[54:55], v126 offset:51200
    v_mfma_f32_16x16x32_bf16 v[36:39], v[68:71], v[96:99], v[36:39]
    ds_read_b64_tr_b16 v[56:57], v127 offset:49152
    v_mfma_f32_16x16x32_bf16 v[24:27], v[72:75], v[92:95], v[24:27]
    ds_read_b64_tr_b16 v[58:59], v127 offset:51200
    v_mfma_f32_16x16x32_bf16 v[40:43], v[72:75], v[96:99], v[40:43]
    s_waitcnt lgkmcnt(0)
    s_barrier
    s_waitcnt vmcnt(2)
    v_mfma_f32_16x16x32_bf16 v[12:15], v[44:47], v[100:103], v[12:15]
    ds_read_b64_tr_b16 v[60:61], v129 offset:0
    v_mfma_f32_16x16x32_bf16 v[28:31], v[44:47], v[104:107], v[28:31]
    ds_read_b64_tr_b16 v[62:63], v129 offset:2048
    v_mfma_f32_16x16x32_bf16 v[16:19], v[48:51], v[100:103], v[16:19]
    ds_read_b64_tr_b16 v[64:65], v131 offset:0
    v_mfma_f32_16x16x32_bf16 v[32:35], v[48:51], v[104:107], v[32:35]
    ds_read_b64_tr_b16 v[66:67], v131 offset:2048
    ds_read_b64_tr_b16 v[68:69], v133 offset:0
    v_mfma_f32_16x16x32_bf16 v[20:23], v[52:55], v[100:103], v[20:23]
    ds_read_b64_tr_b16 v[70:71], v133 offset:2048
    v_mfma_f32_16x16x32_bf16 v[36:39], v[52:55], v[104:107], v[36:39]
    ds_read_b64_tr_b16 v[72:73], v135 offset:0
    v_mfma_f32_16x16x32_bf16 v[24:27], v[56:59], v[100:103], v[24:27]
    ds_read_b64_tr_b16 v[74:75], v135 offset:2048
    v_mfma_f32_16x16x32_bf16 v[40:43], v[56:59], v[104:107], v[40:43]
    s_waitcnt lgkmcnt(0)
    s_waitcnt vmcnt(0)
    v_mfma_f32_16x16x32_bf16 v[12:15], v[60:63], v[108:111], v[12:15]
    v_mfma_f32_16x16x32_bf16 v[28:31], v[60:63], v[112:115], v[28:31]
    v_mfma_f32_16x16x32_bf16 v[16:19], v[64:67], v[108:111], v[16:19]
    v_mfma_f32_16x16x32_bf16 v[32:35], v[64:67], v[112:115], v[32:35]
    v_mfma_f32_16x16x32_bf16 v[20:23], v[68:71], v[108:111], v[20:23]
    v_mfma_f32_16x16x32_bf16 v[36:39], v[68:71], v[112:115], v[36:39]
    v_mfma_f32_16x16x32_bf16 v[24:27], v[72:75], v[108:111], v[24:27]
    v_mfma_f32_16x16x32_bf16 v[40:43], v[72:75], v[112:115], v[40:43]
    s_waitcnt lgkmcnt(0)
    s_barrier
    s_lshl_b32 s62, s7, 1
    s_add_u32 s62, s62, s8
    s_mul_i32 s62, s62, 8704
    s_add_u32 s62, s62, 90112
    v_mul_u32_u24 v137, 272, v3
    v_lshl_add_u32 v137, v2, 4, v137
    v_add_u32 v137, s62, v137
    ds_write_b128 v137, v[12:15] offset:0
    ds_write_b128 v137, v[16:19] offset:64
    ds_write_b128 v137, v[20:23] offset:128
    ds_write_b128 v137, v[24:27] offset:192
    ds_write_b128 v137, v[28:31] offset:4352
    ds_write_b128 v137, v[32:35] offset:4416
    ds_write_b128 v137, v[36:39] offset:4480
    ds_write_b128 v137, v[40:43] offset:4544
    s_mul_i32 s62, s8, 8704
    s_add_u32 s62, s62, 90112
    v_lshrrev_b32 v138, 3, v1
    s_lshl_b32 s63, s7, 3
    v_add_u32 v138, s63, v138
    v_mul_u32_u24 v138, 272, v138
    v_and_b32 v137, 7, v1
    v_lshl_add_u32 v138, v137, 5, v138
    v_add_u32 v138, s62, v138
    s_waitcnt lgkmcnt(0)
    s_barrier
    ds_read_b128 v[44:47], v138 offset:0
    ds_read_b128 v[48:51], v138 offset:16
    ds_read_b128 v[52:55], v138 offset:17408
    ds_read_b128 v[56:59], v138 offset:17424
    ds_read_b128 v[60:63], v138 offset:34816
    ds_read_b128 v[64:67], v138 offset:34832
    ds_read_b128 v[68:71], v138 offset:52224
    ds_read_b128 v[72:75], v138 offset:52240
    s_waitcnt lgkmcnt(4)
    v_pk_add_f32 v[44:45], v[44:45], v[52:53]
    v_pk_add_f32 v[46:47], v[46:47], v[54:55]
    v_pk_add_f32 v[48:49], v[48:49], v[56:57]
    v_pk_add_f32 v[50:51], v[50:51], v[58:59]
    s_waitcnt lgkmcnt(0)
    v_pk_add_f32 v[60:61], v[60:61], v[68:69]
    v_pk_add_f32 v[62:63], v[62:63], v[70:71]
    v_pk_add_f32 v[64:65], v[64:65], v[72:73]
    v_pk_add_f32 v[66:67], v[66:67], v[74:75]
    v_pk_add_f32 v[44:45], v[44:45], v[60:61]
    v_pk_add_f32 v[46:47], v[46:47], v[62:63]
    v_pk_add_f32 v[48:49], v[48:49], v[64:65]
    v_pk_add_f32 v[50:51], v[50:51], v[66:67]
    s_waitcnt vmcnt(0)
    v_lshlrev_b32 v52, 16, v80
    v_and_b32 v53, 0xffff0000, v80
    v_lshlrev_b32 v54, 16, v81
    v_and_b32 v55, 0xffff0000, v81
    v_lshlrev_b32 v56, 16, v82
    v_and_b32 v57, 0xffff0000, v82
    v_lshlrev_b32 v58, 16, v83
    v_and_b32 v59, 0xffff0000, v83
    v_pk_add_f32 v[44:45], v[44:45], v[52:53]
    v_pk_add_f32 v[46:47], v[46:47], v[54:55]
    v_pk_add_f32 v[48:49], v[48:49], v[56:57]
    v_pk_add_f32 v[50:51], v[50:51], v[58:59]
    v_cvt_pk_bf16_f32 v60, v44, v45
    v_cvt_pk_bf16_f32 v61, v46, v47
    v_cvt_pk_bf16_f32 v62, v48, v49
    v_cvt_pk_bf16_f32 v63, v50, v51
    v_lshlrev_b32 v44, 16, v60
    v_and_b32 v45, 0xffff0000, v60
    v_lshlrev_b32 v52, 16, v76
    v_and_b32 v53, 0xffff0000, v76
    v_lshlrev_b32 v46, 16, v61
    v_and_b32 v47, 0xffff0000, v61
    v_lshlrev_b32 v54, 16, v77
    v_and_b32 v55, 0xffff0000, v77
    v_lshlrev_b32 v48, 16, v62
    v_and_b32 v49, 0xffff0000, v62
    v_lshlrev_b32 v56, 16, v78
    v_and_b32 v57, 0xffff0000, v78
    v_lshlrev_b32 v50, 16, v63
    v_and_b32 v51, 0xffff0000, v63
    v_lshlrev_b32 v58, 16, v79
    v_and_b32 v59, 0xffff0000, v79
    v_pk_add_f32 v[44:45], v[44:45], v[52:53]
    v_pk_add_f32 v[46:47], v[46:47], v[54:55]
    v_pk_add_f32 v[48:49], v[48:49], v[56:57]
    v_pk_add_f32 v[50:51], v[50:51], v[58:59]
    v_cvt_pk_bf16_f32 v60, v44, v45
    v_cvt_pk_bf16_f32 v61, v46, v47
    v_cvt_pk_bf16_f32 v62, v48, v49
    v_cvt_pk_bf16_f32 v63, v50, v51
    buffer_store_dwordx4 v[60:63], v7, s[56:59], s65 offen
    s_endpgm
mega_kernel_cslow:
    s_nop 7
    s_nop 7
    s_lshr_b32 s60, s6, 3
    s_lshl_b32 s61, s5, 1
    s_add_u32 s60, s60, s61
    s_and_b32 s61, s6, 7
    v_lshrrev_b32 v6, 3, v1
    v_lshlrev_b32 v6, 10, v6
    v_and_b32 v4, 7, v1
    v_lshl_add_u32 v6, v4, 4, v6
    s_lshl_b32 s64, s60, 3
    s_add_u32 s64, s64, s4
    s_lshl_b32 s64, s64, 13
    s_lshl_b32 s62, s61, 7
    s_add_u32 s64, s64, s62
    v_lshrrev_b32 v7, 3, v1
    v_lshlrev_b32 v7, 4, v7
    v_and_b32 v4, 7, v1
    v_lshl_add_u32 v7, v4, 8, v7
    s_lshl_b32 s65, s60, 2
    s_lshr_b32 s62, s4, 1
    s_add_u32 s65, s65, s62
    s_lshl_b32 s65, s65, 14
    s_lshl_b32 s62, s61, 11
    s_add_u32 s65, s65, s62
    s_and_b32 s62, s4, 1
    s_lshl_b32 s62, s62, 7
    s_add_u32 s65, s65, s62
    s_mov_b32 s52, s16
    s_mov_b32 s53, s17
    s_mov_b32 s54, 0x200000
    s_mov_b32 s55, 0x00020000
    s_add_u32 s56, s38, 0x600000
    s_addc_u32 s57, s39, 0
    s_mov_b32 s58, 0x200000
    s_mov_b32 s59, 0x00020000
    s_lshl_b32 s62, s7, 11
    v_lshrrev_b32 v4, 2, v1
    v_lshlrev_b32 v140, 7, v4
    v_and_b32 v5, 3, v1
    v_lshl_add_u32 v140, v5, 3, v140
    v_add_u32 v140, s62, v140
    v_bfe_u32 v4, v1, 3, 2
    v_lshl_add_u32 v140, v4, 5, v140
    v_xor_b32 v141, 32, v140
    v_xor_b32 v142, 64, v140
    v_xor_b32 v143, 96, v140
    s_lshl_b32 s66, s7, 11
    s_add_u32 s62, s66, 65536
    v_lshlrev_b32 v144, 4, v1
    s_mov_b32 s44, s38
    s_mov_b32 s45, s39
    s_mov_b32 s46, 0x420000
    s_mov_b32 s47, 0x00020000
    s_lshl_b32 s68, s60, 1
    s_add_u32 s68, s68, s8
    s_mul_i32 s68, s68, 67584
    s_lshl_b32 s63, s7, 13
    s_add_u32 s68, s68, s63
    v_lshlrev_b32 v4, 1, v2
    v_and_b32 v5, 7, v3
    v_xor_b32 v5, v5, v4
    v_lshlrev_b32 v5, 4, v5
    v_lshl_add_u32 v5, v3, 7, v5
    v_add_u32 v145, s62, v5
    v_xor_b32 v146, 16, v145
    v_lshlrev_b32 v4, 5, v2
    s_lshl_b32 s62, s7, 10
    s_add_u32 s62, s62, 106496
    v_add_u32 v147, s62, v4
    buffer_load_dwordx4 v[40:43], v6, s[52:55], s64 offen
    s_mov_b32 s67, 0x358637bd
    s_barrier
    s_add_u32 s63, s68, 0
    buffer_load_dwordx4 v[76:79], v144, s[44:47], s63 offen sc1
    s_add_u32 s63, s68, 33792
    buffer_load_dwordx4 v[80:83], v144, s[44:47], s63 offen sc1
    s_add_u32 s63, s68, 1024
    buffer_load_dwordx4 v[84:87], v144, s[44:47], s63 offen sc1
    s_add_u32 s63, s68, 34816
    buffer_load_dwordx4 v[88:91], v144, s[44:47], s63 offen sc1
    s_add_u32 s63, s68, 2048
    buffer_load_dwordx4 v[92:95], v144, s[44:47], s63 offen sc1
    s_add_u32 s63, s68, 35840
    buffer_load_dwordx4 v[96:99], v144, s[44:47], s63 offen sc1
    s_barrier
    ds_read_b128 v[44:47], v145 offset:0
    ds_read_b128 v[48:51], v146 offset:0
    ds_read_b128 v[52:55], v147 offset:0
    ds_read_b128 v[56:59], v147 offset:16
    s_waitcnt lgkmcnt(0)
    s_barrier
    s_waitcnt vmcnt(4)
    v_cvt_pk_bf16_f32 v44, v44, v45
    v_cvt_pk_bf16_f32 v45, v46, v47
    v_cvt_pk_bf16_f32 v46, v48, v49
    ds_read_b128 v[60:63], v145 offset:8192
    v_cvt_pk_bf16_f32 v47, v50, v51
    v_cvt_pk_bf16_f32 v48, v52, v53
    ds_read_b128 v[64:67], v146 offset:8192
    v_cvt_pk_bf16_f32 v49, v54, v55
    v_cvt_pk_bf16_f32 v50, v56, v57
    v_cvt_pk_bf16_f32 v51, v58, v59
    ds_read_b128 v[68:71], v147 offset:128
    v_mfma_f32_16x16x32_bf16 v[100:103], v[44:47], v[76:79], 0
    v_mfma_f32_16x16x32_bf16 v[104:107], v[48:51], v[76:79], 0
    ds_read_b128 v[72:75], v147 offset:144
    v_mfma_f32_16x16x32_bf16 v[108:111], v[44:47], v[80:83], 0
    v_mfma_f32_16x16x32_bf16 v[112:115], v[48:51], v[80:83], 0
    s_add_u32 s63, s68, 3072
    buffer_load_dwordx4 v[76:79], v144, s[44:47], s63 offen sc1
    s_add_u32 s63, s68, 36864
    buffer_load_dwordx4 v[80:83], v144, s[44:47], s63 offen sc1
    s_waitcnt lgkmcnt(0)
    s_barrier
    s_waitcnt vmcnt(4)
    v_add_f32 v104, s67, v104
    v_cvt_pk_bf16_f32 v60, v60, v61
    ds_read_b128 v[44:47], v145 offset:16384
    v_add_f32 v112, s67, v112
    v_cvt_pk_bf16_f32 v61, v62, v63
    ds_read_b128 v[48:51], v146 offset:16384
    v_rcp_f32 v104, v104
    ds_read_b128 v[52:55], v147 offset:256
    v_cvt_pk_bf16_f32 v62, v64, v65
    v_rcp_f32 v112, v112
    ds_read_b128 v[56:59], v147 offset:272
    v_cvt_pk_bf16_f32 v63, v66, v67
    ds_read_b64_tr_b16 v[124:125], v140 offset:0
    v_pk_mul_f32 v[100:101], v[100:101], v[104:105] op_sel_hi:[1,0]
    v_cvt_pk_bf16_f32 v64, v68, v69
    ds_read_b64_tr_b16 v[128:129], v141 offset:0
    v_pk_mul_f32 v[102:103], v[102:103], v[104:105] op_sel_hi:[1,0]
    v_cvt_pk_bf16_f32 v65, v70, v71
    ds_read_b64_tr_b16 v[132:133], v142 offset:0
    v_pk_mul_f32 v[108:109], v[108:109], v[112:113] op_sel_hi:[1,0]
    ds_read_b64_tr_b16 v[136:137], v143 offset:0
    v_cvt_pk_bf16_f32 v66, v72, v73
    v_pk_mul_f32 v[110:111], v[110:111], v[112:113] op_sel_hi:[1,0]
    ds_read_b64_tr_b16 v[126:127], v140 offset:8192
    v_cvt_pk_bf16_f32 v67, v74, v75
    ds_read_b64_tr_b16 v[130:131], v141 offset:8192
    v_cvt_pk_bf16_f32 v116, v100, v101
    v_mfma_f32_16x16x32_bf16 v[148:151], v[60:63], v[84:87], 0
    ds_read_b64_tr_b16 v[134:135], v142 offset:8192
    v_cvt_pk_bf16_f32 v117, v102, v103
    v_mfma_f32_16x16x32_bf16 v[152:155], v[64:67], v[84:87], 0
    ds_read_b64_tr_b16 v[138:139], v143 offset:8192
    v_cvt_pk_bf16_f32 v120, v108, v109
    v_mfma_f32_16x16x32_bf16 v[156:159], v[60:63], v[88:91], 0
    v_cvt_pk_bf16_f32 v121, v110, v111
    v_mfma_f32_16x16x32_bf16 v[160:163], v[64:67], v[88:91], 0
    s_add_u32 s63, s68, 4096
    buffer_load_dwordx4 v[84:87], v144, s[44:47], s63 offen sc1
    s_add_u32 s63, s68, 37888
    buffer_load_dwordx4 v[88:91], v144, s[44:47], s63 offen sc1
    s_waitcnt lgkmcnt(0)
    s_barrier
    s_waitcnt vmcnt(4)
    v_add_f32 v152, s67, v152
    v_cvt_pk_bf16_f32 v44, v44, v45
    v_add_f32 v160, s67, v160
    v_cvt_pk_bf16_f32 v45, v46, v47
    v_rcp_f32 v152, v152
    v_cvt_pk_bf16_f32 v46, v48, v49
    v_rcp_f32 v160, v160
    ds_read_b128 v[60:63], v145 offset:24576
    v_cvt_pk_bf16_f32 v47, v50, v51
    v_pk_mul_f32 v[148:149], v[148:149], v[152:153] op_sel_hi:[1,0]
    v_cvt_pk_bf16_f32 v48, v52, v53
    v_pk_mul_f32 v[150:151], v[150:151], v[152:153] op_sel_hi:[1,0]
    v_cvt_pk_bf16_f32 v49, v54, v55
    v_pk_mul_f32 v[156:157], v[156:157], v[160:161] op_sel_hi:[1,0]
    ds_read_b128 v[64:67], v146 offset:24576
    v_cvt_pk_bf16_f32 v50, v56, v57
    v_pk_mul_f32 v[158:159], v[158:159], v[160:161] op_sel_hi:[1,0]
    v_cvt_pk_bf16_f32 v51, v58, v59
    v_cvt_pk_bf16_f32 v118, v148, v149
    v_mfma_f32_16x16x32_bf16 v[100:103], v[44:47], v[92:95], 0
    v_cvt_pk_bf16_f32 v119, v150, v151
    v_mfma_f32_16x16x32_bf16 v[104:107], v[48:51], v[92:95], 0
    ds_read_b128 v[68:71], v147 offset:384
    v_cvt_pk_bf16_f32 v122, v156, v157
    v_mfma_f32_16x16x32_bf16 v[108:111], v[44:47], v[96:99], 0
    v_cvt_pk_bf16_f32 v123, v158, v159
    v_mfma_f32_16x16x32_bf16 v[112:115], v[48:51], v[96:99], 0
    v_mfma_f32_16x16x32_bf16 v[8:11], v[124:127], v[116:119], 0
    v_mfma_f32_16x16x32_bf16 v[12:15], v[128:131], v[116:119], 0
    ds_read_b128 v[72:75], v147 offset:400
    v_mfma_f32_16x16x32_bf16 v[16:19], v[132:135], v[116:119], 0
    v_mfma_f32_16x16x32_bf16 v[20:23], v[136:139], v[116:119], 0
    v_mfma_f32_16x16x32_bf16 v[24:27], v[124:127], v[120:123], 0
    v_mfma_f32_16x16x32_bf16 v[28:31], v[128:131], v[120:123], 0
    v_mfma_f32_16x16x32_bf16 v[32:35], v[132:135], v[120:123], 0
    v_mfma_f32_16x16x32_bf16 v[36:39], v[136:139], v[120:123], 0
    s_add_u32 s63, s68, 5120
    buffer_load_dwordx4 v[92:95], v144, s[44:47], s63 offen sc1
    s_add_u32 s63, s68, 38912
    buffer_load_dwordx4 v[96:99], v144, s[44:47], s63 offen sc1
    s_waitcnt lgkmcnt(0)
    s_barrier
    s_waitcnt vmcnt(4)
    v_add_f32 v104, s67, v104
    v_cvt_pk_bf16_f32 v60, v60, v61
    ds_read_b128 v[44:47], v145 offset:32768
    v_add_f32 v112, s67, v112
    v_cvt_pk_bf16_f32 v61, v62, v63
    ds_read_b128 v[48:51], v146 offset:32768
    v_rcp_f32 v104, v104
    ds_read_b128 v[52:55], v147 offset:512
    v_cvt_pk_bf16_f32 v62, v64, v65
    v_rcp_f32 v112, v112
    ds_read_b128 v[56:59], v147 offset:528
    v_cvt_pk_bf16_f32 v63, v66, v67
    ds_read_b64_tr_b16 v[124:125], v140 offset:16384
    v_pk_mul_f32 v[100:101], v[100:101], v[104:105] op_sel_hi:[1,0]
    v_cvt_pk_bf16_f32 v64, v68, v69
    ds_read_b64_tr_b16 v[128:129], v141 offset:16384
    v_pk_mul_f32 v[102:103], v[102:103], v[104:105] op_sel_hi:[1,0]
    v_cvt_pk_bf16_f32 v65, v70, v71
    ds_read_b64_tr_b16 v[132:133], v142 offset:16384
    v_pk_mul_f32 v[108:109], v[108:109], v[112:113] op_sel_hi:[1,0]
    ds_read_b64_tr_b16 v[136:137], v143 offset:16384
    v_cvt_pk_bf16_f32 v66, v72, v73
    v_pk_mul_f32 v[110:111], v[110:111], v[112:113] op_sel_hi:[1,0]
    ds_read_b64_tr_b16 v[126:127], v140 offset:24576
    v_cvt_pk_bf16_f32 v67, v74, v75
    ds_read_b64_tr_b16 v[130:131], v141 offset:24576
    v_cvt_pk_bf16_f32 v116, v100, v101
    v_mfma_f32_16x16x32_bf16 v[148:151], v[60:63], v[76:79], 0
    ds_read_b64_tr_b16 v[134:135], v142 offset:24576
    v_cvt_pk_bf16_f32 v117, v102, v103
    v_mfma_f32_16x16x32_bf16 v[152:155], v[64:67], v[76:79], 0
    ds_read_b64_tr_b16 v[138:139], v143 offset:24576
    v_cvt_pk_bf16_f32 v120, v108, v109
    v_mfma_f32_16x16x32_bf16 v[156:159], v[60:63], v[80:83], 0
    v_cvt_pk_bf16_f32 v121, v110, v111
    v_mfma_f32_16x16x32_bf16 v[160:163], v[64:67], v[80:83], 0
    s_add_u32 s63, s68, 6144
    buffer_load_dwordx4 v[76:79], v144, s[44:47], s63 offen sc1
    s_add_u32 s63, s68, 39936
    buffer_load_dwordx4 v[80:83], v144, s[44:47], s63 offen sc1
    s_waitcnt lgkmcnt(0)
    s_barrier
    s_waitcnt vmcnt(4)
    v_add_f32 v152, s67, v152
    v_cvt_pk_bf16_f32 v44, v44, v45
    v_add_f32 v160, s67, v160
    v_cvt_pk_bf16_f32 v45, v46, v47
    v_rcp_f32 v152, v152
    v_cvt_pk_bf16_f32 v46, v48, v49
    v_rcp_f32 v160, v160
    ds_read_b128 v[60:63], v145 offset:0
    v_cvt_pk_bf16_f32 v47, v50, v51
    v_pk_mul_f32 v[148:149], v[148:149], v[152:153] op_sel_hi:[1,0]
    v_cvt_pk_bf16_f32 v48, v52, v53
    v_pk_mul_f32 v[150:151], v[150:151], v[152:153] op_sel_hi:[1,0]
    v_cvt_pk_bf16_f32 v49, v54, v55
    v_pk_mul_f32 v[156:157], v[156:157], v[160:161] op_sel_hi:[1,0]
    ds_read_b128 v[64:67], v146 offset:0
    v_cvt_pk_bf16_f32 v50, v56, v57
    v_pk_mul_f32 v[158:159], v[158:159], v[160:161] op_sel_hi:[1,0]
    v_cvt_pk_bf16_f32 v51, v58, v59
    v_cvt_pk_bf16_f32 v118, v148, v149
    v_mfma_f32_16x16x32_bf16 v[100:103], v[44:47], v[84:87], 0
    v_cvt_pk_bf16_f32 v119, v150, v151
    v_mfma_f32_16x16x32_bf16 v[104:107], v[48:51], v[84:87], 0
    ds_read_b128 v[68:71], v147 offset:640
    v_cvt_pk_bf16_f32 v122, v156, v157
    v_mfma_f32_16x16x32_bf16 v[108:111], v[44:47], v[88:91], 0
    v_cvt_pk_bf16_f32 v123, v158, v159
    v_mfma_f32_16x16x32_bf16 v[112:115], v[48:51], v[88:91], 0
    v_mfma_f32_16x16x32_bf16 v[8:11], v[124:127], v[116:119], v[8:11]
    v_mfma_f32_16x16x32_bf16 v[12:15], v[128:131], v[116:119], v[12:15]
    ds_read_b128 v[72:75], v147 offset:656
    v_mfma_f32_16x16x32_bf16 v[16:19], v[132:135], v[116:119], v[16:19]
    v_mfma_f32_16x16x32_bf16 v[20:23], v[136:139], v[116:119], v[20:23]
    v_mfma_f32_16x16x32_bf16 v[24:27], v[124:127], v[120:123], v[24:27]
    v_mfma_f32_16x16x32_bf16 v[28:31], v[128:131], v[120:123], v[28:31]
    v_mfma_f32_16x16x32_bf16 v[32:35], v[132:135], v[120:123], v[32:35]
    v_mfma_f32_16x16x32_bf16 v[36:39], v[136:139], v[120:123], v[36:39]
    s_add_u32 s63, s68, 7168
    buffer_load_dwordx4 v[84:87], v144, s[44:47], s63 offen sc1
    s_add_u32 s63, s68, 40960
    buffer_load_dwordx4 v[88:91], v144, s[44:47], s63 offen sc1
    s_waitcnt lgkmcnt(0)
    s_barrier
    s_waitcnt vmcnt(4)
    v_add_f32 v104, s67, v104
    v_cvt_pk_bf16_f32 v60, v60, v61
    ds_read_b128 v[44:47], v145 offset:8192
    v_add_f32 v112, s67, v112
    v_cvt_pk_bf16_f32 v61, v62, v63
    ds_read_b128 v[48:51], v146 offset:8192
    v_rcp_f32 v104, v104
    ds_read_b128 v[52:55], v147 offset:768
    v_cvt_pk_bf16_f32 v62, v64, v65
    v_rcp_f32 v112, v112
    ds_read_b128 v[56:59], v147 offset:784
    v_cvt_pk_bf16_f32 v63, v66, v67
    ds_read_b64_tr_b16 v[124:125], v140 offset:32768
    v_pk_mul_f32 v[100:101], v[100:101], v[104:105] op_sel_hi:[1,0]
    v_cvt_pk_bf16_f32 v64, v68, v69
    ds_read_b64_tr_b16 v[128:129], v141 offset:32768
    v_pk_mul_f32 v[102:103], v[102:103], v[104:105] op_sel_hi:[1,0]
    v_cvt_pk_bf16_f32 v65, v70, v71
    ds_read_b64_tr_b16 v[132:133], v142 offset:32768
    v_pk_mul_f32 v[108:109], v[108:109], v[112:113] op_sel_hi:[1,0]
    ds_read_b64_tr_b16 v[136:137], v143 offset:32768
    v_cvt_pk_bf16_f32 v66, v72, v73
    v_pk_mul_f32 v[110:111], v[110:111], v[112:113] op_sel_hi:[1,0]
    ds_read_b64_tr_b16 v[126:127], v140 offset:40960
    v_cvt_pk_bf16_f32 v67, v74, v75
    ds_read_b64_tr_b16 v[130:131], v141 offset:40960
    v_cvt_pk_bf16_f32 v116, v100, v101
    v_mfma_f32_16x16x32_bf16 v[148:151], v[60:63], v[92:95], 0
    ds_read_b64_tr_b16 v[134:135], v142 offset:40960
    v_cvt_pk_bf16_f32 v117, v102, v103
    v_mfma_f32_16x16x32_bf16 v[152:155], v[64:67], v[92:95], 0
    ds_read_b64_tr_b16 v[138:139], v143 offset:40960
    v_cvt_pk_bf16_f32 v120, v108, v109
    v_mfma_f32_16x16x32_bf16 v[156:159], v[60:63], v[96:99], 0
    v_cvt_pk_bf16_f32 v121, v110, v111
    v_mfma_f32_16x16x32_bf16 v[160:163], v[64:67], v[96:99], 0
    s_waitcnt lgkmcnt(0)
    s_barrier
    s_waitcnt vmcnt(2)
    v_add_f32 v152, s67, v152
    v_cvt_pk_bf16_f32 v44, v44, v45
    s_nop 2
    v_add_f32 v160, s67, v160
    v_cvt_pk_bf16_f32 v45, v46, v47
    v_rcp_f32 v152, v152
    v_cvt_pk_bf16_f32 v46, v48, v49
    v_rcp_f32 v160, v160
    ds_read_b128 v[60:63], v145 offset:16384
    v_cvt_pk_bf16_f32 v47, v50, v51
    v_pk_mul_f32 v[148:149], v[148:149], v[152:153] op_sel_hi:[1,0]
    v_cvt_pk_bf16_f32 v48, v52, v53
    v_pk_mul_f32 v[150:151], v[150:151], v[152:153] op_sel_hi:[1,0]
    v_cvt_pk_bf16_f32 v49, v54, v55
    v_pk_mul_f32 v[156:157], v[156:157], v[160:161] op_sel_hi:[1,0]
    ds_read_b128 v[64:67], v146 offset:16384
    v_cvt_pk_bf16_f32 v50, v56, v57
    v_pk_mul_f32 v[158:159], v[158:159], v[160:161] op_sel_hi:[1,0]
    v_cvt_pk_bf16_f32 v51, v58, v59
    v_cvt_pk_bf16_f32 v118, v148, v149
    v_mfma_f32_16x16x32_bf16 v[100:103], v[44:47], v[76:79], 0
    v_cvt_pk_bf16_f32 v119, v150, v151
    v_mfma_f32_16x16x32_bf16 v[104:107], v[48:51], v[76:79], 0
    ds_read_b128 v[68:71], v147 offset:896
    v_cvt_pk_bf16_f32 v122, v156, v157
    v_mfma_f32_16x16x32_bf16 v[108:111], v[44:47], v[80:83], 0
    v_cvt_pk_bf16_f32 v123, v158, v159
    v_mfma_f32_16x16x32_bf16 v[112:115], v[48:51], v[80:83], 0
    v_mfma_f32_16x16x32_bf16 v[8:11], v[124:127], v[116:119], v[8:11]
    v_mfma_f32_16x16x32_bf16 v[12:15], v[128:131], v[116:119], v[12:15]
    ds_read_b128 v[72:75], v147 offset:912
    v_mfma_f32_16x16x32_bf16 v[16:19], v[132:135], v[116:119], v[16:19]
    v_mfma_f32_16x16x32_bf16 v[20:23], v[136:139], v[116:119], v[20:23]
    v_mfma_f32_16x16x32_bf16 v[24:27], v[124:127], v[120:123], v[24:27]
    v_mfma_f32_16x16x32_bf16 v[28:31], v[128:131], v[120:123], v[28:31]
    v_mfma_f32_16x16x32_bf16 v[32:35], v[132:135], v[120:123], v[32:35]
    v_mfma_f32_16x16x32_bf16 v[36:39], v[136:139], v[120:123], v[36:39]
    s_waitcnt lgkmcnt(0)
    s_waitcnt vmcnt(0)
    v_add_f32 v104, s67, v104
    v_cvt_pk_bf16_f32 v60, v60, v61
    v_add_f32 v112, s67, v112
    ds_read_b64_tr_b16 v[124:125], v140 offset:49152
    v_cvt_pk_bf16_f32 v61, v62, v63
    v_rcp_f32 v104, v104
    ds_read_b64_tr_b16 v[128:129], v141 offset:49152
    v_cvt_pk_bf16_f32 v62, v64, v65
    v_rcp_f32 v112, v112
    v_cvt_pk_bf16_f32 v63, v66, v67
    ds_read_b64_tr_b16 v[132:133], v142 offset:49152
    v_pk_mul_f32 v[100:101], v[100:101], v[104:105] op_sel_hi:[1,0]
    v_cvt_pk_bf16_f32 v64, v68, v69
    ds_read_b64_tr_b16 v[136:137], v143 offset:49152
    v_pk_mul_f32 v[102:103], v[102:103], v[104:105] op_sel_hi:[1,0]
    v_cvt_pk_bf16_f32 v65, v70, v71
    ds_read_b64_tr_b16 v[126:127], v140 offset:57344
    v_pk_mul_f32 v[108:109], v[108:109], v[112:113] op_sel_hi:[1,0]
    v_cvt_pk_bf16_f32 v66, v72, v73
    v_pk_mul_f32 v[110:111], v[110:111], v[112:113] op_sel_hi:[1,0]
    ds_read_b64_tr_b16 v[130:131], v141 offset:57344
    v_cvt_pk_bf16_f32 v67, v74, v75
    v_cvt_pk_bf16_f32 v116, v100, v101
    ds_read_b64_tr_b16 v[134:135], v142 offset:57344
    v_mfma_f32_16x16x32_bf16 v[148:151], v[60:63], v[84:87], 0
    v_cvt_pk_bf16_f32 v117, v102, v103
    v_mfma_f32_16x16x32_bf16 v[152:155], v[64:67], v[84:87], 0
    ds_read_b64_tr_b16 v[138:139], v143 offset:57344
    v_cvt_pk_bf16_f32 v120, v108, v109
    v_mfma_f32_16x16x32_bf16 v[156:159], v[60:63], v[88:91], 0
    v_cvt_pk_bf16_f32 v121, v110, v111
    v_mfma_f32_16x16x32_bf16 v[160:163], v[64:67], v[88:91], 0
    s_waitcnt lgkmcnt(0)
    s_nop 1
    v_add_f32 v152, s67, v152
    s_nop 3
    v_add_f32 v160, s67, v160
    v_rcp_f32 v152, v152
    v_rcp_f32 v160, v160
    v_pk_mul_f32 v[148:149], v[148:149], v[152:153] op_sel_hi:[1,0]
    v_pk_mul_f32 v[150:151], v[150:151], v[152:153] op_sel_hi:[1,0]
    v_pk_mul_f32 v[156:157], v[156:157], v[160:161] op_sel_hi:[1,0]
    v_pk_mul_f32 v[158:159], v[158:159], v[160:161] op_sel_hi:[1,0]
    v_cvt_pk_bf16_f32 v118, v148, v149
    v_cvt_pk_bf16_f32 v119, v150, v151
    v_cvt_pk_bf16_f32 v122, v156, v157
    v_cvt_pk_bf16_f32 v123, v158, v159
    v_mfma_f32_16x16x32_bf16 v[8:11], v[124:127], v[116:119], v[8:11]
    v_mfma_f32_16x16x32_bf16 v[12:15], v[128:131], v[116:119], v[12:15]
    v_mfma_f32_16x16x32_bf16 v[16:19], v[132:135], v[116:119], v[16:19]
    v_mfma_f32_16x16x32_bf16 v[20:23], v[136:139], v[116:119], v[20:23]
    v_mfma_f32_16x16x32_bf16 v[24:27], v[124:127], v[120:123], v[24:27]
    v_mfma_f32_16x16x32_bf16 v[28:31], v[128:131], v[120:123], v[28:31]
    v_mfma_f32_16x16x32_bf16 v[32:35], v[132:135], v[120:123], v[32:35]
    v_mfma_f32_16x16x32_bf16 v[36:39], v[136:139], v[120:123], v[36:39]
    s_waitcnt lgkmcnt(0)
    s_barrier
    s_lshl_b32 s62, s7, 1
    s_add_u32 s62, s62, s8
    s_mul_i32 s62, s62, 8704
    s_add_u32 s62, s62, 65536
    v_mul_u32_u24 v124, 272, v3
    v_lshl_add_u32 v124, v2, 4, v124
    v_add_u32 v124, s62, v124
    ds_write_b128 v124, v[8:11] offset:0
    ds_write_b128 v124, v[12:15] offset:64
    ds_write_b128 v124, v[16:19] offset:128
    ds_write_b128 v124, v[20:23] offset:192
    ds_write_b128 v124, v[24:27] offset:4352
    ds_write_b128 v124, v[28:31] offset:4416
    ds_write_b128 v124, v[32:35] offset:4480
    ds_write_b128 v124, v[36:39] offset:4544
    s_mul_i32 s62, s8, 8704
    s_add_u32 s62, s62, 65536
    v_lshrrev_b32 v125, 3, v1
    s_lshl_b32 s63, s7, 3
    v_add_u32 v125, s63, v125
    v_mul_u32_u24 v125, 272, v125
    v_and_b32 v124, 7, v1
    v_lshl_add_u32 v125, v124, 5, v125
    v_add_u32 v125, s62, v125
    s_waitcnt lgkmcnt(0)
    s_barrier
    ds_read_b128 v[44:47], v125 offset:0
    ds_read_b128 v[48:51], v125 offset:16
    ds_read_b128 v[52:55], v125 offset:17408
    ds_read_b128 v[56:59], v125 offset:17424
    ds_read_b128 v[60:63], v125 offset:34816
    ds_read_b128 v[64:67], v125 offset:34832
    ds_read_b128 v[68:71], v125 offset:52224
    ds_read_b128 v[72:75], v125 offset:52240
    s_waitcnt lgkmcnt(4)
    v_pk_add_f32 v[44:45], v[44:45], v[52:53]
    v_pk_add_f32 v[46:47], v[46:47], v[54:55]
    v_pk_add_f32 v[48:49], v[48:49], v[56:57]
    v_pk_add_f32 v[50:51], v[50:51], v[58:59]
    s_waitcnt lgkmcnt(0)
    v_pk_add_f32 v[60:61], v[60:61], v[68:69]
    v_pk_add_f32 v[62:63], v[62:63], v[70:71]
    v_pk_add_f32 v[64:65], v[64:65], v[72:73]
    v_pk_add_f32 v[66:67], v[66:67], v[74:75]
    v_pk_add_f32 v[44:45], v[44:45], v[60:61]
    v_pk_add_f32 v[46:47], v[46:47], v[62:63]
    v_pk_add_f32 v[48:49], v[48:49], v[64:65]
    v_pk_add_f32 v[50:51], v[50:51], v[66:67]
    s_waitcnt vmcnt(0)
    v_cvt_pk_bf16_f32 v60, v44, v45
    v_cvt_pk_bf16_f32 v61, v46, v47
    v_cvt_pk_bf16_f32 v62, v48, v49
    v_cvt_pk_bf16_f32 v63, v50, v51
    v_lshlrev_b32 v44, 16, v60
    v_and_b32 v45, 0xffff0000, v60
    v_lshlrev_b32 v52, 16, v40
    v_and_b32 v53, 0xffff0000, v40
    v_lshlrev_b32 v46, 16, v61
    v_and_b32 v47, 0xffff0000, v61
    v_lshlrev_b32 v54, 16, v41
    v_and_b32 v55, 0xffff0000, v41
    v_lshlrev_b32 v48, 16, v62
    v_and_b32 v49, 0xffff0000, v62
    v_lshlrev_b32 v56, 16, v42
    v_and_b32 v57, 0xffff0000, v42
    v_lshlrev_b32 v50, 16, v63
    v_and_b32 v51, 0xffff0000, v63
    v_lshlrev_b32 v58, 16, v43
    v_and_b32 v59, 0xffff0000, v43
    v_pk_add_f32 v[44:45], v[44:45], v[52:53]
    v_pk_add_f32 v[46:47], v[46:47], v[54:55]
    v_pk_add_f32 v[48:49], v[48:49], v[56:57]
    v_pk_add_f32 v[50:51], v[50:51], v[58:59]
    v_cvt_pk_bf16_f32 v60, v44, v45
    v_cvt_pk_bf16_f32 v61, v46, v47
    v_cvt_pk_bf16_f32 v62, v48, v49
    v_cvt_pk_bf16_f32 v63, v50, v51
    buffer_store_dwordx4 v[60:63], v7, s[56:59], s65 offen sc1
    s_mov_b32 s62, 0x3f803f80
    v_mov_b32 v68, 0
    v_mov_b32 v69, 0
    v_dot2c_f32_bf16 v68, s62, v60
    v_dot2c_f32_bf16 v69, v60, v60
    v_dot2c_f32_bf16 v68, s62, v61
    v_dot2c_f32_bf16 v69, v61, v61
    v_dot2c_f32_bf16 v68, s62, v62
    v_dot2c_f32_bf16 v69, v62, v62
    v_dot2c_f32_bf16 v68, s62, v63
    v_dot2c_f32_bf16 v69, v63, v63
    s_nop 1
    v_add_f32_dpp v68, v68, v68 quad_perm:[1,0,3,2] row_mask:0xf bank_mask:0xf
    v_add_f32_dpp v69, v69, v69 quad_perm:[1,0,3,2] row_mask:0xf bank_mask:0xf
    s_nop 0
    v_add_f32_dpp v68, v68, v68 quad_perm:[2,3,0,1] row_mask:0xf bank_mask:0xf
    v_add_f32_dpp v69, v69, v69 quad_perm:[2,3,0,1] row_mask:0xf bank_mask:0xf
    s_nop 0
    v_add_f32_dpp v68, v68, v68 row_half_mirror row_mask:0xf bank_mask:0xf
    v_add_f32_dpp v69, v69, v69 row_half_mirror row_mask:0xf bank_mask:0xf
    s_add_u32 s40, s38, 0x14a0000
    s_addc_u32 s41, s39, 0
    s_mov_b32 s42, 0x20000
    s_mov_b32 s43, 0x00020000
    v_lshrrev_b32 v124, 3, v1
    v_lshlrev_b32 v124, 6, v124
    s_lshl_b32 s62, s60, 3
    s_add_u32 s62, s62, s4
    s_lshl_b32 s62, s62, 6
    s_add_u32 s62, s62, s61
    s_lshl_b32 s62, s62, 3
    s_mov_b32 exec_lo, 0x01010101
    s_mov_b32 exec_hi, 0x01010101
    buffer_store_dwordx2 v[68:69], v124, s[40:43], s62 offen sc1
    s_mov_b64 exec, -1
    v_mov_b32 v4, 163808
    v_mov_b32 v5, 1
    s_add_u32 s72, s38, 0x1580000
    s_addc_u32 s73, s39, 0
    s_mov_b32 s74, 0x3000
    s_mov_b32 s75, 0x00020000
    s_waitcnt vmcnt(0) lgkmcnt(0)
    s_mov_b64 exec, 1
    ds_add_rtn_u32 v5, v4, v5
    s_waitcnt lgkmcnt(0)
    s_mov_b64 exec, -1
    v_readfirstlane_b32 s70, v5
    s_nop 3
    s_and_b32 s70, s70, 7
    s_cmp_lg_u32 s70, 7
    s_cbranch_scc1 Lsg_139
    s_lshl_b32 s70, s5, 6
    s_add_u32 s70, s70, s6
    s_lshl_b32 s70, s70, 2
    v_mov_b32 v4, 3
    v_mov_b32 v5, 0
    s_mov_b64 exec, 1
    buffer_store_dword v4, v5, s[72:75], s70 offen sc1
    s_mov_b64 exec, -1
    s_nop 1
Lsg_139:
    s_nop 7
    s_nop 7
    s_barrier
    s_lshl_b32 s63, s5, 2
    s_add_u32 s63, s63, s7
    s_mul_i32 s64, s63, 116736
    s_lshl_b32 s63, s63, 11
    s_add_u32 s48, s38, 0x14a0000
    s_addc_u32 s49, s39, 0
    s_mov_b32 s50, 0x20000
    s_mov_b32 s51, 0x00020000
    s_mov_b32 s52, s28
    s_mov_b32 s53, s29
    s_mov_b32 s54, 0xe00
    s_mov_b32 s55, 0x00020000
    s_add_u32 s56, s38, 0xc00000
    s_addc_u32 s57, s39, 0
    s_mov_b32 s58, 0x720000
    s_mov_b32 s59, 0x00020000
    s_mul_i32 s62, s6, 112
    s_lshl_b32 s60, s8, 6
    s_add_u32 s62, s62, s60
    s_lshl_b32 s60, s62, 1
    v_lshlrev_b32 v5, 3, v2
    buffer_load_dwordx2 v[56:57], v5, s[52:55], s60 offen offset:0
    buffer_load_dwordx2 v[58:59], v5, s[52:55], s60 offen offset:32
    buffer_load_dwordx2 v[60:61], v5, s[52:55], s60 offen offset:64
    buffer_load_dwordx2 v[62:63], v5, s[52:55], s60 offen offset:96
    s_lshr_b32 s60, s6, 1
    s_mul_i32 s60, s60, 7168
    s_add_u32 s64, s64, s60
    s_and_b32 s60, s6, 1
    s_lshl_b32 s65, s60, 3
    s_add_u32 s65, s65, s64
    s_add_u32 s65, s65, 6144
    s_mul_i32 s60, s60, 3072
    s_add_u32 s64, s64, s60
    s_lshl_b32 s60, s8, 11
    s_add_u32 s64, s64, s60
    v_lshlrev_b32 v144, 4, v1
    v_mov_b32 v146, 0xbdd2d3e8
    v_mov_b32 v148, 0xc0135761
    v_mov_b32 v150, 1.0
    s_cmp_lg_u32 s8, 0
    s_cbranch_scc1 Lnh1_140
    s_lshl_b32 s79, s7, 12
    v_lshlrev_b32 v152, 4, v1
    v_add_u32 v154, s79, v152
    v_add_u32 v155, 0x10000, v154
    v_add_u32 v156, 0x20000, v154
    v_lshlrev_b32 v152, 4, v1
    v_add_u32 v157, 0, v152
    v_add_u32 v158, 0x10000, v157
    s_lshl_b32 s79, s4, 8
    s_add_u32 s79, s79, 0
    v_lshlrev_b32 v159, 4, v2
    v_add_u32 v159, s79, v159
    s_barrier
    ds_read_b128 v[64:67], v155 offset:20480
    ds_read_b128 v[68:71], v155 offset:22528
    ds_read_b128 v[72:75], v157 offset:0
    ds_read_b128 v[76:79], v157 offset:1024
    ds_read_b128 v[80:83], v157 offset:2048
    ds_read_b128 v[84:87], v157 offset:3072
    ds_read_b128 v[88:91], v155 offset:21504
    ds_read_b128 v[92:95], v155 offset:23552
    ds_read_b128 v[96:99], v157 offset:7168
    ds_read_b128 v[100:103], v157 offset:8192
    ds_read_b128 v[104:107], v157 offset:9216
    ds_read_b128 v[108:111], v157 offset:10240
    s_waitcnt lgkmcnt(6)
    s_waitcnt lgkmcnt(0)
    s_barrier
    v_mfma_f32_16x16x32_bf16 v[8:11], v[72:75], v[64:67], 0
    v_mfma_f32_16x16x32_bf16 v[24:27], v[72:75], v[68:71], 0
    ds_read_b128 v[112:115], v155 offset:36864
    v_mfma_f32_16x16x32_bf16 v[12:15], v[76:79], v[64:67], 0
    ds_read_b128 v[116:119], v155 offset:38912
    v_mfma_f32_16x16x32_bf16 v[28:31], v[76:79], v[68:71], 0
    ds_read_b128 v[120:123], v157 offset:14336
    v_mfma_f32_16x16x32_bf16 v[16:19], v[80:83], v[64:67], 0
    ds_read_b128 v[124:127], v157 offset:15360
    v_mfma_f32_16x16x32_bf16 v[32:35], v[80:83], v[68:71], 0
    ds_read_b128 v[128:131], v157 offset:16384
    v_mfma_f32_16x16x32_bf16 v[20:23], v[84:87], v[64:67], 0
    ds_read_b128 v[132:135], v157 offset:17408
    v_mfma_f32_16x16x32_bf16 v[36:39], v[84:87], v[68:71], 0
    v_mfma_f32_16x16x32_bf16 v[8:11], v[96:99], v[88:91], v[8:11]
    v_mfma_f32_16x16x32_bf16 v[24:27], v[96:99], v[92:95], v[24:27]
    ds_read_b128 v[64:67], v155 offset:37888
    v_mfma_f32_16x16x32_bf16 v[12:15], v[100:103], v[88:91], v[12:15]
    ds_read_b128 v[68:71], v155 offset:39936
    v_mfma_f32_16x16x32_bf16 v[28:31], v[100:103], v[92:95], v[28:31]
    ds_read_b128 v[72:75], v157 offset:21504
    v_mfma_f32_16x16x32_bf16 v[16:19], v[104:107], v[88:91], v[16:19]
    ds_read_b128 v[76:79], v157 offset:22528
    v_mfma_f32_16x16x32_bf16 v[32:35], v[104:107], v[92:95], v[32:35]
    ds_read_b128 v[80:83], v157 offset:23552
    v_mfma_f32_16x16x32_bf16 v[20:23], v[108:111], v[88:91], v[20:23]
    ds_read_b128 v[84:87], v157 offset:24576
    v_mfma_f32_16x16x32_bf16 v[36:39], v[108:111], v[92:95], v[36:39]
    s_waitcnt lgkmcnt(6)
    s_waitcnt lgkmcnt(0)
    s_barrier
    v_mfma_f32_16x16x32_bf16 v[8:11], v[120:123], v[112:115], v[8:11]
    v_mfma_f32_16x16x32_bf16 v[24:27], v[120:123], v[116:119], v[24:27]
    ds_read_b128 v[88:91], v155 offset:53248
    v_mfma_f32_16x16x32_bf16 v[12:15], v[124:127], v[112:115], v[12:15]
    ds_read_b128 v[92:95], v155 offset:55296
    v_mfma_f32_16x16x32_bf16 v[28:31], v[124:127], v[116:119], v[28:31]
    ds_read_b128 v[96:99], v157 offset:28672
    v_mfma_f32_16x16x32_bf16 v[16:19], v[128:131], v[112:115], v[16:19]
    ds_read_b128 v[100:103], v157 offset:29696
    v_mfma_f32_16x16x32_bf16 v[32:35], v[128:131], v[116:119], v[32:35]
    ds_read_b128 v[104:107], v157 offset:30720
    v_mfma_f32_16x16x32_bf16 v[20:23], v[132:135], v[112:115], v[20:23]
    ds_read_b128 v[108:111], v157 offset:31744
    v_mfma_f32_16x16x32_bf16 v[36:39], v[132:135], v[116:119], v[36:39]
    v_mfma_f32_16x16x32_bf16 v[8:11], v[72:75], v[64:67], v[8:11]
    v_mfma_f32_16x16x32_bf16 v[24:27], v[72:75], v[68:71], v[24:27]
    ds_read_b128 v[112:115], v155 offset:54272
    v_mfma_f32_16x16x32_bf16 v[12:15], v[76:79], v[64:67], v[12:15]
    ds_read_b128 v[116:119], v155 offset:56320
    v_mfma_f32_16x16x32_bf16 v[28:31], v[76:79], v[68:71], v[28:31]
    ds_read_b128 v[120:123], v157 offset:35840
    v_mfma_f32_16x16x32_bf16 v[16:19], v[80:83], v[64:67], v[16:19]
    ds_read_b128 v[124:127], v157 offset:36864
    v_mfma_f32_16x16x32_bf16 v[32:35], v[80:83], v[68:71], v[32:35]
    ds_read_b128 v[128:131], v157 offset:37888
    v_mfma_f32_16x16x32_bf16 v[20:23], v[84:87], v[64:67], v[20:23]
    ds_read_b128 v[132:135], v157 offset:38912
    v_mfma_f32_16x16x32_bf16 v[36:39], v[84:87], v[68:71], v[36:39]
    s_waitcnt lgkmcnt(6)
    s_waitcnt lgkmcnt(0)
    s_barrier
    v_mfma_f32_16x16x32_bf16 v[8:11], v[96:99], v[88:91], v[8:11]
    v_mfma_f32_16x16x32_bf16 v[24:27], v[96:99], v[92:95], v[24:27]
    ds_read_b128 v[64:67], v156 offset:4096
    v_mfma_f32_16x16x32_bf16 v[12:15], v[100:103], v[88:91], v[12:15]
    ds_read_b128 v[68:71], v156 offset:6144
    v_mfma_f32_16x16x32_bf16 v[28:31], v[100:103], v[92:95], v[28:31]
    ds_read_b128 v[72:75], v157 offset:43008
    v_mfma_f32_16x16x32_bf16 v[16:19], v[104:107], v[88:91], v[16:19]
    ds_read_b128 v[76:79], v157 offset:44032
    v_mfma_f32_16x16x32_bf16 v[32:35], v[104:107], v[92:95], v[32:35]
    ds_read_b128 v[80:83], v157 offset:45056
    v_mfma_f32_16x16x32_bf16 v[20:23], v[108:111], v[88:91], v[20:23]
    ds_read_b128 v[84:87], v157 offset:46080
    v_mfma_f32_16x16x32_bf16 v[36:39], v[108:111], v[92:95], v[36:39]
    v_mfma_f32_16x16x32_bf16 v[8:11], v[120:123], v[112:115], v[8:11]
    v_mfma_f32_16x16x32_bf16 v[24:27], v[120:123], v[116:119], v[24:27]
    ds_read_b128 v[88:91], v156 offset:5120
    v_mfma_f32_16x16x32_bf16 v[12:15], v[124:127], v[112:115], v[12:15]
    ds_read_b128 v[92:95], v156 offset:7168
    v_mfma_f32_16x16x32_bf16 v[28:31], v[124:127], v[116:119], v[28:31]
    ds_read_b128 v[96:99], v157 offset:50176
    v_mfma_f32_16x16x32_bf16 v[16:19], v[128:131], v[112:115], v[16:19]
    ds_read_b128 v[100:103], v157 offset:51200
    v_mfma_f32_16x16x32_bf16 v[32:35], v[128:131], v[116:119], v[32:35]
    ds_read_b128 v[104:107], v157 offset:52224
    v_mfma_f32_16x16x32_bf16 v[20:23], v[132:135], v[112:115], v[20:23]
    ds_read_b128 v[108:111], v157 offset:53248
    v_mfma_f32_16x16x32_bf16 v[36:39], v[132:135], v[116:119], v[36:39]
    s_waitcnt lgkmcnt(6)
    s_waitcnt lgkmcnt(0)
    s_barrier
    v_mfma_f32_16x16x32_bf16 v[8:11], v[72:75], v[64:67], v[8:11]
    v_mfma_f32_16x16x32_bf16 v[24:27], v[72:75], v[68:71], v[24:27]
    ds_read_b128 v[112:115], v155 offset:20480
    v_mfma_f32_16x16x32_bf16 v[12:15], v[76:79], v[64:67], v[12:15]
    ds_read_b128 v[116:119], v155 offset:22528
    v_mfma_f32_16x16x32_bf16 v[28:31], v[76:79], v[68:71], v[28:31]
    ds_read_b128 v[120:123], v157 offset:57344
    v_mfma_f32_16x16x32_bf16 v[16:19], v[80:83], v[64:67], v[16:19]
    ds_read_b128 v[124:127], v157 offset:58368
    v_mfma_f32_16x16x32_bf16 v[32:35], v[80:83], v[68:71], v[32:35]
    ds_read_b128 v[128:131], v157 offset:59392
    v_mfma_f32_16x16x32_bf16 v[20:23], v[84:87], v[64:67], v[20:23]
    ds_read_b128 v[132:135], v157 offset:60416
    v_mfma_f32_16x16x32_bf16 v[36:39], v[84:87], v[68:71], v[36:39]
    v_mfma_f32_16x16x32_bf16 v[8:11], v[96:99], v[88:91], v[8:11]
    v_mfma_f32_16x16x32_bf16 v[24:27], v[96:99], v[92:95], v[24:27]
    ds_read_b128 v[64:67], v155 offset:21504
    v_mfma_f32_16x16x32_bf16 v[12:15], v[100:103], v[88:91], v[12:15]
    ds_read_b128 v[68:71], v155 offset:23552
    v_mfma_f32_16x16x32_bf16 v[28:31], v[100:103], v[92:95], v[28:31]
    ds_read_b128 v[72:75], v157 offset:64512
    v_mfma_f32_16x16x32_bf16 v[16:19], v[104:107], v[88:91], v[16:19]
    ds_read_b128 v[76:79], v158 offset:0
    v_mfma_f32_16x16x32_bf16 v[32:35], v[104:107], v[92:95], v[32:35]
    ds_read_b128 v[80:83], v158 offset:1024
    v_mfma_f32_16x16x32_bf16 v[20:23], v[108:111], v[88:91], v[20:23]
    ds_read_b128 v[84:87], v158 offset:2048
    v_mfma_f32_16x16x32_bf16 v[36:39], v[108:111], v[92:95], v[36:39]
    s_waitcnt lgkmcnt(6)
    s_waitcnt lgkmcnt(0)
    s_barrier
    v_mfma_f32_16x16x32_bf16 v[8:11], v[120:123], v[112:115], v[8:11]
    v_mfma_f32_16x16x32_bf16 v[24:27], v[120:123], v[116:119], v[24:27]
    ds_read_b128 v[88:91], v155 offset:36864
    v_mfma_f32_16x16x32_bf16 v[12:15], v[124:127], v[112:115], v[12:15]
    ds_read_b128 v[92:95], v155 offset:38912
    v_mfma_f32_16x16x32_bf16 v[28:31], v[124:127], v[116:119], v[28:31]
    ds_read_b128 v[96:99], v158 offset:6144
    v_mfma_f32_16x16x32_bf16 v[16:19], v[128:131], v[112:115], v[16:19]
    ds_read_b128 v[100:103], v158 offset:7168
    v_mfma_f32_16x16x32_bf16 v[32:35], v[128:131], v[116:119], v[32:35]
    ds_read_b128 v[104:107], v158 offset:8192
    v_mfma_f32_16x16x32_bf16 v[20:23], v[132:135], v[112:115], v[20:23]
    ds_read_b128 v[108:111], v158 offset:9216
    v_mfma_f32_16x16x32_bf16 v[36:39], v[132:135], v[116:119], v[36:39]
    v_mfma_f32_16x16x32_bf16 v[8:11], v[72:75], v[64:67], v[8:11]
    v_mfma_f32_16x16x32_bf16 v[24:27], v[72:75], v[68:71], v[24:27]
    ds_read_b128 v[112:115], v155 offset:37888
    v_mfma_f32_16x16x32_bf16 v[12:15], v[76:79], v[64:67], v[12:15]
    ds_read_b128 v[116:119], v155 offset:39936
    v_mfma_f32_16x16x32_bf16 v[28:31], v[76:79], v[68:71], v[28:31]
    ds_read_b128 v[120:123], v158 offset:13312
    v_mfma_f32_16x16x32_bf16 v[16:19], v[80:83], v[64:67], v[16:19]
    ds_read_b128 v[124:127], v158 offset:14336
    v_mfma_f32_16x16x32_bf16 v[32:35], v[80:83], v[68:71], v[32:35]
    ds_read_b128 v[128:131], v158 offset:15360
    v_mfma_f32_16x16x32_bf16 v[20:23], v[84:87], v[64:67], v[20:23]
    ds_read_b128 v[132:135], v158 offset:16384
    v_mfma_f32_16x16x32_bf16 v[36:39], v[84:87], v[68:71], v[36:39]
    s_waitcnt lgkmcnt(6)
    s_waitcnt lgkmcnt(0)
    s_barrier
    v_mfma_f32_16x16x32_bf16 v[8:11], v[96:99], v[88:91], v[8:11]
    v_mfma_f32_16x16x32_bf16 v[24:27], v[96:99], v[92:95], v[24:27]
    ds_read_b128 v[64:67], v155 offset:53248
    v_mfma_f32_16x16x32_bf16 v[12:15], v[100:103], v[88:91], v[12:15]
    ds_read_b128 v[68:71], v155 offset:55296
    v_mfma_f32_16x16x32_bf16 v[28:31], v[100:103], v[92:95], v[28:31]
    ds_read_b128 v[72:75], v157 offset:0
    v_mfma_f32_16x16x32_bf16 v[16:19], v[104:107], v[88:91], v[16:19]
    ds_read_b128 v[76:79], v157 offset:1024
    v_mfma_f32_16x16x32_bf16 v[32:35], v[104:107], v[92:95], v[32:35]
    ds_read_b128 v[80:83], v157 offset:2048
    v_mfma_f32_16x16x32_bf16 v[20:23], v[108:111], v[88:91], v[20:23]
    ds_read_b128 v[84:87], v157 offset:3072
    v_mfma_f32_16x16x32_bf16 v[36:39], v[108:111], v[92:95], v[36:39]
    v_mfma_f32_16x16x32_bf16 v[8:11], v[120:123], v[112:115], v[8:11]
    v_mfma_f32_16x16x32_bf16 v[24:27], v[120:123], v[116:119], v[24:27]
    ds_read_b128 v[88:91], v155 offset:54272
    v_mfma_f32_16x16x32_bf16 v[12:15], v[124:127], v[112:115], v[12:15]
    ds_read_b128 v[92:95], v155 offset:56320
    v_mfma_f32_16x16x32_bf16 v[28:31], v[124:127], v[116:119], v[28:31]
    ds_read_b128 v[96:99], v157 offset:7168
    v_mfma_f32_16x16x32_bf16 v[16:19], v[128:131], v[112:115], v[16:19]
    ds_read_b128 v[100:103], v157 offset:8192
    v_mfma_f32_16x16x32_bf16 v[32:35], v[128:131], v[116:119], v[32:35]
    ds_read_b128 v[104:107], v157 offset:9216
    v_mfma_f32_16x16x32_bf16 v[20:23], v[132:135], v[112:115], v[20:23]
    ds_read_b128 v[108:111], v157 offset:10240
    v_mfma_f32_16x16x32_bf16 v[36:39], v[132:135], v[116:119], v[36:39]
    s_waitcnt lgkmcnt(6)
    s_waitcnt lgkmcnt(0)
    s_barrier
    v_mfma_f32_16x16x32_bf16 v[8:11], v[72:75], v[64:67], v[8:11]
    v_mfma_f32_16x16x32_bf16 v[24:27], v[72:75], v[68:71], v[24:27]
    ds_read_b128 v[112:115], v156 offset:4096
    v_mfma_f32_16x16x32_bf16 v[12:15], v[76:79], v[64:67], v[12:15]
    ds_read_b128 v[116:119], v156 offset:6144
    v_mfma_f32_16x16x32_bf16 v[28:31], v[76:79], v[68:71], v[28:31]
    ds_read_b128 v[120:123], v157 offset:14336
    v_mfma_f32_16x16x32_bf16 v[16:19], v[80:83], v[64:67], v[16:19]
    ds_read_b128 v[124:127], v157 offset:15360
    v_mfma_f32_16x16x32_bf16 v[32:35], v[80:83], v[68:71], v[32:35]
    ds_read_b128 v[128:131], v157 offset:16384
    v_mfma_f32_16x16x32_bf16 v[20:23], v[84:87], v[64:67], v[20:23]
    ds_read_b128 v[132:135], v157 offset:17408
    v_mfma_f32_16x16x32_bf16 v[36:39], v[84:87], v[68:71], v[36:39]
    v_mfma_f32_16x16x32_bf16 v[8:11], v[96:99], v[88:91], v[8:11]
    v_mfma_f32_16x16x32_bf16 v[24:27], v[96:99], v[92:95], v[24:27]
    ds_read_b128 v[64:67], v156 offset:5120
    v_mfma_f32_16x16x32_bf16 v[12:15], v[100:103], v[88:91], v[12:15]
    ds_read_b128 v[68:71], v156 offset:7168
    v_mfma_f32_16x16x32_bf16 v[28:31], v[100:103], v[92:95], v[28:31]
    ds_read_b128 v[72:75], v157 offset:21504
    v_mfma_f32_16x16x32_bf16 v[16:19], v[104:107], v[88:91], v[16:19]
    ds_read_b128 v[76:79], v157 offset:22528
    v_mfma_f32_16x16x32_bf16 v[32:35], v[104:107], v[92:95], v[32:35]
    ds_read_b128 v[80:83], v157 offset:23552
    v_mfma_f32_16x16x32_bf16 v[20:23], v[108:111], v[88:91], v[20:23]
    ds_read_b128 v[84:87], v157 offset:24576
    v_mfma_f32_16x16x32_bf16 v[36:39], v[108:111], v[92:95], v[36:39]
    s_lshl_b32 s60, s7, 8
    s_add_u32 s60, s60, 161792
    v_lshlrev_b32 v4, 3, v3
    v_add_u32 v4, s60, v4
    ds_read_b64 v[136:137], v4 offset:0
    ds_read_b64 v[138:139], v4 offset:128
    s_lshl_b32 s60, s8, 8
    s_add_u32 s60, s60, 163200
    v_lshlrev_b32 v4, 4, v2
    v_add_u32 v4, s60, v4
    ds_read_b128 v[40:43], v4 offset:0
    ds_read_b128 v[44:47], v4 offset:64
    ds_read_b128 v[48:51], v4 offset:128
    ds_read_b128 v[52:55], v4 offset:192
    s_waitcnt lgkmcnt(12)
    v_mfma_f32_16x16x32_bf16 v[8:11], v[120:123], v[112:115], v[8:11]
    v_mfma_f32_16x16x32_bf16 v[24:27], v[120:123], v[116:119], v[24:27]
    v_mfma_f32_16x16x32_bf16 v[12:15], v[124:127], v[112:115], v[12:15]
    v_mfma_f32_16x16x32_bf16 v[28:31], v[124:127], v[116:119], v[28:31]
    v_mfma_f32_16x16x32_bf16 v[16:19], v[128:131], v[112:115], v[16:19]
    v_mfma_f32_16x16x32_bf16 v[32:35], v[128:131], v[116:119], v[32:35]
    v_mfma_f32_16x16x32_bf16 v[20:23], v[132:135], v[112:115], v[20:23]
    v_mfma_f32_16x16x32_bf16 v[36:39], v[132:135], v[116:119], v[36:39]
    s_waitcnt lgkmcnt(6)
    v_mfma_f32_16x16x32_bf16 v[8:11], v[72:75], v[64:67], v[8:11]
    v_mfma_f32_16x16x32_bf16 v[24:27], v[72:75], v[68:71], v[24:27]
    v_mfma_f32_16x16x32_bf16 v[12:15], v[76:79], v[64:67], v[12:15]
    v_mfma_f32_16x16x32_bf16 v[28:31], v[76:79], v[68:71], v[28:31]
    v_mfma_f32_16x16x32_bf16 v[16:19], v[80:83], v[64:67], v[16:19]
    v_mfma_f32_16x16x32_bf16 v[32:35], v[80:83], v[68:71], v[32:35]
    v_mfma_f32_16x16x32_bf16 v[20:23], v[84:87], v[64:67], v[20:23]
    v_mfma_f32_16x16x32_bf16 v[36:39], v[84:87], v[68:71], v[36:39]
    s_waitcnt vmcnt(0) lgkmcnt(0)
    s_barrier
    v_mov_b32 v140, v137
    v_mov_b32 v142, v139
    v_lshlrev_b32 v96, 16, v56
    v_and_b32 v97, 0xffff0000, v56
    v_lshlrev_b32 v98, 16, v57
    v_and_b32 v99, 0xffff0000, v57
    v_lshlrev_b32 v100, 16, v58
    v_and_b32 v101, 0xffff0000, v58
    v_lshlrev_b32 v102, 16, v59
    v_and_b32 v103, 0xffff0000, v59
    v_lshlrev_b32 v104, 16, v60
    v_and_b32 v105, 0xffff0000, v60
    v_lshlrev_b32 v106, 16, v61
    v_and_b32 v107, 0xffff0000, v61
    v_lshlrev_b32 v108, 16, v62
    v_and_b32 v109, 0xffff0000, v62
    v_lshlrev_b32 v110, 16, v63
    v_and_b32 v111, 0xffff0000, v63
    v_pk_fma_f32 v[8:9], v[8:9], v[140:141], v[96:97] op_sel_hi:[1,0,1]
    v_pk_fma_f32 v[10:11], v[10:11], v[140:141], v[98:99] op_sel_hi:[1,0,1]
    v_pk_fma_f32 v[12:13], v[12:13], v[140:141], v[100:101] op_sel_hi:[1,0,1]
    v_pk_fma_f32 v[14:15], v[14:15], v[140:141], v[102:103] op_sel_hi:[1,0,1]
    v_pk_fma_f32 v[16:17], v[16:17], v[140:141], v[104:105] op_sel_hi:[1,0,1]
    v_pk_fma_f32 v[18:19], v[18:19], v[140:141], v[106:107] op_sel_hi:[1,0,1]
    v_pk_fma_f32 v[20:21], v[20:21], v[140:141], v[108:109] op_sel_hi:[1,0,1]
    v_pk_fma_f32 v[22:23], v[22:23], v[140:141], v[110:111] op_sel_hi:[1,0,1]
    v_pk_fma_f32 v[8:9], v[40:41], v[136:137], v[8:9] op_sel_hi:[1,0,1]
    v_pk_fma_f32 v[10:11], v[42:43], v[136:137], v[10:11] op_sel_hi:[1,0,1]
    v_pk_fma_f32 v[12:13], v[44:45], v[136:137], v[12:13] op_sel_hi:[1,0,1]
    v_pk_fma_f32 v[14:15], v[46:47], v[136:137], v[14:15] op_sel_hi:[1,0,1]
    v_pk_fma_f32 v[16:17], v[48:49], v[136:137], v[16:17] op_sel_hi:[1,0,1]
    v_pk_fma_f32 v[18:19], v[50:51], v[136:137], v[18:19] op_sel_hi:[1,0,1]
    v_pk_fma_f32 v[20:21], v[52:53], v[136:137], v[20:21] op_sel_hi:[1,0,1]
    v_pk_fma_f32 v[22:23], v[54:55], v[136:137], v[22:23] op_sel_hi:[1,0,1]
    v_pk_mul_f32 v[64:65], v[8:9], v[8:9]
    v_pk_mul_f32 v[66:67], v[10:11], v[10:11]
    v_pk_mul_f32 v[68:69], v[12:13], v[12:13]
    v_pk_mul_f32 v[70:71], v[14:15], v[14:15]
    v_pk_mul_f32 v[72:73], v[16:17], v[16:17]
    v_pk_mul_f32 v[74:75], v[18:19], v[18:19]
    v_pk_mul_f32 v[76:77], v[20:21], v[20:21]
    v_pk_mul_f32 v[78:79], v[22:23], v[22:23]
    v_pk_fma_f32 v[64:65], v[64:65], v[146:147], v[148:149] op_sel_hi:[1,0,0]
    v_pk_fma_f32 v[66:67], v[66:67], v[146:147], v[148:149] op_sel_hi:[1,0,0]
    v_pk_fma_f32 v[68:69], v[68:69], v[146:147], v[148:149] op_sel_hi:[1,0,0]
    v_pk_fma_f32 v[70:71], v[70:71], v[146:147], v[148:149] op_sel_hi:[1,0,0]
    v_pk_fma_f32 v[72:73], v[72:73], v[146:147], v[148:149] op_sel_hi:[1,0,0]
    v_pk_fma_f32 v[74:75], v[74:75], v[146:147], v[148:149] op_sel_hi:[1,0,0]
    v_pk_fma_f32 v[76:77], v[76:77], v[146:147], v[148:149] op_sel_hi:[1,0,0]
    v_pk_fma_f32 v[78:79], v[78:79], v[146:147], v[148:149] op_sel_hi:[1,0,0]
    v_pk_mul_f32 v[64:65], v[64:65], v[8:9]
    v_pk_mul_f32 v[66:67], v[66:67], v[10:11]
    v_pk_mul_f32 v[68:69], v[68:69], v[12:13]
    v_pk_mul_f32 v[70:71], v[70:71], v[14:15]
    v_pk_mul_f32 v[72:73], v[72:73], v[16:17]
    v_pk_mul_f32 v[74:75], v[74:75], v[18:19]
    v_pk_mul_f32 v[76:77], v[76:77], v[20:21]
    v_pk_mul_f32 v[78:79], v[78:79], v[22:23]
    v_exp_f32 v64, v64
    v_exp_f32 v65, v65
    v_exp_f32 v66, v66
    v_exp_f32 v67, v67
    v_exp_f32 v68, v68
    v_exp_f32 v69, v69
    v_exp_f32 v70, v70
    v_exp_f32 v71, v71
    v_exp_f32 v72, v72
    v_exp_f32 v73, v73
    v_exp_f32 v74, v74
    v_exp_f32 v75, v75
    v_exp_f32 v76, v76
    v_exp_f32 v77, v77
    v_exp_f32 v78, v78
    v_exp_f32 v79, v79
    v_pk_add_f32 v[64:65], v[64:65], v[150:151] op_sel_hi:[1,0]
    v_pk_add_f32 v[66:67], v[66:67], v[150:151] op_sel_hi:[1,0]
    v_pk_add_f32 v[68:69], v[68:69], v[150:151] op_sel_hi:[1,0]
    v_pk_add_f32 v[70:71], v[70:71], v[150:151] op_sel_hi:[1,0]
    v_pk_add_f32 v[72:73], v[72:73], v[150:151] op_sel_hi:[1,0]
    v_pk_add_f32 v[74:75], v[74:75], v[150:151] op_sel_hi:[1,0]
    v_pk_add_f32 v[76:77], v[76:77], v[150:151] op_sel_hi:[1,0]
    v_pk_add_f32 v[78:79], v[78:79], v[150:151] op_sel_hi:[1,0]
    v_rcp_f32 v64, v64
    v_rcp_f32 v65, v65
    v_rcp_f32 v66, v66
    v_rcp_f32 v67, v67
    v_rcp_f32 v68, v68
    v_rcp_f32 v69, v69
    v_rcp_f32 v70, v70
    v_rcp_f32 v71, v71
    v_rcp_f32 v72, v72
    v_rcp_f32 v73, v73
    v_rcp_f32 v74, v74
    v_rcp_f32 v75, v75
    v_rcp_f32 v76, v76
    v_rcp_f32 v77, v77
    v_rcp_f32 v78, v78
    v_rcp_f32 v79, v79
    v_pk_mul_f32 v[8:9], v[8:9], v[64:65]
    v_pk_mul_f32 v[10:11], v[10:11], v[66:67]
    v_pk_mul_f32 v[12:13], v[12:13], v[68:69]
    v_pk_mul_f32 v[14:15], v[14:15], v[70:71]
    v_pk_mul_f32 v[16:17], v[16:17], v[72:73]
    v_pk_mul_f32 v[18:19], v[18:19], v[74:75]
    v_pk_mul_f32 v[20:21], v[20:21], v[76:77]
    v_pk_mul_f32 v[22:23], v[22:23], v[78:79]
    v_cvt_pk_bf16_f32 v128, v8, v9
    v_cvt_pk_bf16_f32 v129, v10, v11
    v_cvt_pk_bf16_f32 v130, v12, v13
    v_cvt_pk_bf16_f32 v131, v14, v15
    v_cvt_pk_bf16_f32 v132, v16, v17
    v_cvt_pk_bf16_f32 v133, v18, v19
    v_cvt_pk_bf16_f32 v134, v20, v21
    v_cvt_pk_bf16_f32 v135, v22, v23
    buffer_store_dwordx4 v[128:131], v144, s[56:59], s64 offen sc1
    buffer_store_dwordx4 v[132:135], v144, s[56:59], s64 offen offset:1024 sc1
    v_pk_fma_f32 v[24:25], v[24:25], v[142:143], v[96:97] op_sel_hi:[1,0,1]
    v_pk_fma_f32 v[26:27], v[26:27], v[142:143], v[98:99] op_sel_hi:[1,0,1]
    v_pk_fma_f32 v[28:29], v[28:29], v[142:143], v[100:101] op_sel_hi:[1,0,1]
    v_pk_fma_f32 v[30:31], v[30:31], v[142:143], v[102:103] op_sel_hi:[1,0,1]
    v_pk_fma_f32 v[32:33], v[32:33], v[142:143], v[104:105] op_sel_hi:[1,0,1]
    v_pk_fma_f32 v[34:35], v[34:35], v[142:143], v[106:107] op_sel_hi:[1,0,1]
    v_pk_fma_f32 v[36:37], v[36:37], v[142:143], v[108:109] op_sel_hi:[1,0,1]
    v_pk_fma_f32 v[38:39], v[38:39], v[142:143], v[110:111] op_sel_hi:[1,0,1]
    v_pk_fma_f32 v[24:25], v[40:41], v[138:139], v[24:25] op_sel_hi:[1,0,1]
    v_pk_fma_f32 v[26:27], v[42:43], v[138:139], v[26:27] op_sel_hi:[1,0,1]
    v_pk_fma_f32 v[28:29], v[44:45], v[138:139], v[28:29] op_sel_hi:[1,0,1]
    v_pk_fma_f32 v[30:31], v[46:47], v[138:139], v[30:31] op_sel_hi:[1,0,1]
    v_pk_fma_f32 v[32:33], v[48:49], v[138:139], v[32:33] op_sel_hi:[1,0,1]
    v_pk_fma_f32 v[34:35], v[50:51], v[138:139], v[34:35] op_sel_hi:[1,0,1]
    v_pk_fma_f32 v[36:37], v[52:53], v[138:139], v[36:37] op_sel_hi:[1,0,1]
    v_pk_fma_f32 v[38:39], v[54:55], v[138:139], v[38:39] op_sel_hi:[1,0,1]
    v_pk_mul_f32 v[80:81], v[24:25], v[24:25]
    v_pk_mul_f32 v[82:83], v[26:27], v[26:27]
    v_pk_mul_f32 v[84:85], v[28:29], v[28:29]
    v_pk_mul_f32 v[86:87], v[30:31], v[30:31]
    v_pk_mul_f32 v[88:89], v[32:33], v[32:33]
    v_pk_mul_f32 v[90:91], v[34:35], v[34:35]
    v_pk_mul_f32 v[92:93], v[36:37], v[36:37]
    v_pk_mul_f32 v[94:95], v[38:39], v[38:39]
    v_pk_fma_f32 v[80:81], v[80:81], v[146:147], v[148:149] op_sel_hi:[1,0,0]
    v_pk_fma_f32 v[82:83], v[82:83], v[146:147], v[148:149] op_sel_hi:[1,0,0]
    v_pk_fma_f32 v[84:85], v[84:85], v[146:147], v[148:149] op_sel_hi:[1,0,0]
    v_pk_fma_f32 v[86:87], v[86:87], v[146:147], v[148:149] op_sel_hi:[1,0,0]
    v_pk_fma_f32 v[88:89], v[88:89], v[146:147], v[148:149] op_sel_hi:[1,0,0]
    v_pk_fma_f32 v[90:91], v[90:91], v[146:147], v[148:149] op_sel_hi:[1,0,0]
    v_pk_fma_f32 v[92:93], v[92:93], v[146:147], v[148:149] op_sel_hi:[1,0,0]
    v_pk_fma_f32 v[94:95], v[94:95], v[146:147], v[148:149] op_sel_hi:[1,0,0]
    v_pk_mul_f32 v[80:81], v[80:81], v[24:25]
    v_pk_mul_f32 v[82:83], v[82:83], v[26:27]
    v_pk_mul_f32 v[84:85], v[84:85], v[28:29]
    v_pk_mul_f32 v[86:87], v[86:87], v[30:31]
    v_pk_mul_f32 v[88:89], v[88:89], v[32:33]
    v_pk_mul_f32 v[90:91], v[90:91], v[34:35]
    v_pk_mul_f32 v[92:93], v[92:93], v[36:37]
    v_pk_mul_f32 v[94:95], v[94:95], v[38:39]
    v_exp_f32 v80, v80
    v_exp_f32 v81, v81
    v_exp_f32 v82, v82
    v_exp_f32 v83, v83
    v_exp_f32 v84, v84
    v_exp_f32 v85, v85
    v_exp_f32 v86, v86
    v_exp_f32 v87, v87
    v_exp_f32 v88, v88
    v_exp_f32 v89, v89
    v_exp_f32 v90, v90
    v_exp_f32 v91, v91
    v_exp_f32 v92, v92
    v_exp_f32 v93, v93
    v_exp_f32 v94, v94
    v_exp_f32 v95, v95
    v_pk_add_f32 v[80:81], v[80:81], v[150:151] op_sel_hi:[1,0]
    v_pk_add_f32 v[82:83], v[82:83], v[150:151] op_sel_hi:[1,0]
    v_pk_add_f32 v[84:85], v[84:85], v[150:151] op_sel_hi:[1,0]
    v_pk_add_f32 v[86:87], v[86:87], v[150:151] op_sel_hi:[1,0]
    v_pk_add_f32 v[88:89], v[88:89], v[150:151] op_sel_hi:[1,0]
    v_pk_add_f32 v[90:91], v[90:91], v[150:151] op_sel_hi:[1,0]
    v_pk_add_f32 v[92:93], v[92:93], v[150:151] op_sel_hi:[1,0]
    v_pk_add_f32 v[94:95], v[94:95], v[150:151] op_sel_hi:[1,0]
    v_rcp_f32 v80, v80
    v_rcp_f32 v81, v81
    v_rcp_f32 v82, v82
    v_rcp_f32 v83, v83
    v_rcp_f32 v84, v84
    v_rcp_f32 v85, v85
    v_rcp_f32 v86, v86
    v_rcp_f32 v87, v87
    v_rcp_f32 v88, v88
    v_rcp_f32 v89, v89
    v_rcp_f32 v90, v90
    v_rcp_f32 v91, v91
    v_rcp_f32 v92, v92
    v_rcp_f32 v93, v93
    v_rcp_f32 v94, v94
    v_rcp_f32 v95, v95
    v_pk_mul_f32 v[24:25], v[24:25], v[80:81]
    v_pk_mul_f32 v[26:27], v[26:27], v[82:83]
    v_pk_mul_f32 v[28:29], v[28:29], v[84:85]
    v_pk_mul_f32 v[30:31], v[30:31], v[86:87]
    v_pk_mul_f32 v[32:33], v[32:33], v[88:89]
    v_pk_mul_f32 v[34:35], v[34:35], v[90:91]
    v_pk_mul_f32 v[36:37], v[36:37], v[92:93]
    v_pk_mul_f32 v[38:39], v[38:39], v[94:95]
    v_cvt_pk_bf16_f32 v56, v24, v25
    v_cvt_pk_bf16_f32 v57, v26, v27
    v_cvt_pk_bf16_f32 v58, v28, v29
    v_cvt_pk_bf16_f32 v59, v30, v31
    v_cvt_pk_bf16_f32 v60, v32, v33
    v_cvt_pk_bf16_f32 v61, v34, v35
    v_cvt_pk_bf16_f32 v62, v36, v37
    v_cvt_pk_bf16_f32 v63, v38, v39
    s_add_u32 s64, s64, 58368
    s_add_u32 s65, s65, 58368
    buffer_store_dwordx4 v[56:59], v144, s[56:59], s64 offen sc1
    buffer_store_dwordx4 v[60:63], v144, s[56:59], s64 offen offset:1024 sc1
    s_branch Lcj_141
Lnh1_140:
    s_nop 7
    s_nop 7
    s_lshl_b32 s79, s7, 12
    v_lshlrev_b32 v152, 4, v1
    v_add_u32 v154, s79, v152
    v_add_u32 v155, 0x10000, v154
    v_add_u32 v156, 0x20000, v154
    v_lshlrev_b32 v152, 4, v1
    v_add_u32 v157, 0x1000, v152
    v_add_u32 v158, 0x10000, v157
    s_lshl_b32 s79, s4, 8
    s_add_u32 s79, s79, 0
    v_lshlrev_b32 v159, 4, v2
    v_add_u32 v159, s79, v159
    s_barrier
    ds_read_b128 v[64:67], v155 offset:20480
    ds_read_b128 v[68:71], v155 offset:22528
    ds_read_b128 v[72:75], v157 offset:0
    ds_read_b128 v[76:79], v157 offset:1024
    ds_read_b128 v[80:83], v157 offset:2048
    ds_read_b128 v[84:87], v155 offset:21504
    ds_read_b128 v[88:91], v155 offset:23552
    ds_read_b128 v[92:95], v157 offset:7168
    ds_read_b128 v[96:99], v157 offset:8192
    ds_read_b128 v[100:103], v157 offset:9216
    s_waitcnt lgkmcnt(5)
    s_waitcnt lgkmcnt(0)
    s_barrier
    v_mfma_f32_16x16x32_bf16 v[8:11], v[72:75], v[64:67], 0
    ds_read_b128 v[104:107], v155 offset:36864
    v_mfma_f32_16x16x32_bf16 v[20:23], v[72:75], v[68:71], 0
    ds_read_b128 v[108:111], v155 offset:38912
    v_mfma_f32_16x16x32_bf16 v[12:15], v[76:79], v[64:67], 0
    ds_read_b128 v[112:115], v157 offset:14336
    v_mfma_f32_16x16x32_bf16 v[24:27], v[76:79], v[68:71], 0
    ds_read_b128 v[116:119], v157 offset:15360
    v_mfma_f32_16x16x32_bf16 v[16:19], v[80:83], v[64:67], 0
    ds_read_b128 v[120:123], v157 offset:16384
    v_mfma_f32_16x16x32_bf16 v[28:31], v[80:83], v[68:71], 0
    v_mfma_f32_16x16x32_bf16 v[8:11], v[92:95], v[84:87], v[8:11]
    ds_read_b128 v[64:67], v155 offset:37888
    v_mfma_f32_16x16x32_bf16 v[20:23], v[92:95], v[88:91], v[20:23]
    ds_read_b128 v[68:71], v155 offset:39936
    v_mfma_f32_16x16x32_bf16 v[12:15], v[96:99], v[84:87], v[12:15]
    ds_read_b128 v[72:75], v157 offset:21504
    v_mfma_f32_16x16x32_bf16 v[24:27], v[96:99], v[88:91], v[24:27]
    ds_read_b128 v[76:79], v157 offset:22528
    v_mfma_f32_16x16x32_bf16 v[16:19], v[100:103], v[84:87], v[16:19]
    ds_read_b128 v[80:83], v157 offset:23552
    v_mfma_f32_16x16x32_bf16 v[28:31], v[100:103], v[88:91], v[28:31]
    s_waitcnt lgkmcnt(5)
    s_waitcnt lgkmcnt(0)
    s_barrier
    v_mfma_f32_16x16x32_bf16 v[8:11], v[112:115], v[104:107], v[8:11]
    ds_read_b128 v[84:87], v155 offset:53248
    v_mfma_f32_16x16x32_bf16 v[20:23], v[112:115], v[108:111], v[20:23]
    ds_read_b128 v[88:91], v155 offset:55296
    v_mfma_f32_16x16x32_bf16 v[12:15], v[116:119], v[104:107], v[12:15]
    ds_read_b128 v[92:95], v157 offset:28672
    v_mfma_f32_16x16x32_bf16 v[24:27], v[116:119], v[108:111], v[24:27]
    ds_read_b128 v[96:99], v157 offset:29696
    v_mfma_f32_16x16x32_bf16 v[16:19], v[120:123], v[104:107], v[16:19]
    ds_read_b128 v[100:103], v157 offset:30720
    v_mfma_f32_16x16x32_bf16 v[28:31], v[120:123], v[108:111], v[28:31]
    v_mfma_f32_16x16x32_bf16 v[8:11], v[72:75], v[64:67], v[8:11]
    ds_read_b128 v[104:107], v155 offset:54272
    v_mfma_f32_16x16x32_bf16 v[20:23], v[72:75], v[68:71], v[20:23]
    ds_read_b128 v[108:111], v155 offset:56320
    v_mfma_f32_16x16x32_bf16 v[12:15], v[76:79], v[64:67], v[12:15]
    ds_read_b128 v[112:115], v157 offset:35840
    v_mfma_f32_16x16x32_bf16 v[24:27], v[76:79], v[68:71], v[24:27]
    ds_read_b128 v[116:119], v157 offset:36864
    v_mfma_f32_16x16x32_bf16 v[16:19], v[80:83], v[64:67], v[16:19]
    ds_read_b128 v[120:123], v157 offset:37888
    v_mfma_f32_16x16x32_bf16 v[28:31], v[80:83], v[68:71], v[28:31]
    s_waitcnt lgkmcnt(5)
    s_waitcnt lgkmcnt(0)
    s_barrier
    v_mfma_f32_16x16x32_bf16 v[8:11], v[92:95], v[84:87], v[8:11]
    ds_read_b128 v[64:67], v156 offset:4096
    v_mfma_f32_16x16x32_bf16 v[20:23], v[92:95], v[88:91], v[20:23]
    ds_read_b128 v[68:71], v156 offset:6144
    v_mfma_f32_16x16x32_bf16 v[12:15], v[96:99], v[84:87], v[12:15]
    ds_read_b128 v[72:75], v157 offset:43008
    v_mfma_f32_16x16x32_bf16 v[24:27], v[96:99], v[88:91], v[24:27]
    ds_read_b128 v[76:79], v157 offset:44032
    v_mfma_f32_16x16x32_bf16 v[16:19], v[100:103], v[84:87], v[16:19]
    ds_read_b128 v[80:83], v157 offset:45056
    v_mfma_f32_16x16x32_bf16 v[28:31], v[100:103], v[88:91], v[28:31]
    v_mfma_f32_16x16x32_bf16 v[8:11], v[112:115], v[104:107], v[8:11]
    ds_read_b128 v[84:87], v156 offset:5120
    v_mfma_f32_16x16x32_bf16 v[20:23], v[112:115], v[108:111], v[20:23]
    ds_read_b128 v[88:91], v156 offset:7168
    v_mfma_f32_16x16x32_bf16 v[12:15], v[116:119], v[104:107], v[12:15]
    ds_read_b128 v[92:95], v157 offset:50176
    v_mfma_f32_16x16x32_bf16 v[24:27], v[116:119], v[108:111], v[24:27]
    ds_read_b128 v[96:99], v157 offset:51200
    v_mfma_f32_16x16x32_bf16 v[16:19], v[120:123], v[104:107], v[16:19]
    ds_read_b128 v[100:103], v157 offset:52224
    v_mfma_f32_16x16x32_bf16 v[28:31], v[120:123], v[108:111], v[28:31]
    s_waitcnt lgkmcnt(5)
    s_waitcnt lgkmcnt(0)
    s_barrier
    v_mfma_f32_16x16x32_bf16 v[8:11], v[72:75], v[64:67], v[8:11]
    ds_read_b128 v[104:107], v155 offset:20480
    v_mfma_f32_16x16x32_bf16 v[20:23], v[72:75], v[68:71], v[20:23]
    ds_read_b128 v[108:111], v155 offset:22528
    v_mfma_f32_16x16x32_bf16 v[12:15], v[76:79], v[64:67], v[12:15]
    ds_read_b128 v[112:115], v157 offset:57344
    v_mfma_f32_16x16x32_bf16 v[24:27], v[76:79], v[68:71], v[24:27]
    ds_read_b128 v[116:119], v157 offset:58368
    v_mfma_f32_16x16x32_bf16 v[16:19], v[80:83], v[64:67], v[16:19]
    ds_read_b128 v[120:123], v157 offset:59392
    v_mfma_f32_16x16x32_bf16 v[28:31], v[80:83], v[68:71], v[28:31]
    v_mfma_f32_16x16x32_bf16 v[8:11], v[92:95], v[84:87], v[8:11]
    ds_read_b128 v[64:67], v155 offset:21504
    v_mfma_f32_16x16x32_bf16 v[20:23], v[92:95], v[88:91], v[20:23]
    ds_read_b128 v[68:71], v155 offset:23552
    v_mfma_f32_16x16x32_bf16 v[12:15], v[96:99], v[84:87], v[12:15]
    ds_read_b128 v[72:75], v157 offset:64512
    v_mfma_f32_16x16x32_bf16 v[24:27], v[96:99], v[88:91], v[24:27]
    ds_read_b128 v[76:79], v158 offset:0
    v_mfma_f32_16x16x32_bf16 v[16:19], v[100:103], v[84:87], v[16:19]
    ds_read_b128 v[80:83], v158 offset:1024
    v_mfma_f32_16x16x32_bf16 v[28:31], v[100:103], v[88:91], v[28:31]
    s_waitcnt lgkmcnt(5)
    s_waitcnt lgkmcnt(0)
    s_barrier
    v_mfma_f32_16x16x32_bf16 v[8:11], v[112:115], v[104:107], v[8:11]
    ds_read_b128 v[84:87], v155 offset:36864
    v_mfma_f32_16x16x32_bf16 v[20:23], v[112:115], v[108:111], v[20:23]
    ds_read_b128 v[88:91], v155 offset:38912
    v_mfma_f32_16x16x32_bf16 v[12:15], v[116:119], v[104:107], v[12:15]
    ds_read_b128 v[92:95], v158 offset:6144
    v_mfma_f32_16x16x32_bf16 v[24:27], v[116:119], v[108:111], v[24:27]
    ds_read_b128 v[96:99], v158 offset:7168
    v_mfma_f32_16x16x32_bf16 v[16:19], v[120:123], v[104:107], v[16:19]
    ds_read_b128 v[100:103], v158 offset:8192
    v_mfma_f32_16x16x32_bf16 v[28:31], v[120:123], v[108:111], v[28:31]
    v_mfma_f32_16x16x32_bf16 v[8:11], v[72:75], v[64:67], v[8:11]
    ds_read_b128 v[104:107], v155 offset:37888
    v_mfma_f32_16x16x32_bf16 v[20:23], v[72:75], v[68:71], v[20:23]
    ds_read_b128 v[108:111], v155 offset:39936
    v_mfma_f32_16x16x32_bf16 v[12:15], v[76:79], v[64:67], v[12:15]
    ds_read_b128 v[112:115], v158 offset:13312
    v_mfma_f32_16x16x32_bf16 v[24:27], v[76:79], v[68:71], v[24:27]
    ds_read_b128 v[116:119], v158 offset:14336
    v_mfma_f32_16x16x32_bf16 v[16:19], v[80:83], v[64:67], v[16:19]
    ds_read_b128 v[120:123], v158 offset:15360
    v_mfma_f32_16x16x32_bf16 v[28:31], v[80:83], v[68:71], v[28:31]
    s_waitcnt lgkmcnt(5)
    s_waitcnt lgkmcnt(0)
    s_barrier
    v_mfma_f32_16x16x32_bf16 v[8:11], v[92:95], v[84:87], v[8:11]
    ds_read_b128 v[64:67], v155 offset:53248
    v_mfma_f32_16x16x32_bf16 v[20:23], v[92:95], v[88:91], v[20:23]
    ds_read_b128 v[68:71], v155 offset:55296
    v_mfma_f32_16x16x32_bf16 v[12:15], v[96:99], v[84:87], v[12:15]
    ds_read_b128 v[72:75], v157 offset:0
    v_mfma_f32_16x16x32_bf16 v[24:27], v[96:99], v[88:91], v[24:27]
    ds_read_b128 v[76:79], v157 offset:1024
    v_mfma_f32_16x16x32_bf16 v[16:19], v[100:103], v[84:87], v[16:19]
    ds_read_b128 v[80:83], v157 offset:2048
    v_mfma_f32_16x16x32_bf16 v[28:31], v[100:103], v[88:91], v[28:31]
    v_mfma_f32_16x16x32_bf16 v[8:11], v[112:115], v[104:107], v[8:11]
    ds_read_b128 v[84:87], v155 offset:54272
    v_mfma_f32_16x16x32_bf16 v[20:23], v[112:115], v[108:111], v[20:23]
    ds_read_b128 v[88:91], v155 offset:56320
    v_mfma_f32_16x16x32_bf16 v[12:15], v[116:119], v[104:107], v[12:15]
    ds_read_b128 v[92:95], v157 offset:7168
    v_mfma_f32_16x16x32_bf16 v[24:27], v[116:119], v[108:111], v[24:27]
    ds_read_b128 v[96:99], v157 offset:8192
    v_mfma_f32_16x16x32_bf16 v[16:19], v[120:123], v[104:107], v[16:19]
    ds_read_b128 v[100:103], v157 offset:9216
    v_mfma_f32_16x16x32_bf16 v[28:31], v[120:123], v[108:111], v[28:31]
    s_waitcnt lgkmcnt(5)
    s_waitcnt lgkmcnt(0)
    s_barrier
    v_mfma_f32_16x16x32_bf16 v[8:11], v[72:75], v[64:67], v[8:11]
    ds_read_b128 v[104:107], v156 offset:4096
    v_mfma_f32_16x16x32_bf16 v[20:23], v[72:75], v[68:71], v[20:23]
    ds_read_b128 v[108:111], v156 offset:6144
    v_mfma_f32_16x16x32_bf16 v[12:15], v[76:79], v[64:67], v[12:15]
    ds_read_b128 v[112:115], v157 offset:14336
    v_mfma_f32_16x16x32_bf16 v[24:27], v[76:79], v[68:71], v[24:27]
    ds_read_b128 v[116:119], v157 offset:15360
    v_mfma_f32_16x16x32_bf16 v[16:19], v[80:83], v[64:67], v[16:19]
    ds_read_b128 v[120:123], v157 offset:16384
    v_mfma_f32_16x16x32_bf16 v[28:31], v[80:83], v[68:71], v[28:31]
    v_mfma_f32_16x16x32_bf16 v[8:11], v[92:95], v[84:87], v[8:11]
    ds_read_b128 v[64:67], v156 offset:5120
    v_mfma_f32_16x16x32_bf16 v[20:23], v[92:95], v[88:91], v[20:23]
    ds_read_b128 v[68:71], v156 offset:7168
    v_mfma_f32_16x16x32_bf16 v[12:15], v[96:99], v[84:87], v[12:15]
    ds_read_b128 v[72:75], v157 offset:21504
    v_mfma_f32_16x16x32_bf16 v[24:27], v[96:99], v[88:91], v[24:27]
    ds_read_b128 v[76:79], v157 offset:22528
    v_mfma_f32_16x16x32_bf16 v[16:19], v[100:103], v[84:87], v[16:19]
    ds_read_b128 v[80:83], v157 offset:23552
    v_mfma_f32_16x16x32_bf16 v[28:31], v[100:103], v[88:91], v[28:31]
    s_lshl_b32 s60, s7, 8
    s_add_u32 s60, s60, 161792
    v_lshlrev_b32 v4, 3, v3
    v_add_u32 v4, s60, v4
    ds_read_b64 v[136:137], v4 offset:0
    ds_read_b64 v[138:139], v4 offset:128
    s_lshl_b32 s60, s8, 8
    s_add_u32 s60, s60, 163200
    v_lshlrev_b32 v4, 4, v2
    v_add_u32 v4, s60, v4
    ds_read_b128 v[40:43], v4 offset:0
    ds_read_b128 v[44:47], v4 offset:64
    ds_read_b128 v[48:51], v4 offset:128
    s_waitcnt lgkmcnt(10)
    v_mfma_f32_16x16x32_bf16 v[8:11], v[112:115], v[104:107], v[8:11]
    v_mfma_f32_16x16x32_bf16 v[20:23], v[112:115], v[108:111], v[20:23]
    v_mfma_f32_16x16x32_bf16 v[12:15], v[116:119], v[104:107], v[12:15]
    v_mfma_f32_16x16x32_bf16 v[24:27], v[116:119], v[108:111], v[24:27]
    v_mfma_f32_16x16x32_bf16 v[16:19], v[120:123], v[104:107], v[16:19]
    v_mfma_f32_16x16x32_bf16 v[28:31], v[120:123], v[108:111], v[28:31]
    s_waitcnt lgkmcnt(5)
    v_mfma_f32_16x16x32_bf16 v[8:11], v[72:75], v[64:67], v[8:11]
    v_mfma_f32_16x16x32_bf16 v[20:23], v[72:75], v[68:71], v[20:23]
    v_mfma_f32_16x16x32_bf16 v[12:15], v[76:79], v[64:67], v[12:15]
    v_mfma_f32_16x16x32_bf16 v[24:27], v[76:79], v[68:71], v[24:27]
    v_mfma_f32_16x16x32_bf16 v[16:19], v[80:83], v[64:67], v[16:19]
    v_mfma_f32_16x16x32_bf16 v[28:31], v[80:83], v[68:71], v[28:31]
    s_waitcnt vmcnt(0) lgkmcnt(0)
    s_barrier
    v_mov_b32 v140, v137
    v_mov_b32 v142, v139
    v_lshlrev_b32 v96, 16, v56
    v_and_b32 v97, 0xffff0000, v56
    v_lshlrev_b32 v98, 16, v57
    v_and_b32 v99, 0xffff0000, v57
    v_lshlrev_b32 v100, 16, v58
    v_and_b32 v101, 0xffff0000, v58
    v_lshlrev_b32 v102, 16, v59
    v_and_b32 v103, 0xffff0000, v59
    v_lshlrev_b32 v104, 16, v60
    v_and_b32 v105, 0xffff0000, v60
    v_lshlrev_b32 v106, 16, v61
    v_and_b32 v107, 0xffff0000, v61
    v_pk_fma_f32 v[8:9], v[8:9], v[140:141], v[96:97] op_sel_hi:[1,0,1]
    v_pk_fma_f32 v[10:11], v[10:11], v[140:141], v[98:99] op_sel_hi:[1,0,1]
    v_pk_fma_f32 v[12:13], v[12:13], v[140:141], v[100:101] op_sel_hi:[1,0,1]
    v_pk_fma_f32 v[14:15], v[14:15], v[140:141], v[102:103] op_sel_hi:[1,0,1]
    v_pk_fma_f32 v[16:17], v[16:17], v[140:141], v[104:105] op_sel_hi:[1,0,1]
    v_pk_fma_f32 v[18:19], v[18:19], v[140:141], v[106:107] op_sel_hi:[1,0,1]
    v_pk_fma_f32 v[8:9], v[40:41], v[136:137], v[8:9] op_sel_hi:[1,0,1]
    v_pk_fma_f32 v[10:11], v[42:43], v[136:137], v[10:11] op_sel_hi:[1,0,1]
    v_pk_fma_f32 v[12:13], v[44:45], v[136:137], v[12:13] op_sel_hi:[1,0,1]
    v_pk_fma_f32 v[14:15], v[46:47], v[136:137], v[14:15] op_sel_hi:[1,0,1]
    v_pk_fma_f32 v[16:17], v[48:49], v[136:137], v[16:17] op_sel_hi:[1,0,1]
    v_pk_fma_f32 v[18:19], v[50:51], v[136:137], v[18:19] op_sel_hi:[1,0,1]
    v_pk_mul_f32 v[64:65], v[8:9], v[8:9]
    v_pk_mul_f32 v[66:67], v[10:11], v[10:11]
    v_pk_mul_f32 v[68:69], v[12:13], v[12:13]
    v_pk_mul_f32 v[70:71], v[14:15], v[14:15]
    v_pk_mul_f32 v[72:73], v[16:17], v[16:17]
    v_pk_mul_f32 v[74:75], v[18:19], v[18:19]
    v_pk_fma_f32 v[64:65], v[64:65], v[146:147], v[148:149] op_sel_hi:[1,0,0]
    v_pk_fma_f32 v[66:67], v[66:67], v[146:147], v[148:149] op_sel_hi:[1,0,0]
    v_pk_fma_f32 v[68:69], v[68:69], v[146:147], v[148:149] op_sel_hi:[1,0,0]
    v_pk_fma_f32 v[70:71], v[70:71], v[146:147], v[148:149] op_sel_hi:[1,0,0]
    v_pk_fma_f32 v[72:73], v[72:73], v[146:147], v[148:149] op_sel_hi:[1,0,0]
    v_pk_fma_f32 v[74:75], v[74:75], v[146:147], v[148:149] op_sel_hi:[1,0,0]
    v_pk_mul_f32 v[64:65], v[64:65], v[8:9]
    v_pk_mul_f32 v[66:67], v[66:67], v[10:11]
    v_pk_mul_f32 v[68:69], v[68:69], v[12:13]
    v_pk_mul_f32 v[70:71], v[70:71], v[14:15]
    v_pk_mul_f32 v[72:73], v[72:73], v[16:17]
    v_pk_mul_f32 v[74:75], v[74:75], v[18:19]
    v_exp_f32 v64, v64
    v_exp_f32 v65, v65
    v_exp_f32 v66, v66
    v_exp_f32 v67, v67
    v_exp_f32 v68, v68
    v_exp_f32 v69, v69
    v_exp_f32 v70, v70
    v_exp_f32 v71, v71
    v_exp_f32 v72, v72
    v_exp_f32 v73, v73
    v_exp_f32 v74, v74
    v_exp_f32 v75, v75
    v_pk_add_f32 v[64:65], v[64:65], v[150:151] op_sel_hi:[1,0]
    v_pk_add_f32 v[66:67], v[66:67], v[150:151] op_sel_hi:[1,0]
    v_pk_add_f32 v[68:69], v[68:69], v[150:151] op_sel_hi:[1,0]
    v_pk_add_f32 v[70:71], v[70:71], v[150:151] op_sel_hi:[1,0]
    v_pk_add_f32 v[72:73], v[72:73], v[150:151] op_sel_hi:[1,0]
    v_pk_add_f32 v[74:75], v[74:75], v[150:151] op_sel_hi:[1,0]
    v_rcp_f32 v64, v64
    v_rcp_f32 v65, v65
    v_rcp_f32 v66, v66
    v_rcp_f32 v67, v67
    v_rcp_f32 v68, v68
    v_rcp_f32 v69, v69
    v_rcp_f32 v70, v70
    v_rcp_f32 v71, v71
    v_rcp_f32 v72, v72
    v_rcp_f32 v73, v73
    v_rcp_f32 v74, v74
    v_rcp_f32 v75, v75
    v_pk_mul_f32 v[8:9], v[8:9], v[64:65]
    v_pk_mul_f32 v[10:11], v[10:11], v[66:67]
    v_pk_mul_f32 v[12:13], v[12:13], v[68:69]
    v_pk_mul_f32 v[14:15], v[14:15], v[70:71]
    v_pk_mul_f32 v[16:17], v[16:17], v[72:73]
    v_pk_mul_f32 v[18:19], v[18:19], v[74:75]
    v_cvt_pk_bf16_f32 v128, v8, v9
    v_cvt_pk_bf16_f32 v129, v10, v11
    v_cvt_pk_bf16_f32 v130, v12, v13
    v_cvt_pk_bf16_f32 v131, v14, v15
    v_cvt_pk_bf16_f32 v132, v16, v17
    v_cvt_pk_bf16_f32 v133, v18, v19
    buffer_store_dwordx4 v[128:131], v144, s[56:59], s64 offen sc1
    buffer_store_dwordx2 v[132:133], v144, s[56:59], s65 offen sc1
    v_pk_fma_f32 v[20:21], v[20:21], v[142:143], v[96:97] op_sel_hi:[1,0,1]
    v_pk_fma_f32 v[22:23], v[22:23], v[142:143], v[98:99] op_sel_hi:[1,0,1]
    v_pk_fma_f32 v[24:25], v[24:25], v[142:143], v[100:101] op_sel_hi:[1,0,1]
    v_pk_fma_f32 v[26:27], v[26:27], v[142:143], v[102:103] op_sel_hi:[1,0,1]
    v_pk_fma_f32 v[28:29], v[28:29], v[142:143], v[104:105] op_sel_hi:[1,0,1]
    v_pk_fma_f32 v[30:31], v[30:31], v[142:143], v[106:107] op_sel_hi:[1,0,1]
    v_pk_fma_f32 v[20:21], v[40:41], v[138:139], v[20:21] op_sel_hi:[1,0,1]
    v_pk_fma_f32 v[22:23], v[42:43], v[138:139], v[22:23] op_sel_hi:[1,0,1]
    v_pk_fma_f32 v[24:25], v[44:45], v[138:139], v[24:25] op_sel_hi:[1,0,1]
    v_pk_fma_f32 v[26:27], v[46:47], v[138:139], v[26:27] op_sel_hi:[1,0,1]
    v_pk_fma_f32 v[28:29], v[48:49], v[138:139], v[28:29] op_sel_hi:[1,0,1]
    v_pk_fma_f32 v[30:31], v[50:51], v[138:139], v[30:31] op_sel_hi:[1,0,1]
    v_pk_mul_f32 v[80:81], v[20:21], v[20:21]
    v_pk_mul_f32 v[82:83], v[22:23], v[22:23]
    v_pk_mul_f32 v[84:85], v[24:25], v[24:25]
    v_pk_mul_f32 v[86:87], v[26:27], v[26:27]
    v_pk_mul_f32 v[88:89], v[28:29], v[28:29]
    v_pk_mul_f32 v[90:91], v[30:31], v[30:31]
    v_pk_fma_f32 v[80:81], v[80:81], v[146:147], v[148:149] op_sel_hi:[1,0,0]
    v_pk_fma_f32 v[82:83], v[82:83], v[146:147], v[148:149] op_sel_hi:[1,0,0]
    v_pk_fma_f32 v[84:85], v[84:85], v[146:147], v[148:149] op_sel_hi:[1,0,0]
    v_pk_fma_f32 v[86:87], v[86:87], v[146:147], v[148:149] op_sel_hi:[1,0,0]
    v_pk_fma_f32 v[88:89], v[88:89], v[146:147], v[148:149] op_sel_hi:[1,0,0]
    v_pk_fma_f32 v[90:91], v[90:91], v[146:147], v[148:149] op_sel_hi:[1,0,0]
    v_pk_mul_f32 v[80:81], v[80:81], v[20:21]
    v_pk_mul_f32 v[82:83], v[82:83], v[22:23]
    v_pk_mul_f32 v[84:85], v[84:85], v[24:25]
    v_pk_mul_f32 v[86:87], v[86:87], v[26:27]
    v_pk_mul_f32 v[88:89], v[88:89], v[28:29]
    v_pk_mul_f32 v[90:91], v[90:91], v[30:31]
    v_exp_f32 v80, v80
    v_exp_f32 v81, v81
    v_exp_f32 v82, v82
    v_exp_f32 v83, v83
    v_exp_f32 v84, v84
    v_exp_f32 v85, v85
    v_exp_f32 v86, v86
    v_exp_f32 v87, v87
    v_exp_f32 v88, v88
    v_exp_f32 v89, v89
    v_exp_f32 v90, v90
    v_exp_f32 v91, v91
    v_pk_add_f32 v[80:81], v[80:81], v[150:151] op_sel_hi:[1,0]
    v_pk_add_f32 v[82:83], v[82:83], v[150:151] op_sel_hi:[1,0]
    v_pk_add_f32 v[84:85], v[84:85], v[150:151] op_sel_hi:[1,0]
    v_pk_add_f32 v[86:87], v[86:87], v[150:151] op_sel_hi:[1,0]
    v_pk_add_f32 v[88:89], v[88:89], v[150:151] op_sel_hi:[1,0]
    v_pk_add_f32 v[90:91], v[90:91], v[150:151] op_sel_hi:[1,0]
    v_rcp_f32 v80, v80
    v_rcp_f32 v81, v81
    v_rcp_f32 v82, v82
    v_rcp_f32 v83, v83
    v_rcp_f32 v84, v84
    v_rcp_f32 v85, v85
    v_rcp_f32 v86, v86
    v_rcp_f32 v87, v87
    v_rcp_f32 v88, v88
    v_rcp_f32 v89, v89
    v_rcp_f32 v90, v90
    v_rcp_f32 v91, v91
    v_pk_mul_f32 v[20:21], v[20:21], v[80:81]
    v_pk_mul_f32 v[22:23], v[22:23], v[82:83]
    v_pk_mul_f32 v[24:25], v[24:25], v[84:85]
    v_pk_mul_f32 v[26:27], v[26:27], v[86:87]
    v_pk_mul_f32 v[28:29], v[28:29], v[88:89]
    v_pk_mul_f32 v[30:31], v[30:31], v[90:91]
    v_cvt_pk_bf16_f32 v56, v20, v21
    v_cvt_pk_bf16_f32 v57, v22, v23
    v_cvt_pk_bf16_f32 v58, v24, v25
    v_cvt_pk_bf16_f32 v59, v26, v27
    v_cvt_pk_bf16_f32 v60, v28, v29
    v_cvt_pk_bf16_f32 v61, v30, v31
    s_add_u32 s64, s64, 58368
    s_add_u32 s65, s65, 58368
    buffer_store_dwordx4 v[56:59], v144, s[56:59], s64 offen sc1
    buffer_store_dwordx2 v[60:61], v144, s[56:59], s65 offen sc1
Lcj_141:
    s_nop 7
    s_nop 7
    v_mov_b32 v4, 163808
    v_mov_b32 v5, 1
    s_add_u32 s72, s38, 0x1580000
    s_addc_u32 s73, s39, 0
    s_mov_b32 s74, 0x3000
    s_mov_b32 s75, 0x00020000
    s_waitcnt vmcnt(0) lgkmcnt(0)
    s_mov_b64 exec, 1
    ds_add_rtn_u32 v5, v4, v5
    s_waitcnt lgkmcnt(0)
    s_mov_b64 exec, -1
    v_readfirstlane_b32 s70, v5
    s_nop 3
    s_and_b32 s70, s70, 7
    s_cmp_lg_u32 s70, 7
    s_cbranch_scc1 Lsg_142
    s_lshl_b32 s70, s5, 6
    s_add_u32 s70, s70, s6
    s_lshl_b32 s70, s70, 2
    v_mov_b32 v4, 4
    v_mov_b32 v5, 0
    s_mov_b64 exec, 1
    buffer_store_dword v4, v5, s[72:75], s70 offen sc1
    s_mov_b64 exec, -1
    s_nop 1
Lsg_142:
    s_nop 7
    s_nop 7
    s_barrier
    s_lshr_b32 s60, s6, 3
    s_lshl_b32 s61, s5, 1
    s_add_u32 s60, s60, s61
    s_and_b32 s61, s6, 7
    v_lshrrev_b32 v6, 3, v1
    v_lshlrev_b32 v6, 4, v6
    v_and_b32 v4, 7, v1
    v_lshl_add_u32 v6, v4, 8, v6
    s_lshl_b32 s64, s60, 2
    s_lshr_b32 s62, s4, 1
    s_add_u32 s64, s64, s62
    s_lshl_b32 s64, s64, 14
    s_lshl_b32 s62, s61, 11
    s_add_u32 s64, s64, s62
    s_and_b32 s62, s4, 1
    s_lshl_b32 s62, s62, 7
    s_add_u32 s64, s64, s62
    v_lshrrev_b32 v7, 3, v1
    v_lshlrev_b32 v7, 4, v7
    v_and_b32 v4, 7, v1
    v_lshl_add_u32 v7, v4, 8, v7
    s_lshl_b32 s65, s60, 2
    s_lshr_b32 s62, s4, 1
    s_add_u32 s65, s65, s62
    s_lshl_b32 s65, s65, 14
    s_lshl_b32 s62, s61, 11
    s_add_u32 s65, s65, s62
    s_and_b32 s62, s4, 1
    s_lshl_b32 s62, s62, 7
    s_add_u32 s65, s65, s62
    s_mov_b32 s48, s32
    s_mov_b32 s49, s33
    s_mov_b32 s50, 0x400
    s_mov_b32 s51, 0x00020000
    s_add_u32 s52, s38, 0x600000
    s_addc_u32 s53, s39, 0
    s_mov_b32 s54, 0x200000
    s_mov_b32 s55, 0x00020000
    s_add_u32 s56, s38, 0x800000
    s_addc_u32 s57, s39, 0
    s_mov_b32 s58, 0x200000
    s_mov_b32 s59, 0x00020000
    s_lshl_b32 s66, s7, 12
    v_lshrrev_b32 v4, 2, v1
    v_lshlrev_b32 v124, 7, v4
    v_and_b32 v5, 3, v1
    v_lshl_add_u32 v124, v5, 3, v124
    v_add_u32 v124, s66, v124
    v_bfe_u32 v4, v1, 3, 2
    v_lshl_add_u32 v124, v4, 5, v124
    v_xor_b32 v125, 32, v124
    v_xor_b32 v126, 64, v124
    v_xor_b32 v127, 96, v124
    v_add_u32 v129, 0x10000, v124
    v_add_u32 v130, 0x20000, v124
    v_add_u32 v131, 0x10000, v125
    v_add_u32 v132, 0x20000, v125
    v_add_u32 v133, 0x10000, v126
    v_add_u32 v134, 0x20000, v126
    v_add_u32 v135, 0x10000, v127
    v_add_u32 v136, 0x20000, v127
    v_lshlrev_b32 v128, 4, v1
    s_add_u32 s44, s38, 0xc00000
    s_addc_u32 s45, s39, 0
    s_mov_b32 s46, 0x720000
    s_mov_b32 s47, 0x00020000
    s_lshl_b32 s67, s60, 1
    s_add_u32 s67, s67, s8
    s_mul_i32 s67, s67, 116736
    s_mul_i32 s62, s7, 14336
    s_add_u32 s67, s67, s62
    v_and_b32 v8, 7, v1
    v_lshlrev_b32 v8, 4, v8
    s_lshl_b32 s63, s61, 7
    buffer_load_dwordx4 v[80:83], v8, s[48:51], s63 offen
    buffer_load_dwordx4 v[76:79], v6, s[52:55], s64 offen sc1
    s_barrier
    s_add_u32 s62, s67, 0
    buffer_load_dwordx4 v[84:87], v128, s[44:47], s62 offen sc1
    s_add_u32 s62, s67, 58368
    buffer_load_dwordx4 v[88:91], v128, s[44:47], s62 offen sc1
    s_add_u32 s62, s67, 1024
    buffer_load_dwordx4 v[92:95], v128, s[44:47], s62 offen sc1
    s_add_u32 s62, s67, 59392
    buffer_load_dwordx4 v[96:99], v128, s[44:47], s62 offen sc1
    s_add_u32 s62, s67, 2048
    buffer_load_dwordx4 v[100:103], v128, s[44:47], s62 offen sc1
    s_add_u32 s62, s67, 60416
    buffer_load_dwordx4 v[104:107], v128, s[44:47], s62 offen sc1
    s_add_u32 s62, s67, 3072
    buffer_load_dwordx4 v[108:111], v128, s[44:47], s62 offen sc1
    s_add_u32 s62, s67, 61440
    buffer_load_dwordx4 v[112:115], v128, s[44:47], s62 offen sc1
    s_add_u32 s62, s67, 4096
    buffer_load_dwordx4 v[116:119], v128, s[44:47], s62 offen sc1
    s_add_u32 s62, s67, 62464
    buffer_load_dwordx4 v[120:123], v128, s[44:47], s62 offen sc1
    s_barrier
    ds_read_b64_tr_b16 v[44:45], v124 offset:0
    ds_read_b64_tr_b16 v[46:47], v124 offset:2048
    ds_read_b64_tr_b16 v[48:49], v125 offset:0
    ds_read_b64_tr_b16 v[50:51], v125 offset:2048
    ds_read_b64_tr_b16 v[52:53], v126 offset:0
    ds_read_b64_tr_b16 v[54:55], v126 offset:2048
    ds_read_b64_tr_b16 v[56:57], v127 offset:0
    ds_read_b64_tr_b16 v[58:59], v127 offset:2048
    s_waitcnt lgkmcnt(0)
    s_barrier
    s_waitcnt vmcnt(8)
    v_mfma_f32_16x16x32_bf16 v[12:15], v[44:47], v[84:87], 0
    ds_read_b64_tr_b16 v[60:61], v124 offset:16384
    v_mfma_f32_16x16x32_bf16 v[28:31], v[44:47], v[88:91], 0
    ds_read_b64_tr_b16 v[62:63], v124 offset:18432
    v_mfma_f32_16x16x32_bf16 v[16:19], v[48:51], v[84:87], 0
    ds_read_b64_tr_b16 v[64:65], v125 offset:16384
    v_mfma_f32_16x16x32_bf16 v[32:35], v[48:51], v[88:91], 0
    ds_read_b64_tr_b16 v[66:67], v125 offset:18432
    ds_read_b64_tr_b16 v[68:69], v126 offset:16384
    v_mfma_f32_16x16x32_bf16 v[20:23], v[52:55], v[84:87], 0
    ds_read_b64_tr_b16 v[70:71], v126 offset:18432
    v_mfma_f32_16x16x32_bf16 v[36:39], v[52:55], v[88:91], 0
    ds_read_b64_tr_b16 v[72:73], v127 offset:16384
    v_mfma_f32_16x16x32_bf16 v[24:27], v[56:59], v[84:87], 0
    ds_read_b64_tr_b16 v[74:75], v127 offset:18432
    v_mfma_f32_16x16x32_bf16 v[40:43], v[56:59], v[88:91], 0
    s_add_u32 s62, s67, 5120
    buffer_load_dwordx4 v[84:87], v128, s[44:47], s62 offen sc1
    s_add_u32 s62, s67, 63488
    buffer_load_dwordx4 v[88:91], v128, s[44:47], s62 offen sc1
    s_waitcnt lgkmcnt(0)
    s_barrier
    s_waitcnt vmcnt(8)
    v_mfma_f32_16x16x32_bf16 v[12:15], v[60:63], v[92:95], v[12:15]
    ds_read_b64_tr_b16 v[44:45], v124 offset:32768
    v_mfma_f32_16x16x32_bf16 v[28:31], v[60:63], v[96:99], v[28:31]
    ds_read_b64_tr_b16 v[46:47], v124 offset:34816
    v_mfma_f32_16x16x32_bf16 v[16:19], v[64:67], v[92:95], v[16:19]
    ds_read_b64_tr_b16 v[48:49], v125 offset:32768
    v_mfma_f32_16x16x32_bf16 v[32:35], v[64:67], v[96:99], v[32:35]
    ds_read_b64_tr_b16 v[50:51], v125 offset:34816
    ds_read_b64_tr_b16 v[52:53], v126 offset:32768
    v_mfma_f32_16x16x32_bf16 v[20:23], v[68:71], v[92:95], v[20:23]
    ds_read_b64_tr_b16 v[54:55], v126 offset:34816
    v_mfma_f32_16x16x32_bf16 v[36:39], v[68:71], v[96:99], v[36:39]
    ds_read_b64_tr_b16 v[56:57], v127 offset:32768
    v_mfma_f32_16x16x32_bf16 v[24:27], v[72:75], v[92:95], v[24:27]
    ds_read_b64_tr_b16 v[58:59], v127 offset:34816
    v_mfma_f32_16x16x32_bf16 v[40:43], v[72:75], v[96:99], v[40:43]
    s_add_u32 s62, s67, 6144
    buffer_load_dwordx4 v[92:95], v128, s[44:47], s62 offen sc1
    s_add_u32 s62, s67, 64512
    buffer_load_dwordx4 v[96:99], v128, s[44:47], s62 offen sc1
    s_waitcnt lgkmcnt(0)
    s_barrier
    s_waitcnt vmcnt(8)
    v_mfma_f32_16x16x32_bf16 v[12:15], v[44:47], v[100:103], v[12:15]
    ds_read_b64_tr_b16 v[60:61], v124 offset:49152
    v_mfma_f32_16x16x32_bf16 v[28:31], v[44:47], v[104:107], v[28:31]
    ds_read_b64_tr_b16 v[62:63], v124 offset:51200
    v_mfma_f32_16x16x32_bf16 v[16:19], v[48:51], v[100:103], v[16:19]
    ds_read_b64_tr_b16 v[64:65], v125 offset:49152
    v_mfma_f32_16x16x32_bf16 v[32:35], v[48:51], v[104:107], v[32:35]
    ds_read_b64_tr_b16 v[66:67], v125 offset:51200
    ds_read_b64_tr_b16 v[68:69], v126 offset:49152
    v_mfma_f32_16x16x32_bf16 v[20:23], v[52:55], v[100:103], v[20:23]
    ds_read_b64_tr_b16 v[70:71], v126 offset:51200
    v_mfma_f32_16x16x32_bf16 v[36:39], v[52:55], v[104:107], v[36:39]
    ds_read_b64_tr_b16 v[72:73], v127 offset:49152
    v_mfma_f32_16x16x32_bf16 v[24:27], v[56:59], v[100:103], v[24:27]
    ds_read_b64_tr_b16 v[74:75], v127 offset:51200
    v_mfma_f32_16x16x32_bf16 v[40:43], v[56:59], v[104:107], v[40:43]
    s_add_u32 s62, s67, 7168
    buffer_load_dwordx4 v[100:103], v128, s[44:47], s62 offen sc1
    s_add_u32 s62, s67, 65536
    buffer_load_dwordx4 v[104:107], v128, s[44:47], s62 offen sc1
    s_waitcnt lgkmcnt(0)
    s_barrier
    s_waitcnt vmcnt(8)
    v_mfma_f32_16x16x32_bf16 v[12:15], v[60:63], v[108:111], v[12:15]
    ds_read_b64_tr_b16 v[44:45], v129 offset:0
    v_mfma_f32_16x16x32_bf16 v[28:31], v[60:63], v[112:115], v[28:31]
    ds_read_b64_tr_b16 v[46:47], v129 offset:2048
    v_mfma_f32_16x16x32_bf16 v[16:19], v[64:67], v[108:111], v[16:19]
    ds_read_b64_tr_b16 v[48:49], v131 offset:0
    v_mfma_f32_16x16x32_bf16 v[32:35], v[64:67], v[112:115], v[32:35]
    ds_read_b64_tr_b16 v[50:51], v131 offset:2048
    ds_read_b64_tr_b16 v[52:53], v133 offset:0
    v_mfma_f32_16x16x32_bf16 v[20:23], v[68:71], v[108:111], v[20:23]
    ds_read_b64_tr_b16 v[54:55], v133 offset:2048
    v_mfma_f32_16x16x32_bf16 v[36:39], v[68:71], v[112:115], v[36:39]
    ds_read_b64_tr_b16 v[56:57], v135 offset:0
    v_mfma_f32_16x16x32_bf16 v[24:27], v[72:75], v[108:111], v[24:27]
    ds_read_b64_tr_b16 v[58:59], v135 offset:2048
    v_mfma_f32_16x16x32_bf16 v[40:43], v[72:75], v[112:115], v[40:43]
    s_add_u32 s62, s67, 8192
    buffer_load_dwordx4 v[108:111], v128, s[44:47], s62 offen sc1
    s_add_u32 s62, s67, 66560
    buffer_load_dwordx4 v[112:115], v128, s[44:47], s62 offen sc1
    s_waitcnt lgkmcnt(0)
    s_barrier
    s_waitcnt vmcnt(8)
    v_mfma_f32_16x16x32_bf16 v[12:15], v[44:47], v[116:119], v[12:15]
    ds_read_b64_tr_b16 v[60:61], v129 offset:16384
    v_mfma_f32_16x16x32_bf16 v[28:31], v[44:47], v[120:123], v[28:31]
    ds_read_b64_tr_b16 v[62:63], v129 offset:18432
    v_mfma_f32_16x16x32_bf16 v[16:19], v[48:51], v[116:119], v[16:19]
    ds_read_b64_tr_b16 v[64:65], v131 offset:16384
    v_mfma_f32_16x16x32_bf16 v[32:35], v[48:51], v[120:123], v[32:35]
    ds_read_b64_tr_b16 v[66:67], v131 offset:18432
    ds_read_b64_tr_b16 v[68:69], v133 offset:16384
    v_mfma_f32_16x16x32_bf16 v[20:23], v[52:55], v[116:119], v[20:23]
    ds_read_b64_tr_b16 v[70:71], v133 offset:18432
    v_mfma_f32_16x16x32_bf16 v[36:39], v[52:55], v[120:123], v[36:39]
    ds_read_b64_tr_b16 v[72:73], v135 offset:16384
    v_mfma_f32_16x16x32_bf16 v[24:27], v[56:59], v[116:119], v[24:27]
    ds_read_b64_tr_b16 v[74:75], v135 offset:18432
    v_mfma_f32_16x16x32_bf16 v[40:43], v[56:59], v[120:123], v[40:43]
    s_add_u32 s62, s67, 9216
    buffer_load_dwordx4 v[116:119], v128, s[44:47], s62 offen sc1
    s_add_u32 s62, s67, 67584
    buffer_load_dwordx4 v[120:123], v128, s[44:47], s62 offen sc1
    s_waitcnt lgkmcnt(0)
    s_barrier
    s_waitcnt vmcnt(8)
    v_mfma_f32_16x16x32_bf16 v[12:15], v[60:63], v[84:87], v[12:15]
    ds_read_b64_tr_b16 v[44:45], v129 offset:32768
    v_mfma_f32_16x16x32_bf16 v[28:31], v[60:63], v[88:91], v[28:31]
    ds_read_b64_tr_b16 v[46:47], v129 offset:34816
    v_mfma_f32_16x16x32_bf16 v[16:19], v[64:67], v[84:87], v[16:19]
    ds_read_b64_tr_b16 v[48:49], v131 offset:32768
    v_mfma_f32_16x16x32_bf16 v[32:35], v[64:67], v[88:91], v[32:35]
    ds_read_b64_tr_b16 v[50:51], v131 offset:34816
    ds_read_b64_tr_b16 v[52:53], v133 offset:32768
    v_mfma_f32_16x16x32_bf16 v[20:23], v[68:71], v[84:87], v[20:23]
    ds_read_b64_tr_b16 v[54:55], v133 offset:34816
    v_mfma_f32_16x16x32_bf16 v[36:39], v[68:71], v[88:91], v[36:39]
    ds_read_b64_tr_b16 v[56:57], v135 offset:32768
    v_mfma_f32_16x16x32_bf16 v[24:27], v[72:75], v[84:87], v[24:27]
    ds_read_b64_tr_b16 v[58:59], v135 offset:34816
    v_mfma_f32_16x16x32_bf16 v[40:43], v[72:75], v[88:91], v[40:43]
    s_add_u32 s62, s67, 10240
    buffer_load_dwordx4 v[84:87], v128, s[44:47], s62 offen sc1
    s_add_u32 s62, s67, 68608
    buffer_load_dwordx4 v[88:91], v128, s[44:47], s62 offen sc1
    s_waitcnt lgkmcnt(0)
    s_barrier
    s_waitcnt vmcnt(8)
    v_mfma_f32_16x16x32_bf16 v[12:15], v[44:47], v[92:95], v[12:15]
    ds_read_b64_tr_b16 v[60:61], v129 offset:49152
    v_mfma_f32_16x16x32_bf16 v[28:31], v[44:47], v[96:99], v[28:31]
    ds_read_b64_tr_b16 v[62:63], v129 offset:51200
    v_mfma_f32_16x16x32_bf16 v[16:19], v[48:51], v[92:95], v[16:19]
    ds_read_b64_tr_b16 v[64:65], v131 offset:49152
    v_mfma_f32_16x16x32_bf16 v[32:35], v[48:51], v[96:99], v[32:35]
    ds_read_b64_tr_b16 v[66:67], v131 offset:51200
    ds_read_b64_tr_b16 v[68:69], v133 offset:49152
    v_mfma_f32_16x16x32_bf16 v[20:23], v[52:55], v[92:95], v[20:23]
    ds_read_b64_tr_b16 v[70:71], v133 offset:51200
    v_mfma_f32_16x16x32_bf16 v[36:39], v[52:55], v[96:99], v[36:39]
    ds_read_b64_tr_b16 v[72:73], v135 offset:49152
    v_mfma_f32_16x16x32_bf16 v[24:27], v[56:59], v[92:95], v[24:27]
    ds_read_b64_tr_b16 v[74:75], v135 offset:51200
    v_mfma_f32_16x16x32_bf16 v[40:43], v[56:59], v[96:99], v[40:43]
    s_add_u32 s62, s67, 11264
    buffer_load_dwordx4 v[92:95], v128, s[44:47], s62 offen sc1
    s_add_u32 s62, s67, 69632
    buffer_load_dwordx4 v[96:99], v128, s[44:47], s62 offen sc1
    s_waitcnt lgkmcnt(0)
    s_barrier
    s_waitcnt vmcnt(8)
    v_mfma_f32_16x16x32_bf16 v[12:15], v[60:63], v[100:103], v[12:15]
    ds_read_b64_tr_b16 v[44:45], v130 offset:0
    v_mfma_f32_16x16x32_bf16 v[28:31], v[60:63], v[104:107], v[28:31]
    ds_read_b64_tr_b16 v[46:47], v130 offset:2048
    v_mfma_f32_16x16x32_bf16 v[16:19], v[64:67], v[100:103], v[16:19]
    ds_read_b64_tr_b16 v[48:49], v132 offset:0
    v_mfma_f32_16x16x32_bf16 v[32:35], v[64:67], v[104:107], v[32:35]
    ds_read_b64_tr_b16 v[50:51], v132 offset:2048
    ds_read_b64_tr_b16 v[52:53], v134 offset:0
    v_mfma_f32_16x16x32_bf16 v[20:23], v[68:71], v[100:103], v[20:23]
    ds_read_b64_tr_b16 v[54:55], v134 offset:2048
    v_mfma_f32_16x16x32_bf16 v[36:39], v[68:71], v[104:107], v[36:39]
    ds_read_b64_tr_b16 v[56:57], v136 offset:0
    v_mfma_f32_16x16x32_bf16 v[24:27], v[72:75], v[100:103], v[24:27]
    ds_read_b64_tr_b16 v[58:59], v136 offset:2048
    v_mfma_f32_16x16x32_bf16 v[40:43], v[72:75], v[104:107], v[40:43]
    s_add_u32 s62, s67, 12288
    buffer_load_dwordx4 v[100:103], v128, s[44:47], s62 offen sc1
    s_add_u32 s62, s67, 70656
    buffer_load_dwordx4 v[104:107], v128, s[44:47], s62 offen sc1
    s_waitcnt lgkmcnt(0)
    s_barrier
    s_waitcnt vmcnt(8)
    v_mfma_f32_16x16x32_bf16 v[12:15], v[44:47], v[108:111], v[12:15]
    ds_read_b64_tr_b16 v[60:61], v124 offset:0
    v_mfma_f32_16x16x32_bf16 v[28:31], v[44:47], v[112:115], v[28:31]
    ds_read_b64_tr_b16 v[62:63], v124 offset:2048
    v_mfma_f32_16x16x32_bf16 v[16:19], v[48:51], v[108:111], v[16:19]
    ds_read_b64_tr_b16 v[64:65], v125 offset:0
    v_mfma_f32_16x16x32_bf16 v[32:35], v[48:51], v[112:115], v[32:35]
    ds_read_b64_tr_b16 v[66:67], v125 offset:2048
    ds_read_b64_tr_b16 v[68:69], v126 offset:0
    v_mfma_f32_16x16x32_bf16 v[20:23], v[52:55], v[108:111], v[20:23]
    ds_read_b64_tr_b16 v[70:71], v126 offset:2048
    v_mfma_f32_16x16x32_bf16 v[36:39], v[52:55], v[112:115], v[36:39]
    ds_read_b64_tr_b16 v[72:73], v127 offset:0
    v_mfma_f32_16x16x32_bf16 v[24:27], v[56:59], v[108:111], v[24:27]
    ds_read_b64_tr_b16 v[74:75], v127 offset:2048
    v_mfma_f32_16x16x32_bf16 v[40:43], v[56:59], v[112:115], v[40:43]
    s_add_u32 s62, s67, 13312
    buffer_load_dwordx4 v[108:111], v128, s[44:47], s62 offen sc1
    s_add_u32 s62, s67, 71680
    buffer_load_dwordx4 v[112:115], v128, s[44:47], s62 offen sc1
    s_waitcnt lgkmcnt(0)
    s_barrier
    s_waitcnt vmcnt(8)
    v_mfma_f32_16x16x32_bf16 v[12:15], v[60:63], v[116:119], v[12:15]
    ds_read_b64_tr_b16 v[44:45], v124 offset:16384
    v_mfma_f32_16x16x32_bf16 v[28:31], v[60:63], v[120:123], v[28:31]
    ds_read_b64_tr_b16 v[46:47], v124 offset:18432
    v_mfma_f32_16x16x32_bf16 v[16:19], v[64:67], v[116:119], v[16:19]
    ds_read_b64_tr_b16 v[48:49], v125 offset:16384
    v_mfma_f32_16x16x32_bf16 v[32:35], v[64:67], v[120:123], v[32:35]
    ds_read_b64_tr_b16 v[50:51], v125 offset:18432
    ds_read_b64_tr_b16 v[52:53], v126 offset:16384
    v_mfma_f32_16x16x32_bf16 v[20:23], v[68:71], v[116:119], v[20:23]
    ds_read_b64_tr_b16 v[54:55], v126 offset:18432
    v_mfma_f32_16x16x32_bf16 v[36:39], v[68:71], v[120:123], v[36:39]
    ds_read_b64_tr_b16 v[56:57], v127 offset:16384
    v_mfma_f32_16x16x32_bf16 v[24:27], v[72:75], v[116:119], v[24:27]
    ds_read_b64_tr_b16 v[58:59], v127 offset:18432
    v_mfma_f32_16x16x32_bf16 v[40:43], v[72:75], v[120:123], v[40:43]
    s_waitcnt lgkmcnt(0)
    s_barrier
    s_waitcnt vmcnt(6)
    v_mfma_f32_16x16x32_bf16 v[12:15], v[44:47], v[84:87], v[12:15]
    ds_read_b64_tr_b16 v[60:61], v124 offset:32768
    v_mfma_f32_16x16x32_bf16 v[28:31], v[44:47], v[88:91], v[28:31]
    ds_read_b64_tr_b16 v[62:63], v124 offset:34816
    v_mfma_f32_16x16x32_bf16 v[16:19], v[48:51], v[84:87], v[16:19]
    ds_read_b64_tr_b16 v[64:65], v125 offset:32768
    v_mfma_f32_16x16x32_bf16 v[32:35], v[48:51], v[88:91], v[32:35]
    ds_read_b64_tr_b16 v[66:67], v125 offset:34816
    ds_read_b64_tr_b16 v[68:69], v126 offset:32768
    v_mfma_f32_16x16x32_bf16 v[20:23], v[52:55], v[84:87], v[20:23]
    ds_read_b64_tr_b16 v[70:71], v126 offset:34816
    v_mfma_f32_16x16x32_bf16 v[36:39], v[52:55], v[88:91], v[36:39]
    ds_read_b64_tr_b16 v[72:73], v127 offset:32768
    v_mfma_f32_16x16x32_bf16 v[24:27], v[56:59], v[84:87], v[24:27]
    ds_read_b64_tr_b16 v[74:75], v127 offset:34816
    v_mfma_f32_16x16x32_bf16 v[40:43], v[56:59], v[88:91], v[40:43]
    s_waitcnt lgkmcnt(0)
    s_barrier
    s_waitcnt vmcnt(4)
    v_mfma_f32_16x16x32_bf16 v[12:15], v[60:63], v[92:95], v[12:15]
    ds_read_b64_tr_b16 v[44:45], v124 offset:49152
    v_mfma_f32_16x16x32_bf16 v[28:31], v[60:63], v[96:99], v[28:31]
    ds_read_b64_tr_b16 v[46:47], v124 offset:51200
    v_mfma_f32_16x16x32_bf16 v[16:19], v[64:67], v[92:95], v[16:19]
    ds_read_b64_tr_b16 v[48:49], v125 offset:49152
    v_mfma_f32_16x16x32_bf16 v[32:35], v[64:67], v[96:99], v[32:35]
    ds_read_b64_tr_b16 v[50:51], v125 offset:51200
    ds_read_b64_tr_b16 v[52:53], v126 offset:49152
    v_mfma_f32_16x16x32_bf16 v[20:23], v[68:71], v[92:95], v[20:23]
    ds_read_b64_tr_b16 v[54:55], v126 offset:51200
    v_mfma_f32_16x16x32_bf16 v[36:39], v[68:71], v[96:99], v[36:39]
    ds_read_b64_tr_b16 v[56:57], v127 offset:49152
    v_mfma_f32_16x16x32_bf16 v[24:27], v[72:75], v[92:95], v[24:27]
    ds_read_b64_tr_b16 v[58:59], v127 offset:51200
    v_mfma_f32_16x16x32_bf16 v[40:43], v[72:75], v[96:99], v[40:43]
    s_waitcnt lgkmcnt(0)
    s_barrier
    s_waitcnt vmcnt(2)
    v_mfma_f32_16x16x32_bf16 v[12:15], v[44:47], v[100:103], v[12:15]
    ds_read_b64_tr_b16 v[60:61], v129 offset:0
    v_mfma_f32_16x16x32_bf16 v[28:31], v[44:47], v[104:107], v[28:31]
    ds_read_b64_tr_b16 v[62:63], v129 offset:2048
    v_mfma_f32_16x16x32_bf16 v[16:19], v[48:51], v[100:103], v[16:19]
    ds_read_b64_tr_b16 v[64:65], v131 offset:0
    v_mfma_f32_16x16x32_bf16 v[32:35], v[48:51], v[104:107], v[32:35]
    ds_read_b64_tr_b16 v[66:67], v131 offset:2048
    ds_read_b64_tr_b16 v[68:69], v133 offset:0
    v_mfma_f32_16x16x32_bf16 v[20:23], v[52:55], v[100:103], v[20:23]
    ds_read_b64_tr_b16 v[70:71], v133 offset:2048
    v_mfma_f32_16x16x32_bf16 v[36:39], v[52:55], v[104:107], v[36:39]
    ds_read_b64_tr_b16 v[72:73], v135 offset:0
    v_mfma_f32_16x16x32_bf16 v[24:27], v[56:59], v[100:103], v[24:27]
    ds_read_b64_tr_b16 v[74:75], v135 offset:2048
    v_mfma_f32_16x16x32_bf16 v[40:43], v[56:59], v[104:107], v[40:43]
    s_waitcnt lgkmcnt(0)
    s_waitcnt vmcnt(0)
    v_mfma_f32_16x16x32_bf16 v[12:15], v[60:63], v[108:111], v[12:15]
    v_mfma_f32_16x16x32_bf16 v[28:31], v[60:63], v[112:115], v[28:31]
    v_mfma_f32_16x16x32_bf16 v[16:19], v[64:67], v[108:111], v[16:19]
    v_mfma_f32_16x16x32_bf16 v[32:35], v[64:67], v[112:115], v[32:35]
    v_mfma_f32_16x16x32_bf16 v[20:23], v[68:71], v[108:111], v[20:23]
    v_mfma_f32_16x16x32_bf16 v[36:39], v[68:71], v[112:115], v[36:39]
    v_mfma_f32_16x16x32_bf16 v[24:27], v[72:75], v[108:111], v[24:27]
    v_mfma_f32_16x16x32_bf16 v[40:43], v[72:75], v[112:115], v[40:43]
    s_waitcnt lgkmcnt(0)
    s_barrier
    s_lshl_b32 s62, s7, 1
    s_add_u32 s62, s62, s8
    s_mul_i32 s62, s62, 8704
    s_add_u32 s62, s62, 90112
    v_mul_u32_u24 v137, 272, v3
    v_lshl_add_u32 v137, v2, 4, v137
    v_add_u32 v137, s62, v137
    ds_write_b128 v137, v[12:15] offset:0
    ds_write_b128 v137, v[16:19] offset:64
    ds_write_b128 v137, v[20:23] offset:128
    ds_write_b128 v137, v[24:27] offset:192
    ds_write_b128 v137, v[28:31] offset:4352
    ds_write_b128 v137, v[32:35] offset:4416
    ds_write_b128 v137, v[36:39] offset:4480
    ds_write_b128 v137, v[40:43] offset:4544
    s_mul_i32 s62, s8, 8704
    s_add_u32 s62, s62, 90112
    v_lshrrev_b32 v138, 3, v1
    s_lshl_b32 s63, s7, 3
    v_add_u32 v138, s63, v138
    v_mul_u32_u24 v138, 272, v138
    v_and_b32 v137, 7, v1
    v_lshl_add_u32 v138, v137, 5, v138
    v_add_u32 v138, s62, v138
    s_waitcnt lgkmcnt(0)
    s_barrier
    ds_read_b128 v[44:47], v138 offset:0
    ds_read_b128 v[48:51], v138 offset:16
    ds_read_b128 v[52:55], v138 offset:17408
    ds_read_b128 v[56:59], v138 offset:17424
    ds_read_b128 v[60:63], v138 offset:34816
    ds_read_b128 v[64:67], v138 offset:34832
    ds_read_b128 v[68:71], v138 offset:52224
    ds_read_b128 v[72:75], v138 offset:52240
    s_waitcnt lgkmcnt(4)
    v_pk_add_f32 v[44:45], v[44:45], v[52:53]
    v_pk_add_f32 v[46:47], v[46:47], v[54:55]
    v_pk_add_f32 v[48:49], v[48:49], v[56:57]
    v_pk_add_f32 v[50:51], v[50:51], v[58:59]
    s_waitcnt lgkmcnt(0)
    v_pk_add_f32 v[60:61], v[60:61], v[68:69]
    v_pk_add_f32 v[62:63], v[62:63], v[70:71]
    v_pk_add_f32 v[64:65], v[64:65], v[72:73]
    v_pk_add_f32 v[66:67], v[66:67], v[74:75]
    v_pk_add_f32 v[44:45], v[44:45], v[60:61]
    v_pk_add_f32 v[46:47], v[46:47], v[62:63]
    v_pk_add_f32 v[48:49], v[48:49], v[64:65]
    v_pk_add_f32 v[50:51], v[50:51], v[66:67]
    s_waitcnt vmcnt(0)
    v_lshlrev_b32 v52, 16, v80
    v_and_b32 v53, 0xffff0000, v80
    v_lshlrev_b32 v54, 16, v81
    v_and_b32 v55, 0xffff0000, v81
    v_lshlrev_b32 v56, 16, v82
    v_and_b32 v57, 0xffff0000, v82
    v_lshlrev_b32 v58, 16, v83
    v_and_b32 v59, 0xffff0000, v83
    v_pk_add_f32 v[44:45], v[44:45], v[52:53]
    v_pk_add_f32 v[46:47], v[46:47], v[54:55]
    v_pk_add_f32 v[48:49], v[48:49], v[56:57]
    v_pk_add_f32 v[50:51], v[50:51], v[58:59]
    v_cvt_pk_bf16_f32 v60, v44, v45
    v_cvt_pk_bf16_f32 v61, v46, v47
    v_cvt_pk_bf16_f32 v62, v48, v49
    v_cvt_pk_bf16_f32 v63, v50, v51
    v_lshlrev_b32 v44, 16, v60
    v_and_b32 v45, 0xffff0000, v60
    v_lshlrev_b32 v52, 16, v76
    v_and_b32 v53, 0xffff0000, v76
    v_lshlrev_b32 v46, 16, v61
    v_and_b32 v47, 0xffff0000, v61
    v_lshlrev_b32 v54, 16, v77
    v_and_b32 v55, 0xffff0000, v77
    v_lshlrev_b32 v48, 16, v62
    v_and_b32 v49, 0xffff0000, v62
    v_lshlrev_b32 v56, 16, v78
    v_and_b32 v57, 0xffff0000, v78
    v_lshlrev_b32 v50, 16, v63
    v_and_b32 v51, 0xffff0000, v63
    v_lshlrev_b32 v58, 16, v79
    v_and_b32 v59, 0xffff0000, v79
    v_pk_add_f32 v[44:45], v[44:45], v[52:53]
    v_pk_add_f32 v[46:47], v[46:47], v[54:55]
    v_pk_add_f32 v[48:49], v[48:49], v[56:57]
    v_pk_add_f32 v[50:51], v[50:51], v[58:59]
    v_cvt_pk_bf16_f32 v60, v44, v45
    v_cvt_pk_bf16_f32 v61, v46, v47
    v_cvt_pk_bf16_f32 v62, v48, v49
    v_cvt_pk_bf16_f32 v63, v50, v51
    buffer_store_dwordx4 v[60:63], v7, s[56:59], s65 offen sc1
    s_mov_b32 s62, 0x3f803f80
    v_mov_b32 v68, 0
    v_mov_b32 v69, 0
    v_dot2c_f32_bf16 v68, s62, v60
    v_dot2c_f32_bf16 v69, v60, v60
    v_dot2c_f32_bf16 v68, s62, v61
    v_dot2c_f32_bf16 v69, v61, v61
    v_dot2c_f32_bf16 v68, s62, v62
    v_dot2c_f32_bf16 v69, v62, v62
    v_dot2c_f32_bf16 v68, s62, v63
    v_dot2c_f32_bf16 v69, v63, v63
    s_nop 1
    v_add_f32_dpp v68, v68, v68 quad_perm:[1,0,3,2] row_mask:0xf bank_mask:0xf
    v_add_f32_dpp v69, v69, v69 quad_perm:[1,0,3,2] row_mask:0xf bank_mask:0xf
    s_nop 0
    v_add_f32_dpp v68, v68, v68 quad_perm:[2,3,0,1] row_mask:0xf bank_mask:0xf
    v_add_f32_dpp v69, v69, v69 quad_perm:[2,3,0,1] row_mask:0xf bank_mask:0xf
    s_nop 0
    v_add_f32_dpp v68, v68, v68 row_half_mirror row_mask:0xf bank_mask:0xf
    v_add_f32_dpp v69, v69, v69 row_half_mirror row_mask:0xf bank_mask:0xf
    s_add_u32 s40, s38, 0x14c0000
    s_addc_u32 s41, s39, 0
    s_mov_b32 s42, 0x20000
    s_mov_b32 s43, 0x00020000
    v_lshrrev_b32 v137, 3, v1
    v_lshlrev_b32 v137, 6, v137
    s_lshl_b32 s62, s60, 3
    s_add_u32 s62, s62, s4
    s_lshl_b32 s62, s62, 6
    s_add_u32 s62, s62, s61
    s_lshl_b32 s62, s62, 3
    s_mov_b32 exec_lo, 0x01010101
    s_mov_b32 exec_hi, 0x01010101
    buffer_store_dwordx2 v[68:69], v137, s[40:43], s62 offen sc1
    s_mov_b64 exec, -1
    v_mov_b32 v4, 163808
    v_mov_b32 v5, 1
    s_add_u32 s72, s38, 0x1580000
    s_addc_u32 s73, s39, 0
    s_mov_b32 s74, 0x3000
    s_mov_b32 s75, 0x00020000
    s_waitcnt vmcnt(0) lgkmcnt(0)
    s_mov_b64 exec, 1
    ds_add_rtn_u32 v5, v4, v5
    s_waitcnt lgkmcnt(0)
    s_mov_b64 exec, -1
    v_readfirstlane_b32 s70, v5
    s_nop 3
    s_and_b32 s70, s70, 7
    s_cmp_lg_u32 s70, 7
    s_cbranch_scc1 Lsg_143
    s_lshl_b32 s70, s5, 6
    s_add_u32 s70, s70, s6
    s_lshl_b32 s70, s70, 2
    v_mov_b32 v4, 5
    v_mov_b32 v5, 0
    s_mov_b64 exec, 1
    buffer_store_dword v4, v5, s[72:75], s70 offen sc1
    s_mov_b64 exec, -1
    s_nop 1
Lsg_143:
    s_nop 7
    s_nop 7
    s_barrier
    s_lshl_b32 s63, s5, 2
    s_add_u32 s63, s63, s7
    s_mul_i32 s65, s63, 67584
    s_lshl_b32 s63, s63, 11
    s_lshl_b32 s62, s6, 1
    s_add_u32 s62, s62, s8
    s_lshl_b32 s60, s62, 10
    s_add_u32 s65, s65, s60
    v_mov_b32 v44, 0x3f803f80
    v_mov_b32 v45, 0x3f803f80
    v_mov_b32 v46, 0x3f803f80
    v_mov_b32 v47, 0x3f803f80
    v_lshlrev_b32 v5, 7, v2
    v_and_b32 v4, 4, v3
    v_lshl_add_u32 v5, v4, 2, v5
    v_and_b32 v4, 3, v3
    v_lshl_add_u32 v5, v4, 1, v5
    s_mov_b32 s48, s20
    s_mov_b32 s49, s21
    s_mov_b32 s50, 0x4000
    s_mov_b32 s51, 0x00020000
    s_add_u32 s52, s38, 0x2000000
    s_addc_u32 s53, s39, 0
    s_mov_b32 s54, 0x420000
    s_mov_b32 s55, 0x00020000
    s_add_u32 s56, s38, 0x1411000
    s_addc_u32 s57, s39, 0
    s_mov_b32 s58, 0x11000
    s_mov_b32 s59, 0x00020000
    s_lshl_b32 s60, s62, 9
    buffer_load_ushort v48, v5, s[48:51], s60 offen offset:0
    buffer_load_ushort v49, v5, s[48:51], s60 offen offset:32
    buffer_load_ushort v50, v5, s[48:51], s60 offen offset:64
    buffer_load_ushort v51, v5, s[48:51], s60 offen offset:96
    buffer_load_ushort v52, v5, s[48:51], s60 offen offset:8
    buffer_load_ushort v53, v5, s[48:51], s60 offen offset:40
    buffer_load_ushort v54, v5, s[48:51], s60 offen offset:72
    buffer_load_ushort v55, v5, s[48:51], s60 offen offset:104
    s_add_u32 s40, s38, 0x14c0000
    s_addc_u32 s41, s39, 0
    s_mov_b32 s42, 0x20000
    s_mov_b32 s43, 0x00020000
    s_mul_i32 s66, s8, 3072
    s_lshl_b32 s79, s7, 12
    v_lshlrev_b32 v140, 4, v1
    v_add_u32 v142, s79, v140
    v_add_u32 v143, 0x10000, v142
    v_add_u32 v144, 0x20000, v142
    v_lshlrev_b32 v140, 4, v1
    v_add_u32 v145, s66, v140
    v_add_u32 v146, 0x10000, v145
    s_lshl_b32 s79, s4, 8
    s_add_u32 s79, s79, 143360
    v_lshlrev_b32 v147, 4, v2
    v_add_u32 v147, s79, v147
    s_barrier
    ds_read_b128 v[72:75], v143 offset:20480
    ds_read_b128 v[76:79], v143 offset:22528
    ds_read_b128 v[80:83], v145 offset:0
    ds_read_b128 v[84:87], v145 offset:1024
    ds_read_b128 v[88:91], v145 offset:2048
    ds_read_b128 v[92:95], v143 offset:21504
    ds_read_b128 v[96:99], v143 offset:23552
    ds_read_b128 v[100:103], v145 offset:6144
    ds_read_b128 v[104:107], v145 offset:7168
    ds_read_b128 v[108:111], v145 offset:8192
    s_waitcnt lgkmcnt(5)
    s_waitcnt lgkmcnt(0)
    s_barrier
    v_mfma_f32_16x16x32_bf16 v[8:11], v[80:83], v[72:75], 0
    ds_read_b128 v[112:115], v143 offset:36864
    v_mfma_f32_16x16x32_bf16 v[20:23], v[80:83], v[76:79], 0
    ds_read_b128 v[116:119], v143 offset:38912
    v_mfma_f32_16x16x32_bf16 v[12:15], v[84:87], v[72:75], 0
    ds_read_b128 v[120:123], v145 offset:12288
    v_mfma_f32_16x16x32_bf16 v[24:27], v[84:87], v[76:79], 0
    ds_read_b128 v[124:127], v145 offset:13312
    v_mfma_f32_16x16x32_bf16 v[16:19], v[88:91], v[72:75], 0
    ds_read_b128 v[128:131], v145 offset:14336
    v_mfma_f32_16x16x32_bf16 v[28:31], v[88:91], v[76:79], 0
    v_mfma_f32_16x16x32_bf16 v[8:11], v[100:103], v[92:95], v[8:11]
    ds_read_b128 v[72:75], v143 offset:37888
    v_mfma_f32_16x16x32_bf16 v[20:23], v[100:103], v[96:99], v[20:23]
    ds_read_b128 v[76:79], v143 offset:39936
    v_mfma_f32_16x16x32_bf16 v[12:15], v[104:107], v[92:95], v[12:15]
    ds_read_b128 v[80:83], v145 offset:18432
    v_mfma_f32_16x16x32_bf16 v[24:27], v[104:107], v[96:99], v[24:27]
    ds_read_b128 v[84:87], v145 offset:19456
    v_mfma_f32_16x16x32_bf16 v[16:19], v[108:111], v[92:95], v[16:19]
    ds_read_b128 v[88:91], v145 offset:20480
    v_mfma_f32_16x16x32_bf16 v[28:31], v[108:111], v[96:99], v[28:31]
    s_waitcnt lgkmcnt(5)
    s_waitcnt lgkmcnt(0)
    s_barrier
    v_mfma_f32_16x16x32_bf16 v[8:11], v[120:123], v[112:115], v[8:11]
    ds_read_b128 v[92:95], v143 offset:53248
    v_mfma_f32_16x16x32_bf16 v[20:23], v[120:123], v[116:119], v[20:23]
    ds_read_b128 v[96:99], v143 offset:55296
    v_mfma_f32_16x16x32_bf16 v[12:15], v[124:127], v[112:115], v[12:15]
    ds_read_b128 v[100:103], v145 offset:24576
    v_mfma_f32_16x16x32_bf16 v[24:27], v[124:127], v[116:119], v[24:27]
    ds_read_b128 v[104:107], v145 offset:25600
    v_mfma_f32_16x16x32_bf16 v[16:19], v[128:131], v[112:115], v[16:19]
    ds_read_b128 v[108:111], v145 offset:26624
    v_mfma_f32_16x16x32_bf16 v[28:31], v[128:131], v[116:119], v[28:31]
    v_mfma_f32_16x16x32_bf16 v[8:11], v[80:83], v[72:75], v[8:11]
    ds_read_b128 v[112:115], v143 offset:54272
    v_mfma_f32_16x16x32_bf16 v[20:23], v[80:83], v[76:79], v[20:23]
    ds_read_b128 v[116:119], v143 offset:56320
    v_mfma_f32_16x16x32_bf16 v[12:15], v[84:87], v[72:75], v[12:15]
    ds_read_b128 v[120:123], v145 offset:30720
    v_mfma_f32_16x16x32_bf16 v[24:27], v[84:87], v[76:79], v[24:27]
    ds_read_b128 v[124:127], v145 offset:31744
    v_mfma_f32_16x16x32_bf16 v[16:19], v[88:91], v[72:75], v[16:19]
    ds_read_b128 v[128:131], v145 offset:32768
    v_mfma_f32_16x16x32_bf16 v[28:31], v[88:91], v[76:79], v[28:31]
    s_waitcnt lgkmcnt(5)
    s_waitcnt lgkmcnt(0)
    s_barrier
    v_mfma_f32_16x16x32_bf16 v[8:11], v[100:103], v[92:95], v[8:11]
    ds_read_b128 v[72:75], v144 offset:4096
    v_mfma_f32_16x16x32_bf16 v[20:23], v[100:103], v[96:99], v[20:23]
    ds_read_b128 v[76:79], v144 offset:6144
    v_mfma_f32_16x16x32_bf16 v[12:15], v[104:107], v[92:95], v[12:15]
    ds_read_b128 v[80:83], v145 offset:36864
    v_mfma_f32_16x16x32_bf16 v[24:27], v[104:107], v[96:99], v[24:27]
    ds_read_b128 v[84:87], v145 offset:37888
    v_mfma_f32_16x16x32_bf16 v[16:19], v[108:111], v[92:95], v[16:19]
    ds_read_b128 v[88:91], v145 offset:38912
    v_mfma_f32_16x16x32_bf16 v[28:31], v[108:111], v[96:99], v[28:31]
    v_mfma_f32_16x16x32_bf16 v[8:11], v[120:123], v[112:115], v[8:11]
    ds_read_b128 v[92:95], v144 offset:5120
    v_mfma_f32_16x16x32_bf16 v[20:23], v[120:123], v[116:119], v[20:23]
    ds_read_b128 v[96:99], v144 offset:7168
    v_mfma_f32_16x16x32_bf16 v[12:15], v[124:127], v[112:115], v[12:15]
    ds_read_b128 v[100:103], v145 offset:43008
    v_mfma_f32_16x16x32_bf16 v[24:27], v[124:127], v[116:119], v[24:27]
    ds_read_b128 v[104:107], v145 offset:44032
    v_mfma_f32_16x16x32_bf16 v[16:19], v[128:131], v[112:115], v[16:19]
    ds_read_b128 v[108:111], v145 offset:45056
    v_mfma_f32_16x16x32_bf16 v[28:31], v[128:131], v[116:119], v[28:31]
    s_waitcnt lgkmcnt(5)
    s_waitcnt lgkmcnt(0)
    s_barrier
    v_mfma_f32_16x16x32_bf16 v[8:11], v[80:83], v[72:75], v[8:11]
    ds_read_b128 v[112:115], v143 offset:20480
    v_mfma_f32_16x16x32_bf16 v[20:23], v[80:83], v[76:79], v[20:23]
    ds_read_b128 v[116:119], v143 offset:22528
    v_mfma_f32_16x16x32_bf16 v[12:15], v[84:87], v[72:75], v[12:15]
    ds_read_b128 v[120:123], v145 offset:49152
    v_mfma_f32_16x16x32_bf16 v[24:27], v[84:87], v[76:79], v[24:27]
    ds_read_b128 v[124:127], v145 offset:50176
    v_mfma_f32_16x16x32_bf16 v[16:19], v[88:91], v[72:75], v[16:19]
    ds_read_b128 v[128:131], v145 offset:51200
    v_mfma_f32_16x16x32_bf16 v[28:31], v[88:91], v[76:79], v[28:31]
    v_mfma_f32_16x16x32_bf16 v[8:11], v[100:103], v[92:95], v[8:11]
    ds_read_b128 v[72:75], v143 offset:21504
    v_mfma_f32_16x16x32_bf16 v[20:23], v[100:103], v[96:99], v[20:23]
    ds_read_b128 v[76:79], v143 offset:23552
    v_mfma_f32_16x16x32_bf16 v[12:15], v[104:107], v[92:95], v[12:15]
    ds_read_b128 v[80:83], v145 offset:55296
    v_mfma_f32_16x16x32_bf16 v[24:27], v[104:107], v[96:99], v[24:27]
    ds_read_b128 v[84:87], v145 offset:56320
    v_mfma_f32_16x16x32_bf16 v[16:19], v[108:111], v[92:95], v[16:19]
    ds_read_b128 v[88:91], v145 offset:57344
    v_mfma_f32_16x16x32_bf16 v[28:31], v[108:111], v[96:99], v[28:31]
    s_waitcnt vmcnt(0)
    v_cmp_gt_u32 vcc, 8, v3
    v_lshl_or_b32 v4, v49, 16, v48
    v_lshl_or_b32 v5, v51, 16, v50
    v_cndmask_b32 v56, 0, v4, vcc
    v_cndmask_b32 v57, 0, v5, vcc
    v_cndmask_b32 v58, v4, 0, vcc
    v_cndmask_b32 v59, v5, 0, vcc
    v_lshl_or_b32 v4, v53, 16, v52
    v_lshl_or_b32 v5, v55, 16, v54
    v_cndmask_b32 v60, 0, v4, vcc
    v_cndmask_b32 v61, 0, v5, vcc
    v_cndmask_b32 v62, v4, 0, vcc
    v_cndmask_b32 v63, v5, 0, vcc
    s_waitcnt lgkmcnt(5)
    s_waitcnt lgkmcnt(0)
    s_barrier
    v_mfma_f32_16x16x32_bf16 v[8:11], v[120:123], v[112:115], v[8:11]
    ds_read_b128 v[92:95], v143 offset:36864
    v_mfma_f32_16x16x32_bf16 v[20:23], v[120:123], v[116:119], v[20:23]
    ds_read_b128 v[96:99], v143 offset:38912
    v_mfma_f32_16x16x32_bf16 v[12:15], v[124:127], v[112:115], v[12:15]
    ds_read_b128 v[100:103], v145 offset:61440
    v_mfma_f32_16x16x32_bf16 v[24:27], v[124:127], v[116:119], v[24:27]
    ds_read_b128 v[104:107], v145 offset:62464
    v_mfma_f32_16x16x32_bf16 v[16:19], v[128:131], v[112:115], v[16:19]
    ds_read_b128 v[108:111], v145 offset:63488
    v_mfma_f32_16x16x32_bf16 v[28:31], v[128:131], v[116:119], v[28:31]
    v_mfma_f32_16x16x32_bf16 v[8:11], v[80:83], v[72:75], v[8:11]
    ds_read_b128 v[112:115], v143 offset:37888
    v_mfma_f32_16x16x32_bf16 v[20:23], v[80:83], v[76:79], v[20:23]
    ds_read_b128 v[116:119], v143 offset:39936
    v_mfma_f32_16x16x32_bf16 v[12:15], v[84:87], v[72:75], v[12:15]
    ds_read_b128 v[120:123], v146 offset:2048
    v_mfma_f32_16x16x32_bf16 v[24:27], v[84:87], v[76:79], v[24:27]
    ds_read_b128 v[124:127], v146 offset:3072
    v_mfma_f32_16x16x32_bf16 v[16:19], v[88:91], v[72:75], v[16:19]
    ds_read_b128 v[128:131], v146 offset:4096
    v_mfma_f32_16x16x32_bf16 v[28:31], v[88:91], v[76:79], v[28:31]
    s_waitcnt lgkmcnt(5)
    s_waitcnt lgkmcnt(0)
    s_barrier
    v_mfma_f32_16x16x32_bf16 v[8:11], v[100:103], v[92:95], v[8:11]
    ds_read_b128 v[72:75], v143 offset:53248
    v_mfma_f32_16x16x32_bf16 v[20:23], v[100:103], v[96:99], v[20:23]
    ds_read_b128 v[76:79], v143 offset:55296
    v_mfma_f32_16x16x32_bf16 v[12:15], v[104:107], v[92:95], v[12:15]
    ds_read_b128 v[80:83], v146 offset:8192
    v_mfma_f32_16x16x32_bf16 v[24:27], v[104:107], v[96:99], v[24:27]
    ds_read_b128 v[84:87], v146 offset:9216
    v_mfma_f32_16x16x32_bf16 v[16:19], v[108:111], v[92:95], v[16:19]
    ds_read_b128 v[88:91], v146 offset:10240
    v_mfma_f32_16x16x32_bf16 v[28:31], v[108:111], v[96:99], v[28:31]
    v_mfma_f32_16x16x32_bf16 v[8:11], v[120:123], v[112:115], v[8:11]
    ds_read_b128 v[92:95], v143 offset:54272
    v_mfma_f32_16x16x32_bf16 v[20:23], v[120:123], v[116:119], v[20:23]
    ds_read_b128 v[96:99], v143 offset:56320
    v_mfma_f32_16x16x32_bf16 v[12:15], v[124:127], v[112:115], v[12:15]
    ds_read_b128 v[100:103], v146 offset:14336
    v_mfma_f32_16x16x32_bf16 v[24:27], v[124:127], v[116:119], v[24:27]
    ds_read_b128 v[104:107], v146 offset:15360
    v_mfma_f32_16x16x32_bf16 v[16:19], v[128:131], v[112:115], v[16:19]
    ds_read_b128 v[108:111], v146 offset:16384
    v_mfma_f32_16x16x32_bf16 v[28:31], v[128:131], v[116:119], v[28:31]
    s_waitcnt lgkmcnt(5)
    s_waitcnt lgkmcnt(0)
    s_barrier
    v_mfma_f32_16x16x32_bf16 v[8:11], v[80:83], v[72:75], v[8:11]
    ds_read_b128 v[112:115], v144 offset:4096
    v_mfma_f32_16x16x32_bf16 v[20:23], v[80:83], v[76:79], v[20:23]
    ds_read_b128 v[116:119], v144 offset:6144
    v_mfma_f32_16x16x32_bf16 v[12:15], v[84:87], v[72:75], v[12:15]
    ds_read_b128 v[120:123], v145 offset:0
    v_mfma_f32_16x16x32_bf16 v[24:27], v[84:87], v[76:79], v[24:27]
    ds_read_b128 v[124:127], v145 offset:1024
    v_mfma_f32_16x16x32_bf16 v[16:19], v[88:91], v[72:75], v[16:19]
    ds_read_b128 v[128:131], v145 offset:2048
    v_mfma_f32_16x16x32_bf16 v[28:31], v[88:91], v[76:79], v[28:31]
    v_mfma_f32_16x16x32_bf16 v[8:11], v[100:103], v[92:95], v[8:11]
    ds_read_b128 v[72:75], v144 offset:5120
    v_mfma_f32_16x16x32_bf16 v[20:23], v[100:103], v[96:99], v[20:23]
    ds_read_b128 v[76:79], v144 offset:7168
    v_mfma_f32_16x16x32_bf16 v[12:15], v[104:107], v[92:95], v[12:15]
    ds_read_b128 v[80:83], v145 offset:6144
    v_mfma_f32_16x16x32_bf16 v[24:27], v[104:107], v[96:99], v[24:27]
    ds_read_b128 v[84:87], v145 offset:7168
    v_mfma_f32_16x16x32_bf16 v[16:19], v[108:111], v[92:95], v[16:19]
    ds_read_b128 v[88:91], v145 offset:8192
    v_mfma_f32_16x16x32_bf16 v[28:31], v[108:111], v[96:99], v[28:31]
    s_lshl_b32 s60, s7, 8
    s_add_u32 s60, s60, 161792
    v_lshlrev_b32 v4, 3, v3
    v_add_u32 v4, s60, v4
    ds_read_b64 v[132:133], v4 offset:0
    ds_read_b64 v[134:135], v4 offset:128
    s_mul_i32 s60, s8, 192
    s_add_u32 s60, s60, 162816
    v_lshlrev_b32 v4, 4, v2
    v_add_u32 v4, s60, v4
    ds_read_b128 v[32:35], v4 offset:0
    ds_read_b128 v[36:39], v4 offset:64
    ds_read_b128 v[40:43], v4 offset:128
    s_waitcnt lgkmcnt(10)
    v_mfma_f32_16x16x32_bf16 v[8:11], v[120:123], v[112:115], v[8:11]
    v_mfma_f32_16x16x32_bf16 v[20:23], v[120:123], v[116:119], v[20:23]
    v_mfma_f32_16x16x32_bf16 v[12:15], v[124:127], v[112:115], v[12:15]
    v_mfma_f32_16x16x32_bf16 v[24:27], v[124:127], v[116:119], v[24:27]
    v_mfma_f32_16x16x32_bf16 v[16:19], v[128:131], v[112:115], v[16:19]
    v_mfma_f32_16x16x32_bf16 v[28:31], v[128:131], v[116:119], v[28:31]
    s_waitcnt lgkmcnt(5)
    v_mfma_f32_16x16x32_bf16 v[8:11], v[80:83], v[72:75], v[8:11]
    v_mfma_f32_16x16x32_bf16 v[20:23], v[80:83], v[76:79], v[20:23]
    v_mfma_f32_16x16x32_bf16 v[12:15], v[84:87], v[72:75], v[12:15]
    v_mfma_f32_16x16x32_bf16 v[24:27], v[84:87], v[76:79], v[24:27]
    v_mfma_f32_16x16x32_bf16 v[16:19], v[88:91], v[72:75], v[16:19]
    v_mfma_f32_16x16x32_bf16 v[28:31], v[88:91], v[76:79], v[28:31]
    s_waitcnt lgkmcnt(0)
    s_barrier
    s_waitcnt lgkmcnt(0)
    v_mov_b32 v136, v133
    v_mov_b32 v138, v135
    v_pk_mul_f32 v[8:9], v[8:9], v[136:137] op_sel_hi:[1,0]
    v_pk_fma_f32 v[8:9], v[32:33], v[132:133], v[8:9] op_sel_hi:[1,0,1]
    v_pk_mul_f32 v[10:11], v[10:11], v[136:137] op_sel_hi:[1,0]
    v_pk_fma_f32 v[10:11], v[34:35], v[132:133], v[10:11] op_sel_hi:[1,0,1]
    v_cvt_pk_bf16_f32 v72, v8, v9
    v_cvt_pk_bf16_f32 v73, v10, v11
    v_pk_mul_f32 v[12:13], v[12:13], v[136:137] op_sel_hi:[1,0]
    v_pk_fma_f32 v[12:13], v[36:37], v[132:133], v[12:13] op_sel_hi:[1,0,1]
    v_pk_mul_f32 v[14:15], v[14:15], v[136:137] op_sel_hi:[1,0]
    v_pk_fma_f32 v[14:15], v[38:39], v[132:133], v[14:15] op_sel_hi:[1,0,1]
    v_cvt_pk_bf16_f32 v74, v12, v13
    v_cvt_pk_bf16_f32 v75, v14, v15
    v_pk_mul_f32 v[16:17], v[16:17], v[136:137] op_sel_hi:[1,0]
    v_pk_fma_f32 v[16:17], v[40:41], v[132:133], v[16:17] op_sel_hi:[1,0,1]
    v_pk_mul_f32 v[18:19], v[18:19], v[136:137] op_sel_hi:[1,0]
    v_pk_fma_f32 v[18:19], v[42:43], v[132:133], v[18:19] op_sel_hi:[1,0,1]
    v_cvt_pk_bf16_f32 v76, v16, v17
    v_cvt_pk_bf16_f32 v77, v18, v19
    v_pk_mul_f32 v[20:21], v[20:21], v[138:139] op_sel_hi:[1,0]
    v_pk_fma_f32 v[20:21], v[32:33], v[134:135], v[20:21] op_sel_hi:[1,0,1]
    v_pk_mul_f32 v[22:23], v[22:23], v[138:139] op_sel_hi:[1,0]
    v_pk_fma_f32 v[22:23], v[34:35], v[134:135], v[22:23] op_sel_hi:[1,0,1]
    v_cvt_pk_bf16_f32 v80, v20, v21
    v_cvt_pk_bf16_f32 v81, v22, v23
    v_pk_mul_f32 v[24:25], v[24:25], v[138:139] op_sel_hi:[1,0]
    v_pk_fma_f32 v[24:25], v[36:37], v[134:135], v[24:25] op_sel_hi:[1,0,1]
    v_pk_mul_f32 v[26:27], v[26:27], v[138:139] op_sel_hi:[1,0]
    v_pk_fma_f32 v[26:27], v[38:39], v[134:135], v[26:27] op_sel_hi:[1,0,1]
    v_cvt_pk_bf16_f32 v82, v24, v25
    v_cvt_pk_bf16_f32 v83, v26, v27
    v_pk_mul_f32 v[28:29], v[28:29], v[138:139] op_sel_hi:[1,0]
    v_pk_fma_f32 v[28:29], v[40:41], v[134:135], v[28:29] op_sel_hi:[1,0,1]
    v_pk_mul_f32 v[30:31], v[30:31], v[138:139] op_sel_hi:[1,0]
    v_pk_fma_f32 v[30:31], v[42:43], v[134:135], v[30:31] op_sel_hi:[1,0,1]
    v_cvt_pk_bf16_f32 v84, v28, v29
    v_cvt_pk_bf16_f32 v85, v30, v31
    s_lshl_b32 s60, s7, 5
    v_add_u32 v48, s60, v3
    s_lshl_b32 s60, s8, 12
    s_add_u32 s60, s60, 114688
    v_lshlrev_b32 v49, 5, v48
    v_lshl_add_u32 v49, v2, 3, v49
    v_add_u32 v49, s60, v49
    ds_write_b64 v49, v[76:77] offset:0
    ds_write_b64 v49, v[84:85] offset:512
    v_and_b32 v5, 1, v2
    s_lshl_b32 s60, s8, 13
    s_add_u32 s60, s60, 98304
    v_lshlrev_b32 v50, 6, v48
    v_lshl_add_u32 v50, v5, 4, v50
    v_add_u32 v50, s60, v50
    v_lshlrev_b32 v51, 8, v5
    v_lshl_add_u32 v51, v3, 4, v51
    s_mov_b32 s64, 0x3fb8aa3b
    s_add_u32 s61, s65, 33792
    v_mfma_f32_16x16x32_bf16 v[88:91], v[56:59], v[72:75], 0
    v_mfma_f32_16x16x32_bf16 v[92:95], v[60:63], v[72:75], 0
    v_mfma_f32_16x16x32_bf16 v[8:11], v[56:59], v[80:83], 0
    v_mfma_f32_16x16x32_bf16 v[12:15], v[60:63], v[80:83], 0
    s_nop 4
    v_max3_f32 v32, v88, v89, v90
    s_nop 0
    v_max3_f32 v38, v8, v9, v10
    v_min3_f32 v33, v88, v89, v90
    v_min3_f32 v39, v8, v9, v10
    v_max3_f32 v32, v32, v91, v92
    v_max3_f32 v38, v38, v11, v12
    v_min3_f32 v33, v33, v91, v92
    v_min3_f32 v39, v39, v11, v12
    v_max3_f32 v32, v32, v93, v94
    v_max3_f32 v38, v38, v13, v14
    v_min3_f32 v33, v33, v93, v94
    v_min3_f32 v39, v39, v13, v14
    v_max_f32 v32, v32, v95
    v_max_f32 v38, v38, v15
    v_min_f32 v33, v33, v95
    v_min_f32 v39, v39, v15
    v_mov_b32 v35, v32
    v_mov_b32 v41, v38
    v_mov_b32 v34, v33
    v_mov_b32 v40, v39
    v_permlane16_swap_b32 v32, v35
    v_permlane16_swap_b32 v38, v41
    v_permlane16_swap_b32 v33, v34
    v_permlane16_swap_b32 v39, v40
    v_max_f32 v32, v32, v35
    v_max_f32 v38, v38, v41
    v_min_f32 v33, v33, v34
    v_min_f32 v39, v39, v40
    v_mul_f32 v32, s64, v32
    v_mul_f32 v38, s64, v38
    v_mul_f32 v33, s64, v33
    v_mul_f32 v39, s64, v39
    v_fma_f32 v96, v88, s64, -v32
    v_fma_f32 v16, v8, s64, -v38
    v_fma_f32 v104, -v88, s64, v33
    v_fma_f32 v24, -v8, s64, v39
    v_fma_f32 v97, v89, s64, -v32
    v_fma_f32 v17, v9, s64, -v38
    v_fma_f32 v105, -v89, s64, v33
    v_fma_f32 v25, -v9, s64, v39
    v_fma_f32 v98, v90, s64, -v32
    v_fma_f32 v18, v10, s64, -v38
    v_fma_f32 v106, -v90, s64, v33
    v_fma_f32 v26, -v10, s64, v39
    v_fma_f32 v99, v91, s64, -v32
    v_fma_f32 v19, v11, s64, -v38
    v_fma_f32 v107, -v91, s64, v33
    v_fma_f32 v27, -v11, s64, v39
    v_fma_f32 v100, v92, s64, -v32
    v_fma_f32 v20, v12, s64, -v38
    v_fma_f32 v108, -v92, s64, v33
    v_fma_f32 v28, -v12, s64, v39
    v_fma_f32 v101, v93, s64, -v32
    v_fma_f32 v21, v13, s64, -v38
    v_fma_f32 v109, -v93, s64, v33
    v_fma_f32 v29, -v13, s64, v39
    v_fma_f32 v102, v94, s64, -v32
    v_fma_f32 v22, v14, s64, -v38
    v_fma_f32 v110, -v94, s64, v33
    v_fma_f32 v30, -v14, s64, v39
    v_fma_f32 v103, v95, s64, -v32
    v_fma_f32 v23, v15, s64, -v38
    v_fma_f32 v111, -v95, s64, v33
    v_fma_f32 v31, -v15, s64, v39
    v_exp_f32 v96, v96
    v_exp_f32 v16, v16
    v_exp_f32 v97, v97
    v_exp_f32 v17, v17
    v_exp_f32 v98, v98
    v_exp_f32 v18, v18
    v_exp_f32 v99, v99
    v_exp_f32 v19, v19
    v_exp_f32 v100, v100
    v_exp_f32 v20, v20
    v_exp_f32 v101, v101
    v_exp_f32 v21, v21
    v_exp_f32 v102, v102
    v_exp_f32 v22, v22
    v_exp_f32 v103, v103
    v_exp_f32 v23, v23
    v_exp_f32 v104, v104
    v_exp_f32 v24, v24
    v_exp_f32 v105, v105
    v_exp_f32 v25, v25
    v_exp_f32 v106, v106
    v_exp_f32 v26, v26
    v_exp_f32 v107, v107
    v_exp_f32 v27, v27
    v_exp_f32 v108, v108
    v_exp_f32 v28, v28
    v_exp_f32 v109, v109
    v_exp_f32 v29, v29
    v_exp_f32 v110, v110
    v_exp_f32 v30, v30
    v_exp_f32 v111, v111
    v_exp_f32 v31, v31
    v_pk_add_f32 v[88:89], v[96:97], v[98:99]
    v_pk_add_f32 v[8:9], v[16:17], v[18:19]
    v_pk_add_f32 v[90:91], v[100:101], v[102:103]
    v_pk_add_f32 v[10:11], v[20:21], v[22:23]
    v_pk_add_f32 v[92:93], v[104:105], v[106:107]
    v_pk_add_f32 v[12:13], v[24:25], v[26:27]
    v_pk_add_f32 v[94:95], v[108:109], v[110:111]
    v_pk_add_f32 v[14:15], v[28:29], v[30:31]
    v_pk_add_f32 v[88:89], v[88:89], v[90:91]
    v_pk_add_f32 v[8:9], v[8:9], v[10:11]
    v_pk_add_f32 v[92:93], v[92:93], v[94:95]
    v_pk_add_f32 v[12:13], v[12:13], v[14:15]
    v_add_f32 v34, v88, v89
    v_add_f32 v40, v8, v9
    v_add_f32 v36, v92, v93
    v_add_f32 v42, v12, v13
    v_mov_b32 v35, v34
    v_mov_b32 v41, v40
    v_mov_b32 v32, v36
    v_mov_b32 v38, v42
    v_permlane16_swap_b32 v34, v35
    v_permlane16_swap_b32 v40, v41
    v_permlane16_swap_b32 v36, v32
    v_permlane16_swap_b32 v42, v38
    v_add_f32 v34, v34, v35
    v_add_f32 v40, v40, v41
    v_add_f32 v36, v36, v32
    v_add_f32 v42, v42, v38
    v_rcp_f32 v34, v34
    v_rcp_f32 v40, v40
    v_rcp_f32 v36, v36
    v_rcp_f32 v42, v42
    v_pk_mul_f32 v[96:97], v[96:97], v[34:35] op_sel_hi:[1,0]
    v_pk_mul_f32 v[16:17], v[16:17], v[40:41] op_sel_hi:[1,0]
    v_pk_mul_f32 v[104:105], v[104:105], v[36:37] op_sel_hi:[1,0]
    v_pk_mul_f32 v[24:25], v[24:25], v[42:43] op_sel_hi:[1,0]
    v_pk_mul_f32 v[98:99], v[98:99], v[34:35] op_sel_hi:[1,0]
    v_pk_mul_f32 v[18:19], v[18:19], v[40:41] op_sel_hi:[1,0]
    v_pk_mul_f32 v[106:107], v[106:107], v[36:37] op_sel_hi:[1,0]
    v_pk_mul_f32 v[26:27], v[26:27], v[42:43] op_sel_hi:[1,0]
    v_pk_mul_f32 v[100:101], v[100:101], v[34:35] op_sel_hi:[1,0]
    v_pk_mul_f32 v[20:21], v[20:21], v[40:41] op_sel_hi:[1,0]
    v_pk_mul_f32 v[108:109], v[108:109], v[36:37] op_sel_hi:[1,0]
    v_pk_mul_f32 v[28:29], v[28:29], v[42:43] op_sel_hi:[1,0]
    v_pk_mul_f32 v[102:103], v[102:103], v[34:35] op_sel_hi:[1,0]
    v_pk_mul_f32 v[22:23], v[22:23], v[40:41] op_sel_hi:[1,0]
    v_pk_mul_f32 v[110:111], v[110:111], v[36:37] op_sel_hi:[1,0]
    v_pk_mul_f32 v[30:31], v[30:31], v[42:43] op_sel_hi:[1,0]
    v_cvt_pk_bf16_f32 v112, v96, v97
    v_cvt_pk_bf16_f32 v120, v16, v17
    v_cvt_pk_bf16_f32 v113, v98, v99
    v_cvt_pk_bf16_f32 v121, v18, v19
    v_cvt_pk_bf16_f32 v114, v100, v101
    v_cvt_pk_bf16_f32 v122, v20, v21
    v_cvt_pk_bf16_f32 v115, v102, v103
    v_cvt_pk_bf16_f32 v123, v22, v23
    v_cvt_pk_bf16_f32 v116, v104, v105
    v_cvt_pk_bf16_f32 v124, v24, v25
    v_cvt_pk_bf16_f32 v117, v106, v107
    v_cvt_pk_bf16_f32 v125, v26, v27
    v_cvt_pk_bf16_f32 v118, v108, v109
    v_cvt_pk_bf16_f32 v126, v28, v29
    v_cvt_pk_bf16_f32 v119, v110, v111
    v_cvt_pk_bf16_f32 v127, v30, v31
    s_mov_b32 exec_lo, 0
    s_mov_b32 exec_hi, -1
    ds_write_b128 v50, v[112:115] offset:0
    ds_write_b128 v50, v[116:119] offset:32
    ds_write_b128 v50, v[120:123] offset:1024
    ds_write_b128 v50, v[124:127] offset:1056
    s_not_b64 exec, exec
    buffer_store_dwordx4 v[112:115], v51, s[52:55], s65 offen sc1
    buffer_store_dwordx4 v[116:119], v51, s[52:55], s65 offen offset:512 sc1
    buffer_store_dwordx4 v[120:123], v51, s[52:55], s61 offen sc1
    buffer_store_dwordx4 v[124:127], v51, s[52:55], s61 offen offset:512 sc1
    s_mov_b64 exec, -1
    s_waitcnt lgkmcnt(0)
    s_barrier
    s_cmp_ge_u32 s4, 4
    s_cbranch_scc1 Ladone_144
    v_lshrrev_b32 v4, 2, v1
    v_and_b32 v5, 3, v1
    s_lshr_b32 s60, s4, 1
    s_and_b32 s61, s4, 1
    s_lshl_b32 s62, s60, 12
    s_add_u32 s62, s62, 114688
    v_lshlrev_b32 v49, 5, v4
    v_lshl_add_u32 v49, v5, 3, v49
    v_add_u32 v49, s62, v49
    s_lshl_b32 s62, s60, 13
    s_lshl_b32 s67, s61, 5
    s_add_u32 s62, s62, s67
    s_add_u32 s62, s62, 98304
    v_lshlrev_b32 v50, 6, v4
    v_lshl_add_u32 v50, v5, 3, v50
    v_add_u32 v50, s62, v50
    ds_read_b64_tr_b16 v[72:73], v49 offset:0
    ds_read_b64_tr_b16 v[88:89], v50 offset:0
    ds_read_b64_tr_b16 v[74:75], v49 offset:512
    ds_read_b64_tr_b16 v[90:91], v50 offset:1024
    ds_read_b64_tr_b16 v[76:77], v49 offset:1024
    ds_read_b64_tr_b16 v[92:93], v50 offset:2048
    ds_read_b64_tr_b16 v[78:79], v49 offset:1536
    ds_read_b64_tr_b16 v[94:95], v50 offset:3072
    ds_read_b64_tr_b16 v[80:81], v49 offset:2048
    ds_read_b64_tr_b16 v[96:97], v50 offset:4096
    ds_read_b64_tr_b16 v[82:83], v49 offset:2560
    ds_read_b64_tr_b16 v[98:99], v50 offset:5120
    ds_read_b64_tr_b16 v[84:85], v49 offset:3072
    ds_read_b64_tr_b16 v[100:101], v50 offset:6144
    ds_read_b64_tr_b16 v[86:87], v49 offset:3584
    ds_read_b64_tr_b16 v[102:103], v50 offset:7168
    s_waitcnt lgkmcnt(12)
    v_mfma_f32_16x16x32_bf16 v[108:111], v[72:75], v[88:91], 0
    v_mfma_f32_16x16x32_bf16 v[112:115], v[44:47], v[88:91], 0
    s_waitcnt lgkmcnt(8)
    v_mfma_f32_16x16x32_bf16 v[108:111], v[76:79], v[92:95], v[108:111]
    v_mfma_f32_16x16x32_bf16 v[112:115], v[44:47], v[92:95], v[112:115]
    s_waitcnt lgkmcnt(4)
    v_mfma_f32_16x16x32_bf16 v[108:111], v[80:83], v[96:99], v[108:111]
    v_mfma_f32_16x16x32_bf16 v[112:115], v[44:47], v[96:99], v[112:115]
    s_waitcnt lgkmcnt(0)
    v_mfma_f32_16x16x32_bf16 v[108:111], v[84:87], v[100:103], v[108:111]
    v_mfma_f32_16x16x32_bf16 v[112:115], v[44:47], v[100:103], v[112:115]
    s_lshl_b32 s62, s6, 1
    s_add_u32 s62, s62, s60
    s_mul_i32 s62, s62, 2176
    s_lshl_b32 s61, s61, 6
    s_add_u32 s62, s62, s61
    v_lshlrev_b32 v49, 9, v2
    v_lshl_add_u32 v49, v3, 2, v49
    buffer_atomic_add_f32 v108, v49, s[56:59], s62 offen offset:0
    buffer_atomic_add_f32 v109, v49, s[56:59], s62 offen offset:128
    buffer_atomic_add_f32 v110, v49, s[56:59], s62 offen offset:256
    buffer_atomic_add_f32 v111, v49, s[56:59], s62 offen offset:384
    s_mov_b64 exec, 0xffff
    buffer_atomic_add_f32 v112, v49, s[56:59], s62 offen offset:2048
    s_mov_b64 exec, -1
Ladone_144:
    s_nop 7
    s_nop 7
    v_mov_b32 v4, 163808
    v_mov_b32 v5, 1
    s_add_u32 s72, s38, 0x1580000
    s_addc_u32 s73, s39, 0
    s_mov_b32 s74, 0x3000
    s_mov_b32 s75, 0x00020000
    s_waitcnt vmcnt(0) lgkmcnt(0)
    s_mov_b64 exec, 1
    ds_add_rtn_u32 v5, v4, v5
    s_waitcnt lgkmcnt(0)
    s_mov_b64 exec, -1
    v_readfirstlane_b32 s70, v5
    s_nop 3
    s_and_b32 s70, s70, 7
    s_cmp_lg_u32 s70, 7
    s_cbranch_scc1 Lsg_145
    s_lshl_b32 s70, s5, 6
    s_add_u32 s70, s70, s6
    s_lshl_b32 s70, s70, 2
    v_mov_b32 v4, 6
    v_mov_b32 v5, 0
    s_mov_b64 exec, 1
    buffer_store_dword v4, v5, s[72:75], s70 offen sc1
    s_mov_b64 exec, -1
    s_nop 1
Lsg_145:
    s_nop 7
    s_nop 7
    s_barrier
    s_lshr_b32 s60, s6, 3
    s_lshl_b32 s61, s5, 1
    s_add_u32 s60, s60, s61
    s_and_b32 s61, s6, 7
    v_lshrrev_b32 v6, 3, v1
    v_lshlrev_b32 v6, 4, v6
    v_and_b32 v4, 7, v1
    v_lshl_add_u32 v6, v4, 8, v6
    s_lshl_b32 s64, s60, 2
    s_lshr_b32 s62, s4, 1
    s_add_u32 s64, s64, s62
    s_lshl_b32 s64, s64, 14
    s_lshl_b32 s62, s61, 11
    s_add_u32 s64, s64, s62
    s_and_b32 s62, s4, 1
    s_lshl_b32 s62, s62, 7
    s_add_u32 s64, s64, s62
    v_lshrrev_b32 v7, 3, v1
    v_lshlrev_b32 v7, 4, v7
    v_and_b32 v4, 7, v1
    v_lshl_add_u32 v7, v4, 8, v7
    s_lshl_b32 s65, s60, 2
    s_lshr_b32 s62, s4, 1
    s_add_u32 s65, s65, s62
    s_lshl_b32 s65, s65, 14
    s_lshl_b32 s62, s61, 11
    s_add_u32 s65, s65, s62
    s_and_b32 s62, s4, 1
    s_lshl_b32 s62, s62, 7
    s_add_u32 s65, s65, s62
    s_add_u32 s52, s38, 0x800000
    s_addc_u32 s53, s39, 0
    s_mov_b32 s54, 0x200000
    s_mov_b32 s55, 0x00020000
    s_add_u32 s56, s38, 0xa00000
    s_addc_u32 s57, s39, 0
    s_mov_b32 s58, 0x200000
    s_mov_b32 s59, 0x00020000
    s_lshl_b32 s62, s7, 11
    v_lshrrev_b32 v4, 2, v1
    v_lshlrev_b32 v140, 7, v4
    v_and_b32 v5, 3, v1
    v_lshl_add_u32 v140, v5, 3, v140
    v_add_u32 v140, s62, v140
    v_bfe_u32 v4, v1, 3, 2
    v_lshl_add_u32 v140, v4, 5, v140
    v_xor_b32 v141, 32, v140
    v_xor_b32 v142, 64, v140
    v_xor_b32 v143, 96, v140
    s_lshl_b32 s66, s7, 11
    s_add_u32 s62, s66, 65536
    v_lshlrev_b32 v144, 4, v1
    s_add_u32 s44, s38, 0x2000000
    s_addc_u32 s45, s39, 0
    s_mov_b32 s46, 0x420000
    s_mov_b32 s47, 0x00020000
    s_lshl_b32 s68, s60, 1
    s_add_u32 s68, s68, s8
    s_mul_i32 s68, s68, 67584
    s_lshl_b32 s63, s7, 13
    s_add_u32 s68, s68, s63
    v_lshlrev_b32 v4, 1, v2
    v_and_b32 v5, 7, v3
    v_xor_b32 v5, v5, v4
    v_lshlrev_b32 v5, 4, v5
    v_lshl_add_u32 v5, v3, 7, v5
    v_add_u32 v145, s62, v5
    v_xor_b32 v146, 16, v145
    v_lshlrev_b32 v4, 5, v2
    s_lshl_b32 s62, s7, 10
    s_add_u32 s62, s62, 106496
    v_add_u32 v147, s62, v4
    buffer_load_dwordx4 v[40:43], v6, s[52:55], s64 offen sc1
    s_mov_b32 s67, 0x358637bd
    s_barrier
    s_add_u32 s63, s68, 0
    buffer_load_dwordx4 v[76:79], v144, s[44:47], s63 offen sc1
    s_add_u32 s63, s68, 33792
    buffer_load_dwordx4 v[80:83], v144, s[44:47], s63 offen sc1
    s_add_u32 s63, s68, 1024
    buffer_load_dwordx4 v[84:87], v144, s[44:47], s63 offen sc1
    s_add_u32 s63, s68, 34816
    buffer_load_dwordx4 v[88:91], v144, s[44:47], s63 offen sc1
    s_add_u32 s63, s68, 2048
    buffer_load_dwordx4 v[92:95], v144, s[44:47], s63 offen sc1
    s_add_u32 s63, s68, 35840
    buffer_load_dwordx4 v[96:99], v144, s[44:47], s63 offen sc1
    s_barrier
    ds_read_b128 v[44:47], v145 offset:0
    ds_read_b128 v[48:51], v146 offset:0
    ds_read_b128 v[52:55], v147 offset:0
    ds_read_b128 v[56:59], v147 offset:16
    s_waitcnt lgkmcnt(0)
    s_barrier
    s_waitcnt vmcnt(4)
    v_cvt_pk_bf16_f32 v44, v44, v45
    v_cvt_pk_bf16_f32 v45, v46, v47
    v_cvt_pk_bf16_f32 v46, v48, v49
    ds_read_b128 v[60:63], v145 offset:8192
    v_cvt_pk_bf16_f32 v47, v50, v51
    v_cvt_pk_bf16_f32 v48, v52, v53
    ds_read_b128 v[64:67], v146 offset:8192
    v_cvt_pk_bf16_f32 v49, v54, v55
    v_cvt_pk_bf16_f32 v50, v56, v57
    v_cvt_pk_bf16_f32 v51, v58, v59
    ds_read_b128 v[68:71], v147 offset:128
    v_mfma_f32_16x16x32_bf16 v[100:103], v[44:47], v[76:79], 0
    v_mfma_f32_16x16x32_bf16 v[104:107], v[48:51], v[76:79], 0
    ds_read_b128 v[72:75], v147 offset:144
    v_mfma_f32_16x16x32_bf16 v[108:111], v[44:47], v[80:83], 0
    v_mfma_f32_16x16x32_bf16 v[112:115], v[48:51], v[80:83], 0
    s_add_u32 s63, s68, 3072
    buffer_load_dwordx4 v[76:79], v144, s[44:47], s63 offen sc1
    s_add_u32 s63, s68, 36864
    buffer_load_dwordx4 v[80:83], v144, s[44:47], s63 offen sc1
    s_waitcnt lgkmcnt(0)
    s_barrier
    s_waitcnt vmcnt(4)
    v_add_f32 v104, s67, v104
    v_cvt_pk_bf16_f32 v60, v60, v61
    ds_read_b128 v[44:47], v145 offset:16384
    v_add_f32 v112, s67, v112
    v_cvt_pk_bf16_f32 v61, v62, v63
    ds_read_b128 v[48:51], v146 offset:16384
    v_rcp_f32 v104, v104
    ds_read_b128 v[52:55], v147 offset:256
    v_cvt_pk_bf16_f32 v62, v64, v65
    v_rcp_f32 v112, v112
    ds_read_b128 v[56:59], v147 offset:272
    v_cvt_pk_bf16_f32 v63, v66, v67
    ds_read_b64_tr_b16 v[124:125], v140 offset:0
    v_pk_mul_f32 v[100:101], v[100:101], v[104:105] op_sel_hi:[1,0]
    v_cvt_pk_bf16_f32 v64, v68, v69
    ds_read_b64_tr_b16 v[128:129], v141 offset:0
    v_pk_mul_f32 v[102:103], v[102:103], v[104:105] op_sel_hi:[1,0]
    v_cvt_pk_bf16_f32 v65, v70, v71
    ds_read_b64_tr_b16 v[132:133], v142 offset:0
    v_pk_mul_f32 v[108:109], v[108:109], v[112:113] op_sel_hi:[1,0]
    ds_read_b64_tr_b16 v[136:137], v143 offset:0
    v_cvt_pk_bf16_f32 v66, v72, v73
    v_pk_mul_f32 v[110:111], v[110:111], v[112:113] op_sel_hi:[1,0]
    ds_read_b64_tr_b16 v[126:127], v140 offset:8192
    v_cvt_pk_bf16_f32 v67, v74, v75
    ds_read_b64_tr_b16 v[130:131], v141 offset:8192
    v_cvt_pk_bf16_f32 v116, v100, v101
    v_mfma_f32_16x16x32_bf16 v[148:151], v[60:63], v[84:87], 0
    ds_read_b64_tr_b16 v[134:135], v142 offset:8192
    v_cvt_pk_bf16_f32 v117, v102, v103
    v_mfma_f32_16x16x32_bf16 v[152:155], v[64:67], v[84:87], 0
    ds_read_b64_tr_b16 v[138:139], v143 offset:8192
    v_cvt_pk_bf16_f32 v120, v108, v109
    v_mfma_f32_16x16x32_bf16 v[156:159], v[60:63], v[88:91], 0
    v_cvt_pk_bf16_f32 v121, v110, v111
    v_mfma_f32_16x16x32_bf16 v[160:163], v[64:67], v[88:91], 0
    s_add_u32 s63, s68, 4096
    buffer_load_dwordx4 v[84:87], v144, s[44:47], s63 offen sc1
    s_add_u32 s63, s68, 37888
    buffer_load_dwordx4 v[88:91], v144, s[44:47], s63 offen sc1
    s_waitcnt lgkmcnt(0)
    s_barrier
    s_waitcnt vmcnt(4)
    v_add_f32 v152, s67, v152
    v_cvt_pk_bf16_f32 v44, v44, v45
    v_add_f32 v160, s67, v160
    v_cvt_pk_bf16_f32 v45, v46, v47
    v_rcp_f32 v152, v152
    v_cvt_pk_bf16_f32 v46, v48, v49
    v_rcp_f32 v160, v160
    ds_read_b128 v[60:63], v145 offset:24576
    v_cvt_pk_bf16_f32 v47, v50, v51
    v_pk_mul_f32 v[148:149], v[148:149], v[152:153] op_sel_hi:[1,0]
    v_cvt_pk_bf16_f32 v48, v52, v53
    v_pk_mul_f32 v[150:151], v[150:151], v[152:153] op_sel_hi:[1,0]
    v_cvt_pk_bf16_f32 v49, v54, v55
    v_pk_mul_f32 v[156:157], v[156:157], v[160:161] op_sel_hi:[1,0]
    ds_read_b128 v[64:67], v146 offset:24576
    v_cvt_pk_bf16_f32 v50, v56, v57
    v_pk_mul_f32 v[158:159], v[158:159], v[160:161] op_sel_hi:[1,0]
    v_cvt_pk_bf16_f32 v51, v58, v59
    v_cvt_pk_bf16_f32 v118, v148, v149
    v_mfma_f32_16x16x32_bf16 v[100:103], v[44:47], v[92:95], 0
    v_cvt_pk_bf16_f32 v119, v150, v151
    v_mfma_f32_16x16x32_bf16 v[104:107], v[48:51], v[92:95], 0
    ds_read_b128 v[68:71], v147 offset:384
    v_cvt_pk_bf16_f32 v122, v156, v157
    v_mfma_f32_16x16x32_bf16 v[108:111], v[44:47], v[96:99], 0
    v_cvt_pk_bf16_f32 v123, v158, v159
    v_mfma_f32_16x16x32_bf16 v[112:115], v[48:51], v[96:99], 0
    v_mfma_f32_16x16x32_bf16 v[8:11], v[124:127], v[116:119], 0
    v_mfma_f32_16x16x32_bf16 v[12:15], v[128:131], v[116:119], 0
    ds_read_b128 v[72:75], v147 offset:400
    v_mfma_f32_16x16x32_bf16 v[16:19], v[132:135], v[116:119], 0
    v_mfma_f32_16x16x32_bf16 v[20:23], v[136:139], v[116:119], 0
    v_mfma_f32_16x16x32_bf16 v[24:27], v[124:127], v[120:123], 0
    v_mfma_f32_16x16x32_bf16 v[28:31], v[128:131], v[120:123], 0
    v_mfma_f32_16x16x32_bf16 v[32:35], v[132:135], v[120:123], 0
    v_mfma_f32_16x16x32_bf16 v[36:39], v[136:139], v[120:123], 0
    s_add_u32 s63, s68, 5120
    buffer_load_dwordx4 v[92:95], v144, s[44:47], s63 offen sc1
    s_add_u32 s63, s68, 38912
    buffer_load_dwordx4 v[96:99], v144, s[44:47], s63 offen sc1
    s_waitcnt lgkmcnt(0)
    s_barrier
    s_waitcnt vmcnt(4)
    v_add_f32 v104, s67, v104
    v_cvt_pk_bf16_f32 v60, v60, v61
    ds_read_b128 v[44:47], v145 offset:32768
    v_add_f32 v112, s67, v112
    v_cvt_pk_bf16_f32 v61, v62, v63
    ds_read_b128 v[48:51], v146 offset:32768
    v_rcp_f32 v104, v104
    ds_read_b128 v[52:55], v147 offset:512
    v_cvt_pk_bf16_f32 v62, v64, v65
    v_rcp_f32 v112, v112
    ds_read_b128 v[56:59], v147 offset:528
    v_cvt_pk_bf16_f32 v63, v66, v67
    ds_read_b64_tr_b16 v[124:125], v140 offset:16384
    v_pk_mul_f32 v[100:101], v[100:101], v[104:105] op_sel_hi:[1,0]
    v_cvt_pk_bf16_f32 v64, v68, v69
    ds_read_b64_tr_b16 v[128:129], v141 offset:16384
    v_pk_mul_f32 v[102:103], v[102:103], v[104:105] op_sel_hi:[1,0]
    v_cvt_pk_bf16_f32 v65, v70, v71
    ds_read_b64_tr_b16 v[132:133], v142 offset:16384
    v_pk_mul_f32 v[108:109], v[108:109], v[112:113] op_sel_hi:[1,0]
    ds_read_b64_tr_b16 v[136:137], v143 offset:16384
    v_cvt_pk_bf16_f32 v66, v72, v73
    v_pk_mul_f32 v[110:111], v[110:111], v[112:113] op_sel_hi:[1,0]
    ds_read_b64_tr_b16 v[126:127], v140 offset:24576
    v_cvt_pk_bf16_f32 v67, v74, v75
    ds_read_b64_tr_b16 v[130:131], v141 offset:24576
    v_cvt_pk_bf16_f32 v116, v100, v101
    v_mfma_f32_16x16x32_bf16 v[148:151], v[60:63], v[76:79], 0
    ds_read_b64_tr_b16 v[134:135], v142 offset:24576
    v_cvt_pk_bf16_f32 v117, v102, v103
    v_mfma_f32_16x16x32_bf16 v[152:155], v[64:67], v[76:79], 0
    ds_read_b64_tr_b16 v[138:139], v143 offset:24576
    v_cvt_pk_bf16_f32 v120, v108, v109
    v_mfma_f32_16x16x32_bf16 v[156:159], v[60:63], v[80:83], 0
    v_cvt_pk_bf16_f32 v121, v110, v111
    v_mfma_f32_16x16x32_bf16 v[160:163], v[64:67], v[80:83], 0
    s_add_u32 s63, s68, 6144
    buffer_load_dwordx4 v[76:79], v144, s[44:47], s63 offen sc1
    s_add_u32 s63, s68, 39936
    buffer_load_dwordx4 v[80:83], v144, s[44:47], s63 offen sc1
    s_waitcnt lgkmcnt(0)
    s_barrier
    s_waitcnt vmcnt(4)
    v_add_f32 v152, s67, v152
    v_cvt_pk_bf16_f32 v44, v44, v45
    v_add_f32 v160, s67, v160
    v_cvt_pk_bf16_f32 v45, v46, v47
    v_rcp_f32 v152, v152
    v_cvt_pk_bf16_f32 v46, v48, v49
    v_rcp_f32 v160, v160
    ds_read_b128 v[60:63], v145 offset:0
    v_cvt_pk_bf16_f32 v47, v50, v51
    v_pk_mul_f32 v[148:149], v[148:149], v[152:153] op_sel_hi:[1,0]
    v_cvt_pk_bf16_f32 v48, v52, v53
    v_pk_mul_f32 v[150:151], v[150:151], v[152:153] op_sel_hi:[1,0]
    v_cvt_pk_bf16_f32 v49, v54, v55
    v_pk_mul_f32 v[156:157], v[156:157], v[160:161] op_sel_hi:[1,0]
    ds_read_b128 v[64:67], v146 offset:0
    v_cvt_pk_bf16_f32 v50, v56, v57
    v_pk_mul_f32 v[158:159], v[158:159], v[160:161] op_sel_hi:[1,0]
    v_cvt_pk_bf16_f32 v51, v58, v59
    v_cvt_pk_bf16_f32 v118, v148, v149
    v_mfma_f32_16x16x32_bf16 v[100:103], v[44:47], v[84:87], 0
    v_cvt_pk_bf16_f32 v119, v150, v151
    v_mfma_f32_16x16x32_bf16 v[104:107], v[48:51], v[84:87], 0
    ds_read_b128 v[68:71], v147 offset:640
    v_cvt_pk_bf16_f32 v122, v156, v157
    v_mfma_f32_16x16x32_bf16 v[108:111], v[44:47], v[88:91], 0
    v_cvt_pk_bf16_f32 v123, v158, v159
    v_mfma_f32_16x16x32_bf16 v[112:115], v[48:51], v[88:91], 0
    v_mfma_f32_16x16x32_bf16 v[8:11], v[124:127], v[116:119], v[8:11]
    v_mfma_f32_16x16x32_bf16 v[12:15], v[128:131], v[116:119], v[12:15]
    ds_read_b128 v[72:75], v147 offset:656
    v_mfma_f32_16x16x32_bf16 v[16:19], v[132:135], v[116:119], v[16:19]
    v_mfma_f32_16x16x32_bf16 v[20:23], v[136:139], v[116:119], v[20:23]
    v_mfma_f32_16x16x32_bf16 v[24:27], v[124:127], v[120:123], v[24:27]
    v_mfma_f32_16x16x32_bf16 v[28:31], v[128:131], v[120:123], v[28:31]
    v_mfma_f32_16x16x32_bf16 v[32:35], v[132:135], v[120:123], v[32:35]
    v_mfma_f32_16x16x32_bf16 v[36:39], v[136:139], v[120:123], v[36:39]
    s_add_u32 s63, s68, 7168
    buffer_load_dwordx4 v[84:87], v144, s[44:47], s63 offen sc1
    s_add_u32 s63, s68, 40960
    buffer_load_dwordx4 v[88:91], v144, s[44:47], s63 offen sc1
    s_waitcnt lgkmcnt(0)
    s_barrier
    s_waitcnt vmcnt(4)
    v_add_f32 v104, s67, v104
    v_cvt_pk_bf16_f32 v60, v60, v61
    ds_read_b128 v[44:47], v145 offset:8192
    v_add_f32 v112, s67, v112
    v_cvt_pk_bf16_f32 v61, v62, v63
    ds_read_b128 v[48:51], v146 offset:8192
    v_rcp_f32 v104, v104
    ds_read_b128 v[52:55], v147 offset:768
    v_cvt_pk_bf16_f32 v62, v64, v65
    v_rcp_f32 v112, v112
    ds_read_b128 v[56:59], v147 offset:784
    v_cvt_pk_bf16_f32 v63, v66, v67
    ds_read_b64_tr_b16 v[124:125], v140 offset:32768
    v_pk_mul_f32 v[100:101], v[100:101], v[104:105] op_sel_hi:[1,0]
    v_cvt_pk_bf16_f32 v64, v68, v69
    ds_read_b64_tr_b16 v[128:129], v141 offset:32768
    v_pk_mul_f32 v[102:103], v[102:103], v[104:105] op_sel_hi:[1,0]
    v_cvt_pk_bf16_f32 v65, v70, v71
    ds_read_b64_tr_b16 v[132:133], v142 offset:32768
    v_pk_mul_f32 v[108:109], v[108:109], v[112:113] op_sel_hi:[1,0]
    ds_read_b64_tr_b16 v[136:137], v143 offset:32768
    v_cvt_pk_bf16_f32 v66, v72, v73
    v_pk_mul_f32 v[110:111], v[110:111], v[112:113] op_sel_hi:[1,0]
    ds_read_b64_tr_b16 v[126:127], v140 offset:40960
    v_cvt_pk_bf16_f32 v67, v74, v75
    ds_read_b64_tr_b16 v[130:131], v141 offset:40960
    v_cvt_pk_bf16_f32 v116, v100, v101
    v_mfma_f32_16x16x32_bf16 v[148:151], v[60:63], v[92:95], 0
    ds_read_b64_tr_b16 v[134:135], v142 offset:40960
    v_cvt_pk_bf16_f32 v117, v102, v103
    v_mfma_f32_16x16x32_bf16 v[152:155], v[64:67], v[92:95], 0
    ds_read_b64_tr_b16 v[138:139], v143 offset:40960
    v_cvt_pk_bf16_f32 v120, v108, v109
    v_mfma_f32_16x16x32_bf16 v[156:159], v[60:63], v[96:99], 0
    v_cvt_pk_bf16_f32 v121, v110, v111
    v_mfma_f32_16x16x32_bf16 v[160:163], v[64:67], v[96:99], 0
    s_waitcnt lgkmcnt(0)
    s_barrier
    s_waitcnt vmcnt(2)
    v_add_f32 v152, s67, v152
    v_cvt_pk_bf16_f32 v44, v44, v45
    s_nop 2
    v_add_f32 v160, s67, v160
    v_cvt_pk_bf16_f32 v45, v46, v47
    v_rcp_f32 v152, v152
    v_cvt_pk_bf16_f32 v46, v48, v49
    v_rcp_f32 v160, v160
    ds_read_b128 v[60:63], v145 offset:16384
    v_cvt_pk_bf16_f32 v47, v50, v51
    v_pk_mul_f32 v[148:149], v[148:149], v[152:153] op_sel_hi:[1,0]
    v_cvt_pk_bf16_f32 v48, v52, v53
    v_pk_mul_f32 v[150:151], v[150:151], v[152:153] op_sel_hi:[1,0]
    v_cvt_pk_bf16_f32 v49, v54, v55
    v_pk_mul_f32 v[156:157], v[156:157], v[160:161] op_sel_hi:[1,0]
    ds_read_b128 v[64:67], v146 offset:16384
    v_cvt_pk_bf16_f32 v50, v56, v57
    v_pk_mul_f32 v[158:159], v[158:159], v[160:161] op_sel_hi:[1,0]
    v_cvt_pk_bf16_f32 v51, v58, v59
    v_cvt_pk_bf16_f32 v118, v148, v149
    v_mfma_f32_16x16x32_bf16 v[100:103], v[44:47], v[76:79], 0
    v_cvt_pk_bf16_f32 v119, v150, v151
    v_mfma_f32_16x16x32_bf16 v[104:107], v[48:51], v[76:79], 0
    ds_read_b128 v[68:71], v147 offset:896
    v_cvt_pk_bf16_f32 v122, v156, v157
    v_mfma_f32_16x16x32_bf16 v[108:111], v[44:47], v[80:83], 0
    v_cvt_pk_bf16_f32 v123, v158, v159
    v_mfma_f32_16x16x32_bf16 v[112:115], v[48:51], v[80:83], 0
    v_mfma_f32_16x16x32_bf16 v[8:11], v[124:127], v[116:119], v[8:11]
    v_mfma_f32_16x16x32_bf16 v[12:15], v[128:131], v[116:119], v[12:15]
    ds_read_b128 v[72:75], v147 offset:912
    v_mfma_f32_16x16x32_bf16 v[16:19], v[132:135], v[116:119], v[16:19]
    v_mfma_f32_16x16x32_bf16 v[20:23], v[136:139], v[116:119], v[20:23]
    v_mfma_f32_16x16x32_bf16 v[24:27], v[124:127], v[120:123], v[24:27]
    v_mfma_f32_16x16x32_bf16 v[28:31], v[128:131], v[120:123], v[28:31]
    v_mfma_f32_16x16x32_bf16 v[32:35], v[132:135], v[120:123], v[32:35]
    v_mfma_f32_16x16x32_bf16 v[36:39], v[136:139], v[120:123], v[36:39]
    s_waitcnt lgkmcnt(0)
    s_waitcnt vmcnt(0)
    v_add_f32 v104, s67, v104
    v_cvt_pk_bf16_f32 v60, v60, v61
    v_add_f32 v112, s67, v112
    ds_read_b64_tr_b16 v[124:125], v140 offset:49152
    v_cvt_pk_bf16_f32 v61, v62, v63
    v_rcp_f32 v104, v104
    ds_read_b64_tr_b16 v[128:129], v141 offset:49152
    v_cvt_pk_bf16_f32 v62, v64, v65
    v_rcp_f32 v112, v112
    v_cvt_pk_bf16_f32 v63, v66, v67
    ds_read_b64_tr_b16 v[132:133], v142 offset:49152
    v_pk_mul_f32 v[100:101], v[100:101], v[104:105] op_sel_hi:[1,0]
    v_cvt_pk_bf16_f32 v64, v68, v69
    ds_read_b64_tr_b16 v[136:137], v143 offset:49152
    v_pk_mul_f32 v[102:103], v[102:103], v[104:105] op_sel_hi:[1,0]
    v_cvt_pk_bf16_f32 v65, v70, v71
    ds_read_b64_tr_b16 v[126:127], v140 offset:57344
    v_pk_mul_f32 v[108:109], v[108:109], v[112:113] op_sel_hi:[1,0]
    v_cvt_pk_bf16_f32 v66, v72, v73
    v_pk_mul_f32 v[110:111], v[110:111], v[112:113] op_sel_hi:[1,0]
    ds_read_b64_tr_b16 v[130:131], v141 offset:57344
    v_cvt_pk_bf16_f32 v67, v74, v75
    v_cvt_pk_bf16_f32 v116, v100, v101
    ds_read_b64_tr_b16 v[134:135], v142 offset:57344
    v_mfma_f32_16x16x32_bf16 v[148:151], v[60:63], v[84:87], 0
    v_cvt_pk_bf16_f32 v117, v102, v103
    v_mfma_f32_16x16x32_bf16 v[152:155], v[64:67], v[84:87], 0
    ds_read_b64_tr_b16 v[138:139], v143 offset:57344
    v_cvt_pk_bf16_f32 v120, v108, v109
    v_mfma_f32_16x16x32_bf16 v[156:159], v[60:63], v[88:91], 0
    v_cvt_pk_bf16_f32 v121, v110, v111
    v_mfma_f32_16x16x32_bf16 v[160:163], v[64:67], v[88:91], 0
    s_waitcnt lgkmcnt(0)
    s_nop 1
    v_add_f32 v152, s67, v152
    s_nop 3
    v_add_f32 v160, s67, v160
    v_rcp_f32 v152, v152
    v_rcp_f32 v160, v160
    v_pk_mul_f32 v[148:149], v[148:149], v[152:153] op_sel_hi:[1,0]
    v_pk_mul_f32 v[150:151], v[150:151], v[152:153] op_sel_hi:[1,0]
    v_pk_mul_f32 v[156:157], v[156:157], v[160:161] op_sel_hi:[1,0]
    v_pk_mul_f32 v[158:159], v[158:159], v[160:161] op_sel_hi:[1,0]
    v_cvt_pk_bf16_f32 v118, v148, v149
    v_cvt_pk_bf16_f32 v119, v150, v151
    v_cvt_pk_bf16_f32 v122, v156, v157
    v_cvt_pk_bf16_f32 v123, v158, v159
    v_mfma_f32_16x16x32_bf16 v[8:11], v[124:127], v[116:119], v[8:11]
    v_mfma_f32_16x16x32_bf16 v[12:15], v[128:131], v[116:119], v[12:15]
    v_mfma_f32_16x16x32_bf16 v[16:19], v[132:135], v[116:119], v[16:19]
    v_mfma_f32_16x16x32_bf16 v[20:23], v[136:139], v[116:119], v[20:23]
    v_mfma_f32_16x16x32_bf16 v[24:27], v[124:127], v[120:123], v[24:27]
    v_mfma_f32_16x16x32_bf16 v[28:31], v[128:131], v[120:123], v[28:31]
    v_mfma_f32_16x16x32_bf16 v[32:35], v[132:135], v[120:123], v[32:35]
    v_mfma_f32_16x16x32_bf16 v[36:39], v[136:139], v[120:123], v[36:39]
    s_waitcnt lgkmcnt(0)
    s_barrier
    s_lshl_b32 s62, s7, 1
    s_add_u32 s62, s62, s8
    s_mul_i32 s62, s62, 8704
    s_add_u32 s62, s62, 65536
    v_mul_u32_u24 v124, 272, v3
    v_lshl_add_u32 v124, v2, 4, v124
    v_add_u32 v124, s62, v124
    ds_write_b128 v124, v[8:11] offset:0
    ds_write_b128 v124, v[12:15] offset:64
    ds_write_b128 v124, v[16:19] offset:128
    ds_write_b128 v124, v[20:23] offset:192
    ds_write_b128 v124, v[24:27] offset:4352
    ds_write_b128 v124, v[28:31] offset:4416
    ds_write_b128 v124, v[32:35] offset:4480
    ds_write_b128 v124, v[36:39] offset:4544
    s_mul_i32 s62, s8, 8704
    s_add_u32 s62, s62, 65536
    v_lshrrev_b32 v125, 3, v1
    s_lshl_b32 s63, s7, 3
    v_add_u32 v125, s63, v125
    v_mul_u32_u24 v125, 272, v125
    v_and_b32 v124, 7, v1
    v_lshl_add_u32 v125, v124, 5, v125
    v_add_u32 v125, s62, v125
    s_waitcnt lgkmcnt(0)
    s_barrier
    ds_read_b128 v[44:47], v125 offset:0
    ds_read_b128 v[48:51], v125 offset:16
    ds_read_b128 v[52:55], v125 offset:17408
    ds_read_b128 v[56:59], v125 offset:17424
    ds_read_b128 v[60:63], v125 offset:34816
    ds_read_b128 v[64:67], v125 offset:34832
    ds_read_b128 v[68:71], v125 offset:52224
    ds_read_b128 v[72:75], v125 offset:52240
    s_waitcnt lgkmcnt(4)
    v_pk_add_f32 v[44:45], v[44:45], v[52:53]
    v_pk_add_f32 v[46:47], v[46:47], v[54:55]
    v_pk_add_f32 v[48:49], v[48:49], v[56:57]
    v_pk_add_f32 v[50:51], v[50:51], v[58:59]
    s_waitcnt lgkmcnt(0)
    v_pk_add_f32 v[60:61], v[60:61], v[68:69]
    v_pk_add_f32 v[62:63], v[62:63], v[70:71]
    v_pk_add_f32 v[64:65], v[64:65], v[72:73]
    v_pk_add_f32 v[66:67], v[66:67], v[74:75]
    v_pk_add_f32 v[44:45], v[44:45], v[60:61]
    v_pk_add_f32 v[46:47], v[46:47], v[62:63]
    v_pk_add_f32 v[48:49], v[48:49], v[64:65]
    v_pk_add_f32 v[50:51], v[50:51], v[66:67]
    s_waitcnt vmcnt(0)
    v_cvt_pk_bf16_f32 v60, v44, v45
    v_cvt_pk_bf16_f32 v61, v46, v47
    v_cvt_pk_bf16_f32 v62, v48, v49
    v_cvt_pk_bf16_f32 v63, v50, v51
    v_lshlrev_b32 v44, 16, v60
    v_and_b32 v45, 0xffff0000, v60
    v_lshlrev_b32 v52, 16, v40
    v_and_b32 v53, 0xffff0000, v40
    v_lshlrev_b32 v46, 16, v61
    v_and_b32 v47, 0xffff0000, v61
    v_lshlrev_b32 v54, 16, v41
    v_and_b32 v55, 0xffff0000, v41
    v_lshlrev_b32 v48, 16, v62
    v_and_b32 v49, 0xffff0000, v62
    v_lshlrev_b32 v56, 16, v42
    v_and_b32 v57, 0xffff0000, v42
    v_lshlrev_b32 v50, 16, v63
    v_and_b32 v51, 0xffff0000, v63
    v_lshlrev_b32 v58, 16, v43
    v_and_b32 v59, 0xffff0000, v43
    v_pk_add_f32 v[44:45], v[44:45], v[52:53]
    v_pk_add_f32 v[46:47], v[46:47], v[54:55]
    v_pk_add_f32 v[48:49], v[48:49], v[56:57]
    v_pk_add_f32 v[50:51], v[50:51], v[58:59]
    v_cvt_pk_bf16_f32 v60, v44, v45
    v_cvt_pk_bf16_f32 v61, v46, v47
    v_cvt_pk_bf16_f32 v62, v48, v49
    v_cvt_pk_bf16_f32 v63, v50, v51
    buffer_store_dwordx4 v[60:63], v7, s[56:59], s65 offen sc1
    s_mov_b32 s62, 0x3f803f80
    v_mov_b32 v68, 0
    v_mov_b32 v69, 0
    v_dot2c_f32_bf16 v68, s62, v60
    v_dot2c_f32_bf16 v69, v60, v60
    v_dot2c_f32_bf16 v68, s62, v61
    v_dot2c_f32_bf16 v69, v61, v61
    v_dot2c_f32_bf16 v68, s62, v62
    v_dot2c_f32_bf16 v69, v62, v62
    v_dot2c_f32_bf16 v68, s62, v63
    v_dot2c_f32_bf16 v69, v63, v63
    s_nop 1
    v_add_f32_dpp v68, v68, v68 quad_perm:[1,0,3,2] row_mask:0xf bank_mask:0xf
    v_add_f32_dpp v69, v69, v69 quad_perm:[1,0,3,2] row_mask:0xf bank_mask:0xf
    s_nop 0
    v_add_f32_dpp v68, v68, v68 quad_perm:[2,3,0,1] row_mask:0xf bank_mask:0xf
    v_add_f32_dpp v69, v69, v69 quad_perm:[2,3,0,1] row_mask:0xf bank_mask:0xf
    s_nop 0
    v_add_f32_dpp v68, v68, v68 row_half_mirror row_mask:0xf bank_mask:0xf
    v_add_f32_dpp v69, v69, v69 row_half_mirror row_mask:0xf bank_mask:0xf
    s_add_u32 s40, s38, 0x14e0000
    s_addc_u32 s41, s39, 0
    s_mov_b32 s42, 0x20000
    s_mov_b32 s43, 0x00020000
    v_lshrrev_b32 v124, 3, v1
    v_lshlrev_b32 v124, 6, v124
    s_lshl_b32 s62, s60, 3
    s_add_u32 s62, s62, s4
    s_lshl_b32 s62, s62, 6
    s_add_u32 s62, s62, s61
    s_lshl_b32 s62, s62, 3
    s_mov_b32 exec_lo, 0x01010101
    s_mov_b32 exec_hi, 0x01010101
    buffer_store_dwordx2 v[68:69], v124, s[40:43], s62 offen sc1
    s_mov_b64 exec, -1
    v_mov_b32 v4, 163808
    v_mov_b32 v5, 1
    s_add_u32 s72, s38, 0x1580000
    s_addc_u32 s73, s39, 0
    s_mov_b32 s74, 0x3000
    s_mov_b32 s75, 0x00020000
    s_waitcnt vmcnt(0) lgkmcnt(0)
    s_mov_b64 exec, 1
    ds_add_rtn_u32 v5, v4, v5
    s_waitcnt lgkmcnt(0)
    s_mov_b64 exec, -1
    v_readfirstlane_b32 s70, v5
    s_nop 3
    s_and_b32 s70, s70, 7
    s_cmp_lg_u32 s70, 7
    s_cbranch_scc1 Lsg_146
    s_lshl_b32 s70, s5, 6
    s_add_u32 s70, s70, s6
    s_lshl_b32 s70, s70, 2
    v_mov_b32 v4, 7
    v_mov_b32 v5, 0
    s_mov_b64 exec, 1
    buffer_store_dword v4, v5, s[72:75], s70 offen sc1
    s_mov_b64 exec, -1
    s_nop 1
Lsg_146:
    s_nop 7
    s_nop 7
    s_barrier
    s_lshl_b32 s63, s5, 2
    s_add_u32 s63, s63, s7
    s_mul_i32 s64, s63, 116736
    s_lshl_b32 s63, s63, 11
    s_add_u32 s48, s38, 0x14e0000
    s_addc_u32 s49, s39, 0
    s_mov_b32 s50, 0x20000
    s_mov_b32 s51, 0x00020000
    s_mov_b32 s52, s28
    s_mov_b32 s53, s29
    s_mov_b32 s54, 0xe00
    s_mov_b32 s55, 0x00020000
    s_add_u32 s56, s38, 0x2500000
    s_addc_u32 s57, s39, 0
    s_mov_b32 s58, 0x720000
    s_mov_b32 s59, 0x00020000
    s_mul_i32 s62, s6, 112
    s_lshl_b32 s60, s8, 6
    s_add_u32 s62, s62, s60
    s_lshl_b32 s60, s62, 1
    v_lshlrev_b32 v5, 3, v2
    buffer_load_dwordx2 v[56:57], v5, s[52:55], s60 offen offset:0
    buffer_load_dwordx2 v[58:59], v5, s[52:55], s60 offen offset:32
    buffer_load_dwordx2 v[60:61], v5, s[52:55], s60 offen offset:64
    buffer_load_dwordx2 v[62:63], v5, s[52:55], s60 offen offset:96
    s_lshr_b32 s60, s6, 1
    s_mul_i32 s60, s60, 7168
    s_add_u32 s64, s64, s60
    s_and_b32 s60, s6, 1
    s_lshl_b32 s65, s60, 3
    s_add_u32 s65, s65, s64
    s_add_u32 s65, s65, 6144
    s_mul_i32 s60, s60, 3072
    s_add_u32 s64, s64, s60
    s_lshl_b32 s60, s8, 11
    s_add_u32 s64, s64, s60
    v_lshlrev_b32 v144, 4, v1
    v_mov_b32 v146, 0xbdd2d3e8
    v_mov_b32 v148, 0xc0135761
    v_mov_b32 v150, 1.0
    s_cmp_lg_u32 s8, 0
    s_cbranch_scc1 Lnh1_147
    s_lshl_b32 s79, s7, 12
    v_lshlrev_b32 v152, 4, v1
    v_add_u32 v154, s79, v152
    v_add_u32 v155, 0x10000, v154
    v_add_u32 v156, 0x20000, v154
    v_lshlrev_b32 v152, 4, v1
    v_add_u32 v157, 0, v152
    v_add_u32 v158, 0x10000, v157
    s_lshl_b32 s79, s4, 8
    s_add_u32 s79, s79, 0
    v_lshlrev_b32 v159, 4, v2
    v_add_u32 v159, s79, v159
    s_barrier
    ds_read_b128 v[64:67], v155 offset:20480
    ds_read_b128 v[68:71], v155 offset:22528
    ds_read_b128 v[72:75], v157 offset:0
    ds_read_b128 v[76:79], v157 offset:1024
    ds_read_b128 v[80:83], v157 offset:2048
    ds_read_b128 v[84:87], v157 offset:3072
    ds_read_b128 v[88:91], v155 offset:21504
    ds_read_b128 v[92:95], v155 offset:23552
    ds_read_b128 v[96:99], v157 offset:7168
    ds_read_b128 v[100:103], v157 offset:8192
    ds_read_b128 v[104:107], v157 offset:9216
    ds_read_b128 v[108:111], v157 offset:10240
    s_waitcnt lgkmcnt(6)
    s_waitcnt lgkmcnt(0)
    s_barrier
    v_mfma_f32_16x16x32_bf16 v[8:11], v[72:75], v[64:67], 0
    v_mfma_f32_16x16x32_bf16 v[24:27], v[72:75], v[68:71], 0
    ds_read_b128 v[112:115], v155 offset:36864
    v_mfma_f32_16x16x32_bf16 v[12:15], v[76:79], v[64:67], 0
    ds_read_b128 v[116:119], v155 offset:38912
    v_mfma_f32_16x16x32_bf16 v[28:31], v[76:79], v[68:71], 0
    ds_read_b128 v[120:123], v157 offset:14336
    v_mfma_f32_16x16x32_bf16 v[16:19], v[80:83], v[64:67], 0
    ds_read_b128 v[124:127], v157 offset:15360
    v_mfma_f32_16x16x32_bf16 v[32:35], v[80:83], v[68:71], 0
    ds_read_b128 v[128:131], v157 offset:16384
    v_mfma_f32_16x16x32_bf16 v[20:23], v[84:87], v[64:67], 0
    ds_read_b128 v[132:135], v157 offset:17408
    v_mfma_f32_16x16x32_bf16 v[36:39], v[84:87], v[68:71], 0
    v_mfma_f32_16x16x32_bf16 v[8:11], v[96:99], v[88:91], v[8:11]
    v_mfma_f32_16x16x32_bf16 v[24:27], v[96:99], v[92:95], v[24:27]
    ds_read_b128 v[64:67], v155 offset:37888
    v_mfma_f32_16x16x32_bf16 v[12:15], v[100:103], v[88:91], v[12:15]
    ds_read_b128 v[68:71], v155 offset:39936
    v_mfma_f32_16x16x32_bf16 v[28:31], v[100:103], v[92:95], v[28:31]
    ds_read_b128 v[72:75], v157 offset:21504
    v_mfma_f32_16x16x32_bf16 v[16:19], v[104:107], v[88:91], v[16:19]
    ds_read_b128 v[76:79], v157 offset:22528
    v_mfma_f32_16x16x32_bf16 v[32:35], v[104:107], v[92:95], v[32:35]
    ds_read_b128 v[80:83], v157 offset:23552
    v_mfma_f32_16x16x32_bf16 v[20:23], v[108:111], v[88:91], v[20:23]
    ds_read_b128 v[84:87], v157 offset:24576
    v_mfma_f32_16x16x32_bf16 v[36:39], v[108:111], v[92:95], v[36:39]
    s_waitcnt lgkmcnt(6)
    s_waitcnt lgkmcnt(0)
    s_barrier
    v_mfma_f32_16x16x32_bf16 v[8:11], v[120:123], v[112:115], v[8:11]
    v_mfma_f32_16x16x32_bf16 v[24:27], v[120:123], v[116:119], v[24:27]
    ds_read_b128 v[88:91], v155 offset:53248
    v_mfma_f32_16x16x32_bf16 v[12:15], v[124:127], v[112:115], v[12:15]
    ds_read_b128 v[92:95], v155 offset:55296
    v_mfma_f32_16x16x32_bf16 v[28:31], v[124:127], v[116:119], v[28:31]
    ds_read_b128 v[96:99], v157 offset:28672
    v_mfma_f32_16x16x32_bf16 v[16:19], v[128:131], v[112:115], v[16:19]
    ds_read_b128 v[100:103], v157 offset:29696
    v_mfma_f32_16x16x32_bf16 v[32:35], v[128:131], v[116:119], v[32:35]
    ds_read_b128 v[104:107], v157 offset:30720
    v_mfma_f32_16x16x32_bf16 v[20:23], v[132:135], v[112:115], v[20:23]
    ds_read_b128 v[108:111], v157 offset:31744
    v_mfma_f32_16x16x32_bf16 v[36:39], v[132:135], v[116:119], v[36:39]
    v_mfma_f32_16x16x32_bf16 v[8:11], v[72:75], v[64:67], v[8:11]
    v_mfma_f32_16x16x32_bf16 v[24:27], v[72:75], v[68:71], v[24:27]
    ds_read_b128 v[112:115], v155 offset:54272
    v_mfma_f32_16x16x32_bf16 v[12:15], v[76:79], v[64:67], v[12:15]
    ds_read_b128 v[116:119], v155 offset:56320
    v_mfma_f32_16x16x32_bf16 v[28:31], v[76:79], v[68:71], v[28:31]
    ds_read_b128 v[120:123], v157 offset:35840
    v_mfma_f32_16x16x32_bf16 v[16:19], v[80:83], v[64:67], v[16:19]
    ds_read_b128 v[124:127], v157 offset:36864
    v_mfma_f32_16x16x32_bf16 v[32:35], v[80:83], v[68:71], v[32:35]
    ds_read_b128 v[128:131], v157 offset:37888
    v_mfma_f32_16x16x32_bf16 v[20:23], v[84:87], v[64:67], v[20:23]
    ds_read_b128 v[132:135], v157 offset:38912
    v_mfma_f32_16x16x32_bf16 v[36:39], v[84:87], v[68:71], v[36:39]
    s_waitcnt lgkmcnt(6)
    s_waitcnt lgkmcnt(0)
    s_barrier
    v_mfma_f32_16x16x32_bf16 v[8:11], v[96:99], v[88:91], v[8:11]
    v_mfma_f32_16x16x32_bf16 v[24:27], v[96:99], v[92:95], v[24:27]
    ds_read_b128 v[64:67], v156 offset:4096
    v_mfma_f32_16x16x32_bf16 v[12:15], v[100:103], v[88:91], v[12:15]
    ds_read_b128 v[68:71], v156 offset:6144
    v_mfma_f32_16x16x32_bf16 v[28:31], v[100:103], v[92:95], v[28:31]
    ds_read_b128 v[72:75], v157 offset:43008
    v_mfma_f32_16x16x32_bf16 v[16:19], v[104:107], v[88:91], v[16:19]
    ds_read_b128 v[76:79], v157 offset:44032
    v_mfma_f32_16x16x32_bf16 v[32:35], v[104:107], v[92:95], v[32:35]
    ds_read_b128 v[80:83], v157 offset:45056
    v_mfma_f32_16x16x32_bf16 v[20:23], v[108:111], v[88:91], v[20:23]
    ds_read_b128 v[84:87], v157 offset:46080
    v_mfma_f32_16x16x32_bf16 v[36:39], v[108:111], v[92:95], v[36:39]
    v_mfma_f32_16x16x32_bf16 v[8:11], v[120:123], v[112:115], v[8:11]
    v_mfma_f32_16x16x32_bf16 v[24:27], v[120:123], v[116:119], v[24:27]
    ds_read_b128 v[88:91], v156 offset:5120
    v_mfma_f32_16x16x32_bf16 v[12:15], v[124:127], v[112:115], v[12:15]
    ds_read_b128 v[92:95], v156 offset:7168
    v_mfma_f32_16x16x32_bf16 v[28:31], v[124:127], v[116:119], v[28:31]
    ds_read_b128 v[96:99], v157 offset:50176
    v_mfma_f32_16x16x32_bf16 v[16:19], v[128:131], v[112:115], v[16:19]
    ds_read_b128 v[100:103], v157 offset:51200
    v_mfma_f32_16x16x32_bf16 v[32:35], v[128:131], v[116:119], v[32:35]
    ds_read_b128 v[104:107], v157 offset:52224
    v_mfma_f32_16x16x32_bf16 v[20:23], v[132:135], v[112:115], v[20:23]
    ds_read_b128 v[108:111], v157 offset:53248
    v_mfma_f32_16x16x32_bf16 v[36:39], v[132:135], v[116:119], v[36:39]
    s_waitcnt lgkmcnt(6)
    s_waitcnt lgkmcnt(0)
    s_barrier
    v_mfma_f32_16x16x32_bf16 v[8:11], v[72:75], v[64:67], v[8:11]
    v_mfma_f32_16x16x32_bf16 v[24:27], v[72:75], v[68:71], v[24:27]
    ds_read_b128 v[112:115], v155 offset:20480
    v_mfma_f32_16x16x32_bf16 v[12:15], v[76:79], v[64:67], v[12:15]
    ds_read_b128 v[116:119], v155 offset:22528
    v_mfma_f32_16x16x32_bf16 v[28:31], v[76:79], v[68:71], v[28:31]
    ds_read_b128 v[120:123], v157 offset:57344
    v_mfma_f32_16x16x32_bf16 v[16:19], v[80:83], v[64:67], v[16:19]
    ds_read_b128 v[124:127], v157 offset:58368
    v_mfma_f32_16x16x32_bf16 v[32:35], v[80:83], v[68:71], v[32:35]
    ds_read_b128 v[128:131], v157 offset:59392
    v_mfma_f32_16x16x32_bf16 v[20:23], v[84:87], v[64:67], v[20:23]
    ds_read_b128 v[132:135], v157 offset:60416
    v_mfma_f32_16x16x32_bf16 v[36:39], v[84:87], v[68:71], v[36:39]
    v_mfma_f32_16x16x32_bf16 v[8:11], v[96:99], v[88:91], v[8:11]
    v_mfma_f32_16x16x32_bf16 v[24:27], v[96:99], v[92:95], v[24:27]
    ds_read_b128 v[64:67], v155 offset:21504
    v_mfma_f32_16x16x32_bf16 v[12:15], v[100:103], v[88:91], v[12:15]
    ds_read_b128 v[68:71], v155 offset:23552
    v_mfma_f32_16x16x32_bf16 v[28:31], v[100:103], v[92:95], v[28:31]
    ds_read_b128 v[72:75], v157 offset:64512
    v_mfma_f32_16x16x32_bf16 v[16:19], v[104:107], v[88:91], v[16:19]
    ds_read_b128 v[76:79], v158 offset:0
    v_mfma_f32_16x16x32_bf16 v[32:35], v[104:107], v[92:95], v[32:35]
    ds_read_b128 v[80:83], v158 offset:1024
    v_mfma_f32_16x16x32_bf16 v[20:23], v[108:111], v[88:91], v[20:23]
    ds_read_b128 v[84:87], v158 offset:2048
    v_mfma_f32_16x16x32_bf16 v[36:39], v[108:111], v[92:95], v[36:39]
    s_waitcnt lgkmcnt(6)
    s_waitcnt lgkmcnt(0)
    s_barrier
    v_mfma_f32_16x16x32_bf16 v[8:11], v[120:123], v[112:115], v[8:11]
    v_mfma_f32_16x16x32_bf16 v[24:27], v[120:123], v[116:119], v[24:27]
    ds_read_b128 v[88:91], v155 offset:36864
    v_mfma_f32_16x16x32_bf16 v[12:15], v[124:127], v[112:115], v[12:15]
    ds_read_b128 v[92:95], v155 offset:38912
    v_mfma_f32_16x16x32_bf16 v[28:31], v[124:127], v[116:119], v[28:31]
    ds_read_b128 v[96:99], v158 offset:6144
    v_mfma_f32_16x16x32_bf16 v[16:19], v[128:131], v[112:115], v[16:19]
    ds_read_b128 v[100:103], v158 offset:7168
    v_mfma_f32_16x16x32_bf16 v[32:35], v[128:131], v[116:119], v[32:35]
    ds_read_b128 v[104:107], v158 offset:8192
    v_mfma_f32_16x16x32_bf16 v[20:23], v[132:135], v[112:115], v[20:23]
    ds_read_b128 v[108:111], v158 offset:9216
    v_mfma_f32_16x16x32_bf16 v[36:39], v[132:135], v[116:119], v[36:39]
    v_mfma_f32_16x16x32_bf16 v[8:11], v[72:75], v[64:67], v[8:11]
    v_mfma_f32_16x16x32_bf16 v[24:27], v[72:75], v[68:71], v[24:27]
    ds_read_b128 v[112:115], v155 offset:37888
    v_mfma_f32_16x16x32_bf16 v[12:15], v[76:79], v[64:67], v[12:15]
    ds_read_b128 v[116:119], v155 offset:39936
    v_mfma_f32_16x16x32_bf16 v[28:31], v[76:79], v[68:71], v[28:31]
    ds_read_b128 v[120:123], v158 offset:13312
    v_mfma_f32_16x16x32_bf16 v[16:19], v[80:83], v[64:67], v[16:19]
    ds_read_b128 v[124:127], v158 offset:14336
    v_mfma_f32_16x16x32_bf16 v[32:35], v[80:83], v[68:71], v[32:35]
    ds_read_b128 v[128:131], v158 offset:15360
    v_mfma_f32_16x16x32_bf16 v[20:23], v[84:87], v[64:67], v[20:23]
    ds_read_b128 v[132:135], v158 offset:16384
    v_mfma_f32_16x16x32_bf16 v[36:39], v[84:87], v[68:71], v[36:39]
    s_waitcnt lgkmcnt(6)
    s_waitcnt lgkmcnt(0)
    s_barrier
    v_mfma_f32_16x16x32_bf16 v[8:11], v[96:99], v[88:91], v[8:11]
    v_mfma_f32_16x16x32_bf16 v[24:27], v[96:99], v[92:95], v[24:27]
    ds_read_b128 v[64:67], v155 offset:53248
    v_mfma_f32_16x16x32_bf16 v[12:15], v[100:103], v[88:91], v[12:15]
    ds_read_b128 v[68:71], v155 offset:55296
    v_mfma_f32_16x16x32_bf16 v[28:31], v[100:103], v[92:95], v[28:31]
    ds_read_b128 v[72:75], v157 offset:0
    v_mfma_f32_16x16x32_bf16 v[16:19], v[104:107], v[88:91], v[16:19]
    ds_read_b128 v[76:79], v157 offset:1024
    v_mfma_f32_16x16x32_bf16 v[32:35], v[104:107], v[92:95], v[32:35]
    ds_read_b128 v[80:83], v157 offset:2048
    v_mfma_f32_16x16x32_bf16 v[20:23], v[108:111], v[88:91], v[20:23]
    ds_read_b128 v[84:87], v157 offset:3072
    v_mfma_f32_16x16x32_bf16 v[36:39], v[108:111], v[92:95], v[36:39]
    v_mfma_f32_16x16x32_bf16 v[8:11], v[120:123], v[112:115], v[8:11]
    v_mfma_f32_16x16x32_bf16 v[24:27], v[120:123], v[116:119], v[24:27]
    ds_read_b128 v[88:91], v155 offset:54272
    v_mfma_f32_16x16x32_bf16 v[12:15], v[124:127], v[112:115], v[12:15]
    ds_read_b128 v[92:95], v155 offset:56320
    v_mfma_f32_16x16x32_bf16 v[28:31], v[124:127], v[116:119], v[28:31]
    ds_read_b128 v[96:99], v157 offset:7168
    v_mfma_f32_16x16x32_bf16 v[16:19], v[128:131], v[112:115], v[16:19]
    ds_read_b128 v[100:103], v157 offset:8192
    v_mfma_f32_16x16x32_bf16 v[32:35], v[128:131], v[116:119], v[32:35]
    ds_read_b128 v[104:107], v157 offset:9216
    v_mfma_f32_16x16x32_bf16 v[20:23], v[132:135], v[112:115], v[20:23]
    ds_read_b128 v[108:111], v157 offset:10240
    v_mfma_f32_16x16x32_bf16 v[36:39], v[132:135], v[116:119], v[36:39]
    s_waitcnt lgkmcnt(6)
    s_waitcnt lgkmcnt(0)
    s_barrier
    v_mfma_f32_16x16x32_bf16 v[8:11], v[72:75], v[64:67], v[8:11]
    v_mfma_f32_16x16x32_bf16 v[24:27], v[72:75], v[68:71], v[24:27]
    ds_read_b128 v[112:115], v156 offset:4096
    v_mfma_f32_16x16x32_bf16 v[12:15], v[76:79], v[64:67], v[12:15]
    ds_read_b128 v[116:119], v156 offset:6144
    v_mfma_f32_16x16x32_bf16 v[28:31], v[76:79], v[68:71], v[28:31]
    ds_read_b128 v[120:123], v157 offset:14336
    v_mfma_f32_16x16x32_bf16 v[16:19], v[80:83], v[64:67], v[16:19]
    ds_read_b128 v[124:127], v157 offset:15360
    v_mfma_f32_16x16x32_bf16 v[32:35], v[80:83], v[68:71], v[32:35]
    ds_read_b128 v[128:131], v157 offset:16384
    v_mfma_f32_16x16x32_bf16 v[20:23], v[84:87], v[64:67], v[20:23]
    ds_read_b128 v[132:135], v157 offset:17408
    v_mfma_f32_16x16x32_bf16 v[36:39], v[84:87], v[68:71], v[36:39]
    v_mfma_f32_16x16x32_bf16 v[8:11], v[96:99], v[88:91], v[8:11]
    v_mfma_f32_16x16x32_bf16 v[24:27], v[96:99], v[92:95], v[24:27]
    ds_read_b128 v[64:67], v156 offset:5120
    v_mfma_f32_16x16x32_bf16 v[12:15], v[100:103], v[88:91], v[12:15]
    ds_read_b128 v[68:71], v156 offset:7168
    v_mfma_f32_16x16x32_bf16 v[28:31], v[100:103], v[92:95], v[28:31]
    ds_read_b128 v[72:75], v157 offset:21504
    v_mfma_f32_16x16x32_bf16 v[16:19], v[104:107], v[88:91], v[16:19]
    ds_read_b128 v[76:79], v157 offset:22528
    v_mfma_f32_16x16x32_bf16 v[32:35], v[104:107], v[92:95], v[32:35]
    ds_read_b128 v[80:83], v157 offset:23552
    v_mfma_f32_16x16x32_bf16 v[20:23], v[108:111], v[88:91], v[20:23]
    ds_read_b128 v[84:87], v157 offset:24576
    v_mfma_f32_16x16x32_bf16 v[36:39], v[108:111], v[92:95], v[36:39]
    s_lshl_b32 s60, s7, 8
    s_add_u32 s60, s60, 161792
    v_lshlrev_b32 v4, 3, v3
    v_add_u32 v4, s60, v4
    ds_read_b64 v[136:137], v4 offset:0
    ds_read_b64 v[138:139], v4 offset:128
    s_lshl_b32 s60, s8, 8
    s_add_u32 s60, s60, 163200
    v_lshlrev_b32 v4, 4, v2
    v_add_u32 v4, s60, v4
    ds_read_b128 v[40:43], v4 offset:0
    ds_read_b128 v[44:47], v4 offset:64
    ds_read_b128 v[48:51], v4 offset:128
    ds_read_b128 v[52:55], v4 offset:192
    s_waitcnt lgkmcnt(12)
    v_mfma_f32_16x16x32_bf16 v[8:11], v[120:123], v[112:115], v[8:11]
    v_mfma_f32_16x16x32_bf16 v[24:27], v[120:123], v[116:119], v[24:27]
    v_mfma_f32_16x16x32_bf16 v[12:15], v[124:127], v[112:115], v[12:15]
    v_mfma_f32_16x16x32_bf16 v[28:31], v[124:127], v[116:119], v[28:31]
    v_mfma_f32_16x16x32_bf16 v[16:19], v[128:131], v[112:115], v[16:19]
    v_mfma_f32_16x16x32_bf16 v[32:35], v[128:131], v[116:119], v[32:35]
    v_mfma_f32_16x16x32_bf16 v[20:23], v[132:135], v[112:115], v[20:23]
    v_mfma_f32_16x16x32_bf16 v[36:39], v[132:135], v[116:119], v[36:39]
    s_waitcnt lgkmcnt(6)
    v_mfma_f32_16x16x32_bf16 v[8:11], v[72:75], v[64:67], v[8:11]
    v_mfma_f32_16x16x32_bf16 v[24:27], v[72:75], v[68:71], v[24:27]
    v_mfma_f32_16x16x32_bf16 v[12:15], v[76:79], v[64:67], v[12:15]
    v_mfma_f32_16x16x32_bf16 v[28:31], v[76:79], v[68:71], v[28:31]
    v_mfma_f32_16x16x32_bf16 v[16:19], v[80:83], v[64:67], v[16:19]
    v_mfma_f32_16x16x32_bf16 v[32:35], v[80:83], v[68:71], v[32:35]
    v_mfma_f32_16x16x32_bf16 v[20:23], v[84:87], v[64:67], v[20:23]
    v_mfma_f32_16x16x32_bf16 v[36:39], v[84:87], v[68:71], v[36:39]
    s_waitcnt vmcnt(0) lgkmcnt(0)
    s_barrier
    v_mov_b32 v140, v137
    v_mov_b32 v142, v139
    v_lshlrev_b32 v96, 16, v56
    v_and_b32 v97, 0xffff0000, v56
    v_lshlrev_b32 v98, 16, v57
    v_and_b32 v99, 0xffff0000, v57
    v_lshlrev_b32 v100, 16, v58
    v_and_b32 v101, 0xffff0000, v58
    v_lshlrev_b32 v102, 16, v59
    v_and_b32 v103, 0xffff0000, v59
    v_lshlrev_b32 v104, 16, v60
    v_and_b32 v105, 0xffff0000, v60
    v_lshlrev_b32 v106, 16, v61
    v_and_b32 v107, 0xffff0000, v61
    v_lshlrev_b32 v108, 16, v62
    v_and_b32 v109, 0xffff0000, v62
    v_lshlrev_b32 v110, 16, v63
    v_and_b32 v111, 0xffff0000, v63
    v_pk_fma_f32 v[8:9], v[8:9], v[140:141], v[96:97] op_sel_hi:[1,0,1]
    v_pk_fma_f32 v[10:11], v[10:11], v[140:141], v[98:99] op_sel_hi:[1,0,1]
    v_pk_fma_f32 v[12:13], v[12:13], v[140:141], v[100:101] op_sel_hi:[1,0,1]
    v_pk_fma_f32 v[14:15], v[14:15], v[140:141], v[102:103] op_sel_hi:[1,0,1]
    v_pk_fma_f32 v[16:17], v[16:17], v[140:141], v[104:105] op_sel_hi:[1,0,1]
    v_pk_fma_f32 v[18:19], v[18:19], v[140:141], v[106:107] op_sel_hi:[1,0,1]
    v_pk_fma_f32 v[20:21], v[20:21], v[140:141], v[108:109] op_sel_hi:[1,0,1]
    v_pk_fma_f32 v[22:23], v[22:23], v[140:141], v[110:111] op_sel_hi:[1,0,1]
    v_pk_fma_f32 v[8:9], v[40:41], v[136:137], v[8:9] op_sel_hi:[1,0,1]
    v_pk_fma_f32 v[10:11], v[42:43], v[136:137], v[10:11] op_sel_hi:[1,0,1]
    v_pk_fma_f32 v[12:13], v[44:45], v[136:137], v[12:13] op_sel_hi:[1,0,1]
    v_pk_fma_f32 v[14:15], v[46:47], v[136:137], v[14:15] op_sel_hi:[1,0,1]
    v_pk_fma_f32 v[16:17], v[48:49], v[136:137], v[16:17] op_sel_hi:[1,0,1]
    v_pk_fma_f32 v[18:19], v[50:51], v[136:137], v[18:19] op_sel_hi:[1,0,1]
    v_pk_fma_f32 v[20:21], v[52:53], v[136:137], v[20:21] op_sel_hi:[1,0,1]
    v_pk_fma_f32 v[22:23], v[54:55], v[136:137], v[22:23] op_sel_hi:[1,0,1]
    v_pk_mul_f32 v[64:65], v[8:9], v[8:9]
    v_pk_mul_f32 v[66:67], v[10:11], v[10:11]
    v_pk_mul_f32 v[68:69], v[12:13], v[12:13]
    v_pk_mul_f32 v[70:71], v[14:15], v[14:15]
    v_pk_mul_f32 v[72:73], v[16:17], v[16:17]
    v_pk_mul_f32 v[74:75], v[18:19], v[18:19]
    v_pk_mul_f32 v[76:77], v[20:21], v[20:21]
    v_pk_mul_f32 v[78:79], v[22:23], v[22:23]
    v_pk_fma_f32 v[64:65], v[64:65], v[146:147], v[148:149] op_sel_hi:[1,0,0]
    v_pk_fma_f32 v[66:67], v[66:67], v[146:147], v[148:149] op_sel_hi:[1,0,0]
    v_pk_fma_f32 v[68:69], v[68:69], v[146:147], v[148:149] op_sel_hi:[1,0,0]
    v_pk_fma_f32 v[70:71], v[70:71], v[146:147], v[148:149] op_sel_hi:[1,0,0]
    v_pk_fma_f32 v[72:73], v[72:73], v[146:147], v[148:149] op_sel_hi:[1,0,0]
    v_pk_fma_f32 v[74:75], v[74:75], v[146:147], v[148:149] op_sel_hi:[1,0,0]
    v_pk_fma_f32 v[76:77], v[76:77], v[146:147], v[148:149] op_sel_hi:[1,0,0]
    v_pk_fma_f32 v[78:79], v[78:79], v[146:147], v[148:149] op_sel_hi:[1,0,0]
    v_pk_mul_f32 v[64:65], v[64:65], v[8:9]
    v_pk_mul_f32 v[66:67], v[66:67], v[10:11]
    v_pk_mul_f32 v[68:69], v[68:69], v[12:13]
    v_pk_mul_f32 v[70:71], v[70:71], v[14:15]
    v_pk_mul_f32 v[72:73], v[72:73], v[16:17]
    v_pk_mul_f32 v[74:75], v[74:75], v[18:19]
    v_pk_mul_f32 v[76:77], v[76:77], v[20:21]
    v_pk_mul_f32 v[78:79], v[78:79], v[22:23]
    v_exp_f32 v64, v64
    v_exp_f32 v65, v65
    v_exp_f32 v66, v66
    v_exp_f32 v67, v67
    v_exp_f32 v68, v68
    v_exp_f32 v69, v69
    v_exp_f32 v70, v70
    v_exp_f32 v71, v71
    v_exp_f32 v72, v72
    v_exp_f32 v73, v73
    v_exp_f32 v74, v74
    v_exp_f32 v75, v75
    v_exp_f32 v76, v76
    v_exp_f32 v77, v77
    v_exp_f32 v78, v78
    v_exp_f32 v79, v79
    v_pk_add_f32 v[64:65], v[64:65], v[150:151] op_sel_hi:[1,0]
    v_pk_add_f32 v[66:67], v[66:67], v[150:151] op_sel_hi:[1,0]
    v_pk_add_f32 v[68:69], v[68:69], v[150:151] op_sel_hi:[1,0]
    v_pk_add_f32 v[70:71], v[70:71], v[150:151] op_sel_hi:[1,0]
    v_pk_add_f32 v[72:73], v[72:73], v[150:151] op_sel_hi:[1,0]
    v_pk_add_f32 v[74:75], v[74:75], v[150:151] op_sel_hi:[1,0]
    v_pk_add_f32 v[76:77], v[76:77], v[150:151] op_sel_hi:[1,0]
    v_pk_add_f32 v[78:79], v[78:79], v[150:151] op_sel_hi:[1,0]
    v_rcp_f32 v64, v64
    v_rcp_f32 v65, v65
    v_rcp_f32 v66, v66
    v_rcp_f32 v67, v67
    v_rcp_f32 v68, v68
    v_rcp_f32 v69, v69
    v_rcp_f32 v70, v70
    v_rcp_f32 v71, v71
    v_rcp_f32 v72, v72
    v_rcp_f32 v73, v73
    v_rcp_f32 v74, v74
    v_rcp_f32 v75, v75
    v_rcp_f32 v76, v76
    v_rcp_f32 v77, v77
    v_rcp_f32 v78, v78
    v_rcp_f32 v79, v79
    v_pk_mul_f32 v[8:9], v[8:9], v[64:65]
    v_pk_mul_f32 v[10:11], v[10:11], v[66:67]
    v_pk_mul_f32 v[12:13], v[12:13], v[68:69]
    v_pk_mul_f32 v[14:15], v[14:15], v[70:71]
    v_pk_mul_f32 v[16:17], v[16:17], v[72:73]
    v_pk_mul_f32 v[18:19], v[18:19], v[74:75]
    v_pk_mul_f32 v[20:21], v[20:21], v[76:77]
    v_pk_mul_f32 v[22:23], v[22:23], v[78:79]
    v_cvt_pk_bf16_f32 v128, v8, v9
    v_cvt_pk_bf16_f32 v129, v10, v11
    v_cvt_pk_bf16_f32 v130, v12, v13
    v_cvt_pk_bf16_f32 v131, v14, v15
    v_cvt_pk_bf16_f32 v132, v16, v17
    v_cvt_pk_bf16_f32 v133, v18, v19
    v_cvt_pk_bf16_f32 v134, v20, v21
    v_cvt_pk_bf16_f32 v135, v22, v23
    buffer_store_dwordx4 v[128:131], v144, s[56:59], s64 offen sc1
    buffer_store_dwordx4 v[132:135], v144, s[56:59], s64 offen offset:1024 sc1
    v_pk_fma_f32 v[24:25], v[24:25], v[142:143], v[96:97] op_sel_hi:[1,0,1]
    v_pk_fma_f32 v[26:27], v[26:27], v[142:143], v[98:99] op_sel_hi:[1,0,1]
    v_pk_fma_f32 v[28:29], v[28:29], v[142:143], v[100:101] op_sel_hi:[1,0,1]
    v_pk_fma_f32 v[30:31], v[30:31], v[142:143], v[102:103] op_sel_hi:[1,0,1]
    v_pk_fma_f32 v[32:33], v[32:33], v[142:143], v[104:105] op_sel_hi:[1,0,1]
    v_pk_fma_f32 v[34:35], v[34:35], v[142:143], v[106:107] op_sel_hi:[1,0,1]
    v_pk_fma_f32 v[36:37], v[36:37], v[142:143], v[108:109] op_sel_hi:[1,0,1]
    v_pk_fma_f32 v[38:39], v[38:39], v[142:143], v[110:111] op_sel_hi:[1,0,1]
    v_pk_fma_f32 v[24:25], v[40:41], v[138:139], v[24:25] op_sel_hi:[1,0,1]
    v_pk_fma_f32 v[26:27], v[42:43], v[138:139], v[26:27] op_sel_hi:[1,0,1]
    v_pk_fma_f32 v[28:29], v[44:45], v[138:139], v[28:29] op_sel_hi:[1,0,1]
    v_pk_fma_f32 v[30:31], v[46:47], v[138:139], v[30:31] op_sel_hi:[1,0,1]
    v_pk_fma_f32 v[32:33], v[48:49], v[138:139], v[32:33] op_sel_hi:[1,0,1]
    v_pk_fma_f32 v[34:35], v[50:51], v[138:139], v[34:35] op_sel_hi:[1,0,1]
    v_pk_fma_f32 v[36:37], v[52:53], v[138:139], v[36:37] op_sel_hi:[1,0,1]
    v_pk_fma_f32 v[38:39], v[54:55], v[138:139], v[38:39] op_sel_hi:[1,0,1]
    v_pk_mul_f32 v[80:81], v[24:25], v[24:25]
    v_pk_mul_f32 v[82:83], v[26:27], v[26:27]
    v_pk_mul_f32 v[84:85], v[28:29], v[28:29]
    v_pk_mul_f32 v[86:87], v[30:31], v[30:31]
    v_pk_mul_f32 v[88:89], v[32:33], v[32:33]
    v_pk_mul_f32 v[90:91], v[34:35], v[34:35]
    v_pk_mul_f32 v[92:93], v[36:37], v[36:37]
    v_pk_mul_f32 v[94:95], v[38:39], v[38:39]
    v_pk_fma_f32 v[80:81], v[80:81], v[146:147], v[148:149] op_sel_hi:[1,0,0]
    v_pk_fma_f32 v[82:83], v[82:83], v[146:147], v[148:149] op_sel_hi:[1,0,0]
    v_pk_fma_f32 v[84:85], v[84:85], v[146:147], v[148:149] op_sel_hi:[1,0,0]
    v_pk_fma_f32 v[86:87], v[86:87], v[146:147], v[148:149] op_sel_hi:[1,0,0]
    v_pk_fma_f32 v[88:89], v[88:89], v[146:147], v[148:149] op_sel_hi:[1,0,0]
    v_pk_fma_f32 v[90:91], v[90:91], v[146:147], v[148:149] op_sel_hi:[1,0,0]
    v_pk_fma_f32 v[92:93], v[92:93], v[146:147], v[148:149] op_sel_hi:[1,0,0]
    v_pk_fma_f32 v[94:95], v[94:95], v[146:147], v[148:149] op_sel_hi:[1,0,0]
    v_pk_mul_f32 v[80:81], v[80:81], v[24:25]
    v_pk_mul_f32 v[82:83], v[82:83], v[26:27]
    v_pk_mul_f32 v[84:85], v[84:85], v[28:29]
    v_pk_mul_f32 v[86:87], v[86:87], v[30:31]
    v_pk_mul_f32 v[88:89], v[88:89], v[32:33]
    v_pk_mul_f32 v[90:91], v[90:91], v[34:35]
    v_pk_mul_f32 v[92:93], v[92:93], v[36:37]
    v_pk_mul_f32 v[94:95], v[94:95], v[38:39]
    v_exp_f32 v80, v80
    v_exp_f32 v81, v81
    v_exp_f32 v82, v82
    v_exp_f32 v83, v83
    v_exp_f32 v84, v84
    v_exp_f32 v85, v85
    v_exp_f32 v86, v86
    v_exp_f32 v87, v87
    v_exp_f32 v88, v88
    v_exp_f32 v89, v89
    v_exp_f32 v90, v90
    v_exp_f32 v91, v91
    v_exp_f32 v92, v92
    v_exp_f32 v93, v93
    v_exp_f32 v94, v94
    v_exp_f32 v95, v95
    v_pk_add_f32 v[80:81], v[80:81], v[150:151] op_sel_hi:[1,0]
    v_pk_add_f32 v[82:83], v[82:83], v[150:151] op_sel_hi:[1,0]
    v_pk_add_f32 v[84:85], v[84:85], v[150:151] op_sel_hi:[1,0]
    v_pk_add_f32 v[86:87], v[86:87], v[150:151] op_sel_hi:[1,0]
    v_pk_add_f32 v[88:89], v[88:89], v[150:151] op_sel_hi:[1,0]
    v_pk_add_f32 v[90:91], v[90:91], v[150:151] op_sel_hi:[1,0]
    v_pk_add_f32 v[92:93], v[92:93], v[150:151] op_sel_hi:[1,0]
    v_pk_add_f32 v[94:95], v[94:95], v[150:151] op_sel_hi:[1,0]
    v_rcp_f32 v80, v80
    v_rcp_f32 v81, v81
    v_rcp_f32 v82, v82
    v_rcp_f32 v83, v83
    v_rcp_f32 v84, v84
    v_rcp_f32 v85, v85
    v_rcp_f32 v86, v86
    v_rcp_f32 v87, v87
    v_rcp_f32 v88, v88
    v_rcp_f32 v89, v89
    v_rcp_f32 v90, v90
    v_rcp_f32 v91, v91
    v_rcp_f32 v92, v92
    v_rcp_f32 v93, v93
    v_rcp_f32 v94, v94
    v_rcp_f32 v95, v95
    v_pk_mul_f32 v[24:25], v[24:25], v[80:81]
    v_pk_mul_f32 v[26:27], v[26:27], v[82:83]
    v_pk_mul_f32 v[28:29], v[28:29], v[84:85]
    v_pk_mul_f32 v[30:31], v[30:31], v[86:87]
    v_pk_mul_f32 v[32:33], v[32:33], v[88:89]
    v_pk_mul_f32 v[34:35], v[34:35], v[90:91]
    v_pk_mul_f32 v[36:37], v[36:37], v[92:93]
    v_pk_mul_f32 v[38:39], v[38:39], v[94:95]
    v_cvt_pk_bf16_f32 v56, v24, v25
    v_cvt_pk_bf16_f32 v57, v26, v27
    v_cvt_pk_bf16_f32 v58, v28, v29
    v_cvt_pk_bf16_f32 v59, v30, v31
    v_cvt_pk_bf16_f32 v60, v32, v33
    v_cvt_pk_bf16_f32 v61, v34, v35
    v_cvt_pk_bf16_f32 v62, v36, v37
    v_cvt_pk_bf16_f32 v63, v38, v39
    s_add_u32 s64, s64, 58368
    s_add_u32 s65, s65, 58368
    buffer_store_dwordx4 v[56:59], v144, s[56:59], s64 offen sc1
    buffer_store_dwordx4 v[60:63], v144, s[56:59], s64 offen offset:1024 sc1
    s_branch Lcj_148
Lnh1_147:
    s_nop 7
    s_nop 7
    s_lshl_b32 s79, s7, 12
    v_lshlrev_b32 v152, 4, v1
    v_add_u32 v154, s79, v152
    v_add_u32 v155, 0x10000, v154
    v_add_u32 v156, 0x20000, v154
    v_lshlrev_b32 v152, 4, v1
    v_add_u32 v157, 0x1000, v152
    v_add_u32 v158, 0x10000, v157
    s_lshl_b32 s79, s4, 8
    s_add_u32 s79, s79, 0
    v_lshlrev_b32 v159, 4, v2
    v_add_u32 v159, s79, v159
    s_barrier
    ds_read_b128 v[64:67], v155 offset:20480
    ds_read_b128 v[68:71], v155 offset:22528
    ds_read_b128 v[72:75], v157 offset:0
    ds_read_b128 v[76:79], v157 offset:1024
    ds_read_b128 v[80:83], v157 offset:2048
    ds_read_b128 v[84:87], v155 offset:21504
    ds_read_b128 v[88:91], v155 offset:23552
    ds_read_b128 v[92:95], v157 offset:7168
    ds_read_b128 v[96:99], v157 offset:8192
    ds_read_b128 v[100:103], v157 offset:9216
    s_waitcnt lgkmcnt(5)
    s_waitcnt lgkmcnt(0)
    s_barrier
    v_mfma_f32_16x16x32_bf16 v[8:11], v[72:75], v[64:67], 0
    ds_read_b128 v[104:107], v155 offset:36864
    v_mfma_f32_16x16x32_bf16 v[20:23], v[72:75], v[68:71], 0
    ds_read_b128 v[108:111], v155 offset:38912
    v_mfma_f32_16x16x32_bf16 v[12:15], v[76:79], v[64:67], 0
    ds_read_b128 v[112:115], v157 offset:14336
    v_mfma_f32_16x16x32_bf16 v[24:27], v[76:79], v[68:71], 0
    ds_read_b128 v[116:119], v157 offset:15360
    v_mfma_f32_16x16x32_bf16 v[16:19], v[80:83], v[64:67], 0
    ds_read_b128 v[120:123], v157 offset:16384
    v_mfma_f32_16x16x32_bf16 v[28:31], v[80:83], v[68:71], 0
    v_mfma_f32_16x16x32_bf16 v[8:11], v[92:95], v[84:87], v[8:11]
    ds_read_b128 v[64:67], v155 offset:37888
    v_mfma_f32_16x16x32_bf16 v[20:23], v[92:95], v[88:91], v[20:23]
    ds_read_b128 v[68:71], v155 offset:39936
    v_mfma_f32_16x16x32_bf16 v[12:15], v[96:99], v[84:87], v[12:15]
    ds_read_b128 v[72:75], v157 offset:21504
    v_mfma_f32_16x16x32_bf16 v[24:27], v[96:99], v[88:91], v[24:27]
    ds_read_b128 v[76:79], v157 offset:22528
    v_mfma_f32_16x16x32_bf16 v[16:19], v[100:103], v[84:87], v[16:19]
    ds_read_b128 v[80:83], v157 offset:23552
    v_mfma_f32_16x16x32_bf16 v[28:31], v[100:103], v[88:91], v[28:31]
    s_waitcnt lgkmcnt(5)
    s_waitcnt lgkmcnt(0)
    s_barrier
    v_mfma_f32_16x16x32_bf16 v[8:11], v[112:115], v[104:107], v[8:11]
    ds_read_b128 v[84:87], v155 offset:53248
    v_mfma_f32_16x16x32_bf16 v[20:23], v[112:115], v[108:111], v[20:23]
    ds_read_b128 v[88:91], v155 offset:55296
    v_mfma_f32_16x16x32_bf16 v[12:15], v[116:119], v[104:107], v[12:15]
    ds_read_b128 v[92:95], v157 offset:28672
    v_mfma_f32_16x16x32_bf16 v[24:27], v[116:119], v[108:111], v[24:27]
    ds_read_b128 v[96:99], v157 offset:29696
    v_mfma_f32_16x16x32_bf16 v[16:19], v[120:123], v[104:107], v[16:19]
    ds_read_b128 v[100:103], v157 offset:30720
    v_mfma_f32_16x16x32_bf16 v[28:31], v[120:123], v[108:111], v[28:31]
    v_mfma_f32_16x16x32_bf16 v[8:11], v[72:75], v[64:67], v[8:11]
    ds_read_b128 v[104:107], v155 offset:54272
    v_mfma_f32_16x16x32_bf16 v[20:23], v[72:75], v[68:71], v[20:23]
    ds_read_b128 v[108:111], v155 offset:56320
    v_mfma_f32_16x16x32_bf16 v[12:15], v[76:79], v[64:67], v[12:15]
    ds_read_b128 v[112:115], v157 offset:35840
    v_mfma_f32_16x16x32_bf16 v[24:27], v[76:79], v[68:71], v[24:27]
    ds_read_b128 v[116:119], v157 offset:36864
    v_mfma_f32_16x16x32_bf16 v[16:19], v[80:83], v[64:67], v[16:19]
    ds_read_b128 v[120:123], v157 offset:37888
    v_mfma_f32_16x16x32_bf16 v[28:31], v[80:83], v[68:71], v[28:31]
    s_waitcnt lgkmcnt(5)
    s_waitcnt lgkmcnt(0)
    s_barrier
    v_mfma_f32_16x16x32_bf16 v[8:11], v[92:95], v[84:87], v[8:11]
    ds_read_b128 v[64:67], v156 offset:4096
    v_mfma_f32_16x16x32_bf16 v[20:23], v[92:95], v[88:91], v[20:23]
    ds_read_b128 v[68:71], v156 offset:6144
    v_mfma_f32_16x16x32_bf16 v[12:15], v[96:99], v[84:87], v[12:15]
    ds_read_b128 v[72:75], v157 offset:43008
    v_mfma_f32_16x16x32_bf16 v[24:27], v[96:99], v[88:91], v[24:27]
    ds_read_b128 v[76:79], v157 offset:44032
    v_mfma_f32_16x16x32_bf16 v[16:19], v[100:103], v[84:87], v[16:19]
    ds_read_b128 v[80:83], v157 offset:45056
    v_mfma_f32_16x16x32_bf16 v[28:31], v[100:103], v[88:91], v[28:31]
    v_mfma_f32_16x16x32_bf16 v[8:11], v[112:115], v[104:107], v[8:11]
    ds_read_b128 v[84:87], v156 offset:5120
    v_mfma_f32_16x16x32_bf16 v[20:23], v[112:115], v[108:111], v[20:23]
    ds_read_b128 v[88:91], v156 offset:7168
    v_mfma_f32_16x16x32_bf16 v[12:15], v[116:119], v[104:107], v[12:15]
    ds_read_b128 v[92:95], v157 offset:50176
    v_mfma_f32_16x16x32_bf16 v[24:27], v[116:119], v[108:111], v[24:27]
    ds_read_b128 v[96:99], v157 offset:51200
    v_mfma_f32_16x16x32_bf16 v[16:19], v[120:123], v[104:107], v[16:19]
    ds_read_b128 v[100:103], v157 offset:52224
    v_mfma_f32_16x16x32_bf16 v[28:31], v[120:123], v[108:111], v[28:31]
    s_waitcnt lgkmcnt(5)
    s_waitcnt lgkmcnt(0)
    s_barrier
    v_mfma_f32_16x16x32_bf16 v[8:11], v[72:75], v[64:67], v[8:11]
    ds_read_b128 v[104:107], v155 offset:20480
    v_mfma_f32_16x16x32_bf16 v[20:23], v[72:75], v[68:71], v[20:23]
    ds_read_b128 v[108:111], v155 offset:22528
    v_mfma_f32_16x16x32_bf16 v[12:15], v[76:79], v[64:67], v[12:15]
    ds_read_b128 v[112:115], v157 offset:57344
    v_mfma_f32_16x16x32_bf16 v[24:27], v[76:79], v[68:71], v[24:27]
    ds_read_b128 v[116:119], v157 offset:58368
    v_mfma_f32_16x16x32_bf16 v[16:19], v[80:83], v[64:67], v[16:19]
    ds_read_b128 v[120:123], v157 offset:59392
    v_mfma_f32_16x16x32_bf16 v[28:31], v[80:83], v[68:71], v[28:31]
    v_mfma_f32_16x16x32_bf16 v[8:11], v[92:95], v[84:87], v[8:11]
    ds_read_b128 v[64:67], v155 offset:21504
    v_mfma_f32_16x16x32_bf16 v[20:23], v[92:95], v[88:91], v[20:23]
    ds_read_b128 v[68:71], v155 offset:23552
    v_mfma_f32_16x16x32_bf16 v[12:15], v[96:99], v[84:87], v[12:15]
    ds_read_b128 v[72:75], v157 offset:64512
    v_mfma_f32_16x16x32_bf16 v[24:27], v[96:99], v[88:91], v[24:27]
    ds_read_b128 v[76:79], v158 offset:0
    v_mfma_f32_16x16x32_bf16 v[16:19], v[100:103], v[84:87], v[16:19]
    ds_read_b128 v[80:83], v158 offset:1024
    v_mfma_f32_16x16x32_bf16 v[28:31], v[100:103], v[88:91], v[28:31]
    s_waitcnt lgkmcnt(5)
    s_waitcnt lgkmcnt(0)
    s_barrier
    v_mfma_f32_16x16x32_bf16 v[8:11], v[112:115], v[104:107], v[8:11]
    ds_read_b128 v[84:87], v155 offset:36864
    v_mfma_f32_16x16x32_bf16 v[20:23], v[112:115], v[108:111], v[20:23]
    ds_read_b128 v[88:91], v155 offset:38912
    v_mfma_f32_16x16x32_bf16 v[12:15], v[116:119], v[104:107], v[12:15]
    ds_read_b128 v[92:95], v158 offset:6144
    v_mfma_f32_16x16x32_bf16 v[24:27], v[116:119], v[108:111], v[24:27]
    ds_read_b128 v[96:99], v158 offset:7168
    v_mfma_f32_16x16x32_bf16 v[16:19], v[120:123], v[104:107], v[16:19]
    ds_read_b128 v[100:103], v158 offset:8192
    v_mfma_f32_16x16x32_bf16 v[28:31], v[120:123], v[108:111], v[28:31]
    v_mfma_f32_16x16x32_bf16 v[8:11], v[72:75], v[64:67], v[8:11]
    ds_read_b128 v[104:107], v155 offset:37888
    v_mfma_f32_16x16x32_bf16 v[20:23], v[72:75], v[68:71], v[20:23]
    ds_read_b128 v[108:111], v155 offset:39936
    v_mfma_f32_16x16x32_bf16 v[12:15], v[76:79], v[64:67], v[12:15]
    ds_read_b128 v[112:115], v158 offset:13312
    v_mfma_f32_16x16x32_bf16 v[24:27], v[76:79], v[68:71], v[24:27]
    ds_read_b128 v[116:119], v158 offset:14336
    v_mfma_f32_16x16x32_bf16 v[16:19], v[80:83], v[64:67], v[16:19]
    ds_read_b128 v[120:123], v158 offset:15360
    v_mfma_f32_16x16x32_bf16 v[28:31], v[80:83], v[68:71], v[28:31]
    s_waitcnt lgkmcnt(5)
    s_waitcnt lgkmcnt(0)
    s_barrier
    v_mfma_f32_16x16x32_bf16 v[8:11], v[92:95], v[84:87], v[8:11]
    ds_read_b128 v[64:67], v155 offset:53248
    v_mfma_f32_16x16x32_bf16 v[20:23], v[92:95], v[88:91], v[20:23]
    ds_read_b128 v[68:71], v155 offset:55296
    v_mfma_f32_16x16x32_bf16 v[12:15], v[96:99], v[84:87], v[12:15]
    ds_read_b128 v[72:75], v157 offset:0
    v_mfma_f32_16x16x32_bf16 v[24:27], v[96:99], v[88:91], v[24:27]
    ds_read_b128 v[76:79], v157 offset:1024
    v_mfma_f32_16x16x32_bf16 v[16:19], v[100:103], v[84:87], v[16:19]
    ds_read_b128 v[80:83], v157 offset:2048
    v_mfma_f32_16x16x32_bf16 v[28:31], v[100:103], v[88:91], v[28:31]
    v_mfma_f32_16x16x32_bf16 v[8:11], v[112:115], v[104:107], v[8:11]
    ds_read_b128 v[84:87], v155 offset:54272
    v_mfma_f32_16x16x32_bf16 v[20:23], v[112:115], v[108:111], v[20:23]
    ds_read_b128 v[88:91], v155 offset:56320
    v_mfma_f32_16x16x32_bf16 v[12:15], v[116:119], v[104:107], v[12:15]
    ds_read_b128 v[92:95], v157 offset:7168
    v_mfma_f32_16x16x32_bf16 v[24:27], v[116:119], v[108:111], v[24:27]
    ds_read_b128 v[96:99], v157 offset:8192
    v_mfma_f32_16x16x32_bf16 v[16:19], v[120:123], v[104:107], v[16:19]
    ds_read_b128 v[100:103], v157 offset:9216
    v_mfma_f32_16x16x32_bf16 v[28:31], v[120:123], v[108:111], v[28:31]
    s_waitcnt lgkmcnt(5)
    s_waitcnt lgkmcnt(0)
    s_barrier
    v_mfma_f32_16x16x32_bf16 v[8:11], v[72:75], v[64:67], v[8:11]
    ds_read_b128 v[104:107], v156 offset:4096
    v_mfma_f32_16x16x32_bf16 v[20:23], v[72:75], v[68:71], v[20:23]
    ds_read_b128 v[108:111], v156 offset:6144
    v_mfma_f32_16x16x32_bf16 v[12:15], v[76:79], v[64:67], v[12:15]
    ds_read_b128 v[112:115], v157 offset:14336
    v_mfma_f32_16x16x32_bf16 v[24:27], v[76:79], v[68:71], v[24:27]
    ds_read_b128 v[116:119], v157 offset:15360
    v_mfma_f32_16x16x32_bf16 v[16:19], v[80:83], v[64:67], v[16:19]
    ds_read_b128 v[120:123], v157 offset:16384
    v_mfma_f32_16x16x32_bf16 v[28:31], v[80:83], v[68:71], v[28:31]
    v_mfma_f32_16x16x32_bf16 v[8:11], v[92:95], v[84:87], v[8:11]
    ds_read_b128 v[64:67], v156 offset:5120
    v_mfma_f32_16x16x32_bf16 v[20:23], v[92:95], v[88:91], v[20:23]
    ds_read_b128 v[68:71], v156 offset:7168
    v_mfma_f32_16x16x32_bf16 v[12:15], v[96:99], v[84:87], v[12:15]
    ds_read_b128 v[72:75], v157 offset:21504
    v_mfma_f32_16x16x32_bf16 v[24:27], v[96:99], v[88:91], v[24:27]
    ds_read_b128 v[76:79], v157 offset:22528
    v_mfma_f32_16x16x32_bf16 v[16:19], v[100:103], v[84:87], v[16:19]
    ds_read_b128 v[80:83], v157 offset:23552
    v_mfma_f32_16x16x32_bf16 v[28:31], v[100:103], v[88:91], v[28:31]
    s_lshl_b32 s60, s7, 8
    s_add_u32 s60, s60, 161792
    v_lshlrev_b32 v4, 3, v3
    v_add_u32 v4, s60, v4
    ds_read_b64 v[136:137], v4 offset:0
    ds_read_b64 v[138:139], v4 offset:128
    s_lshl_b32 s60, s8, 8
    s_add_u32 s60, s60, 163200
    v_lshlrev_b32 v4, 4, v2
    v_add_u32 v4, s60, v4
    ds_read_b128 v[40:43], v4 offset:0
    ds_read_b128 v[44:47], v4 offset:64
    ds_read_b128 v[48:51], v4 offset:128
    s_waitcnt lgkmcnt(10)
    v_mfma_f32_16x16x32_bf16 v[8:11], v[112:115], v[104:107], v[8:11]
    v_mfma_f32_16x16x32_bf16 v[20:23], v[112:115], v[108:111], v[20:23]
    v_mfma_f32_16x16x32_bf16 v[12:15], v[116:119], v[104:107], v[12:15]
    v_mfma_f32_16x16x32_bf16 v[24:27], v[116:119], v[108:111], v[24:27]
    v_mfma_f32_16x16x32_bf16 v[16:19], v[120:123], v[104:107], v[16:19]
    v_mfma_f32_16x16x32_bf16 v[28:31], v[120:123], v[108:111], v[28:31]
    s_waitcnt lgkmcnt(5)
    v_mfma_f32_16x16x32_bf16 v[8:11], v[72:75], v[64:67], v[8:11]
    v_mfma_f32_16x16x32_bf16 v[20:23], v[72:75], v[68:71], v[20:23]
    v_mfma_f32_16x16x32_bf16 v[12:15], v[76:79], v[64:67], v[12:15]
    v_mfma_f32_16x16x32_bf16 v[24:27], v[76:79], v[68:71], v[24:27]
    v_mfma_f32_16x16x32_bf16 v[16:19], v[80:83], v[64:67], v[16:19]
    v_mfma_f32_16x16x32_bf16 v[28:31], v[80:83], v[68:71], v[28:31]
    s_waitcnt vmcnt(0) lgkmcnt(0)
    s_barrier
    v_mov_b32 v140, v137
    v_mov_b32 v142, v139
    v_lshlrev_b32 v96, 16, v56
    v_and_b32 v97, 0xffff0000, v56
    v_lshlrev_b32 v98, 16, v57
    v_and_b32 v99, 0xffff0000, v57
    v_lshlrev_b32 v100, 16, v58
    v_and_b32 v101, 0xffff0000, v58
    v_lshlrev_b32 v102, 16, v59
    v_and_b32 v103, 0xffff0000, v59
    v_lshlrev_b32 v104, 16, v60
    v_and_b32 v105, 0xffff0000, v60
    v_lshlrev_b32 v106, 16, v61
    v_and_b32 v107, 0xffff0000, v61
    v_pk_fma_f32 v[8:9], v[8:9], v[140:141], v[96:97] op_sel_hi:[1,0,1]
    v_pk_fma_f32 v[10:11], v[10:11], v[140:141], v[98:99] op_sel_hi:[1,0,1]
    v_pk_fma_f32 v[12:13], v[12:13], v[140:141], v[100:101] op_sel_hi:[1,0,1]
    v_pk_fma_f32 v[14:15], v[14:15], v[140:141], v[102:103] op_sel_hi:[1,0,1]
    v_pk_fma_f32 v[16:17], v[16:17], v[140:141], v[104:105] op_sel_hi:[1,0,1]
    v_pk_fma_f32 v[18:19], v[18:19], v[140:141], v[106:107] op_sel_hi:[1,0,1]
    v_pk_fma_f32 v[8:9], v[40:41], v[136:137], v[8:9] op_sel_hi:[1,0,1]
    v_pk_fma_f32 v[10:11], v[42:43], v[136:137], v[10:11] op_sel_hi:[1,0,1]
    v_pk_fma_f32 v[12:13], v[44:45], v[136:137], v[12:13] op_sel_hi:[1,0,1]
    v_pk_fma_f32 v[14:15], v[46:47], v[136:137], v[14:15] op_sel_hi:[1,0,1]
    v_pk_fma_f32 v[16:17], v[48:49], v[136:137], v[16:17] op_sel_hi:[1,0,1]
    v_pk_fma_f32 v[18:19], v[50:51], v[136:137], v[18:19] op_sel_hi:[1,0,1]
    v_pk_mul_f32 v[64:65], v[8:9], v[8:9]
    v_pk_mul_f32 v[66:67], v[10:11], v[10:11]
    v_pk_mul_f32 v[68:69], v[12:13], v[12:13]
    v_pk_mul_f32 v[70:71], v[14:15], v[14:15]
    v_pk_mul_f32 v[72:73], v[16:17], v[16:17]
    v_pk_mul_f32 v[74:75], v[18:19], v[18:19]
    v_pk_fma_f32 v[64:65], v[64:65], v[146:147], v[148:149] op_sel_hi:[1,0,0]
    v_pk_fma_f32 v[66:67], v[66:67], v[146:147], v[148:149] op_sel_hi:[1,0,0]
    v_pk_fma_f32 v[68:69], v[68:69], v[146:147], v[148:149] op_sel_hi:[1,0,0]
    v_pk_fma_f32 v[70:71], v[70:71], v[146:147], v[148:149] op_sel_hi:[1,0,0]
    v_pk_fma_f32 v[72:73], v[72:73], v[146:147], v[148:149] op_sel_hi:[1,0,0]
    v_pk_fma_f32 v[74:75], v[74:75], v[146:147], v[148:149] op_sel_hi:[1,0,0]
    v_pk_mul_f32 v[64:65], v[64:65], v[8:9]
    v_pk_mul_f32 v[66:67], v[66:67], v[10:11]
    v_pk_mul_f32 v[68:69], v[68:69], v[12:13]
    v_pk_mul_f32 v[70:71], v[70:71], v[14:15]
    v_pk_mul_f32 v[72:73], v[72:73], v[16:17]
    v_pk_mul_f32 v[74:75], v[74:75], v[18:19]
    v_exp_f32 v64, v64
    v_exp_f32 v65, v65
    v_exp_f32 v66, v66
    v_exp_f32 v67, v67
    v_exp_f32 v68, v68
    v_exp_f32 v69, v69
    v_exp_f32 v70, v70
    v_exp_f32 v71, v71
    v_exp_f32 v72, v72
    v_exp_f32 v73, v73
    v_exp_f32 v74, v74
    v_exp_f32 v75, v75
    v_pk_add_f32 v[64:65], v[64:65], v[150:151] op_sel_hi:[1,0]
    v_pk_add_f32 v[66:67], v[66:67], v[150:151] op_sel_hi:[1,0]
    v_pk_add_f32 v[68:69], v[68:69], v[150:151] op_sel_hi:[1,0]
    v_pk_add_f32 v[70:71], v[70:71], v[150:151] op_sel_hi:[1,0]
    v_pk_add_f32 v[72:73], v[72:73], v[150:151] op_sel_hi:[1,0]
    v_pk_add_f32 v[74:75], v[74:75], v[150:151] op_sel_hi:[1,0]
    v_rcp_f32 v64, v64
    v_rcp_f32 v65, v65
    v_rcp_f32 v66, v66
    v_rcp_f32 v67, v67
    v_rcp_f32 v68, v68
    v_rcp_f32 v69, v69
    v_rcp_f32 v70, v70
    v_rcp_f32 v71, v71
    v_rcp_f32 v72, v72
    v_rcp_f32 v73, v73
    v_rcp_f32 v74, v74
    v_rcp_f32 v75, v75
    v_pk_mul_f32 v[8:9], v[8:9], v[64:65]
    v_pk_mul_f32 v[10:11], v[10:11], v[66:67]
    v_pk_mul_f32 v[12:13], v[12:13], v[68:69]
    v_pk_mul_f32 v[14:15], v[14:15], v[70:71]
    v_pk_mul_f32 v[16:17], v[16:17], v[72:73]
    v_pk_mul_f32 v[18:19], v[18:19], v[74:75]
    v_cvt_pk_bf16_f32 v128, v8, v9
    v_cvt_pk_bf16_f32 v129, v10, v11
    v_cvt_pk_bf16_f32 v130, v12, v13
    v_cvt_pk_bf16_f32 v131, v14, v15
    v_cvt_pk_bf16_f32 v132, v16, v17
    v_cvt_pk_bf16_f32 v133, v18, v19
    buffer_store_dwordx4 v[128:131], v144, s[56:59], s64 offen sc1
    buffer_store_dwordx2 v[132:133], v144, s[56:59], s65 offen sc1
    v_pk_fma_f32 v[20:21], v[20:21], v[142:143], v[96:97] op_sel_hi:[1,0,1]
    v_pk_fma_f32 v[22:23], v[22:23], v[142:143], v[98:99] op_sel_hi:[1,0,1]
    v_pk_fma_f32 v[24:25], v[24:25], v[142:143], v[100:101] op_sel_hi:[1,0,1]
    v_pk_fma_f32 v[26:27], v[26:27], v[142:143], v[102:103] op_sel_hi:[1,0,1]
    v_pk_fma_f32 v[28:29], v[28:29], v[142:143], v[104:105] op_sel_hi:[1,0,1]
    v_pk_fma_f32 v[30:31], v[30:31], v[142:143], v[106:107] op_sel_hi:[1,0,1]
    v_pk_fma_f32 v[20:21], v[40:41], v[138:139], v[20:21] op_sel_hi:[1,0,1]
    v_pk_fma_f32 v[22:23], v[42:43], v[138:139], v[22:23] op_sel_hi:[1,0,1]
    v_pk_fma_f32 v[24:25], v[44:45], v[138:139], v[24:25] op_sel_hi:[1,0,1]
    v_pk_fma_f32 v[26:27], v[46:47], v[138:139], v[26:27] op_sel_hi:[1,0,1]
    v_pk_fma_f32 v[28:29], v[48:49], v[138:139], v[28:29] op_sel_hi:[1,0,1]
    v_pk_fma_f32 v[30:31], v[50:51], v[138:139], v[30:31] op_sel_hi:[1,0,1]
    v_pk_mul_f32 v[80:81], v[20:21], v[20:21]
    v_pk_mul_f32 v[82:83], v[22:23], v[22:23]
    v_pk_mul_f32 v[84:85], v[24:25], v[24:25]
    v_pk_mul_f32 v[86:87], v[26:27], v[26:27]
    v_pk_mul_f32 v[88:89], v[28:29], v[28:29]
    v_pk_mul_f32 v[90:91], v[30:31], v[30:31]
    v_pk_fma_f32 v[80:81], v[80:81], v[146:147], v[148:149] op_sel_hi:[1,0,0]
    v_pk_fma_f32 v[82:83], v[82:83], v[146:147], v[148:149] op_sel_hi:[1,0,0]
    v_pk_fma_f32 v[84:85], v[84:85], v[146:147], v[148:149] op_sel_hi:[1,0,0]
    v_pk_fma_f32 v[86:87], v[86:87], v[146:147], v[148:149] op_sel_hi:[1,0,0]
    v_pk_fma_f32 v[88:89], v[88:89], v[146:147], v[148:149] op_sel_hi:[1,0,0]
    v_pk_fma_f32 v[90:91], v[90:91], v[146:147], v[148:149] op_sel_hi:[1,0,0]
    v_pk_mul_f32 v[80:81], v[80:81], v[20:21]
    v_pk_mul_f32 v[82:83], v[82:83], v[22:23]
    v_pk_mul_f32 v[84:85], v[84:85], v[24:25]
    v_pk_mul_f32 v[86:87], v[86:87], v[26:27]
    v_pk_mul_f32 v[88:89], v[88:89], v[28:29]
    v_pk_mul_f32 v[90:91], v[90:91], v[30:31]
    v_exp_f32 v80, v80
    v_exp_f32 v81, v81
    v_exp_f32 v82, v82
    v_exp_f32 v83, v83
    v_exp_f32 v84, v84
    v_exp_f32 v85, v85
    v_exp_f32 v86, v86
    v_exp_f32 v87, v87
    v_exp_f32 v88, v88
    v_exp_f32 v89, v89
    v_exp_f32 v90, v90
    v_exp_f32 v91, v91
    v_pk_add_f32 v[80:81], v[80:81], v[150:151] op_sel_hi:[1,0]
    v_pk_add_f32 v[82:83], v[82:83], v[150:151] op_sel_hi:[1,0]
    v_pk_add_f32 v[84:85], v[84:85], v[150:151] op_sel_hi:[1,0]
    v_pk_add_f32 v[86:87], v[86:87], v[150:151] op_sel_hi:[1,0]
    v_pk_add_f32 v[88:89], v[88:89], v[150:151] op_sel_hi:[1,0]
    v_pk_add_f32 v[90:91], v[90:91], v[150:151] op_sel_hi:[1,0]
    v_rcp_f32 v80, v80
    v_rcp_f32 v81, v81
    v_rcp_f32 v82, v82
    v_rcp_f32 v83, v83
    v_rcp_f32 v84, v84
    v_rcp_f32 v85, v85
    v_rcp_f32 v86, v86
    v_rcp_f32 v87, v87
    v_rcp_f32 v88, v88
    v_rcp_f32 v89, v89
    v_rcp_f32 v90, v90
    v_rcp_f32 v91, v91
    v_pk_mul_f32 v[20:21], v[20:21], v[80:81]
    v_pk_mul_f32 v[22:23], v[22:23], v[82:83]
    v_pk_mul_f32 v[24:25], v[24:25], v[84:85]
    v_pk_mul_f32 v[26:27], v[26:27], v[86:87]
    v_pk_mul_f32 v[28:29], v[28:29], v[88:89]
    v_pk_mul_f32 v[30:31], v[30:31], v[90:91]
    v_cvt_pk_bf16_f32 v56, v20, v21
    v_cvt_pk_bf16_f32 v57, v22, v23
    v_cvt_pk_bf16_f32 v58, v24, v25
    v_cvt_pk_bf16_f32 v59, v26, v27
    v_cvt_pk_bf16_f32 v60, v28, v29
    v_cvt_pk_bf16_f32 v61, v30, v31
    s_add_u32 s64, s64, 58368
    s_add_u32 s65, s65, 58368
    buffer_store_dwordx4 v[56:59], v144, s[56:59], s64 offen sc1
    buffer_store_dwordx2 v[60:61], v144, s[56:59], s65 offen sc1
Lcj_148:
    s_nop 7
    s_nop 7
    v_mov_b32 v4, 163808
    v_mov_b32 v5, 1
    s_add_u32 s72, s38, 0x1580000
    s_addc_u32 s73, s39, 0
    s_mov_b32 s74, 0x3000
    s_mov_b32 s75, 0x00020000
    s_waitcnt vmcnt(0) lgkmcnt(0)
    s_mov_b64 exec, 1
    ds_add_rtn_u32 v5, v4, v5
    s_waitcnt lgkmcnt(0)
    s_mov_b64 exec, -1
    v_readfirstlane_b32 s70, v5
    s_nop 3
    s_and_b32 s70, s70, 7
    s_cmp_lg_u32 s70, 7
    s_cbranch_scc1 Lsg_149
    s_lshl_b32 s70, s5, 6
    s_add_u32 s70, s70, s6
    s_lshl_b32 s70, s70, 2
    v_mov_b32 v4, 8
    v_mov_b32 v5, 0
    s_mov_b64 exec, 1
    buffer_store_dword v4, v5, s[72:75], s70 offen sc1
    s_mov_b64 exec, -1
    s_nop 1
Lsg_149:
    s_nop 7
    s_nop 7
    s_barrier
    s_lshr_b32 s60, s6, 3
    s_lshl_b32 s61, s5, 1
    s_add_u32 s60, s60, s61
    s_and_b32 s61, s6, 7
    v_lshrrev_b32 v6, 3, v1
    v_lshlrev_b32 v6, 4, v6
    v_and_b32 v4, 7, v1
    v_lshl_add_u32 v6, v4, 8, v6
    s_lshl_b32 s64, s60, 2
    s_lshr_b32 s62, s4, 1
    s_add_u32 s64, s64, s62
    s_lshl_b32 s64, s64, 14
    s_lshl_b32 s62, s61, 11
    s_add_u32 s64, s64, s62
    s_and_b32 s62, s4, 1
    s_lshl_b32 s62, s62, 7
    s_add_u32 s64, s64, s62
    v_lshrrev_b32 v7, 3, v1
    v_lshlrev_b32 v7, 10, v7
    v_and_b32 v4, 7, v1
    v_lshl_add_u32 v7, v4, 4, v7
    s_lshl_b32 s65, s60, 3
    s_add_u32 s65, s65, s4
    s_lshl_b32 s65, s65, 13
    s_lshl_b32 s62, s61, 7
    s_add_u32 s65, s65, s62
    s_mov_b32 s48, s32
    s_mov_b32 s49, s33
    s_mov_b32 s50, 0x400
    s_mov_b32 s51, 0x00020000
    s_add_u32 s52, s38, 0xa00000
    s_addc_u32 s53, s39, 0
    s_mov_b32 s54, 0x200000
    s_mov_b32 s55, 0x00020000
    s_mov_b32 s56, s34
    s_mov_b32 s57, s35
    s_mov_b32 s58, 0x200000
    s_mov_b32 s59, 0x00020000
    s_lshl_b32 s66, s7, 12
    v_lshrrev_b32 v4, 2, v1
    v_lshlrev_b32 v124, 7, v4
    v_and_b32 v5, 3, v1
    v_lshl_add_u32 v124, v5, 3, v124
    v_add_u32 v124, s66, v124
    v_bfe_u32 v4, v1, 3, 2
    v_lshl_add_u32 v124, v4, 5, v124
    v_xor_b32 v125, 32, v124
    v_xor_b32 v126, 64, v124
    v_xor_b32 v127, 96, v124
    v_add_u32 v129, 0x10000, v124
    v_add_u32 v130, 0x20000, v124
    v_add_u32 v131, 0x10000, v125
    v_add_u32 v132, 0x20000, v125
    v_add_u32 v133, 0x10000, v126
    v_add_u32 v134, 0x20000, v126
    v_add_u32 v135, 0x10000, v127
    v_add_u32 v136, 0x20000, v127
    v_lshlrev_b32 v128, 4, v1
    s_add_u32 s44, s38, 0x2500000
    s_addc_u32 s45, s39, 0
    s_mov_b32 s46, 0x720000
    s_mov_b32 s47, 0x00020000
    s_lshl_b32 s67, s60, 1
    s_add_u32 s67, s67, s8
    s_mul_i32 s67, s67, 116736
    s_mul_i32 s62, s7, 14336
    s_add_u32 s67, s67, s62
    v_and_b32 v8, 7, v1
    v_lshlrev_b32 v8, 4, v8
    s_lshl_b32 s63, s61, 7
    buffer_load_dwordx4 v[80:83], v8, s[48:51], s63 offen
    buffer_load_dwordx4 v[76:79], v6, s[52:55], s64 offen sc1
    s_barrier
    s_add_u32 s62, s67, 0
    buffer_load_dwordx4 v[84:87], v128, s[44:47], s62 offen sc1
    s_add_u32 s62, s67, 58368
    buffer_load_dwordx4 v[88:91], v128, s[44:47], s62 offen sc1
    s_add_u32 s62, s67, 1024
    buffer_load_dwordx4 v[92:95], v128, s[44:47], s62 offen sc1
    s_add_u32 s62, s67, 59392
    buffer_load_dwordx4 v[96:99], v128, s[44:47], s62 offen sc1
    s_add_u32 s62, s67, 2048
    buffer_load_dwordx4 v[100:103], v128, s[44:47], s62 offen sc1
    s_add_u32 s62, s67, 60416
    buffer_load_dwordx4 v[104:107], v128, s[44:47], s62 offen sc1
    s_add_u32 s62, s67, 3072
    buffer_load_dwordx4 v[108:111], v128, s[44:47], s62 offen sc1
    s_add_u32 s62, s67, 61440
    buffer_load_dwordx4 v[112:115], v128, s[44:47], s62 offen sc1
    s_add_u32 s62, s67, 4096
    buffer_load_dwordx4 v[116:119], v128, s[44:47], s62 offen sc1
    s_add_u32 s62, s67, 62464
    buffer_load_dwordx4 v[120:123], v128, s[44:47], s62 offen sc1
    s_barrier
    ds_read_b64_tr_b16 v[44:45], v124 offset:0
    ds_read_b64_tr_b16 v[46:47], v124 offset:2048
    ds_read_b64_tr_b16 v[48:49], v125 offset:0
    ds_read_b64_tr_b16 v[50:51], v125 offset:2048
    ds_read_b64_tr_b16 v[52:53], v126 offset:0
    ds_read_b64_tr_b16 v[54:55], v126 offset:2048
    ds_read_b64_tr_b16 v[56:57], v127 offset:0
    ds_read_b64_tr_b16 v[58:59], v127 offset:2048
    s_waitcnt lgkmcnt(0)
    s_barrier
    s_waitcnt vmcnt(8)
    v_mfma_f32_16x16x32_bf16 v[12:15], v[44:47], v[84:87], 0
    ds_read_b64_tr_b16 v[60:61], v124 offset:16384
    v_mfma_f32_16x16x32_bf16 v[28:31], v[44:47], v[88:91], 0
    ds_read_b64_tr_b16 v[62:63], v124 offset:18432
    v_mfma_f32_16x16x32_bf16 v[16:19], v[48:51], v[84:87], 0
    ds_read_b64_tr_b16 v[64:65], v125 offset:16384
    v_mfma_f32_16x16x32_bf16 v[32:35], v[48:51], v[88:91], 0
    ds_read_b64_tr_b16 v[66:67], v125 offset:18432
    ds_read_b64_tr_b16 v[68:69], v126 offset:16384
    v_mfma_f32_16x16x32_bf16 v[20:23], v[52:55], v[84:87], 0
    ds_read_b64_tr_b16 v[70:71], v126 offset:18432
    v_mfma_f32_16x16x32_bf16 v[36:39], v[52:55], v[88:91], 0
    ds_read_b64_tr_b16 v[72:73], v127 offset:16384
    v_mfma_f32_16x16x32_bf16 v[24:27], v[56:59], v[84:87], 0
    ds_read_b64_tr_b16 v[74:75], v127 offset:18432
    v_mfma_f32_16x16x32_bf16 v[40:43], v[56:59], v[88:91], 0
    s_add_u32 s62, s67, 5120
    buffer_load_dwordx4 v[84:87], v128, s[44:47], s62 offen sc1
    s_add_u32 s62, s67, 63488
    buffer_load_dwordx4 v[88:91], v128, s[44:47], s62 offen sc1
    s_waitcnt lgkmcnt(0)
    s_barrier
    s_waitcnt vmcnt(8)
    v_mfma_f32_16x16x32_bf16 v[12:15], v[60:63], v[92:95], v[12:15]
    ds_read_b64_tr_b16 v[44:45], v124 offset:32768
    v_mfma_f32_16x16x32_bf16 v[28:31], v[60:63], v[96:99], v[28:31]
    ds_read_b64_tr_b16 v[46:47], v124 offset:34816
    v_mfma_f32_16x16x32_bf16 v[16:19], v[64:67], v[92:95], v[16:19]
    ds_read_b64_tr_b16 v[48:49], v125 offset:32768
    v_mfma_f32_16x16x32_bf16 v[32:35], v[64:67], v[96:99], v[32:35]
    ds_read_b64_tr_b16 v[50:51], v125 offset:34816
    ds_read_b64_tr_b16 v[52:53], v126 offset:32768
    v_mfma_f32_16x16x32_bf16 v[20:23], v[68:71], v[92:95], v[20:23]
    ds_read_b64_tr_b16 v[54:55], v126 offset:34816
    v_mfma_f32_16x16x32_bf16 v[36:39], v[68:71], v[96:99], v[36:39]
    ds_read_b64_tr_b16 v[56:57], v127 offset:32768
    v_mfma_f32_16x16x32_bf16 v[24:27], v[72:75], v[92:95], v[24:27]
    ds_read_b64_tr_b16 v[58:59], v127 offset:34816
    v_mfma_f32_16x16x32_bf16 v[40:43], v[72:75], v[96:99], v[40:43]
    s_add_u32 s62, s67, 6144
    buffer_load_dwordx4 v[92:95], v128, s[44:47], s62 offen sc1
    s_add_u32 s62, s67, 64512
    buffer_load_dwordx4 v[96:99], v128, s[44:47], s62 offen sc1
    s_waitcnt lgkmcnt(0)
    s_barrier
    s_waitcnt vmcnt(8)
    v_mfma_f32_16x16x32_bf16 v[12:15], v[44:47], v[100:103], v[12:15]
    ds_read_b64_tr_b16 v[60:61], v124 offset:49152
    v_mfma_f32_16x16x32_bf16 v[28:31], v[44:47], v[104:107], v[28:31]
    ds_read_b64_tr_b16 v[62:63], v124 offset:51200
    v_mfma_f32_16x16x32_bf16 v[16:19], v[48:51], v[100:103], v[16:19]
    ds_read_b64_tr_b16 v[64:65], v125 offset:49152
    v_mfma_f32_16x16x32_bf16 v[32:35], v[48:51], v[104:107], v[32:35]
    ds_read_b64_tr_b16 v[66:67], v125 offset:51200
    ds_read_b64_tr_b16 v[68:69], v126 offset:49152
    v_mfma_f32_16x16x32_bf16 v[20:23], v[52:55], v[100:103], v[20:23]
    ds_read_b64_tr_b16 v[70:71], v126 offset:51200
    v_mfma_f32_16x16x32_bf16 v[36:39], v[52:55], v[104:107], v[36:39]
    ds_read_b64_tr_b16 v[72:73], v127 offset:49152
    v_mfma_f32_16x16x32_bf16 v[24:27], v[56:59], v[100:103], v[24:27]
    ds_read_b64_tr_b16 v[74:75], v127 offset:51200
    v_mfma_f32_16x16x32_bf16 v[40:43], v[56:59], v[104:107], v[40:43]
    s_add_u32 s62, s67, 7168
    buffer_load_dwordx4 v[100:103], v128, s[44:47], s62 offen sc1
    s_add_u32 s62, s67, 65536
    buffer_load_dwordx4 v[104:107], v128, s[44:47], s62 offen sc1
    s_waitcnt lgkmcnt(0)
    s_barrier
    s_waitcnt vmcnt(8)
    v_mfma_f32_16x16x32_bf16 v[12:15], v[60:63], v[108:111], v[12:15]
    ds_read_b64_tr_b16 v[44:45], v129 offset:0
    v_mfma_f32_16x16x32_bf16 v[28:31], v[60:63], v[112:115], v[28:31]
    ds_read_b64_tr_b16 v[46:47], v129 offset:2048
    v_mfma_f32_16x16x32_bf16 v[16:19], v[64:67], v[108:111], v[16:19]
    ds_read_b64_tr_b16 v[48:49], v131 offset:0
    v_mfma_f32_16x16x32_bf16 v[32:35], v[64:67], v[112:115], v[32:35]
    ds_read_b64_tr_b16 v[50:51], v131 offset:2048
    ds_read_b64_tr_b16 v[52:53], v133 offset:0
    v_mfma_f32_16x16x32_bf16 v[20:23], v[68:71], v[108:111], v[20:23]
    ds_read_b64_tr_b16 v[54:55], v133 offset:2048
    v_mfma_f32_16x16x32_bf16 v[36:39], v[68:71], v[112:115], v[36:39]
    ds_read_b64_tr_b16 v[56:57], v135 offset:0
    v_mfma_f32_16x16x32_bf16 v[24:27], v[72:75], v[108:111], v[24:27]
    ds_read_b64_tr_b16 v[58:59], v135 offset:2048
    v_mfma_f32_16x16x32_bf16 v[40:43], v[72:75], v[112:115], v[40:43]
    s_add_u32 s62, s67, 8192
    buffer_load_dwordx4 v[108:111], v128, s[44:47], s62 offen sc1
    s_add_u32 s62, s67, 66560
    buffer_load_dwordx4 v[112:115], v128, s[44:47], s62 offen sc1
    s_waitcnt lgkmcnt(0)
    s_barrier
    s_waitcnt vmcnt(8)
    v_mfma_f32_16x16x32_bf16 v[12:15], v[44:47], v[116:119], v[12:15]
    ds_read_b64_tr_b16 v[60:61], v129 offset:16384
    v_mfma_f32_16x16x32_bf16 v[28:31], v[44:47], v[120:123], v[28:31]
    ds_read_b64_tr_b16 v[62:63], v129 offset:18432
    v_mfma_f32_16x16x32_bf16 v[16:19], v[48:51], v[116:119], v[16:19]
    ds_read_b64_tr_b16 v[64:65], v131 offset:16384
    v_mfma_f32_16x16x32_bf16 v[32:35], v[48:51], v[120:123], v[32:35]
    ds_read_b64_tr_b16 v[66:67], v131 offset:18432
    ds_read_b64_tr_b16 v[68:69], v133 offset:16384
    v_mfma_f32_16x16x32_bf16 v[20:23], v[52:55], v[116:119], v[20:23]
    ds_read_b64_tr_b16 v[70:71], v133 offset:18432
    v_mfma_f32_16x16x32_bf16 v[36:39], v[52:55], v[120:123], v[36:39]
    ds_read_b64_tr_b16 v[72:73], v135 offset:16384
    v_mfma_f32_16x16x32_bf16 v[24:27], v[56:59], v[116:119], v[24:27]
    ds_read_b64_tr_b16 v[74:75], v135 offset:18432
    v_mfma_f32_16x16x32_bf16 v[40:43], v[56:59], v[120:123], v[40:43]
    s_add_u32 s62, s67, 9216
    buffer_load_dwordx4 v[116:119], v128, s[44:47], s62 offen sc1
    s_add_u32 s62, s67, 67584
    buffer_load_dwordx4 v[120:123], v128, s[44:47], s62 offen sc1
    s_waitcnt lgkmcnt(0)
    s_barrier
    s_waitcnt vmcnt(8)
    v_mfma_f32_16x16x32_bf16 v[12:15], v[60:63], v[84:87], v[12:15]
    ds_read_b64_tr_b16 v[44:45], v129 offset:32768
    v_mfma_f32_16x16x32_bf16 v[28:31], v[60:63], v[88:91], v[28:31]
    ds_read_b64_tr_b16 v[46:47], v129 offset:34816
    v_mfma_f32_16x16x32_bf16 v[16:19], v[64:67], v[84:87], v[16:19]
    ds_read_b64_tr_b16 v[48:49], v131 offset:32768
    v_mfma_f32_16x16x32_bf16 v[32:35], v[64:67], v[88:91], v[32:35]
    ds_read_b64_tr_b16 v[50:51], v131 offset:34816
    ds_read_b64_tr_b16 v[52:53], v133 offset:32768
    v_mfma_f32_16x16x32_bf16 v[20:23], v[68:71], v[84:87], v[20:23]
    ds_read_b64_tr_b16 v[54:55], v133 offset:34816
    v_mfma_f32_16x16x32_bf16 v[36:39], v[68:71], v[88:91], v[36:39]
    ds_read_b64_tr_b16 v[56:57], v135 offset:32768
    v_mfma_f32_16x16x32_bf16 v[24:27], v[72:75], v[84:87], v[24:27]
    ds_read_b64_tr_b16 v[58:59], v135 offset:34816
    v_mfma_f32_16x16x32_bf16 v[40:43], v[72:75], v[88:91], v[40:43]
    s_add_u32 s62, s67, 10240
    buffer_load_dwordx4 v[84:87], v128, s[44:47], s62 offen sc1
    s_add_u32 s62, s67, 68608
    buffer_load_dwordx4 v[88:91], v128, s[44:47], s62 offen sc1
    s_waitcnt lgkmcnt(0)
    s_barrier
    s_waitcnt vmcnt(8)
    v_mfma_f32_16x16x32_bf16 v[12:15], v[44:47], v[92:95], v[12:15]
    ds_read_b64_tr_b16 v[60:61], v129 offset:49152
    v_mfma_f32_16x16x32_bf16 v[28:31], v[44:47], v[96:99], v[28:31]
    ds_read_b64_tr_b16 v[62:63], v129 offset:51200
    v_mfma_f32_16x16x32_bf16 v[16:19], v[48:51], v[92:95], v[16:19]
    ds_read_b64_tr_b16 v[64:65], v131 offset:49152
    v_mfma_f32_16x16x32_bf16 v[32:35], v[48:51], v[96:99], v[32:35]
    ds_read_b64_tr_b16 v[66:67], v131 offset:51200
    ds_read_b64_tr_b16 v[68:69], v133 offset:49152
    v_mfma_f32_16x16x32_bf16 v[20:23], v[52:55], v[92:95], v[20:23]
    ds_read_b64_tr_b16 v[70:71], v133 offset:51200
    v_mfma_f32_16x16x32_bf16 v[36:39], v[52:55], v[96:99], v[36:39]
    ds_read_b64_tr_b16 v[72:73], v135 offset:49152
    v_mfma_f32_16x16x32_bf16 v[24:27], v[56:59], v[92:95], v[24:27]
    ds_read_b64_tr_b16 v[74:75], v135 offset:51200
    v_mfma_f32_16x16x32_bf16 v[40:43], v[56:59], v[96:99], v[40:43]
    s_add_u32 s62, s67, 11264
    buffer_load_dwordx4 v[92:95], v128, s[44:47], s62 offen sc1
    s_add_u32 s62, s67, 69632
    buffer_load_dwordx4 v[96:99], v128, s[44:47], s62 offen sc1
    s_waitcnt lgkmcnt(0)
    s_barrier
    s_waitcnt vmcnt(8)
    v_mfma_f32_16x16x32_bf16 v[12:15], v[60:63], v[100:103], v[12:15]
    ds_read_b64_tr_b16 v[44:45], v130 offset:0
    v_mfma_f32_16x16x32_bf16 v[28:31], v[60:63], v[104:107], v[28:31]
    ds_read_b64_tr_b16 v[46:47], v130 offset:2048
    v_mfma_f32_16x16x32_bf16 v[16:19], v[64:67], v[100:103], v[16:19]
    ds_read_b64_tr_b16 v[48:49], v132 offset:0
    v_mfma_f32_16x16x32_bf16 v[32:35], v[64:67], v[104:107], v[32:35]
    ds_read_b64_tr_b16 v[50:51], v132 offset:2048
    ds_read_b64_tr_b16 v[52:53], v134 offset:0
    v_mfma_f32_16x16x32_bf16 v[20:23], v[68:71], v[100:103], v[20:23]
    ds_read_b64_tr_b16 v[54:55], v134 offset:2048
    v_mfma_f32_16x16x32_bf16 v[36:39], v[68:71], v[104:107], v[36:39]
    ds_read_b64_tr_b16 v[56:57], v136 offset:0
    v_mfma_f32_16x16x32_bf16 v[24:27], v[72:75], v[100:103], v[24:27]
    ds_read_b64_tr_b16 v[58:59], v136 offset:2048
    v_mfma_f32_16x16x32_bf16 v[40:43], v[72:75], v[104:107], v[40:43]
    s_add_u32 s62, s67, 12288
    buffer_load_dwordx4 v[100:103], v128, s[44:47], s62 offen sc1
    s_add_u32 s62, s67, 70656
    buffer_load_dwordx4 v[104:107], v128, s[44:47], s62 offen sc1
    s_waitcnt lgkmcnt(0)
    s_barrier
    s_waitcnt vmcnt(8)
    v_mfma_f32_16x16x32_bf16 v[12:15], v[44:47], v[108:111], v[12:15]
    ds_read_b64_tr_b16 v[60:61], v124 offset:0
    v_mfma_f32_16x16x32_bf16 v[28:31], v[44:47], v[112:115], v[28:31]
    ds_read_b64_tr_b16 v[62:63], v124 offset:2048
    v_mfma_f32_16x16x32_bf16 v[16:19], v[48:51], v[108:111], v[16:19]
    ds_read_b64_tr_b16 v[64:65], v125 offset:0
    v_mfma_f32_16x16x32_bf16 v[32:35], v[48:51], v[112:115], v[32:35]
    ds_read_b64_tr_b16 v[66:67], v125 offset:2048
    ds_read_b64_tr_b16 v[68:69], v126 offset:0
    v_mfma_f32_16x16x32_bf16 v[20:23], v[52:55], v[108:111], v[20:23]
    ds_read_b64_tr_b16 v[70:71], v126 offset:2048
    v_mfma_f32_16x16x32_bf16 v[36:39], v[52:55], v[112:115], v[36:39]
    ds_read_b64_tr_b16 v[72:73], v127 offset:0
    v_mfma_f32_16x16x32_bf16 v[24:27], v[56:59], v[108:111], v[24:27]
    ds_read_b64_tr_b16 v[74:75], v127 offset:2048
    v_mfma_f32_16x16x32_bf16 v[40:43], v[56:59], v[112:115], v[40:43]
    s_add_u32 s62, s67, 13312
    buffer_load_dwordx4 v[108:111], v128, s[44:47], s62 offen sc1
    s_add_u32 s62, s67, 71680
    buffer_load_dwordx4 v[112:115], v128, s[44:47], s62 offen sc1
    s_waitcnt lgkmcnt(0)
    s_barrier
    s_waitcnt vmcnt(8)
    v_mfma_f32_16x16x32_bf16 v[12:15], v[60:63], v[116:119], v[12:15]
    ds_read_b64_tr_b16 v[44:45], v124 offset:16384
    v_mfma_f32_16x16x32_bf16 v[28:31], v[60:63], v[120:123], v[28:31]
    ds_read_b64_tr_b16 v[46:47], v124 offset:18432
    v_mfma_f32_16x16x32_bf16 v[16:19], v[64:67], v[116:119], v[16:19]
    ds_read_b64_tr_b16 v[48:49], v125 offset:16384
    v_mfma_f32_16x16x32_bf16 v[32:35], v[64:67], v[120:123], v[32:35]
    ds_read_b64_tr_b16 v[50:51], v125 offset:18432
    ds_read_b64_tr_b16 v[52:53], v126 offset:16384
    v_mfma_f32_16x16x32_bf16 v[20:23], v[68:71], v[116:119], v[20:23]
    ds_read_b64_tr_b16 v[54:55], v126 offset:18432
    v_mfma_f32_16x16x32_bf16 v[36:39], v[68:71], v[120:123], v[36:39]
    ds_read_b64_tr_b16 v[56:57], v127 offset:16384
    v_mfma_f32_16x16x32_bf16 v[24:27], v[72:75], v[116:119], v[24:27]
    ds_read_b64_tr_b16 v[58:59], v127 offset:18432
    v_mfma_f32_16x16x32_bf16 v[40:43], v[72:75], v[120:123], v[40:43]
    s_waitcnt lgkmcnt(0)
    s_barrier
    s_waitcnt vmcnt(6)
    v_mfma_f32_16x16x32_bf16 v[12:15], v[44:47], v[84:87], v[12:15]
    ds_read_b64_tr_b16 v[60:61], v124 offset:32768
    v_mfma_f32_16x16x32_bf16 v[28:31], v[44:47], v[88:91], v[28:31]
    ds_read_b64_tr_b16 v[62:63], v124 offset:34816
    v_mfma_f32_16x16x32_bf16 v[16:19], v[48:51], v[84:87], v[16:19]
    ds_read_b64_tr_b16 v[64:65], v125 offset:32768
    v_mfma_f32_16x16x32_bf16 v[32:35], v[48:51], v[88:91], v[32:35]
    ds_read_b64_tr_b16 v[66:67], v125 offset:34816
    ds_read_b64_tr_b16 v[68:69], v126 offset:32768
    v_mfma_f32_16x16x32_bf16 v[20:23], v[52:55], v[84:87], v[20:23]
    ds_read_b64_tr_b16 v[70:71], v126 offset:34816
    v_mfma_f32_16x16x32_bf16 v[36:39], v[52:55], v[88:91], v[36:39]
    ds_read_b64_tr_b16 v[72:73], v127 offset:32768
    v_mfma_f32_16x16x32_bf16 v[24:27], v[56:59], v[84:87], v[24:27]
    ds_read_b64_tr_b16 v[74:75], v127 offset:34816
    v_mfma_f32_16x16x32_bf16 v[40:43], v[56:59], v[88:91], v[40:43]
    s_waitcnt lgkmcnt(0)
    s_barrier
    s_waitcnt vmcnt(4)
    v_mfma_f32_16x16x32_bf16 v[12:15], v[60:63], v[92:95], v[12:15]
    ds_read_b64_tr_b16 v[44:45], v124 offset:49152
    v_mfma_f32_16x16x32_bf16 v[28:31], v[60:63], v[96:99], v[28:31]
    ds_read_b64_tr_b16 v[46:47], v124 offset:51200
    v_mfma_f32_16x16x32_bf16 v[16:19], v[64:67], v[92:95], v[16:19]
    ds_read_b64_tr_b16 v[48:49], v125 offset:49152
    v_mfma_f32_16x16x32_bf16 v[32:35], v[64:67], v[96:99], v[32:35]
    ds_read_b64_tr_b16 v[50:51], v125 offset:51200
    ds_read_b64_tr_b16 v[52:53], v126 offset:49152
    v_mfma_f32_16x16x32_bf16 v[20:23], v[68:71], v[92:95], v[20:23]
    ds_read_b64_tr_b16 v[54:55], v126 offset:51200
    v_mfma_f32_16x16x32_bf16 v[36:39], v[68:71], v[96:99], v[36:39]
    ds_read_b64_tr_b16 v[56:57], v127 offset:49152
    v_mfma_f32_16x16x32_bf16 v[24:27], v[72:75], v[92:95], v[24:27]
    ds_read_b64_tr_b16 v[58:59], v127 offset:51200
    v_mfma_f32_16x16x32_bf16 v[40:43], v[72:75], v[96:99], v[40:43]
    s_waitcnt lgkmcnt(0)
    s_barrier
    s_waitcnt vmcnt(2)
    v_mfma_f32_16x16x32_bf16 v[12:15], v[44:47], v[100:103], v[12:15]
    ds_read_b64_tr_b16 v[60:61], v129 offset:0
    v_mfma_f32_16x16x32_bf16 v[28:31], v[44:47], v[104:107], v[28:31]
    ds_read_b64_tr_b16 v[62:63], v129 offset:2048
    v_mfma_f32_16x16x32_bf16 v[16:19], v[48:51], v[100:103], v[16:19]
    ds_read_b64_tr_b16 v[64:65], v131 offset:0
    v_mfma_f32_16x16x32_bf16 v[32:35], v[48:51], v[104:107], v[32:35]
    ds_read_b64_tr_b16 v[66:67], v131 offset:2048
    ds_read_b64_tr_b16 v[68:69], v133 offset:0
    v_mfma_f32_16x16x32_bf16 v[20:23], v[52:55], v[100:103], v[20:23]
    ds_read_b64_tr_b16 v[70:71], v133 offset:2048
    v_mfma_f32_16x16x32_bf16 v[36:39], v[52:55], v[104:107], v[36:39]
    ds_read_b64_tr_b16 v[72:73], v135 offset:0
    v_mfma_f32_16x16x32_bf16 v[24:27], v[56:59], v[100:103], v[24:27]
    ds_read_b64_tr_b16 v[74:75], v135 offset:2048
    v_mfma_f32_16x16x32_bf16 v[40:43], v[56:59], v[104:107], v[40:43]
    s_waitcnt lgkmcnt(0)
    s_waitcnt vmcnt(0)
    v_mfma_f32_16x16x32_bf16 v[12:15], v[60:63], v[108:111], v[12:15]
    v_mfma_f32_16x16x32_bf16 v[28:31], v[60:63], v[112:115], v[28:31]
    v_mfma_f32_16x16x32_bf16 v[16:19], v[64:67], v[108:111], v[16:19]
    v_mfma_f32_16x16x32_bf16 v[32:35], v[64:67], v[112:115], v[32:35]
    v_mfma_f32_16x16x32_bf16 v[20:23], v[68:71], v[108:111], v[20:23]
    v_mfma_f32_16x16x32_bf16 v[36:39], v[68:71], v[112:115], v[36:39]
    v_mfma_f32_16x16x32_bf16 v[24:27], v[72:75], v[108:111], v[24:27]
    v_mfma_f32_16x16x32_bf16 v[40:43], v[72:75], v[112:115], v[40:43]
    s_waitcnt lgkmcnt(0)
    s_barrier
    s_lshl_b32 s62, s7, 1
    s_add_u32 s62, s62, s8
    s_mul_i32 s62, s62, 8704
    s_add_u32 s62, s62, 90112
    v_mul_u32_u24 v137, 272, v3
    v_lshl_add_u32 v137, v2, 4, v137
    v_add_u32 v137, s62, v137
    ds_write_b128 v137, v[12:15] offset:0
    ds_write_b128 v137, v[16:19] offset:64
    ds_write_b128 v137, v[20:23] offset:128
    ds_write_b128 v137, v[24:27] offset:192
    ds_write_b128 v137, v[28:31] offset:4352
    ds_write_b128 v137, v[32:35] offset:4416
    ds_write_b128 v137, v[36:39] offset:4480
    ds_write_b128 v137, v[40:43] offset:4544
    s_mul_i32 s62, s8, 8704
    s_add_u32 s62, s62, 90112
    v_lshrrev_b32 v138, 3, v1
    s_lshl_b32 s63, s7, 3
    v_add_u32 v138, s63, v138
    v_mul_u32_u24 v138, 272, v138
    v_and_b32 v137, 7, v1
    v_lshl_add_u32 v138, v137, 5, v138
    v_add_u32 v138, s62, v138
    s_waitcnt lgkmcnt(0)
    s_barrier
    ds_read_b128 v[44:47], v138 offset:0
    ds_read_b128 v[48:51], v138 offset:16
    ds_read_b128 v[52:55], v138 offset:17408
    ds_read_b128 v[56:59], v138 offset:17424
    ds_read_b128 v[60:63], v138 offset:34816
    ds_read_b128 v[64:67], v138 offset:34832
    ds_read_b128 v[68:71], v138 offset:52224
    ds_read_b128 v[72:75], v138 offset:52240
    s_waitcnt lgkmcnt(4)
    v_pk_add_f32 v[44:45], v[44:45], v[52:53]
    v_pk_add_f32 v[46:47], v[46:47], v[54:55]
    v_pk_add_f32 v[48:49], v[48:49], v[56:57]
    v_pk_add_f32 v[50:51], v[50:51], v[58:59]
    s_waitcnt lgkmcnt(0)
    v_pk_add_f32 v[60:61], v[60:61], v[68:69]
    v_pk_add_f32 v[62:63], v[62:63], v[70:71]
    v_pk_add_f32 v[64:65], v[64:65], v[72:73]
    v_pk_add_f32 v[66:67], v[66:67], v[74:75]
    v_pk_add_f32 v[44:45], v[44:45], v[60:61]
    v_pk_add_f32 v[46:47], v[46:47], v[62:63]
    v_pk_add_f32 v[48:49], v[48:49], v[64:65]
    v_pk_add_f32 v[50:51], v[50:51], v[66:67]
    s_waitcnt vmcnt(0)
    v_lshlrev_b32 v52, 16, v80
    v_and_b32 v53, 0xffff0000, v80
    v_lshlrev_b32 v54, 16, v81
    v_and_b32 v55, 0xffff0000, v81
    v_lshlrev_b32 v56, 16, v82
    v_and_b32 v57, 0xffff0000, v82
    v_lshlrev_b32 v58, 16, v83
    v_and_b32 v59, 0xffff0000, v83
    v_pk_add_f32 v[44:45], v[44:45], v[52:53]
    v_pk_add_f32 v[46:47], v[46:47], v[54:55]
    v_pk_add_f32 v[48:49], v[48:49], v[56:57]
    v_pk_add_f32 v[50:51], v[50:51], v[58:59]
    v_cvt_pk_bf16_f32 v60, v44, v45
    v_cvt_pk_bf16_f32 v61, v46, v47
    v_cvt_pk_bf16_f32 v62, v48, v49
    v_cvt_pk_bf16_f32 v63, v50, v51
    v_lshlrev_b32 v44, 16, v60
    v_and_b32 v45, 0xffff0000, v60
    v_lshlrev_b32 v52, 16, v76
    v_and_b32 v53, 0xffff0000, v76
    v_lshlrev_b32 v46, 16, v61
    v_and_b32 v47, 0xffff0000, v61
    v_lshlrev_b32 v54, 16, v77
    v_and_b32 v55, 0xffff0000, v77
    v_lshlrev_b32 v48, 16, v62
    v_and_b32 v49, 0xffff0000, v62
    v_lshlrev_b32 v56, 16, v78
    v_and_b32 v57, 0xffff0000, v78
    v_lshlrev_b32 v50, 16, v63
    v_and_b32 v51, 0xffff0000, v63
    v_lshlrev_b32 v58, 16, v79
    v_and_b32 v59, 0xffff0000, v79
    v_pk_add_f32 v[44:45], v[44:45], v[52:53]
    v_pk_add_f32 v[46:47], v[46:47], v[54:55]
    v_pk_add_f32 v[48:49], v[48:49], v[56:57]
    v_pk_add_f32 v[50:51], v[50:51], v[58:59]
    v_cvt_pk_bf16_f32 v60, v44, v45
    v_cvt_pk_bf16_f32 v61, v46, v47
    v_cvt_pk_bf16_f32 v62, v48, v49
    v_cvt_pk_bf16_f32 v63, v50, v51
    buffer_store_dwordx4 v[60:63], v7, s[56:59], s65 offen
    s_endpgm
.section .rodata,"a"
.p2align 6
.p2align 6
.amdhsa_kernel mega_kernel
  .amdhsa_next_free_vgpr 168
  .amdhsa_next_free_sgpr 100
  .amdhsa_accum_offset 168
  .amdhsa_group_segment_fixed_size 0
  .amdhsa_kernarg_size 96
  .amdhsa_user_sgpr_count 2
  .amdhsa_user_sgpr_kernarg_segment_ptr 1
  .amdhsa_system_sgpr_workgroup_id_x 1
.end_amdhsa_kernel
```
